```python
import torch

def _softmax(x, axis=-1):
    return torch.softmax(x, dim=axis)
def _gelu(x):
    return torch.nn.functional.gelu(x, approximate="tanh")
def _silu(x):
    return torch.nn.functional.silu(x)
def _sigmoid(x):
    return torch.sigmoid(x)
def _layernorm(x, axis=-1, eps=1e-5):
    m = x.mean(dim=axis, keepdim=True)
    v = x.var(dim=axis, keepdim=True, unbiased=False)
    return (x - m) / torch.sqrt(v + eps)
def _scatter_add(tgt, idx, src, axis=0):
    return tgt.clone().index_add_(axis, idx, src)
def _segment_sum(src, seg, n):
    out = torch.zeros((n,) + src.shape[1:], dtype=src.dtype)
    return out.index_add_(0, seg, src)
def _pad(x, pw):
    flat = tuple(v for pair in reversed(pw) for v in pair)
    return torch.nn.functional.pad(x, flat)

kernel_name = 'recurrent_scan__sliding_block__glu_gated_bilinear__prompt'

def setup_inputs():

    _w = (lambda a: (lambda t: t.to(torch.bfloat16) if t.is_floating_point() else t)(torch.as_tensor(a)))
    def _A_setup():
        B, S, D = 1, 2048, 576
        return {
            "x": _w((lambda *s: torch.randn(*s, dtype=torch.bfloat16) * 0.05)(B, S, D)),
            "wqkv": _w((lambda *s: torch.randn(*s, dtype=torch.bfloat16) * 0.2)(D, 3 * D)),
            "wo": _w((lambda *s: torch.randn(*s, dtype=torch.bfloat16) * 0.2)(D, D)),
        }
    _A_in = _A_setup()

    def _B_setup():
        B, S, D, F = 1, 2048, 576, 4608
        return {
            "x": _w((lambda *s: torch.randn(*s, dtype=torch.bfloat16) * 0.05)(B, S, D)),
            "w_gate": _w((lambda *s: torch.randn(*s, dtype=torch.bfloat16) * 0.1)(D, F) * (D ** -0.5)),
            "w_up": _w((lambda *s: torch.randn(*s, dtype=torch.bfloat16) * 0.1)(D, F) * (D ** -0.5)),
            "w_down": _w((lambda *s: torch.randn(*s, dtype=torch.bfloat16) * 0.1)(F, D) * (F ** -0.5)),
        }
    _B_in = _B_setup()

    return {
        "A_x": _A_in["x"],
        "A_wqkv": _A_in["wqkv"],
        "A_wo": _A_in["wo"],
        "B_x": _B_in["x"],
        "B_w_gate": _B_in["w_gate"],
        "B_w_up": _B_in["w_up"],
        "B_w_down": _B_in["w_down"],
    }

def reference(A_x, A_wqkv, A_wo, B_x, B_w_gate, B_w_up, B_w_down):
    def _A_ref(x, wqkv, wo):
        B, S, D = x.shape
        H = 32; Dh = D // H; W = 256
        qkv = (lambda x, *d: x.permute(*d))((x @ wqkv).reshape(B, S, 3, H, Dh), 2, 0, 3, 1, 4)
        q, k, v = qkv[0], qkv[1], qkv[2]
        scores = torch.einsum("bhqd,bhkd->bhqk", q, k) * (Dh ** -0.5)
        idx = torch.arange(S)
        mask = (idx[:, None] - idx[None, :] >= 0) & (idx[:, None] - idx[None, :] < W)
        scores = torch.where(mask[None, None], scores, -1e9)
        p = _softmax(scores, axis=-1)
        o = torch.einsum("bhqk,bhkd->bhqd", p, v)
        return (lambda x, *d: x.permute(*d))(o, 0, 2, 1, 3).reshape(B, S, D) @ wo

    def _B_ref(x, w_gate, w_up, w_down):
        g = torch.einsum("bsd,df->bsf", x, w_gate)
        u = torch.einsum("bsd,df->bsf", x, w_up)
        h = g * u
        return torch.einsum("bsf,fd->bsd", h, w_down)

    x = A_x
    xn = _layernorm(x, axis=-1)
    s = _A_ref(xn, A_wqkv, A_wo)
    g = _silu(_B_ref(xn, B_w_gate, B_w_up, B_w_down))
    return x + s * g
```

```asm
; @launch grid=(256,1,1) block=(256,1,1) lds=163840
.amdgcn_target "amdgcn-amd-amdhsa--gfx950"
.text
.globl recurrent_scan__sliding_block__glu_gated_bilinear__prompt_kernel
.p2align 12
.p2align 8
.type recurrent_scan__sliding_block__glu_gated_bilinear__prompt_kernel,@function
recurrent_scan__sliding_block__glu_gated_bilinear__prompt_kernel:
    s_cmp_ge_u32 s2, 256
    s_cbranch_scc1 K1_end
    s_load_dwordx16 s[4:19], s[0:1], 0
    s_load_dwordx4 s[20:23], s[0:1], 64
    s_getpc_b64 s[52:53]
K1_pc:
    s_mov_b32 s54, code_end-K1_pc
    s_mov_b32 s55, 0x00020000
    s_lshr_b32 s69, s2, 3
    s_and_b32 s69, s69, 7
    s_mul_i32 s69, s69, 10752
    v_lshlrev_b32_e64 v80, 7, v0
    v_mov_b32 v89, 0x10000000
    v_cmp_gt_u32 vcc, 84, v0
    s_nop 1
    v_cndmask_b32 v80, v89, v80, vcc
    buffer_load_dword v79, v80, s[52:55], s69 offen
    s_lshr_b32 s101, s2, 3
    v_mov_b32 v89, 0x10000000
    v_and_b32 v1, 63, v0
    v_lshrrev_b32 v80, 6, v0
    s_nop 0
    v_readfirstlane_b32 s58, v80
    s_and_b32 s63, s2, 7
    s_and_b32 s57, s63, 3
    s_lshl_b32 s57, s57, 2
    s_and_b32 s65, s101, 3
    s_or_b32 s57, s57, s65
    s_lshr_b32 s56, s63, 2
    s_lshl_b32 s56, s56, 3
    s_lshr_b32 s65, s101, 2
    s_or_b32 s56, s56, s65
    s_and_b32 s59, s58, 1
    s_lshr_b32 s60, s58, 1
    s_and_b32 s61, s57, 1
    s_lshr_b32 s62, s57, 1
    s_and_b32 s3, s57, 3
    v_lshrrev_b32 v82, 3, v1
    v_and_b32_e64 v83, 7, v1
    v_mul_u32_u24 v100, 1152, v82
    v_lshl_add_u32 v100, v83, 4, v100
    s_lshl_b32 s63, s56, 3
    s_lshl_b32 s64, s59, 2
    s_add_u32 s63, s63, s64
    s_add_u32 s64, s63, s60
    s_mul_i32 s64, s64, 18432
    s_xor_b32 s65, s3, 0
    s_and_b32 s66, s65, 1
    s_lshl_b32 s66, s66, 3
    s_and_b32 s65, s65, 2
    s_lshl_b32 s65, s65, 4
    s_or_b32 s97, s65, s66
    s_waitcnt lgkmcnt(0)
    s_mov_b32 s24, s4
    s_mov_b32 s25, s5
    s_mov_b32 s26, 0x240000
    s_mov_b32 s27, 0x00020000
    s_mul_i32 s67, s97, 1152
    s_add_u32 s67, s67, s64
    buffer_load_dwordx4 v[112:115], v100, s[24:27], s67 offen offset:0
    buffer_load_dwordx4 v[116:119], v100, s[24:27], s67 offen offset:128
    buffer_load_dwordx4 v[120:123], v100, s[24:27], s67 offen offset:256
    buffer_load_dwordx4 v[124:127], v100, s[24:27], s67 offen offset:384
    buffer_load_dwordx4 v[128:131], v100, s[24:27], s67 offen offset:512
    buffer_load_dwordx4 v[132:135], v100, s[24:27], s67 offen offset:640
    buffer_load_dwordx4 v[136:139], v100, s[24:27], s67 offen offset:768
    buffer_load_dwordx4 v[140:143], v100, s[24:27], s67 offen offset:896
    buffer_load_dwordx4 v[144:147], v100, s[24:27], s67 offen offset:1024
    s_xor_b32 s65, s3, 1
    s_and_b32 s66, s65, 1
    s_lshl_b32 s66, s66, 3
    s_and_b32 s65, s65, 2
    s_lshl_b32 s65, s65, 4
    s_or_b32 s98, s65, s66
    s_xor_b32 s65, s3, 2
    s_and_b32 s66, s65, 1
    s_lshl_b32 s66, s66, 3
    s_and_b32 s65, s65, 2
    s_lshl_b32 s65, s65, 4
    s_or_b32 s99, s65, s66
    s_xor_b32 s65, s3, 3
    s_and_b32 s66, s65, 1
    s_lshl_b32 s66, s66, 3
    s_and_b32 s65, s65, 2
    s_lshl_b32 s65, s65, 4
    s_or_b32 s100, s65, s66
    s_sub_u32 s28, s6, 2048
    s_subb_u32 s29, s7, 0
    s_mov_b32 s30, 0x1e6800
    s_mov_b32 s31, 0x00020000
    s_and_b32 s90, s57, 12
    s_and_b32 s86, s2, 7
    s_lshr_b32 s86, s86, 2
    s_lshl_b32 s86, s86, 5
    s_add_u32 s86, s86, s101
    v_lshrrev_b32 v86, 3, v0
    v_and_b32 v87, 7, v0
    v_mul_u32_u24 v88, 3456, v86
    v_lshl_add_u32 v87, v87, 7, v88
    v_cmp_gt_u32 vcc, 9, v86
    s_nop 1
    v_cndmask_b32_e64 v87, v89, v87, vcc
    s_mul_i32 s68, s86, 31104
    s_lshl_b32 s65, s90, 8
    s_add_u32 s76, s68, s65
    v_mov_b32_e64 v104, v87
    s_mov_b32 s32, s12
    s_mov_b32 s33, s13
    s_mov_b32 s34, 0x510000
    s_mov_b32 s35, 0x00020000
    s_sub_u32 s36, s14, 2048
    s_subb_u32 s37, s15, 0
    s_mov_b32 s38, 0x510800
    s_mov_b32 s39, 0x00020000
    s_sub_u32 s40, s16, 2048
    s_subb_u32 s41, s17, 0
    s_mov_b32 s42, 0x510800
    s_mov_b32 s43, 0x00020000
    s_mov_b32 s44, s22
    s_mov_b32 s45, s23
    s_mov_b32 s46, 0x10000000
    s_mov_b32 s47, 0x00020000
    s_mov_b32 s48, s20
    s_mov_b32 s49, s21
    s_mov_b32 s50, 0x100
    s_mov_b32 s51, 0x00020000
    s_mov_b64 s[0:1], s[18:19]
    s_cmp_ge_u32 s58, 2
    s_cselect_b32 s52, s14, s12
    s_cselect_b32 s53, s15, s13
    s_mov_b32 s54, 0x510000
    s_mov_b32 s55, 0x00020000
    s_mul_i32 s20, s86, 82944
    s_mul_i32 s65, s59, 1152
    s_add_u32 s20, s20, s65
    s_mul_i32 s65, s90, 576
    s_add_u32 s20, s20, s65
    s_lshl_b32 s70, s58, 12
    s_lshl_b32 s88, s57, 1
    s_add_u32 s88, s88, 4
    s_sub_u32 s65, s88, 8
    s_cmp_ge_u32 s57, 8
    s_cselect_b32 s88, s65, s88
    s_and_b32 s65, s57, 3
    s_cmp_eq_u32 s90, 8
    s_cselect_b32 s88, s65, s88
    s_lshl_b32 s92, s88, 7
    s_mul_i32 s65, s58, 55296
    s_add_u32 s92, s92, s65
    s_mov_b32 s93, 0x3f803f80
    s_mov_b32 s94, 0x00003f80
    s_mov_b32 s95, 0x3f800000
    v_lshrrev_b32 v84, 4, v1
    v_and_b32 v85, 15, v1
    v_cmp_eq_u32 vcc, 0, v0
    s_nop 1
    v_cndmask_b32 v29, v89, 0, vcc
    v_lshlrev_b32 v86, 1, v82
    v_and_b32 v86, 4, v86
    v_xor_b32_e64 v86, v83, v86
    v_mul_u32_u24 v87, 9216, v82
    v_lshl_add_u32 v8, v86, 4, v87
    v_mul_u32_u24 v88, 3456, v82
    v_lshl_add_u32 v90, v86, 4, v88
    v_add_u32 v3, 2048, v90
    v_add_u32 v5, 128, v90
    v_xor_b32_e64 v86, 2, v86
    v_lshl_add_u32 v9, v86, 4, v87
    v_add_u32 v9, 72704, v9
    v_lshl_add_u32 v90, v86, 4, v88
    v_add_u32 v4, 28672, v90
    v_add_u32 v6, 26752, v90
    s_sub_u32 s65, s88, 4
    s_cmp_ge_u32 s65, 22
    s_cselect_b32 s91, 0x10000000, 0
    v_add_u32 v5, s91, v5
    v_add_u32 v6, s91, v6
    s_lshl_b32 s75, s61, 1
    s_sub_u32 s75, 1, s75
    s_mul_i32 s72, s62, 1152
    s_lshl_b32 s66, s61, 10
    s_add_u32 s72, s72, s66
    s_mul_i32 s66, s58, 147456
    s_add_u32 s72, s72, s66
    v_and_b32 v87, 3, v1
    v_lshrrev_b32 v86, 2, v85
    v_and_b32 v88, 1, v84
    v_lshrrev_b32 v92, 1, v84
    v_lshlrev_b32 v90, 12, v92
    v_lshl_add_u32 v90, v88, 10, v90
    v_lshl_add_u32 v90, v86, 7, v90
    v_lshrrev_b32 v91, 1, v86
    v_xor_b32 v91, s60, v91
    v_lshl_add_u32 v90, v91, 6, v90
    v_lshl_add_u32 v90, v88, 5, v90
    v_lshl_add_u32 v14, v87, 3, v90
    v_xor_b32 v15, 32, v14
    s_lshl_b32 s65, s61, 6
    v_xor_b32 v11, s65, v14
    v_xor_b32 v12, s65, v15
    s_mul_i32 s68, s59, 36864
    s_add_u32 s68, s68, 81920
    v_xor_b32 v90, v85, v84
    v_lshlrev_b32 v90, 4, v90
    v_lshl_add_u32 v90, v84, 8, v90
    v_add_u32 v65, s68, v90
    v_xor_b32 v66, 64, v65
    s_mul_i32 s65, s60, 18432
    s_add_u32 s68, s68, s65
    s_and_b32 s65, s97, 8
    s_lshl_b32 s65, s65, 4
    s_add_u32 s68, s68, s65
    v_xor_b32 v90, v82, v83
    v_lshlrev_b32 v90, 4, v90
    v_lshl_add_u32 v90, v83, 8, v90
    v_add_u32_e64 v64, s68, v90
    v_xor_b32 v76, 128, v64
    s_lshl_b32 s65, s59, 6
    s_lshl_b32 s66, s60, 4
    s_add_u32 s65, s65, s66
    v_add_u32 v67, s65, v82
    s_lshl_b32 s65, s56, 4
    s_add_u32 s65, s65, s57
    s_lshl_b32 s6, s65, 7
    s_add_u32 s6, s6, 0x2f10000
    s_lshl_b32 s11, s56, 2
    s_lshl_b32 s65, 1, s57
    v_mov_b32 v105, s65
    v_mov_b32_e64 v86, 0
    buffer_store_dword v86, v29, s[44:47], s6 offen sc1
    s_mul_i32 s67, s98, 1152
    s_add_u32 s67, s67, s64
    s_nop 0
    buffer_load_dwordx4 v[148:151], v100, s[24:27], s67 offen offset:0
    buffer_load_dwordx4 v[152:155], v100, s[24:27], s67 offen offset:128
    buffer_load_dwordx4 v[156:159], v100, s[24:27], s67 offen offset:256
    buffer_load_dwordx4 v[160:163], v100, s[24:27], s67 offen offset:384
    buffer_load_dwordx4 v[164:167], v100, s[24:27], s67 offen offset:512
    buffer_load_dwordx4 v[168:171], v100, s[24:27], s67 offen offset:640
    buffer_load_dwordx4 v[172:175], v100, s[24:27], s67 offen offset:768
    buffer_load_dwordx4 v[176:179], v100, s[24:27], s67 offen offset:896
    buffer_load_dwordx4 v[180:183], v100, s[24:27], s67 offen offset:1024
    s_waitcnt vmcnt(18)
    v_dot2_f32_bf16 v68, v112, s93, 0
    v_dot2_f32_bf16 v69, v113, s93, 0
    v_dot2_f32_bf16 v68, v114, s93, v68
    v_dot2_f32_bf16 v69, v115, s93, v69
    s_waitcnt vmcnt(17)
    v_dot2_f32_bf16 v68, v116, s93, v68
    v_dot2_f32_bf16 v69, v117, s93, v69
    v_dot2_f32_bf16 v68, v118, s93, v68
    v_dot2_f32_bf16 v69, v119, s93, v69
    s_waitcnt vmcnt(16)
    v_dot2_f32_bf16 v68, v120, s93, v68
    v_dot2_f32_bf16 v69, v121, s93, v69
    v_dot2_f32_bf16 v68, v122, s93, v68
    v_dot2_f32_bf16 v69, v123, s93, v69
    s_waitcnt vmcnt(15)
    v_dot2_f32_bf16 v68, v124, s93, v68
    v_dot2_f32_bf16 v69, v125, s93, v69
    v_dot2_f32_bf16 v68, v126, s93, v68
    v_dot2_f32_bf16 v69, v127, s93, v69
    s_waitcnt vmcnt(14)
    v_dot2_f32_bf16 v68, v128, s93, v68
    v_dot2_f32_bf16 v69, v129, s93, v69
    v_dot2_f32_bf16 v68, v130, s93, v68
    v_dot2_f32_bf16 v69, v131, s93, v69
    s_waitcnt vmcnt(13)
    v_dot2_f32_bf16 v68, v132, s93, v68
    v_dot2_f32_bf16 v69, v133, s93, v69
    v_dot2_f32_bf16 v68, v134, s93, v68
    v_dot2_f32_bf16 v69, v135, s93, v69
    s_waitcnt vmcnt(12)
    v_dot2_f32_bf16 v68, v136, s93, v68
    v_dot2_f32_bf16 v69, v137, s93, v69
    v_dot2_f32_bf16 v68, v138, s93, v68
    v_dot2_f32_bf16 v69, v139, s93, v69
    s_waitcnt vmcnt(11)
    v_dot2_f32_bf16 v68, v140, s93, v68
    v_dot2_f32_bf16 v69, v141, s93, v69
    v_dot2_f32_bf16 v68, v142, s93, v68
    v_dot2_f32_bf16 v69, v143, s93, v69
    s_waitcnt vmcnt(10)
    v_dot2_f32_bf16 v68, v144, s93, v68
    v_dot2_f32_bf16 v69, v145, s93, v69
    v_dot2_f32_bf16 v68, v146, s93, v68
    v_dot2_f32_bf16 v69, v147, s93, v69
    s_nop 2
    v_add_f32 v68, v68, v69
    s_nop 1
    v_add_f32_dpp v68, v68, v68 quad_perm:[1,0,3,2] row_mask:0xf bank_mask:0xf
    s_nop 1
    v_add_f32_dpp v68, v68, v68 quad_perm:[2,3,0,1] row_mask:0xf bank_mask:0xf
    s_nop 1
    v_add_f32_dpp v68, v68, v68 row_half_mirror row_mask:0xf bank_mask:0xf
    v_mul_f32 v68, 0xbae38e39, v68
    v_dot2_f32_bf16 v80, v112, s94, v68
    v_dot2_f32_bf16 v81, v112, s95, v68
    v_dot2_f32_bf16 v82, v113, s94, v68
    v_dot2_f32_bf16 v83, v113, s95, v68
    v_dot2_f32_bf16 v84, v114, s94, v68
    s_mul_i32 s67, s99, 1152
    s_add_u32 s67, s67, s64
    s_nop 0
    buffer_load_dwordx4 v[184:187], v100, s[24:27], s67 offen offset:0
    v_dot2_f32_bf16 v85, v114, s95, v68
    v_cvt_pk_bf16_f32 v112, v80, v81
    v_dot2_f32_bf16 v86, v115, s94, v68
    v_dot2_f32_bf16 v87, v115, s95, v68
    v_cvt_pk_bf16_f32 v113, v82, v83
    v_dot2_f32_bf16 v26, v112, v112, 0
    v_dot2_f32_bf16 v88, v116, s94, v68
    v_dot2_f32_bf16 v89, v116, s95, v68
    v_cvt_pk_bf16_f32 v114, v84, v85
    v_dot2_f32_bf16 v26, v113, v113, v26
    v_dot2_f32_bf16 v90, v117, s94, v68
    v_dot2_f32_bf16 v91, v117, s95, v68
    v_cvt_pk_bf16_f32 v115, v86, v87
    v_dot2_f32_bf16 v26, v114, v114, v26
    v_dot2_f32_bf16 v92, v118, s94, v68
    v_dot2_f32_bf16 v93, v118, s95, v68
    v_cvt_pk_bf16_f32 v116, v88, v89
    buffer_load_dwordx4 v[188:191], v100, s[24:27], s67 offen offset:128
    v_dot2_f32_bf16 v26, v115, v115, v26
    ds_write_b128 v64, v[112:115] offset:0
    v_dot2_f32_bf16 v94, v119, s94, v68
    v_dot2_f32_bf16 v95, v119, s95, v68
    v_cvt_pk_bf16_f32 v117, v90, v91
    v_dot2_f32_bf16 v26, v116, v116, v26
    v_dot2_f32_bf16 v80, v120, s94, v68
    v_dot2_f32_bf16 v81, v120, s95, v68
    v_cvt_pk_bf16_f32 v118, v92, v93
    v_dot2_f32_bf16 v26, v117, v117, v26
    v_dot2_f32_bf16 v82, v121, s94, v68
    v_dot2_f32_bf16 v83, v121, s95, v68
    v_cvt_pk_bf16_f32 v119, v94, v95
    v_dot2_f32_bf16 v26, v118, v118, v26
    v_dot2_f32_bf16 v84, v122, s94, v68
    v_dot2_f32_bf16 v85, v122, s95, v68
    v_cvt_pk_bf16_f32 v120, v80, v81
    v_dot2_f32_bf16 v26, v119, v119, v26
    buffer_load_dwordx4 v[192:195], v100, s[24:27], s67 offen offset:256
    ds_write_b128 v64, v[116:119] offset:2048
    v_dot2_f32_bf16 v86, v123, s94, v68
    v_dot2_f32_bf16 v87, v123, s95, v68
    v_cvt_pk_bf16_f32 v121, v82, v83
    v_dot2_f32_bf16 v26, v120, v120, v26
    v_dot2_f32_bf16 v88, v124, s94, v68
    v_dot2_f32_bf16 v89, v124, s95, v68
    v_cvt_pk_bf16_f32 v122, v84, v85
    v_dot2_f32_bf16 v26, v121, v121, v26
    v_dot2_f32_bf16 v90, v125, s94, v68
    v_dot2_f32_bf16 v91, v125, s95, v68
    v_cvt_pk_bf16_f32 v123, v86, v87
    v_dot2_f32_bf16 v26, v122, v122, v26
    v_dot2_f32_bf16 v92, v126, s94, v68
    v_dot2_f32_bf16 v93, v126, s95, v68
    v_cvt_pk_bf16_f32 v124, v88, v89
    v_dot2_f32_bf16 v26, v123, v123, v26
    ds_write_b128 v64, v[120:123] offset:4096
    v_dot2_f32_bf16 v94, v127, s94, v68
    buffer_load_dwordx4 v[196:199], v100, s[24:27], s67 offen offset:384
    v_dot2_f32_bf16 v95, v127, s95, v68
    v_cvt_pk_bf16_f32 v125, v90, v91
    v_dot2_f32_bf16 v26, v124, v124, v26
    v_dot2_f32_bf16 v80, v128, s94, v68
    v_dot2_f32_bf16 v81, v128, s95, v68
    v_cvt_pk_bf16_f32 v126, v92, v93
    v_dot2_f32_bf16 v26, v125, v125, v26
    v_dot2_f32_bf16 v82, v129, s94, v68
    v_dot2_f32_bf16 v83, v129, s95, v68
    v_cvt_pk_bf16_f32 v127, v94, v95
    v_dot2_f32_bf16 v26, v126, v126, v26
    v_dot2_f32_bf16 v84, v130, s94, v68
    v_dot2_f32_bf16 v85, v130, s95, v68
    v_cvt_pk_bf16_f32 v128, v80, v81
    v_dot2_f32_bf16 v26, v127, v127, v26
    ds_write_b128 v64, v[124:127] offset:6144
    v_dot2_f32_bf16 v86, v131, s94, v68
    v_dot2_f32_bf16 v87, v131, s95, v68
    buffer_load_dwordx4 v[200:203], v100, s[24:27], s67 offen offset:512
    v_cvt_pk_bf16_f32 v129, v82, v83
    v_dot2_f32_bf16 v26, v128, v128, v26
    v_dot2_f32_bf16 v88, v132, s94, v68
    v_dot2_f32_bf16 v89, v132, s95, v68
    v_cvt_pk_bf16_f32 v130, v84, v85
    v_dot2_f32_bf16 v26, v129, v129, v26
    v_dot2_f32_bf16 v90, v133, s94, v68
    v_dot2_f32_bf16 v91, v133, s95, v68
    v_cvt_pk_bf16_f32 v131, v86, v87
    v_dot2_f32_bf16 v26, v130, v130, v26
    v_dot2_f32_bf16 v92, v134, s94, v68
    v_dot2_f32_bf16 v93, v134, s95, v68
    v_cvt_pk_bf16_f32 v132, v88, v89
    v_dot2_f32_bf16 v26, v131, v131, v26
    ds_write_b128 v64, v[128:131] offset:8192
    v_dot2_f32_bf16 v94, v135, s94, v68
    v_dot2_f32_bf16 v95, v135, s95, v68
    v_cvt_pk_bf16_f32 v133, v90, v91
    buffer_load_dwordx4 v[204:207], v100, s[24:27], s67 offen offset:640
    v_dot2_f32_bf16 v26, v132, v132, v26
    v_dot2_f32_bf16 v80, v136, s94, v68
    v_dot2_f32_bf16 v81, v136, s95, v68
    v_cvt_pk_bf16_f32 v134, v92, v93
    v_dot2_f32_bf16 v26, v133, v133, v26
    v_dot2_f32_bf16 v82, v137, s94, v68
    v_dot2_f32_bf16 v83, v137, s95, v68
    v_cvt_pk_bf16_f32 v135, v94, v95
    v_dot2_f32_bf16 v26, v134, v134, v26
    v_dot2_f32_bf16 v84, v138, s94, v68
    v_dot2_f32_bf16 v85, v138, s95, v68
    v_cvt_pk_bf16_f32 v136, v80, v81
    v_dot2_f32_bf16 v26, v135, v135, v26
    ds_write_b128 v64, v[132:135] offset:10240
    v_dot2_f32_bf16 v86, v139, s94, v68
    v_dot2_f32_bf16 v87, v139, s95, v68
    v_cvt_pk_bf16_f32 v137, v82, v83
    v_dot2_f32_bf16 v26, v136, v136, v26
    buffer_load_dwordx4 v[208:211], v100, s[24:27], s67 offen offset:768
    v_dot2_f32_bf16 v88, v140, s94, v68
    v_dot2_f32_bf16 v89, v140, s95, v68
    v_cvt_pk_bf16_f32 v138, v84, v85
    v_dot2_f32_bf16 v26, v137, v137, v26
    v_dot2_f32_bf16 v90, v141, s94, v68
    v_dot2_f32_bf16 v91, v141, s95, v68
    v_cvt_pk_bf16_f32 v139, v86, v87
    v_dot2_f32_bf16 v26, v138, v138, v26
    v_dot2_f32_bf16 v92, v142, s94, v68
    v_dot2_f32_bf16 v93, v142, s95, v68
    v_cvt_pk_bf16_f32 v140, v88, v89
    v_dot2_f32_bf16 v26, v139, v139, v26
    ds_write_b128 v64, v[136:139] offset:12288
    v_dot2_f32_bf16 v94, v143, s94, v68
    v_dot2_f32_bf16 v95, v143, s95, v68
    v_cvt_pk_bf16_f32 v141, v90, v91
    v_dot2_f32_bf16 v26, v140, v140, v26
    v_dot2_f32_bf16 v80, v144, s94, v68
    buffer_load_dwordx4 v[212:215], v100, s[24:27], s67 offen offset:896
    v_dot2_f32_bf16 v81, v144, s95, v68
    v_cvt_pk_bf16_f32 v142, v92, v93
    v_dot2_f32_bf16 v26, v141, v141, v26
    v_dot2_f32_bf16 v82, v145, s94, v68
    v_dot2_f32_bf16 v83, v145, s95, v68
    v_cvt_pk_bf16_f32 v143, v94, v95
    v_dot2_f32_bf16 v26, v142, v142, v26
    v_dot2_f32_bf16 v84, v146, s94, v68
    v_dot2_f32_bf16 v85, v146, s95, v68
    v_cvt_pk_bf16_f32 v144, v80, v81
    v_dot2_f32_bf16 v26, v143, v143, v26
    ds_write_b128 v64, v[140:143] offset:14336
    v_dot2_f32_bf16 v86, v147, s94, v68
    v_dot2_f32_bf16 v87, v147, s95, v68
    v_cvt_pk_bf16_f32 v145, v82, v83
    v_dot2_f32_bf16 v26, v144, v144, v26
    v_cvt_pk_bf16_f32 v146, v84, v85
    v_dot2_f32_bf16 v26, v145, v145, v26
    buffer_load_dwordx4 v[216:219], v100, s[24:27], s67 offen offset:1024
    v_cvt_pk_bf16_f32 v147, v86, v87
    v_dot2_f32_bf16 v26, v146, v146, v26
    v_dot2_f32_bf16 v26, v147, v147, v26
    ds_write_b128 v64, v[144:147] offset:16384
    s_waitcnt vmcnt(17)
    v_dot2_f32_bf16 v68, v148, s93, 0
    v_dot2_f32_bf16 v69, v149, s93, 0
    v_dot2_f32_bf16 v68, v150, s93, v68
    v_dot2_f32_bf16 v69, v151, s93, v69
    s_waitcnt vmcnt(16)
    v_dot2_f32_bf16 v68, v152, s93, v68
    v_dot2_f32_bf16 v69, v153, s93, v69
    v_dot2_f32_bf16 v68, v154, s93, v68
    v_dot2_f32_bf16 v69, v155, s93, v69
    s_waitcnt vmcnt(15)
    v_dot2_f32_bf16 v68, v156, s93, v68
    v_dot2_f32_bf16 v69, v157, s93, v69
    v_dot2_f32_bf16 v68, v158, s93, v68
    v_dot2_f32_bf16 v69, v159, s93, v69
    s_waitcnt vmcnt(14)
    v_dot2_f32_bf16 v68, v160, s93, v68
    v_dot2_f32_bf16 v69, v161, s93, v69
    buffer_load_dword v79, v104, s[28:31], s76 offen offset:2048
    v_dot2_f32_bf16 v68, v162, s93, v68
    v_dot2_f32_bf16 v69, v163, s93, v69
    s_waitcnt vmcnt(14)
    v_dot2_f32_bf16 v68, v164, s93, v68
    v_dot2_f32_bf16 v69, v165, s93, v69
    v_dot2_f32_bf16 v68, v166, s93, v68
    v_dot2_f32_bf16 v69, v167, s93, v69
    s_waitcnt vmcnt(13)
    v_dot2_f32_bf16 v68, v168, s93, v68
    v_dot2_f32_bf16 v69, v169, s93, v69
    s_mul_i32 s67, s100, 1152
    s_add_u32 s67, s67, s64
    buffer_load_dwordx4 v[220:223], v100, s[24:27], s67 offen offset:0
    v_dot2_f32_bf16 v68, v170, s93, v68
    v_dot2_f32_bf16 v69, v171, s93, v69
    s_waitcnt vmcnt(13)
    v_dot2_f32_bf16 v68, v172, s93, v68
    v_dot2_f32_bf16 v69, v173, s93, v69
    v_dot2_f32_bf16 v68, v174, s93, v68
    v_dot2_f32_bf16 v69, v175, s93, v69
    s_waitcnt vmcnt(12)
    v_dot2_f32_bf16 v68, v176, s93, v68
    v_dot2_f32_bf16 v69, v177, s93, v69
    v_dot2_f32_bf16 v68, v178, s93, v68
    v_dot2_f32_bf16 v69, v179, s93, v69
    s_waitcnt vmcnt(11)
    v_dot2_f32_bf16 v68, v180, s93, v68
    v_dot2_f32_bf16 v69, v181, s93, v69
    v_dot2_f32_bf16 v68, v182, s93, v68
    v_dot2_f32_bf16 v69, v183, s93, v69
    s_nop 2
    v_add_f32 v68, v68, v69
    s_nop 1
    v_add_f32_dpp v68, v68, v68 quad_perm:[1,0,3,2] row_mask:0xf bank_mask:0xf
    s_nop 1
    v_add_f32_dpp v68, v68, v68 quad_perm:[2,3,0,1] row_mask:0xf bank_mask:0xf
    buffer_load_dwordx4 v[224:227], v100, s[24:27], s67 offen offset:128
    s_nop 0
    s_nop 0
    v_add_f32_dpp v68, v68, v68 row_half_mirror row_mask:0xf bank_mask:0xf
    v_mul_f32 v68, 0xbae38e39, v68
    v_dot2_f32_bf16 v80, v148, s94, v68
    v_dot2_f32_bf16 v81, v148, s95, v68
    v_dot2_f32_bf16 v82, v149, s94, v68
    v_dot2_f32_bf16 v83, v149, s95, v68
    v_dot2_f32_bf16 v84, v150, s94, v68
    v_dot2_f32_bf16 v85, v150, s95, v68
    v_cvt_pk_bf16_f32 v148, v80, v81
    v_dot2_f32_bf16 v86, v151, s94, v68
    v_dot2_f32_bf16 v87, v151, s95, v68
    v_cvt_pk_bf16_f32 v149, v82, v83
    v_dot2_f32_bf16 v27, v148, v148, 0
    v_dot2_f32_bf16 v88, v152, s94, v68
    v_dot2_f32_bf16 v89, v152, s95, v68
    v_cvt_pk_bf16_f32 v150, v84, v85
    v_dot2_f32_bf16 v27, v149, v149, v27
    buffer_load_dwordx4 v[228:231], v100, s[24:27], s67 offen offset:256
    v_dot2_f32_bf16 v90, v153, s94, v68
    v_dot2_f32_bf16 v91, v153, s95, v68
    v_cvt_pk_bf16_f32 v151, v86, v87
    v_dot2_f32_bf16 v27, v150, v150, v27
    v_dot2_f32_bf16 v92, v154, s94, v68
    v_dot2_f32_bf16 v93, v154, s95, v68
    v_cvt_pk_bf16_f32 v152, v88, v89
    v_dot2_f32_bf16 v27, v151, v151, v27
    ds_write_b128 v76, v[148:151] offset:0
    v_dot2_f32_bf16 v94, v155, s94, v68
    v_dot2_f32_bf16 v95, v155, s95, v68
    v_cvt_pk_bf16_f32 v153, v90, v91
    v_dot2_f32_bf16 v27, v152, v152, v27
    v_dot2_f32_bf16 v80, v156, s94, v68
    v_dot2_f32_bf16 v81, v156, s95, v68
    v_cvt_pk_bf16_f32 v154, v92, v93
    v_dot2_f32_bf16 v27, v153, v153, v27
    v_dot2_f32_bf16 v82, v157, s94, v68
    buffer_load_dwordx4 v[232:235], v100, s[24:27], s67 offen offset:384
    v_dot2_f32_bf16 v83, v157, s95, v68
    v_cvt_pk_bf16_f32 v155, v94, v95
    v_dot2_f32_bf16 v27, v154, v154, v27
    v_dot2_f32_bf16 v84, v158, s94, v68
    v_dot2_f32_bf16 v85, v158, s95, v68
    v_cvt_pk_bf16_f32 v156, v80, v81
    v_dot2_f32_bf16 v27, v155, v155, v27
    ds_write_b128 v76, v[152:155] offset:2048
    v_dot2_f32_bf16 v86, v159, s94, v68
    v_dot2_f32_bf16 v87, v159, s95, v68
    v_cvt_pk_bf16_f32 v157, v82, v83
    v_dot2_f32_bf16 v27, v156, v156, v27
    v_dot2_f32_bf16 v88, v160, s94, v68
    v_dot2_f32_bf16 v89, v160, s95, v68
    v_cvt_pk_bf16_f32 v158, v84, v85
    v_dot2_f32_bf16 v27, v157, v157, v27
    v_dot2_f32_bf16 v90, v161, s94, v68
    v_dot2_f32_bf16 v91, v161, s95, v68
    buffer_load_dwordx4 v[236:239], v100, s[24:27], s67 offen offset:512
    v_cvt_pk_bf16_f32 v159, v86, v87
    v_dot2_f32_bf16 v27, v158, v158, v27
    v_dot2_f32_bf16 v92, v162, s94, v68
    v_dot2_f32_bf16 v93, v162, s95, v68
    v_cvt_pk_bf16_f32 v160, v88, v89
    v_dot2_f32_bf16 v27, v159, v159, v27
    ds_write_b128 v76, v[156:159] offset:4096
    v_dot2_f32_bf16 v94, v163, s94, v68
    v_dot2_f32_bf16 v95, v163, s95, v68
    v_cvt_pk_bf16_f32 v161, v90, v91
    v_dot2_f32_bf16 v27, v160, v160, v27
    v_dot2_f32_bf16 v80, v164, s94, v68
    v_dot2_f32_bf16 v81, v164, s95, v68
    v_cvt_pk_bf16_f32 v162, v92, v93
    v_dot2_f32_bf16 v27, v161, v161, v27
    v_dot2_f32_bf16 v82, v165, s94, v68
    v_dot2_f32_bf16 v83, v165, s95, v68
    v_cvt_pk_bf16_f32 v163, v94, v95
    buffer_load_dwordx4 v[240:243], v100, s[24:27], s67 offen offset:640
    v_dot2_f32_bf16 v27, v162, v162, v27
    v_dot2_f32_bf16 v84, v166, s94, v68
    v_dot2_f32_bf16 v85, v166, s95, v68
    v_cvt_pk_bf16_f32 v164, v80, v81
    v_dot2_f32_bf16 v27, v163, v163, v27
    ds_write_b128 v76, v[160:163] offset:6144
    v_dot2_f32_bf16 v86, v167, s94, v68
    v_dot2_f32_bf16 v87, v167, s95, v68
    v_cvt_pk_bf16_f32 v165, v82, v83
    v_dot2_f32_bf16 v27, v164, v164, v27
    v_dot2_f32_bf16 v88, v168, s94, v68
    v_dot2_f32_bf16 v89, v168, s95, v68
    v_cvt_pk_bf16_f32 v166, v84, v85
    v_dot2_f32_bf16 v27, v165, v165, v27
    v_dot2_f32_bf16 v90, v169, s94, v68
    v_dot2_f32_bf16 v91, v169, s95, v68
    v_cvt_pk_bf16_f32 v167, v86, v87
    v_dot2_f32_bf16 v27, v166, v166, v27
    buffer_load_dwordx4 v[244:247], v100, s[24:27], s67 offen offset:768
    v_dot2_f32_bf16 v92, v170, s94, v68
    v_dot2_f32_bf16 v93, v170, s95, v68
    v_cvt_pk_bf16_f32 v168, v88, v89
    v_dot2_f32_bf16 v27, v167, v167, v27
    ds_write_b128 v76, v[164:167] offset:8192
    v_dot2_f32_bf16 v94, v171, s94, v68
    v_dot2_f32_bf16 v95, v171, s95, v68
    v_cvt_pk_bf16_f32 v169, v90, v91
    v_dot2_f32_bf16 v27, v168, v168, v27
    v_dot2_f32_bf16 v80, v172, s94, v68
    v_dot2_f32_bf16 v81, v172, s95, v68
    v_cvt_pk_bf16_f32 v170, v92, v93
    v_dot2_f32_bf16 v27, v169, v169, v27
    v_dot2_f32_bf16 v82, v173, s94, v68
    v_dot2_f32_bf16 v83, v173, s95, v68
    v_cvt_pk_bf16_f32 v171, v94, v95
    v_dot2_f32_bf16 v27, v170, v170, v27
    v_dot2_f32_bf16 v84, v174, s94, v68
    buffer_load_dwordx4 v[248:251], v100, s[24:27], s67 offen offset:896
    v_dot2_f32_bf16 v85, v174, s95, v68
    v_cvt_pk_bf16_f32 v172, v80, v81
    v_dot2_f32_bf16 v27, v171, v171, v27
    ds_write_b128 v76, v[168:171] offset:10240
    v_dot2_f32_bf16 v86, v175, s94, v68
    v_dot2_f32_bf16 v87, v175, s95, v68
    v_cvt_pk_bf16_f32 v173, v82, v83
    v_dot2_f32_bf16 v27, v172, v172, v27
    v_dot2_f32_bf16 v88, v176, s94, v68
    v_dot2_f32_bf16 v89, v176, s95, v68
    v_cvt_pk_bf16_f32 v174, v84, v85
    v_dot2_f32_bf16 v27, v173, v173, v27
    v_dot2_f32_bf16 v90, v177, s94, v68
    v_dot2_f32_bf16 v91, v177, s95, v68
    v_cvt_pk_bf16_f32 v175, v86, v87
    v_dot2_f32_bf16 v27, v174, v174, v27
    v_dot2_f32_bf16 v92, v178, s94, v68
    v_dot2_f32_bf16 v93, v178, s95, v68
    buffer_load_dwordx4 v[252:255], v100, s[24:27], s67 offen offset:1024
    v_cvt_pk_bf16_f32 v176, v88, v89
    v_dot2_f32_bf16 v27, v175, v175, v27
    ds_write_b128 v76, v[172:175] offset:12288
    v_dot2_f32_bf16 v94, v179, s94, v68
    v_dot2_f32_bf16 v95, v179, s95, v68
    v_cvt_pk_bf16_f32 v177, v90, v91
    v_dot2_f32_bf16 v27, v176, v176, v27
    v_dot2_f32_bf16 v80, v180, s94, v68
    v_dot2_f32_bf16 v81, v180, s95, v68
    v_cvt_pk_bf16_f32 v178, v92, v93
    v_dot2_f32_bf16 v27, v177, v177, v27
    v_dot2_f32_bf16 v82, v181, s94, v68
    v_dot2_f32_bf16 v83, v181, s95, v68
    v_cvt_pk_bf16_f32 v179, v94, v95
    v_dot2_f32_bf16 v27, v178, v178, v27
    v_dot2_f32_bf16 v84, v182, s94, v68
    v_dot2_f32_bf16 v85, v182, s95, v68
    v_cvt_pk_bf16_f32 v180, v80, v81
    v_dot2_f32_bf16 v27, v179, v179, v27
    ds_write_b128 v76, v[176:179] offset:14336
    v_dot2_f32_bf16 v86, v183, s94, v68
    v_dot2_f32_bf16 v87, v183, s95, v68
    v_cvt_pk_bf16_f32 v181, v82, v83
    v_dot2_f32_bf16 v27, v180, v180, v27
    v_cvt_pk_bf16_f32 v182, v84, v85
    v_dot2_f32_bf16 v27, v181, v181, v27
    v_cvt_pk_bf16_f32 v183, v86, v87
    v_dot2_f32_bf16 v27, v182, v182, v27
    v_dot2_f32_bf16 v27, v183, v183, v27
    ds_write_b128 v76, v[180:183] offset:16384
    s_waitcnt lgkmcnt(0)
    s_barrier
    s_waitcnt vmcnt(18)
    v_dot2_f32_bf16 v68, v184, s93, 0
    ds_read_b128 a[0:3], v65 offset:0
    ds_read_b128 a[4:7], v65 offset:18432
    v_dot2_f32_bf16 v69, v185, s93, 0
    v_dot2_f32_bf16 v68, v186, s93, v68
    v_dot2_f32_bf16 v69, v187, s93, v69
    s_waitcnt vmcnt(17)
    v_dot2_f32_bf16 v68, v188, s93, v68
    v_dot2_f32_bf16 v69, v189, s93, v69
    v_dot2_f32_bf16 v68, v190, s93, v68
    v_dot2_f32_bf16 v69, v191, s93, v69
    s_waitcnt vmcnt(16)
    v_dot2_f32_bf16 v68, v192, s93, v68
    ds_read_b128 a[16:19], v66 offset:1024
    ds_read_b128 a[20:23], v66 offset:19456
    v_dot2_f32_bf16 v69, v193, s93, v69
    v_dot2_f32_bf16 v68, v194, s93, v68
    v_dot2_f32_bf16 v69, v195, s93, v69
    s_waitcnt vmcnt(15)
    v_dot2_f32_bf16 v68, v196, s93, v68
    v_dot2_f32_bf16 v69, v197, s93, v69
    v_dot2_f32_bf16 v68, v198, s93, v68
    v_dot2_f32_bf16 v69, v199, s93, v69
    s_waitcnt vmcnt(14)
    v_dot2_f32_bf16 v68, v200, s93, v68
    ds_read_b128 a[32:35], v65 offset:2048
    ds_read_b128 a[36:39], v65 offset:20480
    v_dot2_f32_bf16 v69, v201, s93, v69
    s_add_u32 s67, s92, 0
    s_add_u32 m0, s70, 0
    s_nop 0
    buffer_load_dwordx4 v3, s[28:31], s67 offen offset:0 lds
    v_dot2_f32_bf16 v68, v202, s93, v68
    v_dot2_f32_bf16 v69, v203, s93, v69
    s_waitcnt vmcnt(14)
    v_dot2_f32_bf16 v68, v204, s93, v68
    v_dot2_f32_bf16 v69, v205, s93, v69
    v_dot2_f32_bf16 v68, v206, s93, v68
    v_dot2_f32_bf16 v69, v207, s93, v69
    s_waitcnt vmcnt(13)
    v_dot2_f32_bf16 v68, v208, s93, v68
    ds_read_b128 a[48:51], v66 offset:3072
    ds_read_b128 a[52:55], v66 offset:21504
    v_dot2_f32_bf16 v69, v209, s93, v69
    buffer_load_dwordx4 v4, s[28:31], s67 offen offset:1024 lds
    v_dot2_f32_bf16 v68, v210, s93, v68
    v_dot2_f32_bf16 v69, v211, s93, v69
    s_waitcnt vmcnt(13)
    v_dot2_f32_bf16 v68, v212, s93, v68
    v_dot2_f32_bf16 v69, v213, s93, v69
    v_dot2_f32_bf16 v68, v214, s93, v68
    v_dot2_f32_bf16 v69, v215, s93, v69
    s_waitcnt vmcnt(12)
    v_dot2_f32_bf16 v68, v216, s93, v68
    ds_read_b128 a[64:67], v65 offset:4096
    ds_read_b128 a[68:71], v65 offset:22528
    v_dot2_f32_bf16 v69, v217, s93, v69
    buffer_load_dwordx4 v5, s[28:31], s67 offen offset:2048 lds
    v_dot2_f32_bf16 v68, v218, s93, v68
    v_dot2_f32_bf16 v69, v219, s93, v69
    s_nop 2
    v_add_f32 v68, v68, v69
    s_nop 1
    v_add_f32_dpp v68, v68, v68 quad_perm:[1,0,3,2] row_mask:0xf bank_mask:0xf
    s_nop 1
    v_add_f32_dpp v68, v68, v68 quad_perm:[2,3,0,1] row_mask:0xf bank_mask:0xf
    s_nop 1
    s_nop 0
    v_add_f32_dpp v68, v68, v68 row_half_mirror row_mask:0xf bank_mask:0xf
    v_mul_f32 v68, 0xbae38e39, v68
    ds_read_b128 a[80:83], v66 offset:5120
    ds_read_b128 a[84:87], v66 offset:23552
    v_dot2_f32_bf16 v80, v184, s94, v68
    buffer_load_dwordx4 v6, s[28:31], s67 offen offset:3072 lds
    v_dot2_f32_bf16 v81, v184, s95, v68
    v_dot2_f32_bf16 v82, v185, s94, v68
    v_dot2_f32_bf16 v83, v185, s95, v68
    v_dot2_f32_bf16 v84, v186, s94, v68
    v_dot2_f32_bf16 v85, v186, s95, v68
    v_cvt_pk_bf16_f32 v184, v80, v81
    v_dot2_f32_bf16 v86, v187, s94, v68
    ds_read_b128 a[96:99], v65 offset:6144
    ds_read_b128 a[100:103], v65 offset:24576
    v_dot2_f32_bf16 v87, v187, s95, v68
    s_add_u32 s67, s92, 221184
    s_add_u32 m0, s70, 16384
    s_nop 0
    s_nop 0
    buffer_load_dwordx4 v3, s[28:31], s67 offen offset:0 lds
    v_cvt_pk_bf16_f32 v185, v82, v83
    v_dot2_f32_bf16 v24, v184, v184, 0
    v_dot2_f32_bf16 v88, v188, s94, v68
    v_dot2_f32_bf16 v89, v188, s95, v68
    v_cvt_pk_bf16_f32 v186, v84, v85
    v_dot2_f32_bf16 v24, v185, v185, v24
    v_dot2_f32_bf16 v90, v189, s94, v68
    ds_read_b128 a[112:115], v66 offset:7168
    ds_read_b128 a[116:119], v66 offset:25600
    v_dot2_f32_bf16 v91, v189, s95, v68
    buffer_load_dwordx4 v4, s[28:31], s67 offen offset:1024 lds
    v_cvt_pk_bf16_f32 v187, v86, v87
    v_dot2_f32_bf16 v24, v186, v186, v24
    v_dot2_f32_bf16 v92, v190, s94, v68
    v_dot2_f32_bf16 v93, v190, s95, v68
    v_cvt_pk_bf16_f32 v188, v88, v89
    v_dot2_f32_bf16 v24, v187, v187, v24
    v_dot2_f32_bf16 v94, v191, s94, v68
    ds_read_b128 a[128:131], v65 offset:8192
    ds_read_b128 a[132:135], v65 offset:26624
    v_dot2_f32_bf16 v95, v191, s95, v68
    buffer_load_dwordx4 v5, s[28:31], s67 offen offset:2048 lds
    v_cvt_pk_bf16_f32 v189, v90, v91
    v_dot2_f32_bf16 v24, v188, v188, v24
    v_dot2_f32_bf16 v80, v192, s94, v68
    v_dot2_f32_bf16 v81, v192, s95, v68
    v_cvt_pk_bf16_f32 v190, v92, v93
    v_dot2_f32_bf16 v24, v189, v189, v24
    v_dot2_f32_bf16 v82, v193, s94, v68
    ds_read_b128 a[144:147], v66 offset:9216
    ds_read_b128 a[148:151], v66 offset:27648
    v_dot2_f32_bf16 v83, v193, s95, v68
    buffer_load_dwordx4 v6, s[28:31], s67 offen offset:3072 lds
    v_cvt_pk_bf16_f32 v191, v94, v95
    v_dot2_f32_bf16 v24, v190, v190, v24
    v_dot2_f32_bf16 v84, v194, s94, v68
    v_dot2_f32_bf16 v85, v194, s95, v68
    v_cvt_pk_bf16_f32 v192, v80, v81
    v_dot2_f32_bf16 v24, v191, v191, v24
    v_dot2_f32_bf16 v86, v195, s94, v68
    ds_read_b128 a[160:163], v65 offset:10240
    ds_read_b128 a[164:167], v65 offset:28672
    v_dot2_f32_bf16 v87, v195, s95, v68
    s_add_u32 s67, s92, 442368
    s_add_u32 m0, s70, 32768
    s_nop 0
    s_nop 0
    buffer_load_dwordx4 v3, s[28:31], s67 offen offset:0 lds
    v_cvt_pk_bf16_f32 v193, v82, v83
    v_dot2_f32_bf16 v24, v192, v192, v24
    v_dot2_f32_bf16 v88, v196, s94, v68
    v_dot2_f32_bf16 v89, v196, s95, v68
    v_cvt_pk_bf16_f32 v194, v84, v85
    v_dot2_f32_bf16 v24, v193, v193, v24
    v_dot2_f32_bf16 v90, v197, s94, v68
    ds_read_b128 a[176:179], v66 offset:11264
    ds_read_b128 a[180:183], v66 offset:29696
    v_dot2_f32_bf16 v91, v197, s95, v68
    buffer_load_dwordx4 v4, s[28:31], s67 offen offset:1024 lds
    v_cvt_pk_bf16_f32 v195, v86, v87
    v_dot2_f32_bf16 v24, v194, v194, v24
    v_dot2_f32_bf16 v92, v198, s94, v68
    v_dot2_f32_bf16 v93, v198, s95, v68
    v_cvt_pk_bf16_f32 v196, v88, v89
    v_dot2_f32_bf16 v24, v195, v195, v24
    v_dot2_f32_bf16 v94, v199, s94, v68
    ds_read_b128 a[192:195], v65 offset:12288
    ds_read_b128 a[196:199], v65 offset:30720
    v_dot2_f32_bf16 v95, v199, s95, v68
    buffer_load_dwordx4 v5, s[28:31], s67 offen offset:2048 lds
    v_cvt_pk_bf16_f32 v197, v90, v91
    v_dot2_f32_bf16 v24, v196, v196, v24
    v_dot2_f32_bf16 v80, v200, s94, v68
    v_dot2_f32_bf16 v81, v200, s95, v68
    v_cvt_pk_bf16_f32 v198, v92, v93
    v_dot2_f32_bf16 v24, v197, v197, v24
    v_dot2_f32_bf16 v82, v201, s94, v68
    ds_read_b128 a[208:211], v66 offset:13312
    ds_read_b128 a[212:215], v66 offset:31744
    v_dot2_f32_bf16 v83, v201, s95, v68
    buffer_load_dwordx4 v6, s[28:31], s67 offen offset:3072 lds
    v_cvt_pk_bf16_f32 v199, v94, v95
    v_dot2_f32_bf16 v24, v198, v198, v24
    v_dot2_f32_bf16 v84, v202, s94, v68
    v_dot2_f32_bf16 v85, v202, s95, v68
    v_cvt_pk_bf16_f32 v200, v80, v81
    v_dot2_f32_bf16 v24, v199, v199, v24
    v_dot2_f32_bf16 v86, v203, s94, v68
    ds_read_b128 a[224:227], v65 offset:14336
    ds_read_b128 a[228:231], v65 offset:32768
    v_dot2_f32_bf16 v87, v203, s95, v68
    s_add_u32 s67, s92, 663552
    s_add_u32 m0, s70, 49152
    s_nop 0
    s_nop 0
    buffer_load_dwordx4 v3, s[28:31], s67 offen offset:0 lds
    v_cvt_pk_bf16_f32 v201, v82, v83
    v_dot2_f32_bf16 v24, v200, v200, v24
    v_dot2_f32_bf16 v88, v204, s94, v68
    v_dot2_f32_bf16 v89, v204, s95, v68
    v_cvt_pk_bf16_f32 v202, v84, v85
    v_dot2_f32_bf16 v24, v201, v201, v24
    v_dot2_f32_bf16 v90, v205, s94, v68
    ds_read_b128 a[240:243], v66 offset:15360
    ds_read_b128 a[244:247], v66 offset:33792
    v_dot2_f32_bf16 v91, v205, s95, v68
    buffer_load_dwordx4 v4, s[28:31], s67 offen offset:1024 lds
    v_cvt_pk_bf16_f32 v203, v86, v87
    v_dot2_f32_bf16 v24, v202, v202, v24
    v_dot2_f32_bf16 v92, v206, s94, v68
    v_dot2_f32_bf16 v93, v206, s95, v68
    v_cvt_pk_bf16_f32 v204, v88, v89
    v_dot2_f32_bf16 v24, v203, v203, v24
    v_dot2_f32_bf16 v94, v207, s94, v68
    ds_read_b128 v[32:35], v65 offset:16384
    ds_read_b128 v[36:39], v65 offset:34816
    v_dot2_f32_bf16 v95, v207, s95, v68
    buffer_load_dwordx4 v5, s[28:31], s67 offen offset:2048 lds
    v_cvt_pk_bf16_f32 v205, v90, v91
    v_dot2_f32_bf16 v24, v204, v204, v24
    v_dot2_f32_bf16 v80, v208, s94, v68
    v_dot2_f32_bf16 v81, v208, s95, v68
    v_cvt_pk_bf16_f32 v206, v92, v93
    v_dot2_f32_bf16 v24, v205, v205, v24
    v_dot2_f32_bf16 v82, v209, s94, v68
    ds_read_b128 v[48:51], v66 offset:17408
    ds_read_b128 v[52:55], v66 offset:35840
    v_dot2_f32_bf16 v83, v209, s95, v68
    buffer_load_dwordx4 v6, s[28:31], s67 offen offset:3072 lds
    v_cvt_pk_bf16_f32 v207, v94, v95
    v_dot2_f32_bf16 v24, v206, v206, v24
    v_dot2_f32_bf16 v84, v210, s94, v68
    v_dot2_f32_bf16 v85, v210, s95, v68
    v_cvt_pk_bf16_f32 v208, v80, v81
    v_dot2_f32_bf16 v24, v207, v207, v24
    v_dot2_f32_bf16 v86, v211, s94, v68
    v_dot2_f32_bf16 v87, v211, s95, v68
    s_add_u32 s67, s92, 884736
    s_add_u32 m0, s70, 65536
    s_nop 0
    s_nop 0
    buffer_load_dwordx4 v3, s[28:31], s67 offen offset:0 lds
    v_cvt_pk_bf16_f32 v209, v82, v83
    v_dot2_f32_bf16 v24, v208, v208, v24
    v_dot2_f32_bf16 v88, v212, s94, v68
    v_dot2_f32_bf16 v89, v212, s95, v68
    v_cvt_pk_bf16_f32 v210, v84, v85
    v_dot2_f32_bf16 v24, v209, v209, v24
    v_dot2_f32_bf16 v90, v213, s94, v68
    v_dot2_f32_bf16 v91, v213, s95, v68
    buffer_load_dwordx4 v4, s[28:31], s67 offen offset:1024 lds
    v_cvt_pk_bf16_f32 v211, v86, v87
    v_dot2_f32_bf16 v24, v210, v210, v24
    v_dot2_f32_bf16 v92, v214, s94, v68
    v_dot2_f32_bf16 v93, v214, s95, v68
    v_cvt_pk_bf16_f32 v212, v88, v89
    v_dot2_f32_bf16 v24, v211, v211, v24
    v_dot2_f32_bf16 v94, v215, s94, v68
    v_dot2_f32_bf16 v95, v215, s95, v68
    buffer_load_dwordx4 v5, s[28:31], s67 offen offset:2048 lds
    v_cvt_pk_bf16_f32 v213, v90, v91
    v_dot2_f32_bf16 v24, v212, v212, v24
    v_dot2_f32_bf16 v80, v216, s94, v68
    v_dot2_f32_bf16 v81, v216, s95, v68
    v_cvt_pk_bf16_f32 v214, v92, v93
    v_dot2_f32_bf16 v24, v213, v213, v24
    v_dot2_f32_bf16 v82, v217, s94, v68
    v_dot2_f32_bf16 v83, v217, s95, v68
    buffer_load_dwordx4 v6, s[28:31], s67 offen offset:3072 lds
    v_cvt_pk_bf16_f32 v215, v94, v95
    v_dot2_f32_bf16 v24, v214, v214, v24
    v_dot2_f32_bf16 v84, v218, s94, v68
    v_dot2_f32_bf16 v85, v218, s95, v68
    v_cvt_pk_bf16_f32 v216, v80, v81
    v_dot2_f32_bf16 v24, v215, v215, v24
    v_dot2_f32_bf16 v86, v219, s94, v68
    v_dot2_f32_bf16 v87, v219, s95, v68
    v_mul_u32_u24 v107, 13108, v1
    v_lshrrev_b32_e64 v107, 16, v107
    v_cmp_gt_u32 s[78:79], 9, v107
    v_mul_u32_u24 v106, 20, v107
    v_lshlrev_b32 v108, 2, v1
    v_sub_u32_e64 v106, v108, v106
    v_mov_b32 v108, 0x71480
    v_bfe_u32 v106, v108, v106, 4
    v_mul_u32_u24 v107, 9216, v107
    v_lshl_add_u32 v107, v106, 7, v107
    v_mov_b32 v106, 0x10000000
    v_cndmask_b32 v107, v106, v107, s[78:79]
    buffer_load_dword v0, v107, s[52:55], s20 offen
    v_cvt_pk_bf16_f32 v217, v82, v83
    v_dot2_f32_bf16 v24, v216, v216, v24
    v_cvt_pk_bf16_f32 v218, v84, v85
    v_dot2_f32_bf16 v24, v217, v217, v24
    v_cvt_pk_bf16_f32 v219, v86, v87
    v_dot2_f32_bf16 v24, v218, v218, v24
    v_dot2_f32_bf16 v24, v219, v219, v24
    s_waitcnt lgkmcnt(0)
    s_barrier
    s_waitcnt vmcnt(29)
    v_dot2_f32_bf16 v68, v220, s93, 0
    buffer_atomic_or v105, v29, s[48:51], s11 offen offset:8
    ds_write_b128 v64, v[184:187] offset:0
    v_dot2_f32_bf16 v69, v221, s93, 0
    v_dot2_f32_bf16 v68, v222, s93, v68
    v_dot2_f32_bf16 v69, v223, s93, v69
    s_waitcnt vmcnt(29)
    v_dot2_f32_bf16 v68, v224, s93, v68
    v_dot2_f32_bf16 v69, v225, s93, v69
    v_dot2_f32_bf16 v68, v226, s93, v68
    v_dot2_f32_bf16 v69, v227, s93, v69
    s_waitcnt vmcnt(28)
    v_dot2_f32_bf16 v68, v228, s93, v68
    v_dot2_f32_bf16 v69, v229, s93, v69
    v_dot2_f32_bf16 v68, v230, s93, v68
    v_dot2_f32_bf16 v69, v231, s93, v69
    s_waitcnt vmcnt(27)
    v_dot2_f32_bf16 v68, v232, s93, v68
    ds_write_b128 v64, v[188:191] offset:2048
    v_dot2_f32_bf16 v69, v233, s93, v69
    v_dot2_f32_bf16 v68, v234, s93, v68
    v_dot2_f32_bf16 v69, v235, s93, v69
    s_waitcnt vmcnt(26)
    v_dot2_f32_bf16 v68, v236, s93, v68
    v_dot2_f32_bf16 v69, v237, s93, v69
    v_dot2_f32_bf16 v68, v238, s93, v68
    v_dot2_f32_bf16 v69, v239, s93, v69
    s_waitcnt vmcnt(25)
    v_dot2_f32_bf16 v68, v240, s93, v68
    v_dot2_f32_bf16 v69, v241, s93, v69
    v_dot2_f32_bf16 v68, v242, s93, v68
    v_dot2_f32_bf16 v69, v243, s93, v69
    s_waitcnt vmcnt(24)
    v_dot2_f32_bf16 v68, v244, s93, v68
    ds_write_b128 v64, v[192:195] offset:4096
    v_dot2_f32_bf16 v69, v245, s93, v69
    v_dot2_f32_bf16 v68, v246, s93, v68
    v_dot2_f32_bf16 v69, v247, s93, v69
    s_waitcnt vmcnt(23)
    v_dot2_f32_bf16 v68, v248, s93, v68
    v_dot2_f32_bf16 v69, v249, s93, v69
    v_dot2_f32_bf16 v68, v250, s93, v68
    v_dot2_f32_bf16 v69, v251, s93, v69
    s_waitcnt vmcnt(22)
    v_dot2_f32_bf16 v68, v252, s93, v68
    v_dot2_f32_bf16 v69, v253, s93, v69
    v_dot2_f32_bf16 v68, v254, s93, v68
    v_dot2_f32_bf16 v69, v255, s93, v69
    s_nop 2
    v_add_f32_e64 v68, v68, v69
    ds_write_b128 v64, v[196:199] offset:6144
    s_nop 0
    v_add_f32_dpp v68, v68, v68 quad_perm:[1,0,3,2] row_mask:0xf bank_mask:0xf
    s_nop 1
    v_add_f32_dpp v68, v68, v68 quad_perm:[2,3,0,1] row_mask:0xf bank_mask:0xf
    s_nop 1
    s_nop 0
    v_add_f32_dpp v68, v68, v68 row_half_mirror row_mask:0xf bank_mask:0xf
    v_mul_f32 v68, 0xbae38e39, v68
    v_dot2_f32_bf16 v80, v220, s94, v68
    v_dot2_f32_bf16 v81, v220, s95, v68
    v_dot2_f32_bf16 v82, v221, s94, v68
    v_dot2_f32_bf16 v83, v221, s95, v68
    v_dot2_f32_bf16 v84, v222, s94, v68
    v_dot2_f32_bf16 v85, v222, s95, v68
    v_cvt_pk_bf16_f32 v220, v80, v81
    v_dot2_f32_bf16 v86, v223, s94, v68
    ds_write_b128 v64, v[200:203] offset:8192
    v_dot2_f32_bf16 v87, v223, s95, v68
    v_cvt_pk_bf16_f32 v221, v82, v83
    v_dot2_f32_bf16 v25, v220, v220, 0
    v_dot2_f32_bf16 v88, v224, s94, v68
    v_dot2_f32_bf16 v89, v224, s95, v68
    v_cvt_pk_bf16_f32 v222, v84, v85
    v_dot2_f32_bf16 v25, v221, v221, v25
    v_dot2_f32_bf16 v90, v225, s94, v68
    v_dot2_f32_bf16 v91, v225, s95, v68
    v_cvt_pk_bf16_f32 v223, v86, v87
    v_dot2_f32_bf16 v25, v222, v222, v25
    v_dot2_f32_bf16 v92, v226, s94, v68
    ds_write_b128 v64, v[204:207] offset:10240
    v_dot2_f32_bf16 v93, v226, s95, v68
    v_cvt_pk_bf16_f32 v224, v88, v89
    v_dot2_f32_bf16 v25, v223, v223, v25
    ds_write_b128 v76, v[220:223] offset:0
    v_dot2_f32_bf16 v94, v227, s94, v68
    v_dot2_f32_bf16 v95, v227, s95, v68
    v_cvt_pk_bf16_f32 v225, v90, v91
    v_dot2_f32_bf16 v25, v224, v224, v25
    v_dot2_f32_bf16 v80, v228, s94, v68
    v_dot2_f32_bf16 v81, v228, s95, v68
    v_cvt_pk_bf16_f32 v226, v92, v93
    v_dot2_f32_bf16 v25, v225, v225, v25
    v_dot2_f32_bf16 v82, v229, s94, v68
    ds_write_b128 v64, v[208:211] offset:12288
    v_dot2_f32_bf16 v83, v229, s95, v68
    v_cvt_pk_bf16_f32 v227, v94, v95
    v_dot2_f32_bf16 v25, v226, v226, v25
    v_dot2_f32_bf16 v84, v230, s94, v68
    v_dot2_f32_bf16 v85, v230, s95, v68
    v_cvt_pk_bf16_f32 v228, v80, v81
    v_dot2_f32_bf16 v25, v227, v227, v25
    ds_write_b128 v76, v[224:227] offset:2048
    v_dot2_f32_bf16 v86, v231, s94, v68
    v_dot2_f32_bf16 v87, v231, s95, v68
    v_cvt_pk_bf16_f32 v229, v82, v83
    v_dot2_f32_bf16 v25, v228, v228, v25
    v_dot2_f32_bf16 v88, v232, s94, v68
    ds_write_b128 v64, v[212:215] offset:14336
    v_dot2_f32_bf16 v89, v232, s95, v68
    v_cvt_pk_bf16_f32 v230, v84, v85
    v_dot2_f32_bf16 v25, v229, v229, v25
    v_dot2_f32_bf16 v90, v233, s94, v68
    v_dot2_f32_bf16 v91, v233, s95, v68
    v_cvt_pk_bf16_f32 v231, v86, v87
    v_dot2_f32_bf16 v25, v230, v230, v25
    v_dot2_f32_bf16 v92, v234, s94, v68
    v_dot2_f32_bf16 v93, v234, s95, v68
    v_cvt_pk_bf16_f32 v232, v88, v89
    v_dot2_f32_bf16 v25, v231, v231, v25
    ds_write_b128 v76, v[228:231] offset:4096
    v_dot2_f32_bf16 v94, v235, s94, v68
    ds_write_b128 v64, v[216:219] offset:16384
    v_dot2_f32_bf16 v95, v235, s95, v68
    v_cvt_pk_bf16_f32 v233, v90, v91
    v_dot2_f32_bf16 v25, v232, v232, v25
    v_dot2_f32_bf16 v80, v236, s94, v68
    v_dot2_f32_bf16 v81, v236, s95, v68
    v_cvt_pk_bf16_f32 v234, v92, v93
    v_dot2_f32_bf16 v25, v233, v233, v25
    v_dot2_f32_bf16 v82, v237, s94, v68
    v_dot2_f32_bf16 v83, v237, s95, v68
    v_cvt_pk_bf16_f32 v235, v94, v95
    v_dot2_f32_bf16 v25, v234, v234, v25
    v_dot2_f32_bf16 v84, v238, s94, v68
    v_dot2_f32_bf16 v85, v238, s95, v68
    v_cvt_pk_bf16_f32 v236, v80, v81
    v_dot2_f32_bf16 v25, v235, v235, v25
    ds_write_b128 v76, v[232:235] offset:6144
    v_dot2_f32_bf16 v86, v239, s94, v68
    v_dot2_f32_bf16 v87, v239, s95, v68
    v_cvt_pk_bf16_f32 v237, v82, v83
    v_dot2_f32_bf16 v25, v236, v236, v25
    v_dot2_f32_bf16 v88, v240, s94, v68
    v_dot2_f32_bf16 v89, v240, s95, v68
    v_cvt_pk_bf16_f32 v238, v84, v85
    v_dot2_f32_bf16 v25, v237, v237, v25
    v_dot2_f32_bf16 v90, v241, s94, v68
    v_dot2_f32_bf16 v91, v241, s95, v68
    v_cvt_pk_bf16_f32 v239, v86, v87
    v_dot2_f32_bf16 v25, v238, v238, v25
    v_dot2_f32_bf16 v92, v242, s94, v68
    v_dot2_f32_bf16 v93, v242, s95, v68
    v_cvt_pk_bf16_f32 v240, v88, v89
    v_dot2_f32_bf16 v25, v239, v239, v25
    ds_write_b128 v76, v[236:239] offset:8192
    v_dot2_f32_bf16 v94, v243, s94, v68
    v_dot2_f32_bf16 v95, v243, s95, v68
    v_cvt_pk_bf16_f32 v241, v90, v91
    v_dot2_f32_bf16 v25, v240, v240, v25
    v_dot2_f32_bf16 v80, v244, s94, v68
    v_dot2_f32_bf16 v81, v244, s95, v68
    v_cvt_pk_bf16_f32 v242, v92, v93
    v_dot2_f32_bf16 v25, v241, v241, v25
    v_dot2_f32_bf16 v82, v245, s94, v68
    v_dot2_f32_bf16 v83, v245, s95, v68
    v_cvt_pk_bf16_f32 v243, v94, v95
    v_dot2_f32_bf16 v25, v242, v242, v25
    v_dot2_f32_bf16 v84, v246, s94, v68
    v_dot2_f32_bf16 v85, v246, s95, v68
    v_cvt_pk_bf16_f32 v244, v80, v81
    v_dot2_f32_bf16 v25, v243, v243, v25
    ds_write_b128 v76, v[240:243] offset:10240
    v_dot2_f32_bf16 v86, v247, s94, v68
    v_dot2_f32_bf16 v87, v247, s95, v68
    v_cvt_pk_bf16_f32 v245, v82, v83
    v_dot2_f32_bf16 v25, v244, v244, v25
    v_dot2_f32_bf16 v88, v248, s94, v68
    v_dot2_f32_bf16 v89, v248, s95, v68
    v_cvt_pk_bf16_f32 v246, v84, v85
    v_dot2_f32_bf16 v25, v245, v245, v25
    v_dot2_f32_bf16 v90, v249, s94, v68
    v_dot2_f32_bf16 v91, v249, s95, v68
    v_cvt_pk_bf16_f32 v247, v86, v87
    v_dot2_f32_bf16 v25, v246, v246, v25
    v_dot2_f32_bf16 v92, v250, s94, v68
    v_dot2_f32_bf16 v93, v250, s95, v68
    v_cvt_pk_bf16_f32 v248, v88, v89
    v_dot2_f32_bf16 v25, v247, v247, v25
    ds_write_b128 v76, v[244:247] offset:12288
    v_dot2_f32_bf16 v94, v251, s94, v68
    v_dot2_f32_bf16 v95, v251, s95, v68
    v_cvt_pk_bf16_f32 v249, v90, v91
    v_dot2_f32_bf16 v25, v248, v248, v25
    v_dot2_f32_bf16 v80, v252, s94, v68
    v_dot2_f32_bf16 v81, v252, s95, v68
    v_cvt_pk_bf16_f32 v250, v92, v93
    v_dot2_f32_bf16 v25, v249, v249, v25
    v_dot2_f32_bf16 v82, v253, s94, v68
    v_dot2_f32_bf16 v83, v253, s95, v68
    v_cvt_pk_bf16_f32 v251, v94, v95
    v_dot2_f32_bf16 v25, v250, v250, v25
    v_dot2_f32_bf16 v84, v254, s94, v68
    v_dot2_f32_bf16 v85, v254, s95, v68
    v_cvt_pk_bf16_f32 v252, v80, v81
    v_dot2_f32_bf16 v25, v251, v251, v25
    ds_write_b128 v76, v[248:251] offset:14336
    v_dot2_f32_bf16 v86, v255, s94, v68
    v_dot2_f32_bf16 v87, v255, s95, v68
    v_cvt_pk_bf16_f32 v253, v82, v83
    v_dot2_f32_bf16 v25, v252, v252, v25
    v_cvt_pk_bf16_f32 v254, v84, v85
    v_dot2_f32_bf16 v25, v253, v253, v25
    v_cvt_pk_bf16_f32 v255, v86, v87
    v_dot2_f32_bf16 v25, v254, v254, v25
    v_dot2_f32_bf16 v25, v255, v255, v25
    ds_write_b128 v76, v[252:255] offset:16384
    s_waitcnt vmcnt(18) lgkmcnt(0)
    s_barrier
    ds_read_b64_tr_b16 v[80:81], v14 offset:0
    ds_read_b64_tr_b16 v[82:83], v14 offset:512
    ds_read_b64_tr_b16 v[84:85], v14 offset:8192
    ds_read_b64_tr_b16 v[86:87], v14 offset:8704
    ds_read_b64_tr_b16 v[88:89], v15 offset:0
    ds_read_b64_tr_b16 v[90:91], v15 offset:512
    ds_read_b64_tr_b16 v[92:93], v15 offset:8192
    ds_read_b64_tr_b16 v[94:95], v15 offset:8704
    ds_read_b128 a[8:11], v65 offset:0
    ds_read_b128 a[12:15], v65 offset:18432
    ds_read_b128 a[24:27], v66 offset:1024
    ds_read_b128 a[28:31], v66 offset:19456
    ds_read_b128 a[40:43], v65 offset:2048
    ds_read_b128 a[44:47], v65 offset:20480
    ds_read_b128 a[56:59], v66 offset:3072
    ds_read_b128 a[60:63], v66 offset:21504
    s_cmp_ge_u32 s88, 18
    s_cbranch_scc1 qkv_v
    s_cmp_lt_u32 s88, 4
    s_cbranch_scc1 qkv_k
    s_waitcnt lgkmcnt(12)
    v_mfma_f32_16x16x32_bf16 v[112:115], v[80:83], a[0:3], 0
    ds_read_b64_tr_b16 v[96:97], v14 offset:2048
    v_mfma_f32_16x16x32_bf16 v[112:115], v[84:87], a[16:19], v[112:115]
    ds_read_b64_tr_b16 v[98:99], v14 offset:2560
    v_mfma_f32_16x16x32_bf16 v[116:119], v[80:83], a[4:7], 0
    ds_read_b64_tr_b16 v[100:101], v14 offset:10240
    v_add_f32_dpp v26, v26, v26 quad_perm:[1,0,3,2] row_mask:0xf bank_mask:0xf
    v_mfma_f32_16x16x32_bf16 v[116:119], v[84:87], a[20:23], v[116:119]
    ds_read_b64_tr_b16 v[102:103], v14 offset:10752
    v_add_f32_dpp v27, v27, v27 quad_perm:[1,0,3,2] row_mask:0xf bank_mask:0xf
    s_waitcnt lgkmcnt(11)
    v_mfma_f32_16x16x32_bf16 v[120:123], v[80:83], a[8:11], 0
    ds_read_b64_tr_b16 v[104:105], v15 offset:2048
    v_add_f32_dpp v24, v24, v24 quad_perm:[1,0,3,2] row_mask:0xf bank_mask:0xf
    s_waitcnt lgkmcnt(10)
    v_mfma_f32_16x16x32_bf16 v[120:123], v[84:87], a[24:27], v[120:123]
    ds_read_b64_tr_b16 v[106:107], v15 offset:2560
    v_add_f32_dpp v25, v25, v25 quad_perm:[1,0,3,2] row_mask:0xf bank_mask:0xf
    v_mfma_f32_16x16x32_bf16 v[124:127], v[80:83], a[12:15], 0
    ds_read_b64_tr_b16 v[108:109], v15 offset:10240
    v_add_f32_dpp v26, v26, v26 quad_perm:[2,3,0,1] row_mask:0xf bank_mask:0xf
    s_waitcnt lgkmcnt(11)
    v_mfma_f32_16x16x32_bf16 v[124:127], v[84:87], a[28:31], v[124:127]
    ds_read_b64_tr_b16 v[110:111], v15 offset:10752
    s_waitcnt vmcnt(14)
    s_barrier
    v_mfma_f32_16x16x32_bf16 v[128:131], v[88:91], a[0:3], 0
    ds_read_b64_tr_b16 v[80:81], v14 offset:16384
    v_add_f32_dpp v27, v27, v27 quad_perm:[2,3,0,1] row_mask:0xf bank_mask:0xf
    v_mfma_f32_16x16x32_bf16 v[128:131], v[92:95], a[16:19], v[128:131]
    ds_read_b128 a[72:75], v65 offset:4096
    v_add_f32_dpp v24, v24, v24 quad_perm:[2,3,0,1] row_mask:0xf bank_mask:0xf
    v_mfma_f32_16x16x32_bf16 v[132:135], v[88:91], a[4:7], 0
    ds_read_b64_tr_b16 v[82:83], v14 offset:16896
    v_add_f32_dpp v25, v25, v25 quad_perm:[2,3,0,1] row_mask:0xf bank_mask:0xf
    v_mfma_f32_16x16x32_bf16 v[132:135], v[92:95], a[20:23], v[132:135]
    ds_read_b128 a[76:79], v65 offset:22528
    v_add_f32_dpp v26, v26, v26 row_half_mirror row_mask:0xf bank_mask:0xf
    v_mfma_f32_16x16x32_bf16 v[136:139], v[88:91], a[8:11], 0
    ds_read_b64_tr_b16 v[84:85], v14 offset:24576
    v_add_f32_dpp v27, v27, v27 row_half_mirror row_mask:0xf bank_mask:0xf
    v_mfma_f32_16x16x32_bf16 v[136:139], v[92:95], a[24:27], v[136:139]
    ds_read_b128 a[88:91], v66 offset:5120
    v_add_f32_dpp v24, v24, v24 row_half_mirror row_mask:0xf bank_mask:0xf
    v_mfma_f32_16x16x32_bf16 v[140:143], v[88:91], a[12:15], 0
    ds_read_b64_tr_b16 v[86:87], v14 offset:25088
    v_add_f32_dpp v25, v25, v25 row_half_mirror row_mask:0xf bank_mask:0xf
    v_mfma_f32_16x16x32_bf16 v[140:143], v[92:95], a[28:31], v[140:143]
    ds_read_b128 a[92:95], v66 offset:23552
    s_waitcnt lgkmcnt(12)
    v_mfma_f32_16x16x32_bf16 v[144:147], v[96:99], a[0:3], 0
    ds_read_b64_tr_b16 v[88:89], v15 offset:16384
    s_mov_b32 s76, 0xaaaaaaaa
    v_mfma_f32_16x16x32_bf16 v[144:147], v[100:103], a[16:19], v[144:147]
    ds_read_b128 a[104:107], v65 offset:6144
    s_mov_b32 s77, 0xaaaaaaaa
    v_mfma_f32_16x16x32_bf16 v[148:151], v[96:99], a[4:7], 0
    ds_read_b64_tr_b16 v[90:91], v15 offset:16896
    v_cndmask_b32 v26, v26, v27, s[76:77]
    v_mfma_f32_16x16x32_bf16 v[148:151], v[100:103], a[20:23], v[148:151]
    ds_read_b128 a[108:111], v65 offset:24576
    v_cndmask_b32 v24, v24, v25, s[76:77]
    v_mfma_f32_16x16x32_bf16 v[152:155], v[96:99], a[8:11], 0
    ds_read_b64_tr_b16 v[92:93], v15 offset:24576
    s_mov_b32 s76, 0xcccccccc
    v_mfma_f32_16x16x32_bf16 v[152:155], v[100:103], a[24:27], v[152:155]
    ds_read_b128 a[120:123], v66 offset:7168
    s_mov_b32 s77, 0xcccccccc
    v_mfma_f32_16x16x32_bf16 v[156:159], v[96:99], a[12:15], 0
    ds_read_b64_tr_b16 v[94:95], v15 offset:25088
    v_mov_b32 v181, 0x3727c5ac
    v_mfma_f32_16x16x32_bf16 v[156:159], v[100:103], a[28:31], v[156:159]
    ds_read_b128 a[124:127], v66 offset:25600
    s_waitcnt lgkmcnt(15)
    v_mfma_f32_16x16x32_bf16 v[160:163], v[104:107], a[0:3], 0
    ds_read_b64_tr_b16 v[96:97], v14 offset:18432
    v_cndmask_b32 v26, v26, v24, s[76:77]
    v_mfma_f32_16x16x32_bf16 v[160:163], v[108:111], a[16:19], v[160:163]
    ds_read_b128 a[136:139], v65 offset:8192
    v_fmac_f32 v181, 0x3ae38e39, v26
    v_mfma_f32_16x16x32_bf16 v[164:167], v[104:107], a[4:7], 0
    ds_read_b64_tr_b16 v[98:99], v14 offset:18944
    v_mfma_f32_16x16x32_bf16 v[164:167], v[108:111], a[20:23], v[164:167]
    ds_read_b128 a[140:143], v65 offset:26624
    v_mfma_f32_16x16x32_bf16 v[168:171], v[104:107], a[8:11], 0
    ds_read_b64_tr_b16 v[100:101], v14 offset:26624
    v_mfma_f32_16x16x32_bf16 v[168:171], v[108:111], a[24:27], v[168:171]
    ds_read_b128 a[152:155], v66 offset:9216
    v_mfma_f32_16x16x32_bf16 v[172:175], v[104:107], a[12:15], 0
    ds_read_b64_tr_b16 v[102:103], v14 offset:27136
    v_mfma_f32_16x16x32_bf16 v[172:175], v[108:111], a[28:31], v[172:175]
    ds_read_b128 a[156:159], v66 offset:27648
    s_waitcnt lgkmcnt(15)
    v_mfma_f32_16x16x32_bf16 v[112:115], v[80:83], a[32:35], v[112:115]
    ds_read_b64_tr_b16 v[104:105], v15 offset:18432
    v_lshrrev_b32 v68, 2, v1
    v_mfma_f32_16x16x32_bf16 v[112:115], v[84:87], a[48:51], v[112:115]
    ds_read_b128 a[168:171], v65 offset:10240
    v_mul_u32_u24 v68, 9216, v68
    v_mfma_f32_16x16x32_bf16 v[116:119], v[80:83], a[36:39], v[116:119]
    ds_read_b64_tr_b16 v[106:107], v15 offset:18944
    v_bfe_u32 v69, v1, 1, 1
    v_mfma_f32_16x16x32_bf16 v[116:119], v[84:87], a[52:55], v[116:119]
    ds_read_b128 a[172:175], v65 offset:28672
    v_mul_u32_u24 v69, 1152, v69
    v_mfma_f32_16x16x32_bf16 v[120:123], v[80:83], a[40:43], v[120:123]
    ds_read_b64_tr_b16 v[108:109], v15 offset:26624
    v_add_u32_e64 v68, v68, v69
    v_mfma_f32_16x16x32_bf16 v[120:123], v[84:87], a[56:59], v[120:123]
    ds_read_b128 a[184:187], v66 offset:11264
    v_and_b32_e64 v69, 1, v1
    v_mfma_f32_16x16x32_bf16 v[124:127], v[80:83], a[44:47], v[124:127]
    ds_read_b64_tr_b16 v[110:111], v15 offset:27136
    v_lshl_add_u32 v68, v69, 10, v68
    v_mfma_f32_16x16x32_bf16 v[124:127], v[84:87], a[60:63], v[124:127]
    s_waitcnt vmcnt(10) lgkmcnt(15)
    s_barrier
    v_mfma_f32_16x16x32_bf16 v[128:131], v[88:91], a[32:35], v[128:131]
    ds_read_b64_tr_b16 v[80:81], v14 offset:32768
    v_cmp_gt_u32 s[18:19], 36, v1
    v_mfma_f32_16x16x32_bf16 v[128:131], v[92:95], a[48:51], v[128:131]
    ds_read_b128 a[188:191], v66 offset:29696
    v_mov_b32 v70, 0x10000000
    v_mfma_f32_16x16x32_bf16 v[132:135], v[88:91], a[36:39], v[132:135]
    ds_read_b64_tr_b16 v[82:83], v14 offset:33280
    v_lshlrev_b32_e64 v69, 8, v69
    v_mfma_f32_16x16x32_bf16 v[132:135], v[92:95], a[52:55], v[132:135]
    ds_read_b128 a[200:203], v65 offset:12288
    v_cndmask_b32 v68, v70, v68, s[18:19]
    v_mfma_f32_16x16x32_bf16 v[136:139], v[88:91], a[40:43], v[136:139]
    ds_read_b64_tr_b16 v[84:85], v14 offset:40960
    v_sub_u32 v69, 128, v69
    v_mfma_f32_16x16x32_bf16 v[136:139], v[92:95], a[56:59], v[136:139]
    ds_read_b128 a[204:207], v65 offset:30720
    s_lshr_b32 s18, s2, 5
    v_mfma_f32_16x16x32_bf16 v[140:143], v[88:91], a[44:47], v[140:143]
    ds_read_b64_tr_b16 v[86:87], v14 offset:41472
    s_lshl_b32 s18, s18, 3
    v_mfma_f32_16x16x32_bf16 v[140:143], v[92:95], a[60:63], v[140:143]
    ds_read_b128 a[216:219], v66 offset:13312
    s_waitcnt lgkmcnt(15)
    v_mfma_f32_16x16x32_bf16 v[144:147], v[96:99], a[32:35], v[144:147]
    ds_read_b64_tr_b16 v[88:89], v15 offset:32768
    s_and_b32 s19, s2, 7
    v_mfma_f32_16x16x32_bf16 v[144:147], v[100:103], a[48:51], v[144:147]
    ds_read_b128 a[220:223], v66 offset:31744
    s_or_b32 s18, s18, s19
    v_mfma_f32_16x16x32_bf16 v[148:151], v[96:99], a[36:39], v[148:151]
    ds_read_b64_tr_b16 v[90:91], v15 offset:33280
    s_mul_i32 s20, s18, 82944
    v_mfma_f32_16x16x32_bf16 v[148:151], v[100:103], a[52:55], v[148:151]
    ds_read_b128 a[232:235], v65 offset:14336
    s_mul_i32 s19, s58, 2304
    v_mfma_f32_16x16x32_bf16 v[152:155], v[96:99], a[40:43], v[152:155]
    ds_read_b64_tr_b16 v[92:93], v15 offset:40960
    s_add_u32 s20, s20, s19
    v_mfma_f32_16x16x32_bf16 v[152:155], v[100:103], a[56:59], v[152:155]
    ds_read_b128 a[236:239], v65 offset:32768
    s_and_b32 s18, s101, 3
    v_mfma_f32_16x16x32_bf16 v[156:159], v[96:99], a[44:47], v[156:159]
    ds_read_b64_tr_b16 v[94:95], v15 offset:41472
    v_add_u32 v68, v68, v69
    v_mfma_f32_16x16x32_bf16 v[156:159], v[100:103], a[60:63], v[156:159]
    ds_read_b128 a[248:251], v66 offset:15360
    s_waitcnt lgkmcnt(15)
    v_mfma_f32_16x16x32_bf16 v[160:163], v[104:107], a[32:35], v[160:163]
    ds_read_b64_tr_b16 v[96:97], v14 offset:34816
    v_mfma_f32_16x16x32_bf16 v[160:163], v[108:111], a[48:51], v[160:163]
    ds_read_b128 a[252:255], v66 offset:33792
    v_mfma_f32_16x16x32_bf16 v[164:167], v[104:107], a[36:39], v[164:167]
    ds_read_b64_tr_b16 v[98:99], v14 offset:35328
    v_mfma_f32_16x16x32_bf16 v[164:167], v[108:111], a[52:55], v[164:167]
    ds_read_b128 v[40:43], v65 offset:16384
    v_mfma_f32_16x16x32_bf16 v[168:171], v[104:107], a[40:43], v[168:171]
    ds_read_b64_tr_b16 v[100:101], v14 offset:43008
    v_mfma_f32_16x16x32_bf16 v[168:171], v[108:111], a[56:59], v[168:171]
    ds_read_b128 v[44:47], v65 offset:34816
    v_mfma_f32_16x16x32_bf16 v[172:175], v[104:107], a[44:47], v[172:175]
    ds_read_b64_tr_b16 v[102:103], v14 offset:43520
    v_mfma_f32_16x16x32_bf16 v[172:175], v[108:111], a[60:63], v[172:175]
    ds_read_b128 v[56:59], v66 offset:17408
    s_waitcnt lgkmcnt(15)
    v_mfma_f32_16x16x32_bf16 v[112:115], v[80:83], a[64:67], v[112:115]
    ds_read_b64_tr_b16 v[104:105], v15 offset:34816
    v_mfma_f32_16x16x32_bf16 v[112:115], v[84:87], a[80:83], v[112:115]
    ds_read_b128 v[60:63], v66 offset:35840
    v_mfma_f32_16x16x32_bf16 v[116:119], v[80:83], a[68:71], v[116:119]
    ds_read_b64_tr_b16 v[106:107], v15 offset:35328
    v_mfma_f32_16x16x32_bf16 v[116:119], v[84:87], a[84:87], v[116:119]
    v_rsq_f32_e64 v176, v181
    v_mfma_f32_16x16x32_bf16 v[120:123], v[80:83], a[72:75], v[120:123]
    ds_read_b64_tr_b16 v[108:109], v15 offset:43008
    v_lshlrev_b32_e64 v180, 3, v1
    v_mfma_f32_16x16x32_bf16 v[120:123], v[84:87], a[88:91], v[120:123]
    v_xor_b32 v180, s97, v180
    v_and_b32 v180, 8, v180
    v_mfma_f32_16x16x32_bf16 v[124:127], v[80:83], a[76:79], v[124:127]
    ds_read_b64_tr_b16 v[110:111], v15 offset:43520
    v_add_u32_e64 v180, v180, v67
    v_mfma_f32_16x16x32_bf16 v[124:127], v[84:87], a[92:95], v[124:127]
    s_waitcnt vmcnt(6) lgkmcnt(3)
    s_barrier
    v_mfma_f32_16x16x32_bf16 v[128:131], v[88:91], a[64:67], v[128:131]
    ds_read_b64_tr_b16 v[80:81], v14 offset:49152
    s_add_u32 s67, s92, 1105920
    v_mfma_f32_16x16x32_bf16 v[128:131], v[92:95], a[80:83], v[128:131]
    s_add_u32 m0, s70, 81920
    v_and_b32_e64 v181, 2, v1
    v_mfma_f32_16x16x32_bf16 v[132:135], v[88:91], a[68:71], v[132:135]
    ds_read_b64_tr_b16 v[82:83], v14 offset:49664
    v_lshl_add_u32 v180, v181, 4, v180
    v_mfma_f32_16x16x32_bf16 v[132:135], v[92:95], a[84:87], v[132:135]
    buffer_load_dwordx4 v3, s[28:31], s67 offen offset:0 lds
    v_mov_b32_e64 v177, v176
    v_mfma_f32_16x16x32_bf16 v[136:139], v[88:91], a[72:75], v[136:139]
    ds_read_b64_tr_b16 v[84:85], v14 offset:57344
    v_mov_b32_e64 v178, v176
    v_mfma_f32_16x16x32_bf16 v[136:139], v[92:95], a[88:91], v[136:139]
    v_mov_b32_e64 v179, v176
    v_and_b32 v181, 0x70, v180
    v_mfma_f32_16x16x32_bf16 v[140:143], v[88:91], a[76:79], v[140:143]
    ds_read_b64_tr_b16 v[86:87], v14 offset:57856
    v_mul_u32_u24_e64 v181, 12, v181
    v_mfma_f32_16x16x32_bf16 v[140:143], v[92:95], a[92:95], v[140:143]
    buffer_load_dwordx4 v4, s[28:31], s67 offen offset:1024 lds
    v_mfma_f32_16x16x32_bf16 v[144:147], v[96:99], a[64:67], v[144:147]
    ds_read_b64_tr_b16 v[88:89], v15 offset:49152
    v_lshl_add_u32 v181, v180, 2, v181
    v_mfma_f32_16x16x32_bf16 v[144:147], v[100:103], a[80:83], v[144:147]
    v_add_u32 v181, 157696, v181
    v_lshlrev_b32_e64 v193, 2, v180
    v_mfma_f32_16x16x32_bf16 v[148:151], v[96:99], a[68:71], v[148:151]
    ds_read_b64_tr_b16 v[90:91], v15 offset:49664
    v_add_u32 v193, 163328, v193
    v_mfma_f32_16x16x32_bf16 v[148:151], v[100:103], a[84:87], v[148:151]
    buffer_load_dwordx4 v5, s[28:31], s67 offen offset:2048 lds
    v_lshlrev_b32_e64 v180, 4, v180
    v_mfma_f32_16x16x32_bf16 v[152:155], v[96:99], a[72:75], v[152:155]
    ds_read_b64_tr_b16 v[92:93], v15 offset:57344
    v_add_u32 v180, 155648, v180
    v_mfma_f32_16x16x32_bf16 v[152:155], v[100:103], a[88:91], v[152:155]
    ds_write_b128 v180, v[176:179]
    v_mfma_f32_16x16x32_bf16 v[156:159], v[96:99], a[76:79], v[156:159]
    ds_read_b64_tr_b16 v[94:95], v15 offset:57856
    v_mfma_f32_16x16x32_bf16 v[156:159], v[100:103], a[92:95], v[156:159]
    ds_write_b32 v181, v176
    s_waitcnt lgkmcnt(10)
    v_mfma_f32_16x16x32_bf16 v[160:163], v[104:107], a[64:67], v[160:163]
    ds_read_b64_tr_b16 v[96:97], v14 offset:51200
    v_mfma_f32_16x16x32_bf16 v[160:163], v[108:111], a[80:83], v[160:163]
    buffer_load_dwordx4 v6, s[28:31], s67 offen offset:3072 lds
    s_add_u32 s67, s92, 1327104
    v_mfma_f32_16x16x32_bf16 v[164:167], v[104:107], a[68:71], v[164:167]
    ds_read_b64_tr_b16 v[98:99], v14 offset:51712
    s_add_u32 m0, s70, 98304
    v_mfma_f32_16x16x32_bf16 v[164:167], v[108:111], a[84:87], v[164:167]
    ds_write_b32 v193, v176
    s_mul_i32 s71, s58, 3072
    v_mfma_f32_16x16x32_bf16 v[168:171], v[104:107], a[72:75], v[168:171]
    ds_read_b64_tr_b16 v[100:101], v14 offset:59392
    s_lshl_b32 s65, s56, 4
    v_mfma_f32_16x16x32_bf16 v[168:171], v[108:111], a[88:91], v[168:171]
    buffer_load_dwordx4 v3, s[28:31], s67 offen offset:0 lds
    s_add_u32 s65, s65, s57
    v_mfma_f32_16x16x32_bf16 v[172:175], v[104:107], a[76:79], v[172:175]
    ds_read_b64_tr_b16 v[102:103], v14 offset:59904
    v_mov_b32 v207, 0
    v_mfma_f32_16x16x32_bf16 v[172:175], v[108:111], a[92:95], v[172:175]
    s_xor_b32 s7, s6, 128
    s_waitcnt lgkmcnt(11)
    v_mfma_f32_16x16x32_bf16 v[112:115], v[80:83], a[96:99], v[112:115]
    ds_read_b64_tr_b16 v[104:105], v15 offset:51200
    s_mul_i32 s79, s65, 73728
    v_mfma_f32_16x16x32_bf16 v[112:115], v[84:87], a[112:115], v[112:115]
    s_xor_b32 s65, s65, 1
    s_mul_i32 s81, s65, 73728
    v_mfma_f32_16x16x32_bf16 v[116:119], v[80:83], a[100:103], v[116:119]
    ds_read_b64_tr_b16 v[106:107], v15 offset:51712
    s_lshl_b32 s65, s59, 12
    v_mfma_f32_16x16x32_bf16 v[116:119], v[84:87], a[116:119], v[116:119]
    buffer_load_dwordx4 v4, s[28:31], s67 offen offset:1024 lds
    s_add_u32 s79, s79, s65
    v_mfma_f32_16x16x32_bf16 v[120:123], v[80:83], a[104:107], v[120:123]
    ds_read_b64_tr_b16 v[108:109], v15 offset:59392
    s_lshl_b32 s66, s60, 11
    v_mfma_f32_16x16x32_bf16 v[120:123], v[84:87], a[120:123], v[120:123]
    s_add_u32 s80, s79, s66
    s_add_u32 s80, s80, 65536
    v_mfma_f32_16x16x32_bf16 v[124:127], v[80:83], a[108:111], v[124:127]
    ds_read_b64_tr_b16 v[110:111], v15 offset:59904
    s_add_u32 s81, s81, s65
    v_mfma_f32_16x16x32_bf16 v[124:127], v[84:87], a[124:127], v[124:127]
    v_add_u32 v14, 0x10000, v14
    s_waitcnt vmcnt(8) lgkmcnt(10)
    s_barrier
    v_mfma_f32_16x16x32_bf16 v[128:131], v[88:91], a[96:99], v[128:131]
    ds_read_b64_tr_b16 v[80:81], v14 offset:0
    s_lshl_b32 s66, s60, 13
    v_mfma_f32_16x16x32_bf16 v[128:131], v[92:95], a[112:115], v[128:131]
    buffer_load_dwordx4 v5, s[28:31], s67 offen offset:2048 lds
    s_add_u32 s79, s79, s66
    v_mfma_f32_16x16x32_bf16 v[132:135], v[88:91], a[100:103], v[132:135]
    ds_read_b64_tr_b16 v[82:83], v14 offset:512
    s_mul_i32 s73, s62, 1152
    v_mfma_f32_16x16x32_bf16 v[132:135], v[92:95], a[116:119], v[132:135]
    s_lshl_b32 s65, s61, 6
    s_add_u32 s65, s65, 512
    v_mfma_f32_16x16x32_bf16 v[136:139], v[88:91], a[104:107], v[136:139]
    ds_read_b64_tr_b16 v[84:85], v14 offset:8192
    s_add_u32 s73, s73, s65
    v_mfma_f32_16x16x32_bf16 v[136:139], v[92:95], a[120:123], v[136:139]
    buffer_load_dwordx4 v6, s[28:31], s67 offen offset:3072 lds
    s_add_u32 s67, s92, 1548288
    v_mfma_f32_16x16x32_bf16 v[140:143], v[88:91], a[108:111], v[140:143]
    ds_read_b64_tr_b16 v[86:87], v14 offset:8704
    s_add_u32 m0, s70, 114688
    v_mfma_f32_16x16x32_bf16 v[140:143], v[92:95], a[124:127], v[140:143]
    v_add_u32 v15, 0x10000, v15
    s_waitcnt lgkmcnt(8)
    v_mfma_f32_16x16x32_bf16 v[144:147], v[96:99], a[96:99], v[144:147]
    ds_read_b64_tr_b16 v[88:89], v15 offset:0
    s_mul_i32 s66, s59, 442368
    v_mfma_f32_16x16x32_bf16 v[144:147], v[100:103], a[112:115], v[144:147]
    buffer_load_dwordx4 v3, s[28:31], s67 offen offset:0 lds
    s_add_u32 s73, s73, s66
    v_mfma_f32_16x16x32_bf16 v[148:151], v[96:99], a[100:103], v[148:151]
    ds_read_b64_tr_b16 v[90:91], v15 offset:512
    s_mul_i32 s65, s63, 55296
    v_mfma_f32_16x16x32_bf16 v[148:151], v[100:103], a[116:119], v[148:151]
    s_lshl_b32 s66, s88, 12
    s_add_u32 s65, s65, s66
    v_mfma_f32_16x16x32_bf16 v[152:155], v[96:99], a[104:107], v[152:155]
    ds_read_b64_tr_b16 v[92:93], v15 offset:8192
    s_lshl_b32 s66, s60, 11
    v_mfma_f32_16x16x32_bf16 v[152:155], v[100:103], a[120:123], v[152:155]
    s_add_u32 s65, s65, s66
    s_add_u32 s65, s65, 0x241b000
    v_mfma_f32_16x16x32_bf16 v[156:159], v[96:99], a[108:111], v[156:159]
    ds_read_b64_tr_b16 v[94:95], v15 offset:8704
    s_and_b32 s3, s3, 2
    v_mfma_f32_16x16x32_bf16 v[156:159], v[100:103], a[124:127], v[156:159]
    buffer_load_dwordx4 v4, s[28:31], s67 offen offset:1024 lds
    s_waitcnt lgkmcnt(8)
    v_mfma_f32_16x16x32_bf16 v[160:163], v[104:107], a[96:99], v[160:163]
    ds_read_b64_tr_b16 v[96:97], v14 offset:2048
    s_mul_i32 s66, s3, 55296
    v_mfma_f32_16x16x32_bf16 v[160:163], v[108:111], a[112:115], v[160:163]
    s_add_u32 s65, s65, s66
    s_sub_u32 s89, 1, s3
    v_mfma_f32_16x16x32_bf16 v[164:167], v[104:107], a[100:103], v[164:167]
    ds_read_b64_tr_b16 v[98:99], v14 offset:2560
    s_mul_i32 s89, s89, 110592
    v_mfma_f32_16x16x32_bf16 v[164:167], v[108:111], a[116:119], v[164:167]
    buffer_load_dwordx4 v5, s[28:31], s67 offen offset:2048 lds
    s_lshl_b32 s3, s3, 10
    v_mfma_f32_16x16x32_bf16 v[168:171], v[104:107], a[104:107], v[168:171]
    ds_read_b64_tr_b16 v[100:101], v14 offset:10240
    s_add_u32 s91, s91, 4096
    v_mfma_f32_16x16x32_bf16 v[168:171], v[108:111], a[120:123], v[168:171]
    s_mov_b32 s87, s65
    s_mul_i32 s10, s90, 331776
    v_mfma_f32_16x16x32_bf16 v[172:175], v[104:107], a[108:111], v[172:175]
    ds_read_b64_tr_b16 v[102:103], v14 offset:10752
    s_mul_i32 s65, s86, 20736
    v_mfma_f32_16x16x32_bf16 v[172:175], v[108:111], a[124:127], v[172:175]
    s_add_u32 s10, s10, s65
    s_waitcnt lgkmcnt(8)
    v_mfma_f32_16x16x32_bf16 v[112:115], v[80:83], a[128:131], v[112:115]
    ds_read_b64_tr_b16 v[104:105], v15 offset:2048
    s_mul_i32 s65, s58, 5248
    v_mfma_f32_16x16x32_bf16 v[112:115], v[84:87], a[144:147], v[112:115]
    buffer_load_dwordx4 v6, s[28:31], s67 offen offset:3072 lds
    s_add_u32 s67, s92, 1769472
    v_mfma_f32_16x16x32_bf16 v[116:119], v[80:83], a[132:135], v[116:119]
    ds_read_b64_tr_b16 v[106:107], v15 offset:2560
    s_add_u32 m0, s70, 131072
    v_mfma_f32_16x16x32_bf16 v[116:119], v[84:87], a[148:151], v[116:119]
    s_add_u32 s10, s10, s65
    v_lshlrev_b32_e64 v2, 4, v1
    v_mfma_f32_16x16x32_bf16 v[120:123], v[80:83], a[136:139], v[120:123]
    ds_read_b64_tr_b16 v[108:109], v15 offset:10240
    v_lshrrev_b32_e64 v182, 3, v1
    v_mfma_f32_16x16x32_bf16 v[120:123], v[84:87], a[152:155], v[120:123]
    buffer_load_dwordx4 v3, s[28:31], s67 offen offset:0 lds
    v_and_b32_e64 v183, 7, v1
    v_mfma_f32_16x16x32_bf16 v[124:127], v[80:83], a[140:143], v[124:127]
    ds_read_b64_tr_b16 v[110:111], v15 offset:10752
    v_lshrrev_b32_e64 v184, 4, v1
    v_mfma_f32_16x16x32_bf16 v[124:127], v[84:87], a[156:159], v[124:127]
    s_waitcnt vmcnt(9) lgkmcnt(8)
    s_barrier
    v_mfma_f32_16x16x32_bf16 v[128:131], v[88:91], a[128:131], v[128:131]
    ds_read_b64_tr_b16 v[80:81], v14 offset:16384
    v_and_b32_e64 v185, 15, v1
    v_mfma_f32_16x16x32_bf16 v[128:131], v[92:95], a[144:147], v[128:131]
    buffer_load_dwordx4 v4, s[28:31], s67 offen offset:1024 lds
    v_and_b32_e64 v186, 6, v182
    v_mfma_f32_16x16x32_bf16 v[132:135], v[88:91], a[132:135], v[132:135]
    ds_read_b64_tr_b16 v[82:83], v14 offset:16896
    v_xor_b32_e64 v186, v183, v186
    v_mfma_f32_16x16x32_bf16 v[132:135], v[92:95], a[148:151], v[132:135]
    v_mul_u32_u24 v187, 1152, v182
    v_lshl_add_u32 v187, v186, 4, v187
    v_mfma_f32_16x16x32_bf16 v[136:139], v[88:91], a[136:139], v[136:139]
    ds_read_b64_tr_b16 v[84:85], v14 offset:24576
    v_add_u32 v16, 2048, v187
    v_mfma_f32_16x16x32_bf16 v[136:139], v[92:95], a[152:155], v[136:139]
    v_add_u32 v17, 10240, v187
    v_add_u32 v18, 128, v187
    v_mfma_f32_16x16x32_bf16 v[140:143], v[88:91], a[140:143], v[140:143]
    ds_read_b64_tr_b16 v[86:87], v14 offset:25088
    v_add_u32 v19, 8320, v187
    v_mfma_f32_16x16x32_bf16 v[140:143], v[92:95], a[156:159], v[140:143]
    buffer_load_dwordx4 v5, s[28:31], s67 offen offset:2048 lds
    s_waitcnt lgkmcnt(8)
    v_mfma_f32_16x16x32_bf16 v[144:147], v[96:99], a[128:131], v[144:147]
    ds_read_b64_tr_b16 v[88:89], v15 offset:16384
    v_lshrrev_b32 v186, 2, v1
    v_mfma_f32_16x16x32_bf16 v[144:147], v[100:103], a[144:147], v[144:147]
    v_and_b32 v187, 3, v1
    v_and_b32 v188, 2, v184
    v_mfma_f32_16x16x32_bf16 v[148:151], v[96:99], a[132:135], v[148:151]
    ds_read_b64_tr_b16 v[90:91], v15 offset:16896
    v_xor_b32_e64 v188, v187, v188
    v_mfma_f32_16x16x32_bf16 v[148:151], v[100:103], a[148:151], v[148:151]
    buffer_load_dwordx4 v6, s[28:31], s67 offen offset:3072 lds
    s_add_u32 s67, s72, 0
    v_mfma_f32_16x16x32_bf16 v[152:155], v[96:99], a[136:139], v[152:155]
    ds_read_b64_tr_b16 v[92:93], v15 offset:24576
    s_add_u32 m0, s70, 0
    v_mfma_f32_16x16x32_bf16 v[152:155], v[100:103], a[152:155], v[152:155]
    v_mul_u32_u24 v190, 9216, v186
    v_lshl_add_u32 v10, v188, 4, v190
    v_mfma_f32_16x16x32_bf16 v[156:159], v[96:99], a[140:143], v[156:159]
    ds_read_b64_tr_b16 v[94:95], v15 offset:25088
    v_and_b32_e64 v188, 1, v184
    v_mfma_f32_16x16x32_bf16 v[156:159], v[100:103], a[156:159], v[156:159]
    v_lshlrev_b32 v188, 1, v188
    s_waitcnt lgkmcnt(8)
    v_mfma_f32_16x16x32_bf16 v[160:163], v[104:107], a[128:131], v[160:163]
    ds_read_b64_tr_b16 v[96:97], v14 offset:18432
    v_xor_b32_e64 v188, v187, v188
    v_mfma_f32_16x16x32_bf16 v[160:163], v[108:111], a[144:147], v[160:163]
    buffer_load_dwordx4 v8, s[32:35], s67 offen offset:0 lds
    v_mul_u32_u24 v190, 1152, v186
    v_mfma_f32_16x16x32_bf16 v[164:167], v[104:107], a[132:135], v[164:167]
    ds_read_b64_tr_b16 v[98:99], v14 offset:18944
    v_lshl_add_u32 v7, v188, 4, v190
    v_mfma_f32_16x16x32_bf16 v[164:167], v[108:111], a[148:151], v[164:167]
    v_lshrrev_b32 v186, 2, v185
    v_and_b32 v188, 1, v184
    v_mfma_f32_16x16x32_bf16 v[168:171], v[104:107], a[136:139], v[168:171]
    ds_read_b64_tr_b16 v[100:101], v14 offset:26624
    v_lshrrev_b32_e64 v192, 1, v184
    v_mfma_f32_16x16x32_bf16 v[168:171], v[108:111], a[152:155], v[168:171]
    buffer_load_dwordx4 v9, s[32:35], s67 offen offset:1024 lds
    v_lshl_add_u32 v190, v184, 3, v186
    v_mfma_f32_16x16x32_bf16 v[172:175], v[104:107], a[140:143], v[172:175]
    ds_read_b64_tr_b16 v[102:103], v14 offset:27136
    v_lshlrev_b32_e64 v190, 6, v190
    v_mfma_f32_16x16x32_bf16 v[172:175], v[108:111], a[156:159], v[172:175]
    v_xor_b32 v191, s60, v188
    s_waitcnt lgkmcnt(8)
    v_mfma_f32_16x16x32_bf16 v[112:115], v[80:83], a[160:163], v[112:115]
    ds_read_b64_tr_b16 v[104:105], v15 offset:18432
    v_lshl_add_u32 v190, v191, 5, v190
    v_mfma_f32_16x16x32_bf16 v[112:115], v[84:87], a[176:179], v[112:115]
    buffer_load_dwordx4 v8, s[36:39], s67 offen offset:2048 lds
    v_lshl_add_u32 v13, v187, 3, v190
    v_mfma_f32_16x16x32_bf16 v[116:119], v[80:83], a[164:167], v[116:119]
    ds_read_b64_tr_b16 v[106:107], v15 offset:18944
    v_lshl_add_u32 v190, v184, 2, v186
    v_mfma_f32_16x16x32_bf16 v[116:119], v[84:87], a[180:183], v[116:119]
    v_lshlrev_b32_e64 v190, 6, v190
    v_lshl_add_u32 v190, v191, 5, v190
    v_mfma_f32_16x16x32_bf16 v[120:123], v[80:83], a[168:171], v[120:123]
    ds_read_b64_tr_b16 v[108:109], v15 offset:26624
    v_lshl_add_u32 v22, v187, 3, v190
    v_mfma_f32_16x16x32_bf16 v[120:123], v[84:87], a[184:187], v[120:123]
    v_lshl_add_u32 v190, v188, 2, v186
    v_lshrrev_b32_e64 v191, 1, v190
    v_mfma_f32_16x16x32_bf16 v[124:127], v[80:83], a[172:175], v[124:127]
    ds_read_b64_tr_b16 v[110:111], v15 offset:27136
    s_lshl_b32 s65, s60, 1
    v_mfma_f32_16x16x32_bf16 v[124:127], v[84:87], a[188:191], v[124:127]
    s_waitcnt vmcnt(11) lgkmcnt(8)
    s_barrier
    v_mfma_f32_16x16x32_bf16 v[128:131], v[88:91], a[160:163], v[128:131]
    ds_read_b64_tr_b16 v[80:81], v14 offset:32768
    v_xor_b32 v191, s65, v191
    v_mfma_f32_16x16x32_bf16 v[128:131], v[92:95], a[176:179], v[128:131]
    buffer_load_dwordx4 v9, s[36:39], s67 offen offset:3072 lds
    s_add_u32 s67, s72, 589824
    v_mfma_f32_16x16x32_bf16 v[132:135], v[88:91], a[164:167], v[132:135]
    ds_read_b64_tr_b16 v[82:83], v14 offset:33280
    s_add_u32 m0, s70, 16384
    v_mfma_f32_16x16x32_bf16 v[132:135], v[92:95], a[180:183], v[132:135]
    v_lshlrev_b32_e64 v190, 7, v190
    v_lshl_add_u32 v190, v192, 10, v190
    v_mfma_f32_16x16x32_bf16 v[136:139], v[88:91], a[168:171], v[136:139]
    ds_read_b64_tr_b16 v[84:85], v14 offset:40960
    v_lshl_add_u32 v190, v191, 5, v190
    v_mfma_f32_16x16x32_bf16 v[136:139], v[92:95], a[184:187], v[136:139]
    buffer_load_dwordx4 v8, s[32:35], s67 offen offset:0 lds
    v_lshl_add_u32 v20, v187, 3, v190
    v_mfma_f32_16x16x32_bf16 v[140:143], v[88:91], a[172:175], v[140:143]
    ds_read_b64_tr_b16 v[86:87], v14 offset:41472
    v_xor_b32_e64 v21, 32, v20
    v_mfma_f32_16x16x32_bf16 v[140:143], v[92:95], a[188:191], v[140:143]
    v_mov_b32 v189, 0x10000000
    s_waitcnt lgkmcnt(8)
    v_mfma_f32_16x16x32_bf16 v[144:147], v[96:99], a[160:163], v[144:147]
    ds_read_b64_tr_b16 v[88:89], v15 offset:32768
    v_cmp_eq_u32 vcc, 0, v184
    v_mfma_f32_16x16x32_bf16 v[144:147], v[100:103], a[176:179], v[144:147]
    buffer_load_dwordx4 v9, s[32:35], s67 offen offset:1024 lds
    v_lshlrev_b32_e64 v190, 2, v184
    v_mfma_f32_16x16x32_bf16 v[148:151], v[96:99], a[164:167], v[148:151]
    ds_read_b64_tr_b16 v[90:91], v15 offset:33280
    v_sub_u32_e64 v30, v190, v185
    v_mfma_f32_16x16x32_bf16 v[148:151], v[100:103], a[180:183], v[148:151]
    v_cndmask_b32 v31, v189, v2, vcc
    s_lshl_b32 s65, s59, 12
    v_mfma_f32_16x16x32_bf16 v[152:155], v[96:99], a[168:171], v[152:155]
    ds_read_b64_tr_b16 v[92:93], v15 offset:40960
    v_add_u32_e64 v28, s65, v2
    v_mfma_f32_16x16x32_bf16 v[152:155], v[100:103], a[184:187], v[152:155]
    s_cmp_ge_u32 s88, 18
    s_cselect_b64 vcc, -1, 0
    v_mfma_f32_16x16x32_bf16 v[156:159], v[96:99], a[172:175], v[156:159]
    ds_read_b64_tr_b16 v[94:95], v15 offset:41472
    v_lshlrev_b32_e64 v191, 6, v185
    v_mfma_f32_16x16x32_bf16 v[156:159], v[100:103], a[188:191], v[156:159]
    buffer_load_dwordx4 v8, s[36:39], s67 offen offset:2048 lds
    s_waitcnt lgkmcnt(8)
    v_mfma_f32_16x16x32_bf16 v[160:163], v[104:107], a[160:163], v[160:163]
    ds_read_b64_tr_b16 v[96:97], v14 offset:34816
    v_lshl_add_u32 v191, v184, 4, v191
    v_mfma_f32_16x16x32_bf16 v[160:163], v[108:111], a[176:179], v[160:163]
    v_cndmask_b32 v23, v2, v191, vcc
    v_lshlrev_b32_e64 v190, 4, v185
    v_mfma_f32_16x16x32_bf16 v[164:167], v[104:107], a[164:167], v[164:167]
    ds_read_b64_tr_b16 v[98:99], v14 offset:35328
    v_add_u32 v190, 155648, v190
    v_mfma_f32_16x16x32_bf16 v[164:167], v[108:111], a[180:183], v[164:167]
    buffer_load_dwordx4 v9, s[36:39], s67 offen offset:3072 lds
    s_add_u32 s67, s72, 1179648
    v_mfma_f32_16x16x32_bf16 v[168:171], v[104:107], a[168:171], v[168:171]
    ds_read_b64_tr_b16 v[100:101], v14 offset:43008
    s_add_u32 m0, s70, 32768
    v_mfma_f32_16x16x32_bf16 v[168:171], v[108:111], a[184:187], v[168:171]
    v_lshlrev_b32_e64 v191, 4, v184
    v_add_u32 v191, 157696, v191
    v_mfma_f32_16x16x32_bf16 v[172:175], v[104:107], a[172:175], v[172:175]
    ds_read_b64_tr_b16 v[102:103], v14 offset:43520
    v_cndmask_b32_e64 v190, v190, v191, vcc
    v_mfma_f32_16x16x32_bf16 v[172:175], v[108:111], a[188:191], v[172:175]
    s_lshl_b32 s65, s59, 10
    s_waitcnt lgkmcnt(8)
    v_mfma_f32_16x16x32_bf16 v[112:115], v[80:83], a[192:195], v[112:115]
    ds_read_b64_tr_b16 v[104:105], v15 offset:34816
    v_add_u32_e64 v25, s65, v190
    v_mfma_f32_16x16x32_bf16 v[112:115], v[84:87], a[208:211], v[112:115]
    buffer_load_dwordx4 v8, s[32:35], s67 offen offset:0 lds
    s_lshl_b32 s65, s59, 12
    v_mfma_f32_16x16x32_bf16 v[116:119], v[80:83], a[196:199], v[116:119]
    ds_read_b64_tr_b16 v[106:107], v15 offset:35328
    s_lshl_b32 s66, s56, 3
    v_mfma_f32_16x16x32_bf16 v[116:119], v[84:87], a[212:215], v[116:119]
    s_add_u32 s66, s66, s62
    s_mul_i32 s82, s66, 147456
    v_mfma_f32_16x16x32_bf16 v[120:123], v[80:83], a[200:203], v[120:123]
    ds_read_b64_tr_b16 v[108:109], v15 offset:43008
    s_add_u32 s82, s82, s65
    v_mfma_f32_16x16x32_bf16 v[120:123], v[84:87], a[216:219], v[120:123]
    buffer_load_dwordx4 v9, s[32:35], s67 offen offset:1024 lds
    s_add_u32 s82, s82, 0x0
    v_mfma_f32_16x16x32_bf16 v[124:127], v[80:83], a[204:207], v[124:127]
    ds_read_b64_tr_b16 v[110:111], v15 offset:43520
    s_sub_u32 s66, 9, s61
    v_mfma_f32_16x16x32_bf16 v[124:127], v[84:87], a[220:223], v[124:127]
    s_waitcnt vmcnt(14) lgkmcnt(8)
    s_barrier
    v_mfma_f32_16x16x32_bf16 v[128:131], v[88:91], a[192:195], v[128:131]
    ds_read_b64_tr_b16 v[80:81], v14 offset:49152
    s_lshl_b32 s66, s66, 13
    v_mfma_f32_16x16x32_bf16 v[128:131], v[92:95], a[208:211], v[128:131]
    buffer_load_dwordx4 v8, s[36:39], s67 offen offset:2048 lds
    s_add_u32 s83, s82, s66
    v_mfma_f32_16x16x32_bf16 v[132:135], v[88:91], a[196:199], v[132:135]
    ds_read_b64_tr_b16 v[82:83], v14 offset:49664
    s_lshl_b32 s66, s60, 11
    v_mfma_f32_16x16x32_bf16 v[132:135], v[92:95], a[212:215], v[132:135]
    s_xor_b32 s66, s66, s3
    s_add_u32 s83, s83, s66
    v_mfma_f32_16x16x32_bf16 v[136:139], v[88:91], a[200:203], v[136:139]
    ds_read_b64_tr_b16 v[84:85], v14 offset:57344
    s_add_u32 s82, s82, s3
    v_mfma_f32_16x16x32_bf16 v[136:139], v[92:95], a[216:219], v[136:139]
    s_mul_i32 s66, s61, 10
    s_add_u32 s66, s66, s60
    v_mfma_f32_16x16x32_bf16 v[140:143], v[88:91], a[204:207], v[140:143]
    ds_read_b64_tr_b16 v[86:87], v14 offset:57856
    s_sub_u32 s66, 17, s66
    v_mfma_f32_16x16x32_bf16 v[140:143], v[92:95], a[220:223], v[140:143]
    buffer_load_dwordx4 v9, s[36:39], s67 offen offset:3072 lds
    s_waitcnt lgkmcnt(8)
    v_mfma_f32_16x16x32_bf16 v[144:147], v[96:99], a[192:195], v[144:147]
    ds_read_b64_tr_b16 v[88:89], v15 offset:49152
    s_add_u32 s67, s72, 1769472
    v_mfma_f32_16x16x32_bf16 v[144:147], v[100:103], a[208:211], v[144:147]
    s_add_u32 m0, s70, 49152
    s_lshl_b32 s66, s66, 13
    v_mfma_f32_16x16x32_bf16 v[148:151], v[96:99], a[196:199], v[148:151]
    ds_read_b64_tr_b16 v[90:91], v15 offset:49664
    s_add_u32 s82, s82, s66
    v_mfma_f32_16x16x32_bf16 v[148:151], v[100:103], a[212:215], v[148:151]
    buffer_load_dwordx4 v8, s[32:35], s67 offen offset:0 lds
    s_lshl_b32 s65, s61, 6
    v_mfma_f32_16x16x32_bf16 v[152:155], v[96:99], a[200:203], v[152:155]
    ds_read_b64_tr_b16 v[92:93], v15 offset:57344
    s_add_u32 s65, s65, 512
    v_mfma_f32_16x16x32_bf16 v[152:155], v[100:103], a[216:219], v[152:155]
    s_mul_i32 s64, s62, 663552
    s_mul_i32 s66, s61, 626688
    v_mfma_f32_16x16x32_bf16 v[156:159], v[96:99], a[204:207], v[156:159]
    ds_read_b64_tr_b16 v[94:95], v15 offset:57856
    s_add_u32 s64, s64, s66
    v_mfma_f32_16x16x32_bf16 v[156:159], v[100:103], a[220:223], v[156:159]
    s_mul_i32 s74, s61, 640
    s_waitcnt lgkmcnt(8)
    v_mfma_f32_16x16x32_bf16 v[160:163], v[104:107], a[192:195], v[160:163]
    ds_read_b64_tr_b16 v[96:97], v14 offset:51200
    s_add_u32 s74, s74, s64
    v_mfma_f32_16x16x32_bf16 v[160:163], v[108:111], a[208:211], v[160:163]
    buffer_load_dwordx4 v9, s[32:35], s67 offen offset:1024 lds
    s_mul_i32 s66, s60, s75
    v_mfma_f32_16x16x32_bf16 v[164:167], v[104:107], a[196:199], v[164:167]
    ds_read_b64_tr_b16 v[98:99], v14 offset:51712
    s_mul_i32 s66, s66, 36864
    v_mfma_f32_16x16x32_bf16 v[164:167], v[108:111], a[212:215], v[164:167]
    s_add_u32 s74, s74, s66
    s_mul_i32 s66, s59, 18432
    v_mfma_f32_16x16x32_bf16 v[168:171], v[104:107], a[200:203], v[168:171]
    ds_read_b64_tr_b16 v[100:101], v14 offset:59392
    s_add_u32 s74, s74, s66
    v_mfma_f32_16x16x32_bf16 v[168:171], v[108:111], a[216:219], v[168:171]
    buffer_load_dwordx4 v8, s[36:39], s67 offen offset:2048 lds
    s_add_u32 s64, s64, s65
    v_mfma_f32_16x16x32_bf16 v[172:175], v[104:107], a[204:207], v[172:175]
    ds_read_b64_tr_b16 v[102:103], v14 offset:59904
    v_mfma_f32_16x16x32_bf16 v[172:175], v[108:111], a[220:223], v[172:175]
    s_waitcnt lgkmcnt(8)
    v_mfma_f32_16x16x32_bf16 v[112:115], v[80:83], a[224:227], v[112:115]
    ds_read_b64_tr_b16 v[104:105], v15 offset:51200
    v_mfma_f32_16x16x32_bf16 v[112:115], v[84:87], a[240:243], v[112:115]
    buffer_load_dwordx4 v9, s[36:39], s67 offen offset:3072 lds
    s_add_u32 s67, s72, 2359296
    v_mfma_f32_16x16x32_bf16 v[116:119], v[80:83], a[228:231], v[116:119]
    ds_read_b64_tr_b16 v[106:107], v15 offset:51712
    s_add_u32 m0, s70, 65536
    v_mfma_f32_16x16x32_bf16 v[116:119], v[84:87], a[244:247], v[116:119]
    v_mfma_f32_16x16x32_bf16 v[120:123], v[80:83], a[232:235], v[120:123]
    ds_read_b64_tr_b16 v[108:109], v15 offset:59392
    v_mfma_f32_16x16x32_bf16 v[120:123], v[84:87], a[248:251], v[120:123]
    v_mfma_f32_16x16x32_bf16 v[124:127], v[80:83], a[236:239], v[124:127]
    ds_read_b64_tr_b16 v[110:111], v15 offset:59904
    v_mfma_f32_16x16x32_bf16 v[124:127], v[84:87], a[252:255], v[124:127]
    v_add_u32 v14, 0x10000, v14
    s_waitcnt vmcnt(16) lgkmcnt(8)
    s_barrier
    v_mfma_f32_16x16x32_bf16 v[128:131], v[88:91], a[224:227], v[128:131]
    ds_read_b64_tr_b16 v[80:81], v14 offset:0
    v_mfma_f32_16x16x32_bf16 v[128:131], v[92:95], a[240:243], v[128:131]
    buffer_load_dwordx4 v8, s[32:35], s67 offen offset:0 lds
    v_mfma_f32_16x16x32_bf16 v[132:135], v[88:91], a[228:231], v[132:135]
    ds_read_b64_tr_b16 v[82:83], v14 offset:512
    v_mfma_f32_16x16x32_bf16 v[132:135], v[92:95], a[244:247], v[132:135]
    v_mfma_f32_16x16x32_bf16 v[136:139], v[88:91], a[232:235], v[136:139]
    ds_read_b64_tr_b16 v[84:85], v14 offset:8192
    v_mfma_f32_16x16x32_bf16 v[136:139], v[92:95], a[248:251], v[136:139]
    buffer_load_dwordx4 v9, s[32:35], s67 offen offset:1024 lds
    v_mfma_f32_16x16x32_bf16 v[140:143], v[88:91], a[236:239], v[140:143]
    ds_read_b64_tr_b16 v[86:87], v14 offset:8704
    v_mfma_f32_16x16x32_bf16 v[140:143], v[92:95], a[252:255], v[140:143]
    v_add_u32 v15, 0x10000, v15
    s_waitcnt lgkmcnt(8)
    v_mfma_f32_16x16x32_bf16 v[144:147], v[96:99], a[224:227], v[144:147]
    ds_read_b64_tr_b16 v[88:89], v15 offset:0
    v_add_u32_e64 v68, v68, v69
    v_mfma_f32_16x16x32_bf16 v[144:147], v[100:103], a[240:243], v[144:147]
    buffer_load_dwordx4 v8, s[36:39], s67 offen offset:2048 lds
    v_mfma_f32_16x16x32_bf16 v[148:151], v[96:99], a[228:231], v[148:151]
    ds_read_b64_tr_b16 v[90:91], v15 offset:512
    v_mfma_f32_16x16x32_bf16 v[148:151], v[100:103], a[244:247], v[148:151]
    s_cmp_eq_u32 s18, 2
    s_cselect_b32 s21, s20, 0x10000000
    v_mfma_f32_16x16x32_bf16 v[152:155], v[96:99], a[232:235], v[152:155]
    ds_read_b64_tr_b16 v[92:93], v15 offset:8192
    v_mfma_f32_16x16x32_bf16 v[152:155], v[100:103], a[248:251], v[152:155]
    v_mfma_f32_16x16x32_bf16 v[156:159], v[96:99], a[236:239], v[156:159]
    ds_read_b64_tr_b16 v[94:95], v15 offset:8704
    v_mfma_f32_16x16x32_bf16 v[156:159], v[100:103], a[252:255], v[156:159]
    buffer_load_dwordx4 v9, s[36:39], s67 offen offset:3072 lds
    s_waitcnt lgkmcnt(8)
    v_mfma_f32_16x16x32_bf16 v[160:163], v[104:107], a[224:227], v[160:163]
    ds_read_b64_tr_b16 v[96:97], v14 offset:2048
    s_add_u32 s67, s72, 2949120
    v_mfma_f32_16x16x32_bf16 v[160:163], v[108:111], a[240:243], v[160:163]
    s_add_u32 m0, s70, 81920
    v_mfma_f32_16x16x32_bf16 v[164:167], v[104:107], a[228:231], v[164:167]
    ds_read_b64_tr_b16 v[98:99], v14 offset:2560
    v_mfma_f32_16x16x32_bf16 v[164:167], v[108:111], a[244:247], v[164:167]
    buffer_load_dwordx4 v8, s[32:35], s67 offen offset:0 lds
    v_mfma_f32_16x16x32_bf16 v[168:171], v[104:107], a[232:235], v[168:171]
    ds_read_b64_tr_b16 v[100:101], v14 offset:10240
    v_mfma_f32_16x16x32_bf16 v[168:171], v[108:111], a[248:251], v[168:171]
    v_mfma_f32_16x16x32_bf16 v[172:175], v[104:107], a[236:239], v[172:175]
    ds_read_b64_tr_b16 v[102:103], v14 offset:10752
    v_mfma_f32_16x16x32_bf16 v[172:175], v[108:111], a[252:255], v[172:175]
    s_waitcnt lgkmcnt(8)
    v_mfma_f32_16x16x32_bf16 v[112:115], v[80:83], v[32:35], v[112:115]
    ds_read_b64_tr_b16 v[104:105], v15 offset:2048
    v_mfma_f32_16x16x32_bf16 v[112:115], v[84:87], v[48:51], v[112:115]
    buffer_load_dword v0, v68, s[32:35], s21 offen offset:0
    v_mfma_f32_16x16x32_bf16 v[116:119], v[80:83], v[36:39], v[116:119]
    ds_read_b64_tr_b16 v[106:107], v15 offset:2560
    v_mfma_f32_16x16x32_bf16 v[116:119], v[84:87], v[52:55], v[116:119]
    s_cmp_eq_u32 s18, 3
    s_cselect_b32 s21, s20, 0x10000000
    v_mfma_f32_16x16x32_bf16 v[120:123], v[80:83], v[40:43], v[120:123]
    ds_read_b64_tr_b16 v[108:109], v15 offset:10240
    v_mfma_f32_16x16x32_bf16 v[120:123], v[84:87], v[56:59], v[120:123]
    buffer_load_dword v0, v68, s[36:39], s21 offen offset:2048
    v_mfma_f32_16x16x32_bf16 v[124:127], v[80:83], v[44:47], v[124:127]
    ds_read_b64_tr_b16 v[110:111], v15 offset:10752
    v_mfma_f32_16x16x32_bf16 v[124:127], v[84:87], v[60:63], v[124:127]
    s_waitcnt vmcnt(19) lgkmcnt(8)
    s_barrier
    v_mfma_f32_16x16x32_bf16 v[128:131], v[88:91], v[32:35], v[128:131]
    ds_read_b64_tr_b16 v[80:81], v11 offset:0
    v_mfma_f32_16x16x32_bf16 v[128:131], v[92:95], v[48:51], v[128:131]
    v_mfma_f32_16x16x32_bf16 v[132:135], v[88:91], v[36:39], v[132:135]
    ds_read_b64_tr_b16 v[82:83], v11 offset:512
    v_mfma_f32_16x16x32_bf16 v[132:135], v[92:95], v[52:55], v[132:135]
    v_mfma_f32_16x16x32_bf16 v[136:139], v[88:91], v[40:43], v[136:139]
    ds_read_b64_tr_b16 v[84:85], v11 offset:8192
    v_mfma_f32_16x16x32_bf16 v[136:139], v[92:95], v[56:59], v[136:139]
    v_mfma_f32_16x16x32_bf16 v[140:143], v[88:91], v[44:47], v[140:143]
    ds_read_b64_tr_b16 v[86:87], v11 offset:8704
    v_mfma_f32_16x16x32_bf16 v[140:143], v[92:95], v[60:63], v[140:143]
    s_waitcnt lgkmcnt(8)
    v_mfma_f32_16x16x32_bf16 v[144:147], v[96:99], v[32:35], v[144:147]
    ds_read_b64_tr_b16 v[88:89], v12 offset:0
    v_mfma_f32_16x16x32_bf16 v[144:147], v[100:103], v[48:51], v[144:147]
    v_mfma_f32_16x16x32_bf16 v[148:151], v[96:99], v[36:39], v[148:151]
    ds_read_b64_tr_b16 v[90:91], v12 offset:512
    v_mfma_f32_16x16x32_bf16 v[148:151], v[100:103], v[52:55], v[148:151]
    v_mfma_f32_16x16x32_bf16 v[152:155], v[96:99], v[40:43], v[152:155]
    ds_read_b64_tr_b16 v[92:93], v12 offset:8192
    v_mfma_f32_16x16x32_bf16 v[152:155], v[100:103], v[56:59], v[152:155]
    v_mfma_f32_16x16x32_bf16 v[156:159], v[96:99], v[44:47], v[156:159]
    ds_read_b64_tr_b16 v[94:95], v12 offset:8704
    v_mfma_f32_16x16x32_bf16 v[156:159], v[100:103], v[60:63], v[156:159]
    s_waitcnt lgkmcnt(8)
    v_mfma_f32_16x16x32_bf16 v[160:163], v[104:107], v[32:35], v[160:163]
    ds_read_b64_tr_b16 v[96:97], v11 offset:2048
    v_mfma_f32_16x16x32_bf16 v[160:163], v[108:111], v[48:51], v[160:163]
    v_mfma_f32_16x16x32_bf16 v[164:167], v[104:107], v[36:39], v[164:167]
    ds_read_b64_tr_b16 v[98:99], v11 offset:2560
    v_mfma_f32_16x16x32_bf16 v[164:167], v[108:111], v[52:55], v[164:167]
    v_mfma_f32_16x16x32_bf16 v[168:171], v[104:107], v[40:43], v[168:171]
    ds_read_b64_tr_b16 v[100:101], v11 offset:10240
    v_mfma_f32_16x16x32_bf16 v[168:171], v[108:111], v[56:59], v[168:171]
    v_mfma_f32_16x16x32_bf16 v[172:175], v[104:107], v[44:47], v[172:175]
    ds_read_b64_tr_b16 v[102:103], v11 offset:10752
    v_mfma_f32_16x16x32_bf16 v[172:175], v[108:111], v[60:63], v[172:175]
qkv_e:
    s_waitcnt lgkmcnt(8)
    v_mfma_f32_16x16x32_bf16 v[176:179], v[80:83], a[0:3], 0
    ds_read_b64_tr_b16 v[104:105], v12 offset:2048
    v_mfma_f32_16x16x32_bf16 v[176:179], v[84:87], a[16:19], v[176:179]
    v_mfma_f32_16x16x32_bf16 v[180:183], v[80:83], a[4:7], 0
    ds_read_b64_tr_b16 v[106:107], v12 offset:2560
    v_mfma_f32_16x16x32_bf16 v[180:183], v[84:87], a[20:23], v[180:183]
    v_mfma_f32_16x16x32_bf16 v[184:187], v[80:83], a[8:11], 0
    ds_read_b64_tr_b16 v[108:109], v12 offset:10240
    v_mfma_f32_16x16x32_bf16 v[184:187], v[84:87], a[24:27], v[184:187]
    ds_read_b128 v[240:243], v25 offset:0
    v_mfma_f32_16x16x32_bf16 v[188:191], v[80:83], a[12:15], 0
    ds_read_b64_tr_b16 v[110:111], v12 offset:10752
    v_mfma_f32_16x16x32_bf16 v[188:191], v[84:87], a[28:31], v[188:191]
    s_waitcnt vmcnt(15) lgkmcnt(9)
    s_barrier
    v_mfma_f32_16x16x32_bf16 v[192:195], v[88:91], a[0:3], 0
    ds_read_b64_tr_b16 v[80:81], v11 offset:16384
    v_mfma_f32_16x16x32_bf16 v[192:195], v[92:95], a[16:19], v[192:195]
    ds_read_b128 v[244:247], v25 offset:256
    v_mfma_f32_16x16x32_bf16 v[196:199], v[88:91], a[4:7], 0
    ds_read_b64_tr_b16 v[82:83], v11 offset:16896
    v_mfma_f32_16x16x32_bf16 v[196:199], v[92:95], a[20:23], v[196:199]
    ds_read_b128 v[248:251], v25 offset:512
    v_mfma_f32_16x16x32_bf16 v[200:203], v[88:91], a[8:11], 0
    ds_read_b64_tr_b16 v[84:85], v11 offset:24576
    v_mfma_f32_16x16x32_bf16 v[200:203], v[92:95], a[24:27], v[200:203]
    ds_read_b128 v[252:255], v25 offset:768
    v_mfma_f32_16x16x32_bf16 v[204:207], v[88:91], a[12:15], 0
    ds_read_b64_tr_b16 v[86:87], v11 offset:25088
    v_mfma_f32_16x16x32_bf16 v[204:207], v[92:95], a[28:31], v[204:207]
    s_waitcnt lgkmcnt(12)
    v_mfma_f32_16x16x32_bf16 v[208:211], v[96:99], a[0:3], 0
    ds_read_b64_tr_b16 v[88:89], v12 offset:16384
    v_mfma_f32_16x16x32_bf16 v[208:211], v[100:103], a[16:19], v[208:211]
    buffer_load_dwordx4 v9, s[32:35], s67 offen offset:1024 lds
    v_mfma_f32_16x16x32_bf16 v[212:215], v[96:99], a[4:7], 0
    ds_read_b64_tr_b16 v[90:91], v12 offset:16896
    v_mfma_f32_16x16x32_bf16 v[212:215], v[100:103], a[20:23], v[212:215]
    s_waitcnt lgkmcnt(10)
    v_mul_f32 v112, v112, v240
    v_mul_f32_e64 v113, v113, v241
    v_mfma_f32_16x16x32_bf16 v[216:219], v[96:99], a[8:11], 0
    ds_read_b64_tr_b16 v[92:93], v12 offset:24576
    v_mul_f32_e64 v114, v114, v242
    v_mfma_f32_16x16x32_bf16 v[216:219], v[100:103], a[24:27], v[216:219]
    buffer_load_dwordx4 v8, s[36:39], s67 offen offset:2048 lds
    v_mul_f32_e64 v115, v115, v243
    v_mfma_f32_16x16x32_bf16 v[220:223], v[96:99], a[12:15], 0
    ds_read_b64_tr_b16 v[94:95], v12 offset:25088
    s_waitcnt lgkmcnt(9)
    v_mul_f32 v116, v116, v244
    v_mfma_f32_16x16x32_bf16 v[220:223], v[100:103], a[28:31], v[220:223]
    v_mul_f32_e64 v117, v117, v245
    v_mfma_f32_16x16x32_bf16 v[224:227], v[104:107], a[0:3], 0
    ds_read_b64_tr_b16 v[96:97], v11 offset:18432
    v_mul_f32_e64 v118, v118, v246
    v_mfma_f32_16x16x32_bf16 v[224:227], v[108:111], a[16:19], v[224:227]
    buffer_load_dwordx4 v9, s[36:39], s67 offen offset:3072 lds
    s_add_u32 s67, s72, 3538944
    v_mfma_f32_16x16x32_bf16 v[228:231], v[104:107], a[4:7], 0
    ds_read_b64_tr_b16 v[98:99], v11 offset:18944
    s_add_u32 m0, s70, 98304
    v_mfma_f32_16x16x32_bf16 v[228:231], v[108:111], a[20:23], v[228:231]
    v_mul_f32_e64 v119, v119, v247
    v_cvt_pk_bf16_f32 v112, v112, v113
    v_mfma_f32_16x16x32_bf16 v[232:235], v[104:107], a[8:11], 0
    ds_read_b64_tr_b16 v[100:101], v11 offset:26624
    v_cvt_pk_bf16_f32 v113, v114, v115
    v_mfma_f32_16x16x32_bf16 v[232:235], v[108:111], a[24:27], v[232:235]
    v_cvt_pk_bf16_f32 v114, v116, v117
    v_cvt_pk_bf16_f32 v115, v118, v119
    v_mfma_f32_16x16x32_bf16 v[236:239], v[104:107], a[12:15], 0
    ds_read_b64_tr_b16 v[102:103], v11 offset:27136
    v_mfma_f32_16x16x32_bf16 v[236:239], v[108:111], a[28:31], v[236:239]
    buffer_store_dwordx4 v[112:115], v23, s[44:47], s87 offen offset:0 sc1
    s_waitcnt lgkmcnt(8)
    v_mfma_f32_16x16x32_bf16 v[176:179], v[80:83], a[32:35], v[176:179]
    ds_read_b64_tr_b16 v[104:105], v12 offset:18432
    v_mul_f32 v128, v128, v240
    v_mfma_f32_16x16x32_bf16 v[176:179], v[84:87], a[48:51], v[176:179]
    buffer_load_dwordx4 v8, s[32:35], s67 offen offset:0 lds
    v_mul_f32_e64 v129, v129, v241
    v_mfma_f32_16x16x32_bf16 v[180:183], v[80:83], a[36:39], v[180:183]
    ds_read_b64_tr_b16 v[106:107], v12 offset:18944
    v_mul_f32_e64 v130, v130, v242
    v_mfma_f32_16x16x32_bf16 v[180:183], v[84:87], a[52:55], v[180:183]
    v_mul_f32 v131, v131, v243
    v_mul_f32 v132, v132, v244
    v_mfma_f32_16x16x32_bf16 v[184:187], v[80:83], a[40:43], v[184:187]
    ds_read_b64_tr_b16 v[108:109], v12 offset:26624
    v_mul_f32_e64 v133, v133, v245
    v_mfma_f32_16x16x32_bf16 v[184:187], v[84:87], a[56:59], v[184:187]
    buffer_load_dwordx4 v9, s[32:35], s67 offen offset:1024 lds
    v_mul_f32_e64 v134, v134, v246
    v_mfma_f32_16x16x32_bf16 v[188:191], v[80:83], a[44:47], v[188:191]
    ds_read_b64_tr_b16 v[110:111], v12 offset:27136
    v_mul_f32_e64 v135, v135, v247
    v_mfma_f32_16x16x32_bf16 v[188:191], v[84:87], a[60:63], v[188:191]
    s_waitcnt vmcnt(17) lgkmcnt(8)
    s_barrier
    v_mfma_f32_16x16x32_bf16 v[192:195], v[88:91], a[32:35], v[192:195]
    ds_read_b64_tr_b16 v[80:81], v11 offset:32768
    v_cvt_pk_bf16_f32 v128, v128, v129
    v_mfma_f32_16x16x32_bf16 v[192:195], v[92:95], a[48:51], v[192:195]
    v_cvt_pk_bf16_f32 v129, v130, v131
    v_cvt_pk_bf16_f32 v130, v132, v133
    v_mfma_f32_16x16x32_bf16 v[196:199], v[88:91], a[36:39], v[196:199]
    ds_read_b64_tr_b16 v[82:83], v11 offset:33280
    v_cvt_pk_bf16_f32 v131, v134, v135
    v_mfma_f32_16x16x32_bf16 v[196:199], v[92:95], a[52:55], v[196:199]
    buffer_store_dwordx4 v[128:131], v23, s[44:47], s87 offen offset:1024 sc1
    s_add_u32 s65, s87, s91
    v_mfma_f32_16x16x32_bf16 v[200:203], v[88:91], a[40:43], v[200:203]
    ds_read_b64_tr_b16 v[84:85], v11 offset:40960
    v_mul_f32 v144, v144, v240
    v_mfma_f32_16x16x32_bf16 v[200:203], v[92:95], a[56:59], v[200:203]
    buffer_load_dwordx4 v8, s[36:39], s67 offen offset:2048 lds
    v_mul_f32_e64 v145, v145, v241
    v_mfma_f32_16x16x32_bf16 v[204:207], v[88:91], a[44:47], v[204:207]
    ds_read_b64_tr_b16 v[86:87], v11 offset:41472
    v_mul_f32_e64 v146, v146, v242
    v_mfma_f32_16x16x32_bf16 v[204:207], v[92:95], a[60:63], v[204:207]
    v_mul_f32 v147, v147, v243
    s_waitcnt lgkmcnt(8)
    v_mfma_f32_16x16x32_bf16 v[208:211], v[96:99], a[32:35], v[208:211]
    ds_read_b64_tr_b16 v[88:89], v12 offset:32768
    v_mul_f32_e64 v148, v148, v244
    v_mfma_f32_16x16x32_bf16 v[208:211], v[100:103], a[48:51], v[208:211]
    buffer_load_dwordx4 v9, s[36:39], s67 offen offset:3072 lds
    s_add_u32 s67, s72, 4128768
    v_mfma_f32_16x16x32_bf16 v[212:215], v[96:99], a[36:39], v[212:215]
    ds_read_b64_tr_b16 v[90:91], v12 offset:33280
    s_add_u32 m0, s70, 114688
    v_mfma_f32_16x16x32_bf16 v[212:215], v[100:103], a[52:55], v[212:215]
    v_mul_f32 v149, v149, v245
    v_mul_f32 v150, v150, v246
    v_mfma_f32_16x16x32_bf16 v[216:219], v[96:99], a[40:43], v[216:219]
    ds_read_b64_tr_b16 v[92:93], v12 offset:40960
    v_mul_f32_e64 v151, v151, v247
    v_mfma_f32_16x16x32_bf16 v[216:219], v[100:103], a[56:59], v[216:219]
    v_cvt_pk_bf16_f32 v144, v144, v145
    v_cvt_pk_bf16_f32 v145, v146, v147
    v_mfma_f32_16x16x32_bf16 v[220:223], v[96:99], a[44:47], v[220:223]
    ds_read_b64_tr_b16 v[94:95], v12 offset:41472
    v_cvt_pk_bf16_f32 v146, v148, v149
    v_mfma_f32_16x16x32_bf16 v[220:223], v[100:103], a[60:63], v[220:223]
    buffer_load_dwordx4 v8, s[32:35], s67 offen offset:0 lds
    s_waitcnt lgkmcnt(8)
    v_mfma_f32_16x16x32_bf16 v[224:227], v[104:107], a[32:35], v[224:227]
    ds_read_b64_tr_b16 v[96:97], v11 offset:34816
    v_cvt_pk_bf16_f32 v147, v150, v151
    v_mfma_f32_16x16x32_bf16 v[224:227], v[108:111], a[48:51], v[224:227]
    v_mfma_f32_16x16x32_bf16 v[228:231], v[104:107], a[36:39], v[228:231]
    ds_read_b64_tr_b16 v[98:99], v11 offset:35328
    v_mfma_f32_16x16x32_bf16 v[228:231], v[108:111], a[52:55], v[228:231]
    buffer_store_dwordx4 v[144:147], v23, s[44:47], s65 offen offset:0 sc1
    v_mul_f32 v160, v160, v240
    v_mfma_f32_16x16x32_bf16 v[232:235], v[104:107], a[40:43], v[232:235]
    ds_read_b64_tr_b16 v[100:101], v11 offset:43008
    v_mul_f32_e64 v161, v161, v241
    v_mfma_f32_16x16x32_bf16 v[232:235], v[108:111], a[56:59], v[232:235]
    buffer_load_dwordx4 v9, s[32:35], s67 offen offset:1024 lds
    v_mul_f32_e64 v162, v162, v242
    v_mfma_f32_16x16x32_bf16 v[236:239], v[104:107], a[44:47], v[236:239]
    ds_read_b64_tr_b16 v[102:103], v11 offset:43520
    v_mul_f32_e64 v163, v163, v243
    v_mfma_f32_16x16x32_bf16 v[236:239], v[108:111], a[60:63], v[236:239]
    v_mul_f32 v164, v164, v244
    s_waitcnt lgkmcnt(8)
    v_mfma_f32_16x16x32_bf16 v[176:179], v[80:83], a[64:67], v[176:179]
    ds_read_b64_tr_b16 v[104:105], v12 offset:34816
    v_mul_f32_e64 v165, v165, v245
    v_mfma_f32_16x16x32_bf16 v[176:179], v[84:87], a[80:83], v[176:179]
    v_mul_f32 v166, v166, v246
    v_mul_f32 v167, v167, v247
    v_mfma_f32_16x16x32_bf16 v[180:183], v[80:83], a[68:71], v[180:183]
    ds_read_b64_tr_b16 v[106:107], v12 offset:35328
    v_cvt_pk_bf16_f32 v160, v160, v161
    v_mfma_f32_16x16x32_bf16 v[180:183], v[84:87], a[84:87], v[180:183]
    buffer_load_dwordx4 v8, s[36:39], s67 offen offset:2048 lds
    v_cvt_pk_bf16_f32 v161, v162, v163
    v_mfma_f32_16x16x32_bf16 v[184:187], v[80:83], a[72:75], v[184:187]
    ds_read_b64_tr_b16 v[108:109], v12 offset:43008
    v_cvt_pk_bf16_f32 v162, v164, v165
    v_mfma_f32_16x16x32_bf16 v[184:187], v[84:87], a[88:91], v[184:187]
    v_cvt_pk_bf16_f32 v163, v166, v167
    v_mfma_f32_16x16x32_bf16 v[188:191], v[80:83], a[76:79], v[188:191]
    ds_read_b64_tr_b16 v[110:111], v12 offset:43520
    v_mfma_f32_16x16x32_bf16 v[188:191], v[84:87], a[92:95], v[188:191]
    s_waitcnt vmcnt(20) lgkmcnt(8)
    s_barrier
    v_mfma_f32_16x16x32_bf16 v[192:195], v[88:91], a[64:67], v[192:195]
    ds_read_b64_tr_b16 v[80:81], v11 offset:49152
    v_mfma_f32_16x16x32_bf16 v[192:195], v[92:95], a[80:83], v[192:195]
    buffer_store_dwordx4 v[160:163], v23, s[44:47], s65 offen offset:1024 sc1
    s_add_u32 s87, s87, s89
    v_mfma_f32_16x16x32_bf16 v[196:199], v[88:91], a[68:71], v[196:199]
    ds_read_b64_tr_b16 v[82:83], v11 offset:49664
    v_mul_f32 v120, v120, v248
    v_mfma_f32_16x16x32_bf16 v[196:199], v[92:95], a[84:87], v[196:199]
    buffer_load_dwordx4 v9, s[36:39], s67 offen offset:3072 lds
    s_add_u32 s67, s72, 4718592
    v_mfma_f32_16x16x32_bf16 v[200:203], v[88:91], a[72:75], v[200:203]
    ds_read_b64_tr_b16 v[84:85], v11 offset:57344
    s_add_u32 m0, s70, 131072
    v_mfma_f32_16x16x32_bf16 v[200:203], v[92:95], a[88:91], v[200:203]
    v_mul_f32 v121, v121, v249
    v_mul_f32 v122, v122, v250
    v_mfma_f32_16x16x32_bf16 v[204:207], v[88:91], a[76:79], v[204:207]
    ds_read_b64_tr_b16 v[86:87], v11 offset:57856
    v_mul_f32_e64 v123, v123, v251
    v_mfma_f32_16x16x32_bf16 v[204:207], v[92:95], a[92:95], v[204:207]
    buffer_load_dwordx4 v8, s[32:35], s67 offen offset:0 lds
    s_waitcnt lgkmcnt(8)
    v_mfma_f32_16x16x32_bf16 v[208:211], v[96:99], a[64:67], v[208:211]
    ds_read_b64_tr_b16 v[88:89], v12 offset:49152
    v_mul_f32 v124, v124, v252
    v_mfma_f32_16x16x32_bf16 v[208:211], v[100:103], a[80:83], v[208:211]
    v_mul_f32 v125, v125, v253
    v_mul_f32 v126, v126, v254
    v_mfma_f32_16x16x32_bf16 v[212:215], v[96:99], a[68:71], v[212:215]
    ds_read_b64_tr_b16 v[90:91], v12 offset:49664
    v_mul_f32_e64 v127, v127, v255
    v_mfma_f32_16x16x32_bf16 v[212:215], v[100:103], a[84:87], v[212:215]
    v_cvt_pk_bf16_f32 v120, v120, v121
    v_cvt_pk_bf16_f32 v121, v122, v123
    v_mfma_f32_16x16x32_bf16 v[216:219], v[96:99], a[72:75], v[216:219]
    ds_read_b64_tr_b16 v[92:93], v12 offset:57344
    v_cvt_pk_bf16_f32 v122, v124, v125
    v_mfma_f32_16x16x32_bf16 v[216:219], v[100:103], a[88:91], v[216:219]
    buffer_load_dwordx4 v9, s[32:35], s67 offen offset:1024 lds
    v_cvt_pk_bf16_f32 v123, v126, v127
    v_mfma_f32_16x16x32_bf16 v[220:223], v[96:99], a[76:79], v[220:223]
    ds_read_b64_tr_b16 v[94:95], v12 offset:57856
    v_mfma_f32_16x16x32_bf16 v[220:223], v[100:103], a[92:95], v[220:223]
    s_waitcnt lgkmcnt(8)
    v_mfma_f32_16x16x32_bf16 v[224:227], v[104:107], a[64:67], v[224:227]
    ds_read_b64_tr_b16 v[96:97], v11 offset:51200
    v_mfma_f32_16x16x32_bf16 v[224:227], v[108:111], a[80:83], v[224:227]
    buffer_store_dwordx4 v[120:123], v23, s[44:47], s87 offen offset:0 sc1
    v_mul_f32 v136, v136, v248
    v_mfma_f32_16x16x32_bf16 v[228:231], v[104:107], a[68:71], v[228:231]
    ds_read_b64_tr_b16 v[98:99], v11 offset:51712
    v_mul_f32_e64 v137, v137, v249
    v_mfma_f32_16x16x32_bf16 v[228:231], v[108:111], a[84:87], v[228:231]
    buffer_load_dwordx4 v8, s[36:39], s67 offen offset:2048 lds
    v_mul_f32_e64 v138, v138, v250
    v_mfma_f32_16x16x32_bf16 v[232:235], v[104:107], a[72:75], v[232:235]
    ds_read_b64_tr_b16 v[100:101], v11 offset:59392
    v_mul_f32_e64 v139, v139, v251
    v_mfma_f32_16x16x32_bf16 v[232:235], v[108:111], a[88:91], v[232:235]
    v_mul_f32 v140, v140, v252
    v_mul_f32 v141, v141, v253
    v_mfma_f32_16x16x32_bf16 v[236:239], v[104:107], a[76:79], v[236:239]
    ds_read_b64_tr_b16 v[102:103], v11 offset:59904
    v_mul_f32_e64 v142, v142, v254
    v_mfma_f32_16x16x32_bf16 v[236:239], v[108:111], a[92:95], v[236:239]
    v_mul_f32 v143, v143, v255
    s_waitcnt lgkmcnt(8)
    v_mfma_f32_16x16x32_bf16 v[176:179], v[80:83], a[96:99], v[176:179]
    ds_read_b64_tr_b16 v[104:105], v12 offset:51200
    v_cvt_pk_bf16_f32 v136, v136, v137
    v_mfma_f32_16x16x32_bf16 v[176:179], v[84:87], a[112:115], v[176:179]
    buffer_load_dwordx4 v9, s[36:39], s67 offen offset:3072 lds
    s_add_u32 s67, s73, 0
    v_mfma_f32_16x16x32_bf16 v[180:183], v[80:83], a[100:103], v[180:183]
    ds_read_b64_tr_b16 v[106:107], v12 offset:51712
    s_add_u32 m0, s71, 0
    v_mfma_f32_16x16x32_bf16 v[180:183], v[84:87], a[116:119], v[180:183]
    v_cvt_pk_bf16_f32 v137, v138, v139
    v_cvt_pk_bf16_f32 v138, v140, v141
    v_mfma_f32_16x16x32_bf16 v[184:187], v[80:83], a[104:107], v[184:187]
    ds_read_b64_tr_b16 v[108:109], v12 offset:59392
    v_cvt_pk_bf16_f32 v139, v142, v143
    v_mfma_f32_16x16x32_bf16 v[184:187], v[84:87], a[120:123], v[184:187]
    buffer_store_dwordx4 v[136:139], v23, s[44:47], s87 offen offset:1024 sc1
    s_add_u32 s65, s87, s91
    v_mfma_f32_16x16x32_bf16 v[188:191], v[80:83], a[108:111], v[188:191]
    ds_read_b64_tr_b16 v[110:111], v12 offset:59904
    v_mul_f32 v152, v152, v248
    v_mfma_f32_16x16x32_bf16 v[188:191], v[84:87], a[124:127], v[188:191]
    v_add_u32 v11, 0x10000, v11
    s_waitcnt vmcnt(24) lgkmcnt(8)
    s_barrier
    v_mfma_f32_16x16x32_bf16 v[192:195], v[88:91], a[96:99], v[192:195]
    ds_read_b64_tr_b16 v[80:81], v11 offset:0
    v_mul_f32_e64 v153, v153, v249
    v_mfma_f32_16x16x32_bf16 v[192:195], v[92:95], a[112:115], v[192:195]
    buffer_load_dwordx4 v10, s[52:55], s67 offen offset:0 lds
    s_add_u32 s67, s73, 146432
    v_mfma_f32_16x16x32_bf16 v[196:199], v[88:91], a[100:103], v[196:199]
    ds_read_b64_tr_b16 v[82:83], v11 offset:512
    v_mul_f32_e64 v154, v154, v250
    v_mfma_f32_16x16x32_bf16 v[196:199], v[92:95], a[116:119], v[196:199]
    v_mul_f32 v155, v155, v251
    v_mul_f32 v156, v156, v252
    v_mfma_f32_16x16x32_bf16 v[200:203], v[88:91], a[104:107], v[200:203]
    ds_read_b64_tr_b16 v[84:85], v11 offset:8192
    v_mul_f32_e64 v157, v157, v253
    v_mfma_f32_16x16x32_bf16 v[200:203], v[92:95], a[120:123], v[200:203]
    v_mul_f32 v158, v158, v254
    v_mul_f32 v159, v159, v255
    v_mfma_f32_16x16x32_bf16 v[204:207], v[88:91], a[108:111], v[204:207]
    ds_read_b64_tr_b16 v[86:87], v11 offset:8704
    v_cvt_pk_bf16_f32 v152, v152, v153
    v_mfma_f32_16x16x32_bf16 v[204:207], v[92:95], a[124:127], v[204:207]
    v_add_u32 v12, 0x10000, v12
    s_waitcnt lgkmcnt(8)
    v_mfma_f32_16x16x32_bf16 v[208:211], v[96:99], a[96:99], v[208:211]
    ds_read_b64_tr_b16 v[88:89], v12 offset:0
    v_cvt_pk_bf16_f32 v153, v154, v155
    v_mfma_f32_16x16x32_bf16 v[208:211], v[100:103], a[112:115], v[208:211]
    buffer_load_dwordx4 v10, s[52:55], s67 offen offset:1024 lds
    s_add_u32 s67, s73, 292864
    v_mfma_f32_16x16x32_bf16 v[212:215], v[96:99], a[100:103], v[212:215]
    ds_read_b64_tr_b16 v[90:91], v12 offset:512
    v_cvt_pk_bf16_f32 v154, v156, v157
    v_mfma_f32_16x16x32_bf16 v[212:215], v[100:103], a[116:119], v[212:215]
    v_cvt_pk_bf16_f32 v155, v158, v159
    v_mfma_f32_16x16x32_bf16 v[216:219], v[96:99], a[104:107], v[216:219]
    ds_read_b64_tr_b16 v[92:93], v12 offset:8192
    v_mfma_f32_16x16x32_bf16 v[216:219], v[100:103], a[120:123], v[216:219]
    v_mfma_f32_16x16x32_bf16 v[220:223], v[96:99], a[108:111], v[220:223]
    ds_read_b64_tr_b16 v[94:95], v12 offset:8704
    v_mfma_f32_16x16x32_bf16 v[220:223], v[100:103], a[124:127], v[220:223]
    s_waitcnt lgkmcnt(8)
    v_mfma_f32_16x16x32_bf16 v[224:227], v[104:107], a[96:99], v[224:227]
    ds_read_b64_tr_b16 v[96:97], v11 offset:2048
    v_mfma_f32_16x16x32_bf16 v[224:227], v[108:111], a[112:115], v[224:227]
    v_mfma_f32_16x16x32_bf16 v[228:231], v[104:107], a[100:103], v[228:231]
    ds_read_b64_tr_b16 v[98:99], v11 offset:2560
    v_mfma_f32_16x16x32_bf16 v[228:231], v[108:111], a[116:119], v[228:231]
    buffer_store_dwordx4 v[152:155], v23, s[44:47], s65 offen offset:0 sc1
    v_mul_f32_e64 v168, v168, v248
    v_mfma_f32_16x16x32_bf16 v[232:235], v[104:107], a[104:107], v[232:235]
    ds_read_b64_tr_b16 v[100:101], v11 offset:10240
    v_mul_f32_e64 v169, v169, v249
    v_mfma_f32_16x16x32_bf16 v[232:235], v[108:111], a[120:123], v[232:235]
    buffer_load_dwordx4 v10, s[52:55], s67 offen offset:2048 lds
    s_add_u32 s67, s73, 884736
    v_mfma_f32_16x16x32_bf16 v[236:239], v[104:107], a[108:111], v[236:239]
    ds_read_b64_tr_b16 v[102:103], v11 offset:10752
    s_add_u32 m0, s71, 16384
    v_mfma_f32_16x16x32_bf16 v[236:239], v[108:111], a[124:127], v[236:239]
    v_mul_f32 v170, v170, v250
    s_waitcnt lgkmcnt(8)
    v_mfma_f32_16x16x32_bf16 v[176:179], v[80:83], a[128:131], v[176:179]
    ds_read_b64_tr_b16 v[104:105], v12 offset:2048
    v_mul_f32_e64 v171, v171, v251
    v_mfma_f32_16x16x32_bf16 v[176:179], v[84:87], a[144:147], v[176:179]
    v_mul_f32 v172, v172, v252
    v_mul_f32 v173, v173, v253
    v_mfma_f32_16x16x32_bf16 v[180:183], v[80:83], a[132:135], v[180:183]
    ds_read_b64_tr_b16 v[106:107], v12 offset:2560
    v_mul_f32_e64 v174, v174, v254
    v_mfma_f32_16x16x32_bf16 v[180:183], v[84:87], a[148:151], v[180:183]
    v_mul_f32_e64 v175, v175, v255
    v_cvt_pk_bf16_f32 v168, v168, v169
    v_mfma_f32_16x16x32_bf16 v[184:187], v[80:83], a[136:139], v[184:187]
    ds_read_b64_tr_b16 v[108:109], v12 offset:10240
    v_cvt_pk_bf16_f32 v169, v170, v171
    v_mfma_f32_16x16x32_bf16 v[184:187], v[84:87], a[152:155], v[184:187]
    v_cvt_pk_bf16_f32 v170, v172, v173
    v_cvt_pk_bf16_f32 v171, v174, v175
    v_mfma_f32_16x16x32_bf16 v[188:191], v[80:83], a[140:143], v[188:191]
    ds_read_b64_tr_b16 v[110:111], v12 offset:10752
    v_mfma_f32_16x16x32_bf16 v[188:191], v[84:87], a[156:159], v[188:191]
    s_waitcnt vmcnt(22) lgkmcnt(8)
    s_barrier
    v_mfma_f32_16x16x32_bf16 v[192:195], v[88:91], a[128:131], v[192:195]
    ds_read_b64_tr_b16 v[80:81], v11 offset:16384
    v_mfma_f32_16x16x32_bf16 v[192:195], v[92:95], a[144:147], v[192:195]
    buffer_store_dwordx4 v[168:171], v23, s[44:47], s65 offen offset:1024 sc1
    s_mul_i32 s65, s58, 3
    v_mfma_f32_16x16x32_bf16 v[196:199], v[88:91], a[132:135], v[196:199]
    ds_read_b64_tr_b16 v[82:83], v11 offset:16896
    s_add_u32 s65, s65, 0
    v_mfma_f32_16x16x32_bf16 v[196:199], v[92:95], a[148:151], v[196:199]
    buffer_load_dwordx4 v10, s[52:55], s67 offen offset:0 lds
    s_add_u32 s67, s73, 1031168
    v_mfma_f32_16x16x32_bf16 v[200:203], v[88:91], a[136:139], v[200:203]
    ds_read_b64_tr_b16 v[84:85], v11 offset:24576
    s_lshr_b32 s66, s65, 1
    v_mfma_f32_16x16x32_bf16 v[200:203], v[92:95], a[152:155], v[200:203]
    s_mul_i32 s66, s66, s75
    s_mul_i32 s66, s66, 36864
    v_mfma_f32_16x16x32_bf16 v[204:207], v[88:91], a[140:143], v[204:207]
    ds_read_b64_tr_b16 v[86:87], v11 offset:25088
    s_add_u32 s76, s64, s66
    v_mfma_f32_16x16x32_bf16 v[204:207], v[92:95], a[156:159], v[204:207]
    s_and_b32 s65, s65, 1
    s_waitcnt lgkmcnt(8)
    v_mfma_f32_16x16x32_bf16 v[208:211], v[96:99], a[128:131], v[208:211]
    ds_read_b64_tr_b16 v[88:89], v12 offset:16384
    s_mul_i32 s65, s65, 18432
    v_mfma_f32_16x16x32_bf16 v[208:211], v[100:103], a[144:147], v[208:211]
    s_add_u32 s76, s76, s65
    s_add_u32 s76, s76, 2048
    v_mfma_f32_16x16x32_bf16 v[212:215], v[96:99], a[132:135], v[212:215]
    ds_read_b64_tr_b16 v[90:91], v12 offset:16896
    s_mul_i32 s65, s58, 3
    v_mfma_f32_16x16x32_bf16 v[212:215], v[100:103], a[148:151], v[212:215]
    s_add_u32 s65, s65, 1
    s_lshr_b32 s66, s65, 1
    v_mfma_f32_16x16x32_bf16 v[216:219], v[96:99], a[136:139], v[216:219]
    ds_read_b64_tr_b16 v[92:93], v12 offset:24576
    s_mul_i32 s66, s66, s75
    v_mfma_f32_16x16x32_bf16 v[216:219], v[100:103], a[152:155], v[216:219]
    buffer_load_dwordx4 v10, s[52:55], s67 offen offset:1024 lds
    s_add_u32 s67, s73, 1177600
    v_mfma_f32_16x16x32_bf16 v[220:223], v[96:99], a[140:143], v[220:223]
    ds_read_b64_tr_b16 v[94:95], v12 offset:25088
    s_mul_i32 s66, s66, 36864
    v_mfma_f32_16x16x32_bf16 v[220:223], v[100:103], a[156:159], v[220:223]
    s_add_u32 s77, s64, s66
    s_waitcnt lgkmcnt(8)
    v_mfma_f32_16x16x32_bf16 v[224:227], v[104:107], a[128:131], v[224:227]
    ds_read_b64_tr_b16 v[96:97], v11 offset:18432
    s_and_b32 s65, s65, 1
    v_mfma_f32_16x16x32_bf16 v[224:227], v[108:111], a[144:147], v[224:227]
    s_mul_i32 s65, s65, 18432
    s_add_u32 s77, s77, s65
    v_mfma_f32_16x16x32_bf16 v[228:231], v[104:107], a[132:135], v[228:231]
    ds_read_b64_tr_b16 v[98:99], v11 offset:18944
    s_add_u32 s77, s77, 1024
    v_mfma_f32_16x16x32_bf16 v[228:231], v[108:111], a[148:151], v[228:231]
    s_mul_i32 s65, s58, 3
    s_add_u32 s65, s65, 2
    v_mfma_f32_16x16x32_bf16 v[232:235], v[104:107], a[136:139], v[232:235]
    ds_read_b64_tr_b16 v[100:101], v11 offset:26624
    s_lshr_b32 s66, s65, 1
    v_mfma_f32_16x16x32_bf16 v[232:235], v[108:111], a[152:155], v[232:235]
    buffer_load_dwordx4 v10, s[52:55], s67 offen offset:2048 lds
    s_add_u32 s67, s73, 1769472
    v_mfma_f32_16x16x32_bf16 v[236:239], v[104:107], a[140:143], v[236:239]
    ds_read_b64_tr_b16 v[102:103], v11 offset:27136
    s_add_u32 m0, s71, 32768
    v_mfma_f32_16x16x32_bf16 v[236:239], v[108:111], a[156:159], v[236:239]
    s_mul_i32 s66, s66, s75
    s_waitcnt lgkmcnt(8)
    v_mfma_f32_16x16x32_bf16 v[176:179], v[80:83], a[160:163], v[176:179]
    ds_read_b64_tr_b16 v[104:105], v12 offset:18432
    s_mul_i32 s66, s66, 36864
    v_mfma_f32_16x16x32_bf16 v[176:179], v[84:87], a[176:179], v[176:179]
    s_add_u32 s78, s64, s66
    s_and_b32 s65, s65, 1
    v_mfma_f32_16x16x32_bf16 v[180:183], v[80:83], a[164:167], v[180:183]
    ds_read_b64_tr_b16 v[106:107], v12 offset:18944
    s_mul_i32 s65, s65, 18432
    v_mfma_f32_16x16x32_bf16 v[180:183], v[84:87], a[180:183], v[180:183]
    s_add_u32 s78, s78, s65
    s_add_u32 s78, s78, 0
    v_mfma_f32_16x16x32_bf16 v[184:187], v[80:83], a[168:171], v[184:187]
    ds_read_b64_tr_b16 v[108:109], v12 offset:26624
    s_lshl_b32 s65, s60, 1
    v_mfma_f32_16x16x32_bf16 v[184:187], v[84:87], a[184:187], v[184:187]
    s_add_u32 s65, s65, s63
    s_mul_i32 s4, s65, 18432
    v_mfma_f32_16x16x32_bf16 v[188:191], v[80:83], a[172:175], v[188:191]
    ds_read_b64_tr_b16 v[110:111], v12 offset:27136
    s_lshl_b32 s65, s57, 10
    v_mfma_f32_16x16x32_bf16 v[188:191], v[84:87], a[188:191], v[188:191]
    s_waitcnt vmcnt(20) lgkmcnt(8)
    s_barrier
    v_mfma_f32_16x16x32_bf16 v[192:195], v[88:91], a[160:163], v[192:195]
    ds_read_b64_tr_b16 v[80:81], v11 offset:32768
    s_add_u32 s4, s4, s65
    v_mfma_f32_16x16x32_bf16 v[192:195], v[92:95], a[176:179], v[192:195]
    buffer_load_dwordx4 v10, s[52:55], s67 offen offset:0 lds
    s_add_u32 s67, s73, 1915904
    v_mfma_f32_16x16x32_bf16 v[196:199], v[88:91], a[164:167], v[196:199]
    ds_read_b64_tr_b16 v[82:83], v11 offset:33280
    s_add_u32 s4, s4, 0x2c00000
    v_mfma_f32_16x16x32_bf16 v[196:199], v[92:95], a[180:183], v[196:199]
    s_mul_i32 s5, s56, 147456
    s_lshl_b32 s65, s57, 7
    v_mfma_f32_16x16x32_bf16 v[200:203], v[88:91], a[168:171], v[200:203]
    ds_read_b64_tr_b16 v[84:85], v11 offset:40960
    s_add_u32 s5, s5, s65
    v_mfma_f32_16x16x32_bf16 v[200:203], v[92:95], a[184:187], v[200:203]
    s_add_u32 s5, s5, 0x2c04000
    v_mfma_f32_16x16x32_bf16 v[204:207], v[88:91], a[172:175], v[204:207]
    ds_read_b64_tr_b16 v[86:87], v11 offset:41472
    v_mfma_f32_16x16x32_bf16 v[204:207], v[92:95], a[188:191], v[204:207]
    s_waitcnt lgkmcnt(8)
    v_mfma_f32_16x16x32_bf16 v[208:211], v[96:99], a[160:163], v[208:211]
    ds_read_b64_tr_b16 v[88:89], v12 offset:32768
    v_mfma_f32_16x16x32_bf16 v[208:211], v[100:103], a[176:179], v[208:211]
    buffer_load_dwordx4 v10, s[52:55], s67 offen offset:1024 lds
    s_add_u32 s67, s73, 2062336
    v_mfma_f32_16x16x32_bf16 v[212:215], v[96:99], a[164:167], v[212:215]
    ds_read_b64_tr_b16 v[90:91], v12 offset:33280
    v_mfma_f32_16x16x32_bf16 v[212:215], v[100:103], a[180:183], v[212:215]
    s_cmp_eq_u32 s58, 0
    s_cselect_b32 s5, s5, 0x10000000
    v_mfma_f32_16x16x32_bf16 v[216:219], v[96:99], a[168:171], v[216:219]
    ds_read_b64_tr_b16 v[92:93], v12 offset:40960
    s_mov_b32 s84, 0x3eae1a93
    v_mfma_f32_16x16x32_bf16 v[216:219], v[100:103], a[184:187], v[216:219]
    s_cmp_lt_u32 s56, 2
    s_cselect_b32 s85, 0xffff, 0
    v_mfma_f32_16x16x32_bf16 v[220:223], v[96:99], a[172:175], v[220:223]
    ds_read_b64_tr_b16 v[94:95], v12 offset:41472
    v_mfma_f32_16x16x32_bf16 v[220:223], v[100:103], a[188:191], v[220:223]
    s_waitcnt lgkmcnt(8)
    v_mfma_f32_16x16x32_bf16 v[224:227], v[104:107], a[160:163], v[224:227]
    ds_read_b64_tr_b16 v[96:97], v11 offset:34816
    v_mfma_f32_16x16x32_bf16 v[224:227], v[108:111], a[176:179], v[224:227]
    s_cmp_lt_u32 s56, 1
    s_cselect_b32 s86, 0xffff, 0
    v_mfma_f32_16x16x32_bf16 v[228:231], v[104:107], a[164:167], v[228:231]
    ds_read_b64_tr_b16 v[98:99], v11 offset:35328
    s_mov_b32 s28, s8
    v_mfma_f32_16x16x32_bf16 v[228:231], v[108:111], a[180:183], v[228:231]
    buffer_load_dwordx4 v10, s[52:55], s67 offen offset:2048 lds
    s_add_u32 s67, s73, 2654208
    v_mfma_f32_16x16x32_bf16 v[232:235], v[104:107], a[168:171], v[232:235]
    ds_read_b64_tr_b16 v[100:101], v11 offset:43008
    s_add_u32 m0, s71, 49152
    v_mfma_f32_16x16x32_bf16 v[232:235], v[108:111], a[184:187], v[232:235]
    s_mov_b32 s29, s9
    s_mov_b32 s30, 0xa2000
    v_mfma_f32_16x16x32_bf16 v[236:239], v[104:107], a[172:175], v[236:239]
    ds_read_b64_tr_b16 v[102:103], v11 offset:43520
    s_mul_i32 s64, s63, 55296
    v_mfma_f32_16x16x32_bf16 v[236:239], v[108:111], a[188:191], v[236:239]
    s_mul_i32 s65, s57, 2304
    s_waitcnt lgkmcnt(8)
    v_mfma_f32_16x16x32_bf16 v[176:179], v[80:83], a[192:195], v[176:179]
    ds_read_b64_tr_b16 v[104:105], v12 offset:34816
    s_add_u32 s64, s64, s65
    v_mfma_f32_16x16x32_bf16 v[176:179], v[84:87], a[208:211], v[176:179]
    s_mov_b32 s96, 0xffff
    s_mov_b32 s97, 0
    v_mfma_f32_16x16x32_bf16 v[180:183], v[80:83], a[196:199], v[180:183]
    ds_read_b64_tr_b16 v[106:107], v12 offset:35328
    s_mov_b32 s98, 0xffff0000
    v_mfma_f32_16x16x32_bf16 v[180:183], v[84:87], a[212:215], v[180:183]
    s_mov_b32 s99, 0
    s_add_u32 s87, s64, 0x2328000
    v_mfma_f32_16x16x32_bf16 v[184:187], v[80:83], a[200:203], v[184:187]
    ds_read_b64_tr_b16 v[108:109], v12 offset:43008
    v_mfma_f32_16x16x32_bf16 v[184:187], v[84:87], a[216:219], v[184:187]
    buffer_load_dwordx4 v10, s[52:55], s67 offen offset:0 lds
    s_add_u32 s67, s73, 2800640
    v_mfma_f32_16x16x32_bf16 v[188:191], v[80:83], a[204:207], v[188:191]
    ds_read_b64_tr_b16 v[110:111], v12 offset:43520
    v_mfma_f32_16x16x32_bf16 v[188:191], v[84:87], a[220:223], v[188:191]
    s_waitcnt vmcnt(18) lgkmcnt(8)
    s_barrier
    v_mfma_f32_16x16x32_bf16 v[192:195], v[88:91], a[192:195], v[192:195]
    ds_read_b64_tr_b16 v[80:81], v11 offset:49152
    v_mfma_f32_16x16x32_bf16 v[192:195], v[92:95], a[208:211], v[192:195]
    s_cmp_ge_u32 s63, 16
    s_cselect_b32 s87, s87, 0x10000000
    s_cselect_b32 s92, 0, 0xf149
    v_mfma_f32_16x16x32_bf16 v[196:199], v[88:91], a[196:199], v[196:199]
    ds_read_b64_tr_b16 v[82:83], v11 offset:49664
    s_add_u32 s88, s64, 0x235e000
    v_mfma_f32_16x16x32_bf16 v[196:199], v[92:95], a[212:215], v[196:199]
    s_cmp_ge_u32 s63, 12
    s_cselect_b32 s88, s88, 0x10000000
    s_cselect_b32 s93, 0, 0xf149
    v_mfma_f32_16x16x32_bf16 v[200:203], v[88:91], a[200:203], v[200:203]
    ds_read_b64_tr_b16 v[84:85], v11 offset:57344
    s_add_u32 s89, s64, 0x2394000
    v_mfma_f32_16x16x32_bf16 v[200:203], v[92:95], a[216:219], v[200:203]
    s_cmp_ge_u32 s63, 8
    s_cselect_b32 s89, s89, 0x10000000
    s_cselect_b32 s94, 0, 0xf149
    v_mfma_f32_16x16x32_bf16 v[204:207], v[88:91], a[204:207], v[204:207]
    ds_read_b64_tr_b16 v[86:87], v11 offset:57856
    s_add_u32 s90, s64, 0x23ca000
    v_mfma_f32_16x16x32_bf16 v[204:207], v[92:95], a[220:223], v[204:207]
    buffer_load_dwordx4 v10, s[52:55], s67 offen offset:1024 lds
    s_waitcnt lgkmcnt(8)
    v_mfma_f32_16x16x32_bf16 v[208:211], v[96:99], a[192:195], v[208:211]
    ds_read_b64_tr_b16 v[88:89], v12 offset:49152
    s_add_u32 s67, s73, 2947072
    v_mfma_f32_16x16x32_bf16 v[208:211], v[100:103], a[208:211], v[208:211]
    s_cmp_ge_u32 s63, 4
    s_cselect_b32 s90, s90, 0x10000000
    s_cselect_b32 s95, 0, 0xf149
    v_mfma_f32_16x16x32_bf16 v[212:215], v[96:99], a[196:199], v[212:215]
    ds_read_b64_tr_b16 v[90:91], v12 offset:49664
    s_add_u32 s91, s64, 0x2400000
    v_mfma_f32_16x16x32_bf16 v[212:215], v[100:103], a[212:215], v[212:215]
    v_and_b32 v240, 15, v1
    v_lshrrev_b32_e64 v241, 4, v1
    v_mfma_f32_16x16x32_bf16 v[216:219], v[96:99], a[200:203], v[216:219]
    ds_read_b64_tr_b16 v[92:93], v12 offset:57344
    v_mov_b32 v243, 0x10000000
    v_mfma_f32_16x16x32_bf16 v[216:219], v[100:103], a[216:219], v[216:219]
    s_mul_i32 s65, s60, 1280
    s_add_u32 s66, s65, 147456
    v_mfma_f32_16x16x32_bf16 v[220:223], v[96:99], a[204:207], v[220:223]
    ds_read_b64_tr_b16 v[94:95], v12 offset:57856
    v_add_u32_e64 v3, s66, v2
    v_mfma_f32_16x16x32_bf16 v[220:223], v[100:103], a[220:223], v[220:223]
    buffer_load_dwordx4 v10, s[52:55], s67 offen offset:2048 lds
    s_waitcnt lgkmcnt(8)
    v_mfma_f32_16x16x32_bf16 v[224:227], v[104:107], a[192:195], v[224:227]
    ds_read_b64_tr_b16 v[96:97], v11 offset:51200
    s_add_u32 s67, s73, 3538944
    v_mfma_f32_16x16x32_bf16 v[224:227], v[108:111], a[208:211], v[224:227]
    s_add_u32 m0, s71, 65536
    v_lshlrev_b32 v241, 4, v241
    v_mfma_f32_16x16x32_bf16 v[228:231], v[104:107], a[196:199], v[228:231]
    ds_read_b64_tr_b16 v[98:99], v11 offset:51712
    v_lshl_add_u32 v242, v240, 6, v241
    v_mfma_f32_16x16x32_bf16 v[228:231], v[108:111], a[212:215], v[228:231]
    s_add_u32 s66, s65, 184320
    v_add_u32_e64 v5, s66, v242
    v_mfma_f32_16x16x32_bf16 v[232:235], v[104:107], a[200:203], v[232:235]
    ds_read_b64_tr_b16 v[100:101], v11 offset:59392
    v_and_b32_e64 v242, 1, v240
    v_mfma_f32_16x16x32_bf16 v[232:235], v[108:111], a[216:219], v[232:235]
    v_lshl_add_u32 v241, v242, 6, v241
    s_lshl_b32 s65, s60, 7
    v_mfma_f32_16x16x32_bf16 v[236:239], v[104:107], a[204:207], v[236:239]
    ds_read_b64_tr_b16 v[102:103], v11 offset:59904
    v_add_u32 v241, s65, v241
    v_mfma_f32_16x16x32_bf16 v[236:239], v[108:111], a[220:223], v[236:239]
    v_and_b32 v242, 3, v240
    s_waitcnt lgkmcnt(8)
    v_mfma_f32_16x16x32_bf16 v[176:179], v[80:83], a[224:227], v[176:179]
    ds_read_b64_tr_b16 v[104:105], v12 offset:51200
    v_cmp_eq_u32 vcc, 2, v242
    v_mfma_f32_16x16x32_bf16 v[176:179], v[84:87], a[240:243], v[176:179]
    buffer_load_dwordx4 v10, s[52:55], s67 offen offset:0 lds
    s_add_u32 s67, s73, 3685376
    v_mfma_f32_16x16x32_bf16 v[180:183], v[80:83], a[228:231], v[180:183]
    ds_read_b64_tr_b16 v[106:107], v12 offset:51712
    v_mov_b32 v242, 256
    v_mfma_f32_16x16x32_bf16 v[180:183], v[84:87], a[244:247], v[180:183]
    s_mul_i32 s65, s59, 544
    s_add_u32 s65, s65, 155648
    v_mfma_f32_16x16x32_bf16 v[184:187], v[80:83], a[232:235], v[184:187]
    ds_read_b64_tr_b16 v[108:109], v12 offset:59392
    v_cndmask_b32 v241, v241, v242, vcc
    v_mfma_f32_16x16x32_bf16 v[184:187], v[84:87], a[248:251], v[184:187]
    v_add_u32 v6, s65, v241
    s_lshl_b32 s65, s59, 9
    v_mfma_f32_16x16x32_bf16 v[188:191], v[80:83], a[236:239], v[188:191]
    ds_read_b64_tr_b16 v[110:111], v12 offset:59904
    s_lshl_b32 s66, s60, 2
    v_mfma_f32_16x16x32_bf16 v[188:191], v[84:87], a[252:255], v[188:191]
    v_add_u32 v11, 0x10000, v11
    s_waitcnt vmcnt(10) lgkmcnt(8)
    s_barrier
    v_mfma_f32_16x16x32_bf16 v[192:195], v[88:91], a[224:227], v[192:195]
    ds_read_b64_tr_b16 v[80:81], v11 offset:0
    s_add_u32 s65, s65, s66
    v_mfma_f32_16x16x32_bf16 v[192:195], v[92:95], a[240:243], v[192:195]
    s_add_u32 s65, s65, 158912
    v_lshlrev_b32_e64 v242, 4, v240
    v_mfma_f32_16x16x32_bf16 v[196:199], v[88:91], a[228:231], v[196:199]
    ds_read_b64_tr_b16 v[82:83], v11 offset:512
    v_add_u32_e64 v242, s65, v242
    v_mfma_f32_16x16x32_bf16 v[196:199], v[92:95], a[244:247], v[196:199]
    buffer_load_dwordx4 v10, s[52:55], s67 offen offset:1024 lds
    s_add_u32 s67, s73, 3831808
    v_mfma_f32_16x16x32_bf16 v[200:203], v[88:91], a[232:235], v[200:203]
    ds_read_b64_tr_b16 v[84:85], v11 offset:8192
    v_subrev_u32 v241, 248, v242
    v_mfma_f32_16x16x32_bf16 v[200:203], v[92:95], a[248:251], v[200:203]
    v_add_u32 v248, 3072, v242
    v_cndmask_b32 v4, v242, v241, s[98:99]
    v_mfma_f32_16x16x32_bf16 v[204:207], v[88:91], a[236:239], v[204:207]
    ds_read_b64_tr_b16 v[86:87], v11 offset:8704
    v_lshlrev_b32_e64 v241, 7, v1
    v_mfma_f32_16x16x32_bf16 v[204:207], v[92:95], a[252:255], v[204:207]
    v_add_u32 v12, 0x10000, v12
    s_waitcnt lgkmcnt(8)
    v_mfma_f32_16x16x32_bf16 v[208:211], v[96:99], a[224:227], v[208:211]
    ds_read_b64_tr_b16 v[88:89], v12 offset:0
    v_cmp_gt_u32 vcc, 41, v1
    v_mfma_f32_16x16x32_bf16 v[208:211], v[100:103], a[240:243], v[208:211]
    s_nop 0
    s_nop 0
    v_mfma_f32_16x16x32_bf16 v[212:215], v[96:99], a[228:231], v[212:215]
    ds_read_b64_tr_b16 v[90:91], v12 offset:512
    v_cndmask_b32_e64 v76, v243, v241, vcc
    v_mfma_f32_16x16x32_bf16 v[212:215], v[100:103], a[244:247], v[212:215]
    buffer_load_dwordx4 v[252:255], off, s[48:51], s11 sc1
    v_mfma_f32_16x16x32_bf16 v[216:219], v[96:99], a[232:235], v[216:219]
    ds_read_b64_tr_b16 v[92:93], v12 offset:8192
    v_mfma_f32_16x16x32_bf16 v[216:219], v[100:103], a[248:251], v[216:219]
    v_mfma_f32_16x16x32_bf16 v[220:223], v[96:99], a[236:239], v[220:223]
    ds_read_b64_tr_b16 v[94:95], v12 offset:8704
    v_mfma_f32_16x16x32_bf16 v[220:223], v[100:103], a[252:255], v[220:223]
    s_waitcnt lgkmcnt(8)
    v_mfma_f32_16x16x32_bf16 v[224:227], v[104:107], a[224:227], v[224:227]
    ds_read_b64_tr_b16 v[96:97], v11 offset:2048
    v_mfma_f32_16x16x32_bf16 v[224:227], v[108:111], a[240:243], v[224:227]
    v_mfma_f32_16x16x32_bf16 v[228:231], v[104:107], a[228:231], v[228:231]
    ds_read_b64_tr_b16 v[98:99], v11 offset:2560
    v_mfma_f32_16x16x32_bf16 v[228:231], v[108:111], a[244:247], v[228:231]
    v_mfma_f32_16x16x32_bf16 v[232:235], v[104:107], a[232:235], v[232:235]
    ds_read_b64_tr_b16 v[100:101], v11 offset:10240
    v_mfma_f32_16x16x32_bf16 v[232:235], v[108:111], a[248:251], v[232:235]
    v_mfma_f32_16x16x32_bf16 v[236:239], v[104:107], a[236:239], v[236:239]
    ds_read_b64_tr_b16 v[102:103], v11 offset:10752
    v_mfma_f32_16x16x32_bf16 v[236:239], v[108:111], a[252:255], v[236:239]
    s_waitcnt lgkmcnt(8)
    v_mfma_f32_16x16x32_bf16 v[176:179], v[80:83], v[32:35], v[176:179]
    ds_read_b64_tr_b16 v[104:105], v12 offset:2048
    v_mfma_f32_16x16x32_bf16 v[176:179], v[84:87], v[48:51], v[176:179]
    v_mfma_f32_16x16x32_bf16 v[180:183], v[80:83], v[36:39], v[180:183]
    ds_read_b64_tr_b16 v[106:107], v12 offset:2560
    v_mfma_f32_16x16x32_bf16 v[180:183], v[84:87], v[52:55], v[180:183]
    v_mfma_f32_16x16x32_bf16 v[184:187], v[80:83], v[40:43], v[184:187]
    ds_read_b64_tr_b16 v[108:109], v12 offset:10240
    v_mfma_f32_16x16x32_bf16 v[184:187], v[84:87], v[56:59], v[184:187]
    v_mfma_f32_16x16x32_bf16 v[188:191], v[80:83], v[44:47], v[188:191]
    ds_read_b64_tr_b16 v[110:111], v12 offset:10752
    v_mfma_f32_16x16x32_bf16 v[188:191], v[84:87], v[60:63], v[188:191]
    s_waitcnt lgkmcnt(8)
    s_barrier
    v_mfma_f32_16x16x32_bf16 v[192:195], v[88:91], v[32:35], v[192:195]
    ds_read_b64_tr_b16 v[80:81], v13 offset:0
    v_mfma_f32_16x16x32_bf16 v[192:195], v[92:95], v[48:51], v[192:195]
    buffer_load_dwordx4 v10, s[52:55], s67 offen offset:2048 lds
    s_add_u32 s67, s73, 4423680
    v_mfma_f32_16x16x32_bf16 v[196:199], v[88:91], v[36:39], v[196:199]
    ds_read_b64_tr_b16 v[82:83], v13 offset:256
    s_add_u32 m0, s71, 81920
    v_mfma_f32_16x16x32_bf16 v[196:199], v[92:95], v[52:55], v[196:199]
    v_mfma_f32_16x16x32_bf16 v[200:203], v[88:91], v[40:43], v[200:203]
    ds_read_b64_tr_b16 v[84:85], v13 offset:2048
    v_mfma_f32_16x16x32_bf16 v[200:203], v[92:95], v[56:59], v[200:203]
    v_mfma_f32_16x16x32_bf16 v[204:207], v[88:91], v[44:47], v[204:207]
    ds_read_b64_tr_b16 v[86:87], v13 offset:2304
    v_mfma_f32_16x16x32_bf16 v[204:207], v[92:95], v[60:63], v[204:207]
    s_waitcnt lgkmcnt(8)
    v_mfma_f32_16x16x32_bf16 v[208:211], v[96:99], v[32:35], v[208:211]
    ds_read_b64_tr_b16 v[88:89], v13 offset:4096
    v_mfma_f32_16x16x32_bf16 v[208:211], v[100:103], v[48:51], v[208:211]
    buffer_load_dwordx4 v10, s[52:55], s67 offen offset:0 lds
    s_add_u32 s67, s73, 4570112
    v_mfma_f32_16x16x32_bf16 v[212:215], v[96:99], v[36:39], v[212:215]
    ds_read_b64_tr_b16 v[90:91], v13 offset:4352
    v_mfma_f32_16x16x32_bf16 v[212:215], v[100:103], v[52:55], v[212:215]
    v_mfma_f32_16x16x32_bf16 v[216:219], v[96:99], v[40:43], v[216:219]
    ds_read_b64_tr_b16 v[92:93], v13 offset:6144
    v_mfma_f32_16x16x32_bf16 v[216:219], v[100:103], v[56:59], v[216:219]
    v_mfma_f32_16x16x32_bf16 v[220:223], v[96:99], v[44:47], v[220:223]
    ds_read_b64_tr_b16 v[94:95], v13 offset:6400
    v_mfma_f32_16x16x32_bf16 v[220:223], v[100:103], v[60:63], v[220:223]
    s_waitcnt lgkmcnt(8)
    v_mfma_f32_16x16x32_bf16 v[224:227], v[104:107], v[32:35], v[224:227]
    ds_read_b64_tr_b16 v[96:97], v13 offset:8192
    v_mfma_f32_16x16x32_bf16 v[224:227], v[108:111], v[48:51], v[224:227]
    v_mfma_f32_16x16x32_bf16 v[228:231], v[104:107], v[36:39], v[228:231]
    ds_read_b64_tr_b16 v[98:99], v13 offset:8448
    v_mfma_f32_16x16x32_bf16 v[228:231], v[108:111], v[52:55], v[228:231]
    buffer_load_dwordx4 v10, s[52:55], s67 offen offset:1024 lds
    s_add_u32 s67, s73, 4716544
    v_mfma_f32_16x16x32_bf16 v[232:235], v[104:107], v[40:43], v[232:235]
    ds_read_b64_tr_b16 v[100:101], v13 offset:10240
    v_mfma_f32_16x16x32_bf16 v[232:235], v[108:111], v[56:59], v[232:235]
    v_mfma_f32_16x16x32_bf16 v[236:239], v[104:107], v[44:47], v[236:239]
    ds_read_b64_tr_b16 v[102:103], v13 offset:10496
    v_mfma_f32_16x16x32_bf16 v[236:239], v[108:111], v[60:63], v[236:239]
    s_waitcnt vmcnt(12) lgkmcnt(8)
    s_barrier
    v_mfma_f32_16x16x32_bf16 v[112:115], v[80:83], a[0:3], 0
    ds_read_b64_tr_b16 v[104:105], v13 offset:16384
    v_mfma_f32_16x16x32_bf16 v[112:115], v[84:87], a[16:19], v[112:115]
    v_mfma_f32_16x16x32_bf16 v[116:119], v[80:83], a[4:7], 0
    ds_read_b64_tr_b16 v[106:107], v13 offset:16640
    v_mfma_f32_16x16x32_bf16 v[116:119], v[84:87], a[20:23], v[116:119]
    v_mfma_f32_16x16x32_bf16 v[120:123], v[80:83], a[8:11], 0
    ds_read_b64_tr_b16 v[108:109], v13 offset:18432
    s_add_u32 s68, s79, 0
    v_mfma_f32_16x16x32_bf16 v[120:123], v[84:87], a[24:27], v[120:123]
    buffer_load_dwordx4 v10, s[52:55], s67 offen offset:2048 lds
    v_mov_b32 v250, 1
    v_mfma_f32_16x16x32_bf16 v[124:127], v[80:83], a[12:15], 0
    ds_read_b64_tr_b16 v[110:111], v13 offset:18688
    s_lshl_b32 s64, s60, 13
    v_mfma_f32_16x16x32_bf16 v[124:127], v[84:87], a[28:31], v[124:127]
    s_add_u32 s64, s64, 114688
    s_waitcnt lgkmcnt(8)
    v_mfma_f32_16x16x32_bf16 v[112:115], v[88:91], a[32:35], v[112:115]
    ds_read_b64_tr_b16 v[80:81], v13 offset:20480
    v_add_u32_e64 v251, s64, v28
    v_mfma_f32_16x16x32_bf16 v[128:131], v[92:95], a[0:3], 0
    v_mul_f32 v176, v176, v208
    v_mul_f32 v177, v177, v209
    v_mfma_f32_16x16x32_bf16 v[116:119], v[88:91], a[36:39], v[116:119]
    ds_read_b64_tr_b16 v[82:83], v13 offset:20736
    v_mul_f32_e64 v178, v178, v210
    v_mfma_f32_16x16x32_bf16 v[132:135], v[92:95], a[4:7], 0
    v_mul_f32 v179, v179, v211
    v_mul_f32 v192, v192, v224
    v_mfma_f32_16x16x32_bf16 v[120:123], v[88:91], a[40:43], v[120:123]
    ds_read_b64_tr_b16 v[84:85], v13 offset:22528
    v_mul_f32_e64 v193, v193, v225
    v_mfma_f32_16x16x32_bf16 v[136:139], v[92:95], a[8:11], 0
    v_mul_f32 v194, v194, v226
    v_mul_f32 v195, v195, v227
    v_mfma_f32_16x16x32_bf16 v[124:127], v[88:91], a[44:47], v[124:127]
    ds_read_b64_tr_b16 v[86:87], v13 offset:22784
    v_cvt_pk_bf16_f32 v208, v176, v177
    v_mfma_f32_16x16x32_bf16 v[140:143], v[92:95], a[12:15], 0
    buffer_store_dword v250, v29, s[44:47], s6 offen sc1
    s_waitcnt lgkmcnt(8)
    v_mfma_f32_16x16x32_bf16 v[128:131], v[96:99], a[16:19], v[128:131]
    ds_read_b64_tr_b16 v[88:89], v13 offset:24576
    s_lshl_b32 s67, s75, 7
    v_mfma_f32_16x16x32_bf16 v[128:131], v[100:103], a[32:35], v[128:131]
    s_add_u32 s72, s72, s67
    s_add_u32 s67, s72, 0
    v_mfma_f32_16x16x32_bf16 v[132:135], v[96:99], a[20:23], v[132:135]
    ds_read_b64_tr_b16 v[90:91], v13 offset:24832
    s_add_u32 m0, s70, 98304
    v_mfma_f32_16x16x32_bf16 v[132:135], v[100:103], a[36:39], v[132:135]
    buffer_load_dwordx4 v8, s[32:35], s67 offen offset:0 lds
    v_cvt_pk_bf16_f32 v209, v178, v179
    v_mfma_f32_16x16x32_bf16 v[136:139], v[96:99], a[24:27], v[136:139]
    ds_read_b64_tr_b16 v[92:93], v13 offset:26624
    v_cvt_pk_bf16_f32 v210, v192, v193
    v_mfma_f32_16x16x32_bf16 v[136:139], v[100:103], a[40:43], v[136:139]
    v_cvt_pk_bf16_f32 v211, v194, v195
    v_mfma_f32_16x16x32_bf16 v[140:143], v[96:99], a[28:31], v[140:143]
    ds_read_b64_tr_b16 v[94:95], v13 offset:26880
    v_mfma_f32_16x16x32_bf16 v[140:143], v[100:103], a[44:47], v[140:143]
    s_waitcnt vmcnt(12) lgkmcnt(8)
    s_barrier
    v_mfma_f32_16x16x32_bf16 v[112:115], v[104:107], a[48:51], v[112:115]
    ds_read_b64_tr_b16 v[96:97], v13 offset:32768
    v_mfma_f32_16x16x32_bf16 v[112:115], v[108:111], a[64:67], v[112:115]
    buffer_store_dwordx4 v[208:211], v2, s[44:47], s68 offen offset:0 sc1
    v_mfma_f32_16x16x32_bf16 v[116:119], v[104:107], a[52:55], v[116:119]
    ds_read_b64_tr_b16 v[98:99], v13 offset:33024
    v_mfma_f32_16x16x32_bf16 v[116:119], v[108:111], a[68:71], v[116:119]
    ds_write_b128 v251, v[208:211] offset:0
    v_mfma_f32_16x16x32_bf16 v[120:123], v[104:107], a[56:59], v[120:123]
    ds_read_b64_tr_b16 v[100:101], v13 offset:34816
    v_mul_f32_e64 v180, v180, v212
    v_mfma_f32_16x16x32_bf16 v[120:123], v[108:111], a[72:75], v[120:123]
    buffer_load_dwordx4 v9, s[32:35], s67 offen offset:1024 lds
    v_mul_f32_e64 v181, v181, v213
    v_mfma_f32_16x16x32_bf16 v[124:127], v[104:107], a[60:63], v[124:127]
    ds_read_b64_tr_b16 v[102:103], v13 offset:35072
    v_mul_f32_e64 v182, v182, v214
    v_mfma_f32_16x16x32_bf16 v[124:127], v[108:111], a[76:79], v[124:127]
    v_mul_f32 v183, v183, v215
    s_waitcnt lgkmcnt(9)
    v_mfma_f32_16x16x32_bf16 v[112:115], v[80:83], a[80:83], v[112:115]
    ds_read_b64_tr_b16 v[104:105], v13 offset:36864
    v_mul_f32_e64 v196, v196, v228
    v_mfma_f32_16x16x32_bf16 v[128:131], v[84:87], a[48:51], v[128:131]
    buffer_load_dwordx4 v8, s[36:39], s67 offen offset:2048 lds
    v_mul_f32_e64 v197, v197, v229
    v_mfma_f32_16x16x32_bf16 v[116:119], v[80:83], a[84:87], v[116:119]
    ds_read_b64_tr_b16 v[106:107], v13 offset:37120
    v_mul_f32_e64 v198, v198, v230
    v_mfma_f32_16x16x32_bf16 v[132:135], v[84:87], a[52:55], v[132:135]
    v_mul_f32_e64 v199, v199, v231
    v_cvt_pk_bf16_f32 v212, v180, v181
    v_mfma_f32_16x16x32_bf16 v[120:123], v[80:83], a[88:91], v[120:123]
    ds_read_b64_tr_b16 v[108:109], v13 offset:38912
    v_cvt_pk_bf16_f32 v213, v182, v183
    v_mfma_f32_16x16x32_bf16 v[136:139], v[84:87], a[56:59], v[136:139]
    buffer_load_dwordx4 v9, s[36:39], s67 offen offset:3072 lds
    s_add_u32 s67, s72, 589824
    v_mfma_f32_16x16x32_bf16 v[124:127], v[80:83], a[92:95], v[124:127]
    ds_read_b64_tr_b16 v[110:111], v13 offset:39168
    s_add_u32 m0, s70, 131072
    v_mfma_f32_16x16x32_bf16 v[140:143], v[84:87], a[60:63], v[140:143]
    v_cvt_pk_bf16_f32 v214, v196, v197
    s_waitcnt lgkmcnt(9)
    v_mfma_f32_16x16x32_bf16 v[128:131], v[88:91], a[64:67], v[128:131]
    ds_read_b64_tr_b16 v[80:81], v13 offset:40960
    v_cvt_pk_bf16_f32 v215, v198, v199
    v_mfma_f32_16x16x32_bf16 v[128:131], v[92:95], a[80:83], v[128:131]
    v_mfma_f32_16x16x32_bf16 v[132:135], v[88:91], a[68:71], v[132:135]
    ds_read_b64_tr_b16 v[82:83], v13 offset:41216
    v_mfma_f32_16x16x32_bf16 v[132:135], v[92:95], a[84:87], v[132:135]
    buffer_store_dwordx4 v[212:215], v2, s[44:47], s68 offen offset:1024 sc1
    v_mfma_f32_16x16x32_bf16 v[136:139], v[88:91], a[72:75], v[136:139]
    ds_read_b64_tr_b16 v[84:85], v13 offset:43008
    v_mfma_f32_16x16x32_bf16 v[136:139], v[92:95], a[88:91], v[136:139]
    ds_write_b128 v251, v[212:215] offset:1024
    v_mfma_f32_16x16x32_bf16 v[140:143], v[88:91], a[76:79], v[140:143]
    ds_read_b64_tr_b16 v[86:87], v13 offset:43264
    v_mul_f32 v184, v184, v216
    v_mfma_f32_16x16x32_bf16 v[140:143], v[92:95], a[92:95], v[140:143]
    s_waitcnt vmcnt(14) lgkmcnt(9)
    s_barrier
    v_mfma_f32_16x16x32_bf16 v[112:115], v[96:99], a[96:99], v[112:115]
    ds_read_b64_tr_b16 v[88:89], v13 offset:49152
    v_mul_f32_e64 v185, v185, v217
    v_mfma_f32_16x16x32_bf16 v[112:115], v[100:103], a[112:115], v[112:115]
    buffer_load_dwordx4 v8, s[32:35], s67 offen offset:0 lds
    v_mul_f32_e64 v186, v186, v218
    v_mfma_f32_16x16x32_bf16 v[116:119], v[96:99], a[100:103], v[116:119]
    ds_read_b64_tr_b16 v[90:91], v13 offset:49408
    v_mul_f32_e64 v187, v187, v219
    v_mfma_f32_16x16x32_bf16 v[116:119], v[100:103], a[116:119], v[116:119]
    v_mul_f32 v200, v200, v232
    v_mul_f32 v201, v201, v233
    v_mfma_f32_16x16x32_bf16 v[120:123], v[96:99], a[104:107], v[120:123]
    ds_read_b64_tr_b16 v[92:93], v13 offset:51200
    v_mul_f32_e64 v202, v202, v234
    v_mfma_f32_16x16x32_bf16 v[120:123], v[100:103], a[120:123], v[120:123]
    buffer_load_dwordx4 v9, s[32:35], s67 offen offset:1024 lds
    v_mul_f32_e64 v203, v203, v235
    v_mfma_f32_16x16x32_bf16 v[124:127], v[96:99], a[108:111], v[124:127]
    ds_read_b64_tr_b16 v[94:95], v13 offset:51456
    v_cvt_pk_bf16_f32 v216, v184, v185
    v_mfma_f32_16x16x32_bf16 v[124:127], v[100:103], a[124:127], v[124:127]
    v_cvt_pk_bf16_f32 v217, v186, v187
    s_waitcnt lgkmcnt(9)
    v_mfma_f32_16x16x32_bf16 v[112:115], v[104:107], a[128:131], v[112:115]
    ds_read_b64_tr_b16 v[96:97], v13 offset:53248
    v_cvt_pk_bf16_f32 v218, v200, v201
    v_mfma_f32_16x16x32_bf16 v[128:131], v[108:111], a[96:99], v[128:131]
    buffer_load_dwordx4 v8, s[36:39], s67 offen offset:2048 lds
    v_cvt_pk_bf16_f32 v219, v202, v203
    v_mfma_f32_16x16x32_bf16 v[116:119], v[104:107], a[132:135], v[116:119]
    ds_read_b64_tr_b16 v[98:99], v13 offset:53504
    v_mfma_f32_16x16x32_bf16 v[132:135], v[108:111], a[100:103], v[132:135]
    v_mfma_f32_16x16x32_bf16 v[120:123], v[104:107], a[136:139], v[120:123]
    ds_read_b64_tr_b16 v[100:101], v13 offset:55296
    v_mfma_f32_16x16x32_bf16 v[136:139], v[108:111], a[104:107], v[136:139]
    v_mfma_f32_16x16x32_bf16 v[124:127], v[104:107], a[140:143], v[124:127]
    ds_read_b64_tr_b16 v[102:103], v13 offset:55552
    v_mfma_f32_16x16x32_bf16 v[140:143], v[108:111], a[108:111], v[140:143]
    buffer_store_dwordx4 v[216:219], v2, s[44:47], s68 offen offset:2048 sc1
    s_waitcnt lgkmcnt(8)
    v_mfma_f32_16x16x32_bf16 v[128:131], v[80:83], a[112:115], v[128:131]
    ds_read_b64_tr_b16 v[104:105], v13 offset:57344
    v_mfma_f32_16x16x32_bf16 v[128:131], v[84:87], a[128:131], v[128:131]
    ds_write_b128 v251, v[216:219] offset:2048
    v_mfma_f32_16x16x32_bf16 v[132:135], v[80:83], a[116:119], v[132:135]
    ds_read_b64_tr_b16 v[106:107], v13 offset:57600
    v_mul_f32_e64 v188, v188, v220
    v_mfma_f32_16x16x32_bf16 v[132:135], v[84:87], a[132:135], v[132:135]
    buffer_load_dwordx4 v9, s[36:39], s67 offen offset:3072 lds
    s_add_u32 s67, s72, 1179648
    v_mfma_f32_16x16x32_bf16 v[136:139], v[80:83], a[120:123], v[136:139]
    ds_read_b64_tr_b16 v[108:109], v13 offset:59392
    s_add_u32 m0, s70, 0
    v_mfma_f32_16x16x32_bf16 v[136:139], v[84:87], a[136:139], v[136:139]
    v_mul_f32 v189, v189, v221
    v_mul_f32_e64 v190, v190, v222
    v_mfma_f32_16x16x32_bf16 v[140:143], v[80:83], a[124:127], v[140:143]
    ds_read_b64_tr_b16 v[110:111], v13 offset:59648
    v_mul_f32_e64 v191, v191, v223
    v_mfma_f32_16x16x32_bf16 v[140:143], v[84:87], a[140:143], v[140:143]
    v_add_u32 v13, 0x10000, v13
    s_waitcnt vmcnt(15) lgkmcnt(9)
    s_barrier
    v_mfma_f32_16x16x32_bf16 v[112:115], v[88:91], a[144:147], v[112:115]
    ds_read_b64_tr_b16 v[80:81], v13 offset:0
    v_mul_f32_e64 v204, v204, v236
    v_mfma_f32_16x16x32_bf16 v[112:115], v[92:95], a[160:163], v[112:115]
    buffer_load_dwordx4 v8, s[32:35], s67 offen offset:0 lds
    v_mul_f32_e64 v205, v205, v237
    v_mfma_f32_16x16x32_bf16 v[116:119], v[88:91], a[148:151], v[116:119]
    ds_read_b64_tr_b16 v[82:83], v13 offset:256
    v_mul_f32_e64 v206, v206, v238
    v_mfma_f32_16x16x32_bf16 v[116:119], v[92:95], a[164:167], v[116:119]
    v_mul_f32_e64 v207, v207, v239
    v_cvt_pk_bf16_f32 v220, v188, v189
    v_mfma_f32_16x16x32_bf16 v[120:123], v[88:91], a[152:155], v[120:123]
    ds_read_b64_tr_b16 v[84:85], v13 offset:2048
    v_cvt_pk_bf16_f32 v221, v190, v191
    v_mfma_f32_16x16x32_bf16 v[120:123], v[92:95], a[168:171], v[120:123]
    buffer_load_dwordx4 v9, s[32:35], s67 offen offset:1024 lds
    v_cvt_pk_bf16_f32 v222, v204, v205
    v_mfma_f32_16x16x32_bf16 v[124:127], v[88:91], a[156:159], v[124:127]
    ds_read_b64_tr_b16 v[86:87], v13 offset:2304
    v_cvt_pk_bf16_f32 v223, v206, v207
    v_mfma_f32_16x16x32_bf16 v[124:127], v[92:95], a[172:175], v[124:127]
    s_waitcnt lgkmcnt(9)
    v_mfma_f32_16x16x32_bf16 v[112:115], v[96:99], a[176:179], v[112:115]
    ds_read_b64_tr_b16 v[88:89], v13 offset:4096
    v_mfma_f32_16x16x32_bf16 v[128:131], v[100:103], a[144:147], v[128:131]
    buffer_store_dwordx4 v[220:223], v2, s[44:47], s68 offen offset:3072 sc1
    v_mfma_f32_16x16x32_bf16 v[116:119], v[96:99], a[180:183], v[116:119]
    ds_read_b64_tr_b16 v[90:91], v13 offset:4352
    v_mfma_f32_16x16x32_bf16 v[132:135], v[100:103], a[148:151], v[132:135]
    ds_write_b128 v251, v[220:223] offset:3072
    v_mfma_f32_16x16x32_bf16 v[120:123], v[96:99], a[184:187], v[120:123]
    ds_read_b64_tr_b16 v[92:93], v13 offset:6144
    v_mfma_f32_16x16x32_bf16 v[136:139], v[100:103], a[152:155], v[136:139]
    buffer_load_dwordx4 v8, s[36:39], s67 offen offset:2048 lds
    v_mfma_f32_16x16x32_bf16 v[124:127], v[96:99], a[188:191], v[124:127]
    ds_read_b64_tr_b16 v[94:95], v13 offset:6400
    v_mfma_f32_16x16x32_bf16 v[140:143], v[100:103], a[156:159], v[140:143]
    s_waitcnt lgkmcnt(9)
    v_mfma_f32_16x16x32_bf16 v[128:131], v[104:107], a[160:163], v[128:131]
    ds_read_b64_tr_b16 v[96:97], v13 offset:8192
    v_mfma_f32_16x16x32_bf16 v[128:131], v[108:111], a[176:179], v[128:131]
    buffer_load_dwordx4 v9, s[36:39], s67 offen offset:3072 lds
    s_add_u32 s67, s72, 1769472
    v_mfma_f32_16x16x32_bf16 v[132:135], v[104:107], a[164:167], v[132:135]
    ds_read_b64_tr_b16 v[98:99], v13 offset:8448
    s_add_u32 m0, s70, 16384
    v_mfma_f32_16x16x32_bf16 v[132:135], v[108:111], a[180:183], v[132:135]
    v_readfirstlane_b32 s65, v252
    v_readfirstlane_b32 s66, v253
    v_readfirstlane_b32 s64, v254
    s_or_b32 s65, s65, s85
    s_or_b32 s66, s66, s86
    s_and_b32 s65, s65, s66
    s_and_b32 s65, s65, s64
    s_cmp_eq_u32 s65, 0xffff
    s_cbranch_scc0 kv_slow
kv_ok:
    v_mfma_f32_16x16x32_bf16 v[136:139], v[104:107], a[168:171], v[136:139]
    ds_read_b64_tr_b16 v[100:101], v13 offset:10240
    v_lshlrev_b32_e64 v249, 7, v1
    v_mfma_f32_16x16x32_bf16 v[136:139], v[108:111], a[184:187], v[136:139]
    buffer_load_dwordx4 v8, s[32:35], s67 offen offset:0 lds
    v_cmp_gt_u32 vcc, 48, v1
    v_mfma_f32_16x16x32_bf16 v[140:143], v[104:107], a[172:175], v[140:143]
    ds_read_b64_tr_b16 v[102:103], v13 offset:10496
    s_lshl_b32 s11, s56, 11
    v_mfma_f32_16x16x32_bf16 v[140:143], v[108:111], a[188:191], v[140:143]
    s_waitcnt vmcnt(18) lgkmcnt(9)
    s_barrier
    v_mfma_f32_16x16x32_bf16 v[112:115], v[80:83], a[192:195], v[112:115]
    ds_read_b64_tr_b16 v[104:105], v13 offset:16384
    s_add_u32 s11, s11, 0x2f0f000
    v_mfma_f32_16x16x32_bf16 v[112:115], v[84:87], a[208:211], v[112:115]
    v_cndmask_b32 v249, v243, v249, vcc
    s_lshl_b32 s86, s86, 16
    v_mfma_f32_16x16x32_bf16 v[116:119], v[80:83], a[196:199], v[116:119]
    ds_read_b64_tr_b16 v[106:107], v13 offset:16640
    s_or_b32 s86, s86, s85
    v_mfma_f32_16x16x32_bf16 v[116:119], v[84:87], a[212:215], v[116:119]
    buffer_load_dwordx4 v9, s[32:35], s67 offen offset:1024 lds
    v_mfma_f32_16x16x32_bf16 v[120:123], v[80:83], a[200:203], v[120:123]
    ds_read_b64_tr_b16 v[108:109], v13 offset:18432
    v_mfma_f32_16x16x32_bf16 v[120:123], v[84:87], a[216:219], v[120:123]
    v_mfma_f32_16x16x32_bf16 v[124:127], v[80:83], a[204:207], v[124:127]
    ds_read_b64_tr_b16 v[110:111], v13 offset:18688
    v_mfma_f32_16x16x32_bf16 v[124:127], v[84:87], a[220:223], v[124:127]
    buffer_load_dwordx4 v8, s[36:39], s67 offen offset:2048 lds
    s_waitcnt lgkmcnt(8)
    v_mfma_f32_16x16x32_bf16 v[112:115], v[88:91], a[224:227], v[112:115]
    ds_read_b64_tr_b16 v[80:81], v13 offset:20480
    v_mfma_f32_16x16x32_bf16 v[128:131], v[92:95], a[192:195], v[128:131]
    v_mfma_f32_16x16x32_bf16 v[116:119], v[88:91], a[228:231], v[116:119]
    ds_read_b64_tr_b16 v[82:83], v13 offset:20736
    v_mfma_f32_16x16x32_bf16 v[132:135], v[92:95], a[196:199], v[132:135]
    v_mfma_f32_16x16x32_bf16 v[120:123], v[88:91], a[232:235], v[120:123]
    ds_read_b64_tr_b16 v[84:85], v13 offset:22528
    v_mfma_f32_16x16x32_bf16 v[136:139], v[92:95], a[200:203], v[136:139]
    buffer_load_dwordx4 v9, s[36:39], s67 offen offset:3072 lds
    s_add_u32 s67, s72, 2359296
    v_mfma_f32_16x16x32_bf16 v[124:127], v[88:91], a[236:239], v[124:127]
    ds_read_b64_tr_b16 v[86:87], v13 offset:22784
    s_add_u32 m0, s70, 32768
    v_mfma_f32_16x16x32_bf16 v[140:143], v[92:95], a[204:207], v[140:143]
    s_waitcnt lgkmcnt(8)
    v_mfma_f32_16x16x32_bf16 v[128:131], v[96:99], a[208:211], v[128:131]
    ds_read_b64_tr_b16 v[88:89], v13 offset:24576
    v_mfma_f32_16x16x32_bf16 v[128:131], v[100:103], a[224:227], v[128:131]
    buffer_load_dwordx4 v8, s[32:35], s67 offen offset:0 lds
    v_mfma_f32_16x16x32_bf16 v[132:135], v[96:99], a[212:215], v[132:135]
    ds_read_b64_tr_b16 v[90:91], v13 offset:24832
    v_mfma_f32_16x16x32_bf16 v[132:135], v[100:103], a[228:231], v[132:135]
    v_mfma_f32_16x16x32_bf16 v[136:139], v[96:99], a[216:219], v[136:139]
    ds_read_b64_tr_b16 v[92:93], v13 offset:26624
    v_mfma_f32_16x16x32_bf16 v[136:139], v[100:103], a[232:235], v[136:139]
    buffer_load_dwordx4 v9, s[32:35], s67 offen offset:1024 lds
    v_mfma_f32_16x16x32_bf16 v[140:143], v[96:99], a[220:223], v[140:143]
    ds_read_b64_tr_b16 v[94:95], v13 offset:26880
    v_mfma_f32_16x16x32_bf16 v[140:143], v[100:103], a[236:239], v[140:143]
    v_add_u32 v11, 0xffff0000, v11
    s_waitcnt vmcnt(17) lgkmcnt(8)
    s_barrier
    v_mfma_f32_16x16x32_bf16 v[112:115], v[104:107], a[240:243], v[112:115]
    ds_read_b64_tr_b16 v[96:97], v11 offset:32768
    v_mfma_f32_16x16x32_bf16 v[112:115], v[108:111], v[32:35], v[112:115]
    v_mfma_f32_16x16x32_bf16 v[116:119], v[104:107], a[244:247], v[116:119]
    ds_read_b64_tr_b16 v[98:99], v11 offset:33280
    v_mfma_f32_16x16x32_bf16 v[116:119], v[108:111], v[36:39], v[116:119]
    buffer_load_dwordx4 v8, s[36:39], s67 offen offset:2048 lds
    v_mfma_f32_16x16x32_bf16 v[120:123], v[104:107], a[248:251], v[120:123]
    ds_read_b64_tr_b16 v[100:101], v11 offset:40960
    v_mfma_f32_16x16x32_bf16 v[120:123], v[108:111], v[40:43], v[120:123]
    v_mfma_f32_16x16x32_bf16 v[124:127], v[104:107], a[252:255], v[124:127]
    ds_read_b64_tr_b16 v[102:103], v11 offset:41472
    v_mfma_f32_16x16x32_bf16 v[124:127], v[108:111], v[44:47], v[124:127]
    v_add_u32 v12, 0xffff0000, v12
    s_waitcnt lgkmcnt(8)
    v_mfma_f32_16x16x32_bf16 v[112:115], v[80:83], v[48:51], v[112:115]
    ds_read_b64_tr_b16 v[104:105], v12 offset:32768
    v_mfma_f32_16x16x32_bf16 v[128:131], v[84:87], a[240:243], v[128:131]
    buffer_load_dwordx4 v9, s[36:39], s67 offen offset:3072 lds
    s_add_u32 s67, s72, 2949120
    v_mfma_f32_16x16x32_bf16 v[116:119], v[80:83], v[52:55], v[116:119]
    ds_read_b64_tr_b16 v[106:107], v12 offset:33280
    s_add_u32 m0, s70, 49152
    v_mfma_f32_16x16x32_bf16 v[132:135], v[84:87], a[244:247], v[132:135]
    v_mfma_f32_16x16x32_bf16 v[120:123], v[80:83], v[56:59], v[120:123]
    ds_read_b64_tr_b16 v[108:109], v12 offset:40960
    v_mfma_f32_16x16x32_bf16 v[136:139], v[84:87], a[248:251], v[136:139]
    buffer_load_dwordx4 v8, s[32:35], s67 offen offset:0 lds
    v_mfma_f32_16x16x32_bf16 v[124:127], v[80:83], v[60:63], v[124:127]
    ds_read_b64_tr_b16 v[110:111], v12 offset:41472
    v_mfma_f32_16x16x32_bf16 v[140:143], v[84:87], a[252:255], v[140:143]
    s_waitcnt lgkmcnt(8)
    v_mfma_f32_16x16x32_bf16 v[128:131], v[88:91], v[32:35], v[128:131]
    ds_read_b64_tr_b16 v[80:81], v11 offset:34816
    v_mfma_f32_16x16x32_bf16 v[128:131], v[92:95], v[48:51], v[128:131]
    buffer_load_dwordx4 v9, s[32:35], s67 offen offset:1024 lds
    v_mfma_f32_16x16x32_bf16 v[132:135], v[88:91], v[36:39], v[132:135]
    ds_read_b64_tr_b16 v[82:83], v11 offset:35328
    v_mfma_f32_16x16x32_bf16 v[132:135], v[92:95], v[52:55], v[132:135]
    v_mfma_f32_16x16x32_bf16 v[136:139], v[88:91], v[40:43], v[136:139]
    ds_read_b64_tr_b16 v[84:85], v11 offset:43008
    v_mfma_f32_16x16x32_bf16 v[136:139], v[92:95], v[56:59], v[136:139]
    v_mfma_f32_16x16x32_bf16 v[140:143], v[88:91], v[44:47], v[140:143]
    ds_read_b64_tr_b16 v[86:87], v11 offset:43520
    v_mfma_f32_16x16x32_bf16 v[140:143], v[92:95], v[60:63], v[140:143]
    buffer_load_dwordx4 v8, s[36:39], s67 offen offset:2048 lds
    s_waitcnt lgkmcnt(8)
    v_mfma_f32_16x16x32_bf16 v[176:179], v[96:99], a[0:3], 0
    ds_read_b64_tr_b16 v[88:89], v12 offset:34816
    v_mfma_f32_16x16x32_bf16 v[176:179], v[100:103], a[16:19], v[176:179]
    v_mfma_f32_16x16x32_bf16 v[180:183], v[96:99], a[4:7], 0
    ds_read_b64_tr_b16 v[90:91], v12 offset:35328
    v_mfma_f32_16x16x32_bf16 v[180:183], v[100:103], a[20:23], v[180:183]
    buffer_load_dwordx4 v9, s[36:39], s67 offen offset:3072 lds
    s_add_u32 s67, s72, 3538944
    v_mfma_f32_16x16x32_bf16 v[184:187], v[96:99], a[8:11], 0
    ds_read_b64_tr_b16 v[92:93], v12 offset:43008
    s_add_u32 m0, s70, 65536
    v_mfma_f32_16x16x32_bf16 v[184:187], v[100:103], a[24:27], v[184:187]
    s_lshl_b32 s66, s60, 3
    s_add_u32 s66, s66, 147456
    v_mfma_f32_16x16x32_bf16 v[188:191], v[96:99], a[12:15], 0
    ds_read_b64_tr_b16 v[94:95], v12 offset:43520
    v_add_u32 v251, s66, v28
    v_mfma_f32_16x16x32_bf16 v[188:191], v[100:103], a[28:31], v[188:191]
    v_add_u32 v11, 0x10000, v11
    s_waitcnt vmcnt(17) lgkmcnt(8)
    s_barrier
    v_mfma_f32_16x16x32_bf16 v[192:195], v[104:107], a[0:3], 0
    ds_read_b64_tr_b16 v[96:97], v11 offset:0
    v_mul_f32_e64 v112, v112, v128
    v_mfma_f32_16x16x32_bf16 v[192:195], v[108:111], a[16:19], v[192:195]
    buffer_load_dwordx4 v8, s[32:35], s67 offen offset:0 lds
    v_mul_f32_e64 v113, v113, v129
    v_mfma_f32_16x16x32_bf16 v[196:199], v[104:107], a[4:7], 0
    ds_read_b64_tr_b16 v[98:99], v11 offset:512
    v_mul_f32_e64 v114, v114, v130
    v_mfma_f32_16x16x32_bf16 v[196:199], v[108:111], a[20:23], v[196:199]
    v_mul_f32_e64 v115, v115, v131
    v_cvt_pk_bf16_f32 v128, v112, v113
    v_mfma_f32_16x16x32_bf16 v[200:203], v[104:107], a[8:11], 0
    ds_read_b64_tr_b16 v[100:101], v11 offset:8192
    v_cvt_pk_bf16_f32 v129, v114, v115
    v_mfma_f32_16x16x32_bf16 v[200:203], v[108:111], a[24:27], v[200:203]
    ds_write_b64 v251, v[128:129] offset:0
    v_mul_f32_e64 v116, v116, v132
    v_mfma_f32_16x16x32_bf16 v[204:207], v[104:107], a[12:15], 0
    ds_read_b64_tr_b16 v[102:103], v11 offset:8704
    v_mul_f32_e64 v117, v117, v133
    v_mfma_f32_16x16x32_bf16 v[204:207], v[108:111], a[28:31], v[204:207]
    v_add_u32 v12, 0x10000, v12
    s_waitcnt lgkmcnt(9)
    v_mfma_f32_16x16x32_bf16 v[208:211], v[80:83], a[0:3], 0
    ds_read_b64_tr_b16 v[104:105], v12 offset:0
    v_mul_f32 v118, v118, v134
    v_mfma_f32_16x16x32_bf16 v[208:211], v[84:87], a[16:19], v[208:211]
    buffer_load_dwordx4 v9, s[32:35], s67 offen offset:1024 lds
    v_mul_f32_e64 v119, v119, v135
    v_mfma_f32_16x16x32_bf16 v[212:215], v[80:83], a[4:7], 0
    ds_read_b64_tr_b16 v[106:107], v12 offset:512
    v_cvt_pk_bf16_f32 v132, v116, v117
    v_mfma_f32_16x16x32_bf16 v[212:215], v[84:87], a[20:23], v[212:215]
    v_cvt_pk_bf16_f32 v133, v118, v119
    v_mfma_f32_16x16x32_bf16 v[216:219], v[80:83], a[8:11], 0
    ds_read_b64_tr_b16 v[108:109], v12 offset:8192
    v_mfma_f32_16x16x32_bf16 v[216:219], v[84:87], a[24:27], v[216:219]
    ds_write_b64 v251, v[132:133] offset:1024
    v_mul_f32_e64 v120, v120, v136
    v_mfma_f32_16x16x32_bf16 v[220:223], v[80:83], a[12:15], 0
    ds_read_b64_tr_b16 v[110:111], v12 offset:8704
    v_mul_f32_e64 v121, v121, v137
    v_mfma_f32_16x16x32_bf16 v[220:223], v[84:87], a[28:31], v[220:223]
    buffer_load_dwordx4 v8, s[36:39], s67 offen offset:2048 lds
    s_waitcnt lgkmcnt(10)
    v_mfma_f32_16x16x32_bf16 v[224:227], v[88:91], a[0:3], 0
    ds_read_b64_tr_b16 v[80:81], v11 offset:2048
    v_mul_f32 v122, v122, v138
    v_mfma_f32_16x16x32_bf16 v[224:227], v[92:95], a[16:19], v[224:227]
    v_mul_f32_e64 v123, v123, v139
    v_cvt_pk_bf16_f32 v136, v120, v121
    v_mfma_f32_16x16x32_bf16 v[228:231], v[88:91], a[4:7], 0
    ds_read_b64_tr_b16 v[82:83], v11 offset:2560
    v_cvt_pk_bf16_f32 v137, v122, v123
    v_mfma_f32_16x16x32_bf16 v[228:231], v[92:95], a[20:23], v[228:231]
    ds_write_b64 v251, v[136:137] offset:2048
    v_mul_f32_e64 v124, v124, v140
    v_mfma_f32_16x16x32_bf16 v[232:235], v[88:91], a[8:11], 0
    ds_read_b64_tr_b16 v[84:85], v11 offset:10240
    v_mul_f32_e64 v125, v125, v141
    v_mfma_f32_16x16x32_bf16 v[232:235], v[92:95], a[24:27], v[232:235]
    buffer_load_dwordx4 v9, s[36:39], s67 offen offset:3072 lds
    s_add_u32 s67, s72, 4128768
    v_mfma_f32_16x16x32_bf16 v[236:239], v[88:91], a[12:15], 0
    ds_read_b64_tr_b16 v[86:87], v11 offset:10752
    s_add_u32 m0, s70, 81920
    v_mfma_f32_16x16x32_bf16 v[236:239], v[92:95], a[28:31], v[236:239]
    v_mul_f32 v126, v126, v142
    s_waitcnt lgkmcnt(10)
    v_mfma_f32_16x16x32_bf16 v[176:179], v[96:99], a[32:35], v[176:179]
    ds_read_b64_tr_b16 v[88:89], v12 offset:2048
    v_mul_f32_e64 v127, v127, v143
    v_mfma_f32_16x16x32_bf16 v[176:179], v[100:103], a[48:51], v[176:179]
    buffer_load_dwordx4 v8, s[32:35], s67 offen offset:0 lds
    v_cvt_pk_bf16_f32 v140, v124, v125
    v_mfma_f32_16x16x32_bf16 v[180:183], v[96:99], a[36:39], v[180:183]
    ds_read_b64_tr_b16 v[90:91], v12 offset:2560
    v_cvt_pk_bf16_f32 v141, v126, v127
    v_mfma_f32_16x16x32_bf16 v[180:183], v[100:103], a[52:55], v[180:183]
    ds_write_b64 v251, v[140:141] offset:3072
    v_mfma_f32_16x16x32_bf16 v[184:187], v[96:99], a[40:43], v[184:187]
    ds_read_b64_tr_b16 v[92:93], v12 offset:10240
    v_mfma_f32_16x16x32_bf16 v[184:187], v[100:103], a[56:59], v[184:187]
    buffer_load_dwordx4 v9, s[32:35], s67 offen offset:1024 lds
    v_mfma_f32_16x16x32_bf16 v[188:191], v[96:99], a[44:47], v[188:191]
    ds_read_b64_tr_b16 v[94:95], v12 offset:10752
    v_mfma_f32_16x16x32_bf16 v[188:191], v[100:103], a[60:63], v[188:191]
    v_add_u32 v11, 0xfffe0000, v11
    s_waitcnt vmcnt(18) lgkmcnt(10)
    s_barrier
    v_mfma_f32_16x16x32_bf16 v[192:195], v[104:107], a[32:35], v[192:195]
    ds_read_b64_tr_b16 v[96:97], v11 offset:0
    v_mfma_f32_16x16x32_bf16 v[192:195], v[108:111], a[48:51], v[192:195]
    s_getpc_b64 s[48:49]
K1_pc2:
    v_mfma_f32_16x16x32_bf16 v[196:199], v[104:107], a[36:39], v[196:199]
    ds_read_b64_tr_b16 v[98:99], v11 offset:512
    s_mov_b32 s50, code_end-K1_pc2
    v_mfma_f32_16x16x32_bf16 v[196:199], v[108:111], a[52:55], v[196:199]
    buffer_load_dwordx4 v8, s[36:39], s67 offen offset:2048 lds
    s_and_b32 s65, s101, 7
    v_mfma_f32_16x16x32_bf16 v[200:203], v[104:107], a[40:43], v[200:203]
    ds_read_b64_tr_b16 v[100:101], v11 offset:8192
    s_lshl_b32 s65, s65, 2
    v_mfma_f32_16x16x32_bf16 v[200:203], v[108:111], a[56:59], v[200:203]
    s_add_u32 s65, s65, s58
    s_mul_i32 s65, s65, 1408
    v_mfma_f32_16x16x32_bf16 v[204:207], v[104:107], a[44:47], v[204:207]
    ds_read_b64_tr_b16 v[102:103], v11 offset:8704
    v_lshlrev_b32_e64 v240, 7, v1
    v_mfma_f32_16x16x32_bf16 v[204:207], v[108:111], a[60:63], v[204:207]
    v_add_u32 v12, 0xfffe0000, v12
    s_waitcnt lgkmcnt(9)
    v_mfma_f32_16x16x32_bf16 v[208:211], v[80:83], a[32:35], v[208:211]
    ds_read_b64_tr_b16 v[104:105], v12 offset:0
    v_add_u32 v68, v68, v69
    v_mfma_f32_16x16x32_bf16 v[208:211], v[84:87], a[48:51], v[208:211]
    buffer_load_dwordx4 v9, s[36:39], s67 offen offset:3072 lds
    s_add_u32 s67, s72, 4718592
    v_mfma_f32_16x16x32_bf16 v[212:215], v[80:83], a[36:39], v[212:215]
    ds_read_b64_tr_b16 v[106:107], v12 offset:512
    s_add_u32 m0, s70, 98304
    v_mfma_f32_16x16x32_bf16 v[212:215], v[84:87], a[52:55], v[212:215]
    s_cmp_eq_u32 s18, 0
    s_cselect_b32 s21, s20, 0x10000000
    v_mfma_f32_16x16x32_bf16 v[216:219], v[80:83], a[40:43], v[216:219]
    ds_read_b64_tr_b16 v[108:109], v12 offset:8192
    v_cmp_gt_u32 vcc, 11, v1
    v_mfma_f32_16x16x32_bf16 v[216:219], v[84:87], a[56:59], v[216:219]
    buffer_load_dwordx4 v8, s[32:35], s67 offen offset:0 lds
    s_nop 0
    v_mfma_f32_16x16x32_bf16 v[220:223], v[80:83], a[44:47], v[220:223]
    ds_read_b64_tr_b16 v[110:111], v12 offset:8704
    s_nop 0
    v_mfma_f32_16x16x32_bf16 v[220:223], v[84:87], a[60:63], v[220:223]
    v_cndmask_b32 v240, v243, v240, vcc
    s_waitcnt lgkmcnt(8)
    v_mfma_f32_16x16x32_bf16 v[224:227], v[88:91], a[32:35], v[224:227]
    ds_read_b64_tr_b16 v[80:81], v11 offset:2048
    v_mfma_f32_16x16x32_bf16 v[224:227], v[92:95], a[48:51], v[224:227]
    buffer_load_dwordx4 v9, s[32:35], s67 offen offset:1024 lds
    v_mfma_f32_16x16x32_bf16 v[228:231], v[88:91], a[36:39], v[228:231]
    ds_read_b64_tr_b16 v[82:83], v11 offset:2560
    v_mfma_f32_16x16x32_bf16 v[228:231], v[92:95], a[52:55], v[228:231]
    v_mfma_f32_16x16x32_bf16 v[232:235], v[88:91], a[40:43], v[232:235]
    ds_read_b64_tr_b16 v[84:85], v11 offset:10240
    v_mfma_f32_16x16x32_bf16 v[232:235], v[92:95], a[56:59], v[232:235]
    v_mfma_f32_16x16x32_bf16 v[236:239], v[88:91], a[44:47], v[236:239]
    ds_read_b64_tr_b16 v[86:87], v11 offset:10752
    v_mfma_f32_16x16x32_bf16 v[236:239], v[92:95], a[60:63], v[236:239]
    buffer_load_dwordx4 v8, s[36:39], s67 offen offset:2048 lds
    s_waitcnt lgkmcnt(8)
    v_mfma_f32_16x16x32_bf16 v[176:179], v[96:99], a[64:67], v[176:179]
    ds_read_b64_tr_b16 v[88:89], v12 offset:2048
    v_mfma_f32_16x16x32_bf16 v[176:179], v[100:103], a[80:83], v[176:179]
    buffer_load_dword v0, v68, s[32:35], s21 offen offset:0
    v_mfma_f32_16x16x32_bf16 v[180:183], v[96:99], a[68:71], v[180:183]
    ds_read_b64_tr_b16 v[90:91], v12 offset:2560
    v_mfma_f32_16x16x32_bf16 v[180:183], v[100:103], a[84:87], v[180:183]
    buffer_load_dword v252, v249, s[44:47], s11 offen sc1
    v_mfma_f32_16x16x32_bf16 v[184:187], v[96:99], a[72:75], v[184:187]
    ds_read_b64_tr_b16 v[92:93], v12 offset:10240
    v_mfma_f32_16x16x32_bf16 v[184:187], v[100:103], a[88:91], v[184:187]
    buffer_load_dword v0, v240, s[48:51], s65 offen
    s_mul_i32 s65, s2, 2688
    v_mfma_f32_16x16x32_bf16 v[188:191], v[96:99], a[76:79], v[188:191]
    ds_read_b64_tr_b16 v[94:95], v12 offset:10752
    v_mfma_f32_16x16x32_bf16 v[188:191], v[100:103], a[92:95], v[188:191]
    s_waitcnt vmcnt(22) lgkmcnt(8)
    s_barrier
    v_mfma_f32_16x16x32_bf16 v[192:195], v[104:107], a[64:67], v[192:195]
    ds_read_b64_tr_b16 v[96:97], v11 offset:16384
    v_mfma_f32_16x16x32_bf16 v[192:195], v[108:111], a[80:83], v[192:195]
    s_cmp_eq_u32 s18, 1
    s_cselect_b32 s21, s20, 0x10000000
    v_mfma_f32_16x16x32_bf16 v[196:199], v[104:107], a[68:71], v[196:199]
    ds_read_b64_tr_b16 v[98:99], v11 offset:16896
    v_mfma_f32_16x16x32_bf16 v[196:199], v[108:111], a[84:87], v[196:199]
    buffer_load_dword v0, v68, s[36:39], s21 offen offset:2048
    v_mfma_f32_16x16x32_bf16 v[200:203], v[104:107], a[72:75], v[200:203]
    ds_read_b64_tr_b16 v[100:101], v11 offset:24576
    v_mfma_f32_16x16x32_bf16 v[200:203], v[108:111], a[88:91], v[200:203]
    s_cmp_eq_u32 s58, 0
    s_cselect_b32 s65, s65, 0x10000000
    v_mfma_f32_16x16x32_bf16 v[204:207], v[104:107], a[76:79], v[204:207]
    ds_read_b64_tr_b16 v[102:103], v11 offset:25088
    v_mfma_f32_16x16x32_bf16 v[204:207], v[108:111], a[92:95], v[204:207]
    buffer_load_dword v0, v76, s[28:31], s65 offen
    s_waitcnt lgkmcnt(8)
    v_mfma_f32_16x16x32_bf16 v[208:211], v[80:83], a[64:67], v[208:211]
    ds_read_b64_tr_b16 v[104:105], v12 offset:16384
    v_mfma_f32_16x16x32_bf16 v[208:211], v[84:87], a[80:83], v[208:211]
    v_mfma_f32_16x16x32_bf16 v[212:215], v[80:83], a[68:71], v[212:215]
    ds_read_b64_tr_b16 v[106:107], v12 offset:16896
    v_mfma_f32_16x16x32_bf16 v[212:215], v[84:87], a[84:87], v[212:215]
    v_mfma_f32_16x16x32_bf16 v[216:219], v[80:83], a[72:75], v[216:219]
    ds_read_b64_tr_b16 v[108:109], v12 offset:24576
    v_mfma_f32_16x16x32_bf16 v[216:219], v[84:87], a[88:91], v[216:219]
    v_mfma_f32_16x16x32_bf16 v[220:223], v[80:83], a[76:79], v[220:223]
    ds_read_b64_tr_b16 v[110:111], v12 offset:25088
    v_mfma_f32_16x16x32_bf16 v[220:223], v[84:87], a[92:95], v[220:223]
    s_waitcnt lgkmcnt(8)
    v_mfma_f32_16x16x32_bf16 v[224:227], v[88:91], a[64:67], v[224:227]
    ds_read_b64_tr_b16 v[80:81], v11 offset:18432
    v_mfma_f32_16x16x32_bf16 v[224:227], v[92:95], a[80:83], v[224:227]
    v_mfma_f32_16x16x32_bf16 v[228:231], v[88:91], a[68:71], v[228:231]
    ds_read_b64_tr_b16 v[82:83], v11 offset:18944
    v_mfma_f32_16x16x32_bf16 v[228:231], v[92:95], a[84:87], v[228:231]
    v_mfma_f32_16x16x32_bf16 v[232:235], v[88:91], a[72:75], v[232:235]
    ds_read_b64_tr_b16 v[84:85], v11 offset:26624
    v_mfma_f32_16x16x32_bf16 v[232:235], v[92:95], a[88:91], v[232:235]
    v_mfma_f32_16x16x32_bf16 v[236:239], v[88:91], a[76:79], v[236:239]
    ds_read_b64_tr_b16 v[86:87], v11 offset:27136
    v_mfma_f32_16x16x32_bf16 v[236:239], v[92:95], a[92:95], v[236:239]
    s_waitcnt lgkmcnt(8)
    v_mfma_f32_16x16x32_bf16 v[176:179], v[96:99], a[96:99], v[176:179]
    ds_read_b64_tr_b16 v[88:89], v12 offset:18432
    s_lshl_b32 s66, s60, 11
    v_mfma_f32_16x16x32_bf16 v[176:179], v[100:103], a[112:115], v[176:179]
    s_add_u32 s66, s66, 147456
    v_add_u32 v251, s66, v28
    v_mfma_f32_16x16x32_bf16 v[180:183], v[96:99], a[100:103], v[180:183]
    ds_read_b64_tr_b16 v[90:91], v12 offset:18944
    v_mfma_f32_16x16x32_bf16 v[180:183], v[100:103], a[116:119], v[180:183]
    ds_read_b128 v[112:115], v251 offset:0
    v_mfma_f32_16x16x32_bf16 v[184:187], v[96:99], a[104:107], v[184:187]
    ds_read_b64_tr_b16 v[92:93], v12 offset:26624
    v_mfma_f32_16x16x32_bf16 v[184:187], v[100:103], a[120:123], v[184:187]
    ds_read_b128 v[116:119], v251 offset:1024
    v_mfma_f32_16x16x32_bf16 v[188:191], v[96:99], a[108:111], v[188:191]
    ds_read_b64_tr_b16 v[94:95], v12 offset:27136
    v_mfma_f32_16x16x32_bf16 v[188:191], v[100:103], a[124:127], v[188:191]
    s_waitcnt vmcnt(20) lgkmcnt(10)
    s_barrier
    v_mfma_f32_16x16x32_bf16 v[192:195], v[104:107], a[96:99], v[192:195]
    ds_read_b64_tr_b16 v[96:97], v11 offset:32768
    v_mfma_f32_16x16x32_bf16 v[192:195], v[108:111], a[112:115], v[192:195]
    v_mfma_f32_16x16x32_bf16 v[196:199], v[104:107], a[100:103], v[196:199]
    ds_read_b64_tr_b16 v[98:99], v11 offset:33280
    v_mfma_f32_16x16x32_bf16 v[196:199], v[108:111], a[116:119], v[196:199]
    v_mfma_f32_16x16x32_bf16 v[200:203], v[104:107], a[104:107], v[200:203]
    ds_read_b64_tr_b16 v[100:101], v11 offset:40960
    v_mfma_f32_16x16x32_bf16 v[200:203], v[108:111], a[120:123], v[200:203]
    v_mfma_f32_16x16x32_bf16 v[204:207], v[104:107], a[108:111], v[204:207]
    ds_read_b64_tr_b16 v[102:103], v11 offset:41472
    v_mfma_f32_16x16x32_bf16 v[204:207], v[108:111], a[124:127], v[204:207]
    s_waitcnt lgkmcnt(10)
    v_mfma_f32_16x16x32_bf16 v[208:211], v[80:83], a[96:99], v[208:211]
    ds_read_b64_tr_b16 v[104:105], v12 offset:32768
    v_mfma_f32_16x16x32_bf16 v[208:211], v[84:87], a[112:115], v[208:211]
    v_mfma_f32_16x16x32_bf16 v[212:215], v[80:83], a[100:103], v[212:215]
    ds_read_b64_tr_b16 v[106:107], v12 offset:33280
    v_mfma_f32_16x16x32_bf16 v[212:215], v[84:87], a[116:119], v[212:215]
    v_mfma_f32_16x16x32_bf16 v[216:219], v[80:83], a[104:107], v[216:219]
    ds_read_b64_tr_b16 v[108:109], v12 offset:40960
    v_mfma_f32_16x16x32_bf16 v[216:219], v[84:87], a[120:123], v[216:219]
    v_mfma_f32_16x16x32_bf16 v[220:223], v[80:83], a[108:111], v[220:223]
    ds_read_b64_tr_b16 v[110:111], v12 offset:41472
    v_mfma_f32_16x16x32_bf16 v[220:223], v[84:87], a[124:127], v[220:223]
    s_waitcnt lgkmcnt(11)
    buffer_store_dwordx4 v[112:115], v2, s[44:47], s80 offen offset:0 sc1
    s_waitcnt lgkmcnt(8)
    v_mfma_f32_16x16x32_bf16 v[224:227], v[88:91], a[96:99], v[224:227]
    ds_read_b64_tr_b16 v[80:81], v11 offset:34816
    v_mfma_f32_16x16x32_bf16 v[224:227], v[92:95], a[112:115], v[224:227]
    buffer_store_dwordx4 v[116:119], v2, s[44:47], s80 offen offset:1024 sc1
    v_mfma_f32_16x16x32_bf16 v[228:231], v[88:91], a[100:103], v[228:231]
    ds_read_b64_tr_b16 v[82:83], v11 offset:35328
    v_mfma_f32_16x16x32_bf16 v[228:231], v[92:95], a[116:119], v[228:231]
    buffer_load_dwordx4 v9, s[36:39], s67 offen offset:3072 lds
    s_lshl_b32 s67, s75, 7
    v_mfma_f32_16x16x32_bf16 v[232:235], v[88:91], a[104:107], v[232:235]
    ds_read_b64_tr_b16 v[84:85], v11 offset:43008
    s_add_u32 s72, s72, s67
    v_mfma_f32_16x16x32_bf16 v[232:235], v[92:95], a[120:123], v[232:235]
    s_add_u32 s67, s72, 0
    s_add_u32 m0, s70, 131072
    v_mfma_f32_16x16x32_bf16 v[236:239], v[88:91], a[108:111], v[236:239]
    ds_read_b64_tr_b16 v[86:87], v11 offset:43520
    v_mfma_f32_16x16x32_bf16 v[236:239], v[92:95], a[124:127], v[236:239]
    s_waitcnt lgkmcnt(8)
    v_mfma_f32_16x16x32_bf16 v[176:179], v[96:99], a[128:131], v[176:179]
    ds_read_b64_tr_b16 v[88:89], v12 offset:34816
    v_mfma_f32_16x16x32_bf16 v[176:179], v[100:103], a[144:147], v[176:179]
    buffer_load_dwordx4 v8, s[32:35], s67 offen offset:0 lds
    v_mfma_f32_16x16x32_bf16 v[180:183], v[96:99], a[132:135], v[180:183]
    ds_read_b64_tr_b16 v[90:91], v12 offset:35328
    v_mfma_f32_16x16x32_bf16 v[180:183], v[100:103], a[148:151], v[180:183]
    v_mfma_f32_16x16x32_bf16 v[184:187], v[96:99], a[136:139], v[184:187]
    ds_read_b64_tr_b16 v[92:93], v12 offset:43008
    v_mfma_f32_16x16x32_bf16 v[184:187], v[100:103], a[152:155], v[184:187]
    buffer_load_dwordx4 v9, s[32:35], s67 offen offset:1024 lds
    v_mfma_f32_16x16x32_bf16 v[188:191], v[96:99], a[140:143], v[188:191]
    ds_read_b64_tr_b16 v[94:95], v12 offset:43520
    v_mfma_f32_16x16x32_bf16 v[188:191], v[100:103], a[156:159], v[188:191]
    s_waitcnt vmcnt(21) lgkmcnt(8)
    s_barrier
    v_mfma_f32_16x16x32_bf16 v[192:195], v[104:107], a[128:131], v[192:195]
    ds_read_b64_tr_b16 v[96:97], v11 offset:49152
    v_mfma_f32_16x16x32_bf16 v[192:195], v[108:111], a[144:147], v[192:195]
    buffer_load_dwordx4 v8, s[36:39], s67 offen offset:2048 lds
    v_mfma_f32_16x16x32_bf16 v[196:199], v[104:107], a[132:135], v[196:199]
    ds_read_b64_tr_b16 v[98:99], v11 offset:49664
    v_mfma_f32_16x16x32_bf16 v[196:199], v[108:111], a[148:151], v[196:199]
    s_waitcnt vmcnt(9)
    v_cmp_le_u32 vcc, 1, v252
    s_nop 1
    s_or_b32 s65, vcc_lo, s86
    s_or_b32 s66, vcc_hi, 0xffff0000
    s_and_b32 s65, s65, s66
    s_cmp_eq_u32 s65, -1
    s_cbranch_scc0 kw_slow
kw_ok:
    v_mfma_f32_16x16x32_bf16 v[200:203], v[104:107], a[136:139], v[200:203]
    ds_read_b64_tr_b16 v[100:101], v11 offset:57344
    v_lshrrev_b32_e64 v240, 4, v1
    v_mfma_f32_16x16x32_bf16 v[200:203], v[108:111], a[152:155], v[200:203]
    s_mul_i32 s65, s58, 3
    v_add_u32 v240, s65, v240
    v_mfma_f32_16x16x32_bf16 v[204:207], v[104:107], a[140:143], v[204:207]
    ds_read_b64_tr_b16 v[102:103], v11 offset:57856
    v_mul_u32_u24 v241, 110592, v240
    v_mfma_f32_16x16x32_bf16 v[204:207], v[108:111], a[156:159], v[204:207]
    buffer_load_dwordx4 v9, s[36:39], s67 offen offset:3072 lds
    s_waitcnt lgkmcnt(8)
    v_mfma_f32_16x16x32_bf16 v[208:211], v[80:83], a[128:131], v[208:211]
    ds_read_b64_tr_b16 v[104:105], v12 offset:49152
    s_add_u32 s67, s72, 589824
    v_mfma_f32_16x16x32_bf16 v[208:211], v[84:87], a[144:147], v[208:211]
    s_add_u32 m0, s70, 0
    s_lshl_b32 s66, s56, 2
    v_mfma_f32_16x16x32_bf16 v[212:215], v[80:83], a[132:135], v[212:215]
    ds_read_b64_tr_b16 v[106:107], v12 offset:49664
    s_sub_u32 s66, 8, s66
    v_mfma_f32_16x16x32_bf16 v[212:215], v[84:87], a[148:151], v[212:215]
    buffer_load_dwordx4 v8, s[32:35], s67 offen offset:0 lds
    v_cmp_le_i32 vcc, s66, v240
    v_mfma_f32_16x16x32_bf16 v[216:219], v[80:83], a[136:139], v[216:219]
    ds_read_b64_tr_b16 v[108:109], v12 offset:57344
    v_and_b32 v249, 0xf0, v2
    v_mfma_f32_16x16x32_bf16 v[216:219], v[84:87], a[152:155], v[216:219]
    v_add_u32 v241, v241, v249
    v_cndmask_b32_e64 v241, v243, v241, vcc
    v_mfma_f32_16x16x32_bf16 v[220:223], v[80:83], a[140:143], v[220:223]
    ds_read_b64_tr_b16 v[110:111], v12 offset:57856
    v_add_u32 v242, 74752, v241
    v_mfma_f32_16x16x32_bf16 v[220:223], v[84:87], a[156:159], v[220:223]
    v_add_u32 v241, 37888, v241
    s_waitcnt lgkmcnt(8)
    v_mfma_f32_16x16x32_bf16 v[224:227], v[88:91], a[128:131], v[224:227]
    ds_read_b64_tr_b16 v[80:81], v11 offset:51200
    s_add_u32 s65, s58, 8
    v_mfma_f32_16x16x32_bf16 v[224:227], v[92:95], a[144:147], v[224:227]
    buffer_load_dwordx4 v9, s[32:35], s67 offen offset:1024 lds
    s_mul_i32 s65, s65, 110592
    v_mfma_f32_16x16x32_bf16 v[228:231], v[88:91], a[132:135], v[228:231]
    ds_read_b64_tr_b16 v[82:83], v11 offset:51712
    s_add_u32 s65, s65, 1024
    v_mfma_f32_16x16x32_bf16 v[228:231], v[92:95], a[148:151], v[228:231]
    v_cmp_gt_u32 vcc, 48, v1
    v_add_u32 v252, s65, v249
    v_mfma_f32_16x16x32_bf16 v[232:235], v[88:91], a[136:139], v[232:235]
    ds_read_b64_tr_b16 v[84:85], v11 offset:59392
    s_mul_i32 s66, s56, 442368
    v_mfma_f32_16x16x32_bf16 v[232:235], v[92:95], a[152:155], v[232:235]
    buffer_load_dwordx4 v8, s[36:39], s67 offen offset:2048 lds
    v_cndmask_b32_e64 v241, v252, v241, vcc
    v_mfma_f32_16x16x32_bf16 v[236:239], v[88:91], a[140:143], v[236:239]
    ds_read_b64_tr_b16 v[86:87], v11 offset:59904
    v_cndmask_b32_e64 v242, v243, v242, vcc
    v_mfma_f32_16x16x32_bf16 v[236:239], v[92:95], a[156:159], v[236:239]
    s_mul_i32 s65, s57, 2304
    s_waitcnt lgkmcnt(8)
    v_mfma_f32_16x16x32_bf16 v[176:179], v[96:99], a[160:163], v[176:179]
    ds_read_b64_tr_b16 v[88:89], v12 offset:51200
    s_add_u32 s66, s66, s65
    v_mfma_f32_16x16x32_bf16 v[176:179], v[100:103], a[176:179], v[176:179]
    buffer_load_dwordx4 v9, s[36:39], s67 offen offset:3072 lds
    s_add_u32 s67, s72, 1179648
    v_mfma_f32_16x16x32_bf16 v[180:183], v[96:99], a[164:167], v[180:183]
    ds_read_b64_tr_b16 v[90:91], v12 offset:51712
    s_add_u32 m0, s70, 16384
    v_mfma_f32_16x16x32_bf16 v[180:183], v[100:103], a[180:183], v[180:183]
    s_add_u32 s66, s66, 0x2343000
    v_mfma_f32_16x16x32_bf16 v[184:187], v[96:99], a[168:171], v[184:187]
    ds_read_b64_tr_b16 v[92:93], v12 offset:59392
    v_mfma_f32_16x16x32_bf16 v[184:187], v[100:103], a[184:187], v[184:187]
    v_mfma_f32_16x16x32_bf16 v[188:191], v[96:99], a[172:175], v[188:191]
    ds_read_b64_tr_b16 v[94:95], v12 offset:59904
    v_mfma_f32_16x16x32_bf16 v[188:191], v[100:103], a[188:191], v[188:191]
    v_add_u32 v11, 0x10000, v11
    s_waitcnt lgkmcnt(8)
    s_barrier
    v_mfma_f32_16x16x32_bf16 v[192:195], v[104:107], a[160:163], v[192:195]
    ds_read_b64_tr_b16 v[96:97], v11 offset:0
    v_mfma_f32_16x16x32_bf16 v[192:195], v[108:111], a[176:179], v[192:195]
    buffer_load_dwordx4 v[252:255], v241, s[44:47], s66 offen sc1
    v_mfma_f32_16x16x32_bf16 v[196:199], v[104:107], a[164:167], v[196:199]
    ds_read_b64_tr_b16 v[98:99], v11 offset:512
    v_mfma_f32_16x16x32_bf16 v[196:199], v[108:111], a[180:183], v[196:199]
    v_mfma_f32_16x16x32_bf16 v[200:203], v[104:107], a[168:171], v[200:203]
    ds_read_b64_tr_b16 v[100:101], v11 offset:8192
    v_mfma_f32_16x16x32_bf16 v[200:203], v[108:111], a[184:187], v[200:203]
    buffer_load_dwordx4 v[244:247], v242, s[44:47], s66 offen sc1
    s_mul_i32 s65, s58, 768
    v_mfma_f32_16x16x32_bf16 v[204:207], v[104:107], a[172:175], v[204:207]
    ds_read_b64_tr_b16 v[102:103], v11 offset:8704
    s_add_u32 s65, s65, 158912
    v_mfma_f32_16x16x32_bf16 v[204:207], v[108:111], a[188:191], v[204:207]
    v_add_u32 v12, 0x10000, v12
    s_waitcnt lgkmcnt(8)
    v_mfma_f32_16x16x32_bf16 v[208:211], v[80:83], a[160:163], v[208:211]
    ds_read_b64_tr_b16 v[104:105], v12 offset:0
    v_add_u32 v241, s65, v2
    v_mfma_f32_16x16x32_bf16 v[208:211], v[84:87], a[176:179], v[208:211]
    buffer_load_dwordx4 v8, s[32:35], s67 offen offset:0 lds
    s_lshl_b32 s65, s58, 8
    v_mfma_f32_16x16x32_bf16 v[212:215], v[80:83], a[164:167], v[212:215]
    ds_read_b64_tr_b16 v[106:107], v12 offset:512
    s_add_u32 s65, s65, 161984
    v_mfma_f32_16x16x32_bf16 v[212:215], v[84:87], a[180:183], v[212:215]
    s_cmp_eq_u32 s18, 2
    s_cselect_b32 s21, s10, 0x10000000
    v_mfma_f32_16x16x32_bf16 v[216:219], v[80:83], a[168:171], v[216:219]
    ds_read_b64_tr_b16 v[108:109], v12 offset:8192
    v_add_u32_e64 v242, s65, v249
    v_mfma_f32_16x16x32_bf16 v[216:219], v[84:87], a[184:187], v[216:219]
    v_cndmask_b32_e64 v241, v242, v241, vcc
    v_mul_u32_u24 v242, 272, v240
    v_mfma_f32_16x16x32_bf16 v[220:223], v[80:83], a[172:175], v[220:223]
    ds_read_b64_tr_b16 v[110:111], v12 offset:8704
    v_add_u32_e64 v242, v242, v249
    v_mfma_f32_16x16x32_bf16 v[220:223], v[84:87], a[188:191], v[220:223]
    buffer_load_dwordx4 v9, s[32:35], s67 offen offset:1024 lds
    s_waitcnt lgkmcnt(8)
    v_mfma_f32_16x16x32_bf16 v[224:227], v[88:91], a[160:163], v[224:227]
    ds_read_b64_tr_b16 v[80:81], v11 offset:2048
    v_and_b32 v249, 15, v1
    v_mfma_f32_16x16x32_bf16 v[224:227], v[92:95], a[176:179], v[224:227]
    v_min_u32 v249, 2, v249
    v_add_u32 v240, v240, v249
    v_mfma_f32_16x16x32_bf16 v[228:231], v[88:91], a[164:167], v[228:231]
    ds_read_b64_tr_b16 v[82:83], v11 offset:2560
    v_mul_u32_u24 v240, 272, v240
    v_mfma_f32_16x16x32_bf16 v[228:231], v[92:95], a[180:183], v[228:231]
    buffer_load_dwordx4 v8, s[36:39], s67 offen offset:2048 lds
    v_add_u32 v240, 4294966736, v240
    v_mfma_f32_16x16x32_bf16 v[232:235], v[88:91], a[168:171], v[232:235]
    ds_read_b64_tr_b16 v[84:85], v11 offset:10240
    v_cndmask_b32_e64 v242, v240, v242, vcc
    v_mfma_f32_16x16x32_bf16 v[232:235], v[92:95], a[184:187], v[232:235]
    v_add_u32 v242, 155648, v242
    v_mov_b32 v240, 0x3f803f80
    v_mfma_f32_16x16x32_bf16 v[236:239], v[88:91], a[172:175], v[236:239]
    ds_read_b64_tr_b16 v[86:87], v11 offset:10752
    v_mfma_f32_16x16x32_bf16 v[236:239], v[92:95], a[188:191], v[236:239]
    s_waitcnt lgkmcnt(8)
    v_mfma_f32_16x16x32_bf16 v[176:179], v[96:99], a[192:195], v[176:179]
    ds_read_b64_tr_b16 v[88:89], v12 offset:2048
    v_mfma_f32_16x16x32_bf16 v[176:179], v[100:103], a[208:211], v[176:179]
    buffer_load_dword v0, v76, s[40:43], s21 offen offset:2048
    v_mfma_f32_16x16x32_bf16 v[180:183], v[96:99], a[196:199], v[180:183]
    ds_read_b64_tr_b16 v[90:91], v12 offset:2560
    v_mfma_f32_16x16x32_bf16 v[180:183], v[100:103], a[212:215], v[180:183]
    s_cmp_eq_u32 s18, 3
    s_cselect_b32 s21, s10, 0x10000000
    v_mfma_f32_16x16x32_bf16 v[184:187], v[96:99], a[200:203], v[184:187]
    ds_read_b64_tr_b16 v[92:93], v12 offset:10240
    v_mfma_f32_16x16x32_bf16 v[184:187], v[100:103], a[216:219], v[184:187]
    buffer_load_dword v0, v76, s[40:43], s21 offen offset:2048
    v_mfma_f32_16x16x32_bf16 v[188:191], v[96:99], a[204:207], v[188:191]
    ds_read_b64_tr_b16 v[94:95], v12 offset:10752
    v_mfma_f32_16x16x32_bf16 v[188:191], v[100:103], a[220:223], v[188:191]
    s_waitcnt lgkmcnt(8)
    s_barrier
    v_mfma_f32_16x16x32_bf16 v[192:195], v[104:107], a[192:195], v[192:195]
    ds_read_b64_tr_b16 v[96:97], v11 offset:16384
    v_mfma_f32_16x16x32_bf16 v[192:195], v[108:111], a[208:211], v[192:195]
    v_mfma_f32_16x16x32_bf16 v[196:199], v[104:107], a[196:199], v[196:199]
    ds_read_b64_tr_b16 v[98:99], v11 offset:16896
    v_mfma_f32_16x16x32_bf16 v[196:199], v[108:111], a[212:215], v[196:199]
    v_mfma_f32_16x16x32_bf16 v[200:203], v[104:107], a[200:203], v[200:203]
    ds_read_b64_tr_b16 v[100:101], v11 offset:24576
    v_mfma_f32_16x16x32_bf16 v[200:203], v[108:111], a[216:219], v[200:203]
    v_mfma_f32_16x16x32_bf16 v[204:207], v[104:107], a[204:207], v[204:207]
    ds_read_b64_tr_b16 v[102:103], v11 offset:25088
    v_mfma_f32_16x16x32_bf16 v[204:207], v[108:111], a[220:223], v[204:207]
    s_waitcnt lgkmcnt(8)
    v_mfma_f32_16x16x32_bf16 v[208:211], v[80:83], a[192:195], v[208:211]
    ds_read_b64_tr_b16 v[104:105], v12 offset:16384
    v_mfma_f32_16x16x32_bf16 v[208:211], v[84:87], a[208:211], v[208:211]
    v_mfma_f32_16x16x32_bf16 v[212:215], v[80:83], a[196:199], v[212:215]
    ds_read_b64_tr_b16 v[106:107], v12 offset:16896
    v_mfma_f32_16x16x32_bf16 v[212:215], v[84:87], a[212:215], v[212:215]
    v_mfma_f32_16x16x32_bf16 v[216:219], v[80:83], a[200:203], v[216:219]
    ds_read_b64_tr_b16 v[108:109], v12 offset:24576
    v_mfma_f32_16x16x32_bf16 v[216:219], v[84:87], a[216:219], v[216:219]
    v_mfma_f32_16x16x32_bf16 v[220:223], v[80:83], a[204:207], v[220:223]
    ds_read_b64_tr_b16 v[110:111], v12 offset:25088
    v_mfma_f32_16x16x32_bf16 v[220:223], v[84:87], a[220:223], v[220:223]
    s_waitcnt lgkmcnt(8)
    v_mfma_f32_16x16x32_bf16 v[224:227], v[88:91], a[192:195], v[224:227]
    ds_read_b64_tr_b16 v[80:81], v11 offset:18432
    v_mfma_f32_16x16x32_bf16 v[224:227], v[92:95], a[208:211], v[224:227]
    v_mfma_f32_16x16x32_bf16 v[228:231], v[88:91], a[196:199], v[228:231]
    ds_read_b64_tr_b16 v[82:83], v11 offset:18944
    v_mfma_f32_16x16x32_bf16 v[228:231], v[92:95], a[212:215], v[228:231]
    v_mfma_f32_16x16x32_bf16 v[232:235], v[88:91], a[200:203], v[232:235]
    ds_read_b64_tr_b16 v[84:85], v11 offset:26624
    v_mfma_f32_16x16x32_bf16 v[232:235], v[92:95], a[216:219], v[232:235]
    v_mfma_f32_16x16x32_bf16 v[236:239], v[88:91], a[204:207], v[236:239]
    ds_read_b64_tr_b16 v[86:87], v11 offset:27136
    v_mfma_f32_16x16x32_bf16 v[236:239], v[92:95], a[220:223], v[236:239]
    s_waitcnt lgkmcnt(8)
    v_mfma_f32_16x16x32_bf16 v[176:179], v[96:99], a[224:227], v[176:179]
    ds_read_b64_tr_b16 v[88:89], v12 offset:18432
    v_mfma_f32_16x16x32_bf16 v[176:179], v[100:103], a[240:243], v[176:179]
    v_mfma_f32_16x16x32_bf16 v[180:183], v[96:99], a[228:231], v[180:183]
    ds_read_b64_tr_b16 v[90:91], v12 offset:18944
    v_mfma_f32_16x16x32_bf16 v[180:183], v[100:103], a[244:247], v[180:183]
    v_mfma_f32_16x16x32_bf16 v[184:187], v[96:99], a[232:235], v[184:187]
    ds_read_b64_tr_b16 v[92:93], v12 offset:26624
    v_mfma_f32_16x16x32_bf16 v[184:187], v[100:103], a[248:251], v[184:187]
    v_mfma_f32_16x16x32_bf16 v[188:191], v[96:99], a[236:239], v[188:191]
    ds_read_b64_tr_b16 v[94:95], v12 offset:27136
    v_mfma_f32_16x16x32_bf16 v[188:191], v[100:103], a[252:255], v[188:191]
    s_waitcnt vmcnt(15) lgkmcnt(8)
    s_barrier
    v_mfma_f32_16x16x32_bf16 v[192:195], v[104:107], a[224:227], v[192:195]
    ds_read_b64_tr_b16 v[96:97], v11 offset:32768
    v_mfma_f32_16x16x32_bf16 v[192:195], v[108:111], a[240:243], v[192:195]
    v_mfma_f32_16x16x32_bf16 v[196:199], v[104:107], a[228:231], v[196:199]
    ds_read_b64_tr_b16 v[98:99], v11 offset:33280
    v_mfma_f32_16x16x32_bf16 v[196:199], v[108:111], a[244:247], v[196:199]
    v_mfma_f32_16x16x32_bf16 v[200:203], v[104:107], a[232:235], v[200:203]
    ds_read_b64_tr_b16 v[100:101], v11 offset:40960
    v_mfma_f32_16x16x32_bf16 v[200:203], v[108:111], a[248:251], v[200:203]
    v_mfma_f32_16x16x32_bf16 v[204:207], v[104:107], a[236:239], v[204:207]
    ds_read_b64_tr_b16 v[102:103], v11 offset:41472
    v_mfma_f32_16x16x32_bf16 v[204:207], v[108:111], a[252:255], v[204:207]
    s_waitcnt lgkmcnt(8)
    v_mfma_f32_16x16x32_bf16 v[208:211], v[80:83], a[224:227], v[208:211]
    ds_read_b64_tr_b16 v[104:105], v12 offset:32768
    v_mfma_f32_16x16x32_bf16 v[208:211], v[84:87], a[240:243], v[208:211]
    buffer_load_dwordx4 v9, s[36:39], s67 offen offset:3072 lds
    s_add_u32 s67, s72, 1769472
    v_mfma_f32_16x16x32_bf16 v[212:215], v[80:83], a[228:231], v[212:215]
    ds_read_b64_tr_b16 v[106:107], v12 offset:33280
    s_add_u32 m0, s70, 32768
    v_mfma_f32_16x16x32_bf16 v[212:215], v[84:87], a[244:247], v[212:215]
    v_mfma_f32_16x16x32_bf16 v[216:219], v[80:83], a[232:235], v[216:219]
    ds_read_b64_tr_b16 v[108:109], v12 offset:40960
    v_mfma_f32_16x16x32_bf16 v[216:219], v[84:87], a[248:251], v[216:219]
    buffer_load_dwordx4 v8, s[32:35], s67 offen offset:0 lds
    v_mfma_f32_16x16x32_bf16 v[220:223], v[80:83], a[236:239], v[220:223]
    ds_read_b64_tr_b16 v[110:111], v12 offset:41472
    v_mfma_f32_16x16x32_bf16 v[220:223], v[84:87], a[252:255], v[220:223]
    s_waitcnt lgkmcnt(8)
    v_mfma_f32_16x16x32_bf16 v[224:227], v[88:91], a[224:227], v[224:227]
    ds_read_b64_tr_b16 v[80:81], v11 offset:34816
    v_mfma_f32_16x16x32_bf16 v[224:227], v[92:95], a[240:243], v[224:227]
    buffer_load_dwordx4 v9, s[32:35], s67 offen offset:1024 lds
    v_mfma_f32_16x16x32_bf16 v[228:231], v[88:91], a[228:231], v[228:231]
    ds_read_b64_tr_b16 v[82:83], v11 offset:35328
    v_mfma_f32_16x16x32_bf16 v[228:231], v[92:95], a[244:247], v[228:231]
    v_mfma_f32_16x16x32_bf16 v[232:235], v[88:91], a[232:235], v[232:235]
    ds_read_b64_tr_b16 v[84:85], v11 offset:43008
    v_mfma_f32_16x16x32_bf16 v[232:235], v[92:95], a[248:251], v[232:235]
    v_mfma_f32_16x16x32_bf16 v[236:239], v[88:91], a[236:239], v[236:239]
    ds_read_b64_tr_b16 v[86:87], v11 offset:43520
    v_mfma_f32_16x16x32_bf16 v[236:239], v[92:95], a[252:255], v[236:239]
    buffer_load_dwordx4 v8, s[36:39], s67 offen offset:2048 lds
    s_waitcnt lgkmcnt(8)
    v_mfma_f32_16x16x32_bf16 v[176:179], v[96:99], v[32:35], v[176:179]
    ds_read_b64_tr_b16 v[88:89], v12 offset:34816
    v_mfma_f32_16x16x32_bf16 v[176:179], v[100:103], v[48:51], v[176:179]
    v_mfma_f32_16x16x32_bf16 v[180:183], v[96:99], v[36:39], v[180:183]
    ds_read_b64_tr_b16 v[90:91], v12 offset:35328
    v_mfma_f32_16x16x32_bf16 v[180:183], v[100:103], v[52:55], v[180:183]
    buffer_load_dwordx4 v9, s[36:39], s67 offen offset:3072 lds
    s_add_u32 s67, s72, 2359296
    v_mfma_f32_16x16x32_bf16 v[184:187], v[96:99], v[40:43], v[184:187]
    ds_read_b64_tr_b16 v[92:93], v12 offset:43008
    s_add_u32 m0, s70, 49152
    v_mfma_f32_16x16x32_bf16 v[184:187], v[100:103], v[56:59], v[184:187]
    v_mfma_f32_16x16x32_bf16 v[188:191], v[96:99], v[44:47], v[188:191]
    ds_read_b64_tr_b16 v[94:95], v12 offset:43520
    v_mfma_f32_16x16x32_bf16 v[188:191], v[100:103], v[60:63], v[188:191]
    v_add_u32 v11, 0x10000, v11
    s_waitcnt vmcnt(16) lgkmcnt(8)
    s_barrier
    v_mfma_f32_16x16x32_bf16 v[192:195], v[104:107], v[32:35], v[192:195]
    ds_read_b64_tr_b16 v[96:97], v11 offset:0
    v_mfma_f32_16x16x32_bf16 v[192:195], v[108:111], v[48:51], v[192:195]
    buffer_load_dwordx4 v8, s[32:35], s67 offen offset:0 lds
    v_mfma_f32_16x16x32_bf16 v[196:199], v[104:107], v[36:39], v[196:199]
    ds_read_b64_tr_b16 v[98:99], v11 offset:512
    v_mfma_f32_16x16x32_bf16 v[196:199], v[108:111], v[52:55], v[196:199]
    v_mfma_f32_16x16x32_bf16 v[200:203], v[104:107], v[40:43], v[200:203]
    ds_read_b64_tr_b16 v[100:101], v11 offset:8192
    v_mfma_f32_16x16x32_bf16 v[200:203], v[108:111], v[56:59], v[200:203]
    buffer_load_dwordx4 v9, s[32:35], s67 offen offset:1024 lds
    v_mfma_f32_16x16x32_bf16 v[204:207], v[104:107], v[44:47], v[204:207]
    ds_read_b64_tr_b16 v[102:103], v11 offset:8704
    v_mfma_f32_16x16x32_bf16 v[204:207], v[108:111], v[60:63], v[204:207]
    v_add_u32 v12, 0x10000, v12
    s_waitcnt lgkmcnt(8)
    v_mfma_f32_16x16x32_bf16 v[208:211], v[80:83], v[32:35], v[208:211]
    ds_read_b64_tr_b16 v[104:105], v12 offset:0
    v_mfma_f32_16x16x32_bf16 v[208:211], v[84:87], v[48:51], v[208:211]
    buffer_load_dwordx4 v8, s[36:39], s67 offen offset:2048 lds
    v_mfma_f32_16x16x32_bf16 v[212:215], v[80:83], v[36:39], v[212:215]
    ds_read_b64_tr_b16 v[106:107], v12 offset:512
    v_mfma_f32_16x16x32_bf16 v[212:215], v[84:87], v[52:55], v[212:215]
    v_mfma_f32_16x16x32_bf16 v[216:219], v[80:83], v[40:43], v[216:219]
    ds_read_b64_tr_b16 v[108:109], v12 offset:8192
    v_mfma_f32_16x16x32_bf16 v[216:219], v[84:87], v[56:59], v[216:219]
    v_mfma_f32_16x16x32_bf16 v[220:223], v[80:83], v[44:47], v[220:223]
    ds_read_b64_tr_b16 v[110:111], v12 offset:8704
    v_mfma_f32_16x16x32_bf16 v[220:223], v[84:87], v[60:63], v[220:223]
    buffer_load_dwordx4 v9, s[36:39], s67 offen offset:3072 lds
    s_waitcnt lgkmcnt(8)
    v_mfma_f32_16x16x32_bf16 v[224:227], v[88:91], v[32:35], v[224:227]
    ds_read_b64_tr_b16 v[80:81], v11 offset:2048
    s_add_u32 s67, s72, 2949120
    v_mfma_f32_16x16x32_bf16 v[224:227], v[92:95], v[48:51], v[224:227]
    s_add_u32 m0, s70, 65536
    v_mfma_f32_16x16x32_bf16 v[228:231], v[88:91], v[36:39], v[228:231]
    ds_read_b64_tr_b16 v[82:83], v11 offset:2560
    v_mfma_f32_16x16x32_bf16 v[228:231], v[92:95], v[52:55], v[228:231]
    buffer_load_dwordx4 v8, s[32:35], s67 offen offset:0 lds
    v_mfma_f32_16x16x32_bf16 v[232:235], v[88:91], v[40:43], v[232:235]
    ds_read_b64_tr_b16 v[84:85], v11 offset:10240
    v_mfma_f32_16x16x32_bf16 v[232:235], v[92:95], v[56:59], v[232:235]
    v_mfma_f32_16x16x32_bf16 v[236:239], v[88:91], v[44:47], v[236:239]
    ds_read_b64_tr_b16 v[86:87], v11 offset:10752
    v_mfma_f32_16x16x32_bf16 v[236:239], v[92:95], v[60:63], v[236:239]
    s_waitcnt lgkmcnt(8)
    v_mfma_f32_16x16x32_bf16 v[112:115], v[96:99], a[0:3], 0
    ds_read_b64_tr_b16 v[88:89], v12 offset:2048
    v_mfma_f32_16x16x32_bf16 v[112:115], v[100:103], a[16:19], v[112:115]
    buffer_load_dwordx4 v9, s[32:35], s67 offen offset:1024 lds
    v_mfma_f32_16x16x32_bf16 v[116:119], v[96:99], a[4:7], 0
    ds_read_b64_tr_b16 v[90:91], v12 offset:2560
    v_mfma_f32_16x16x32_bf16 v[116:119], v[100:103], a[20:23], v[116:119]
    v_mfma_f32_16x16x32_bf16 v[120:123], v[96:99], a[8:11], 0
    ds_read_b64_tr_b16 v[92:93], v12 offset:10240
    s_add_u32 s68, s79, 16384
    v_mfma_f32_16x16x32_bf16 v[120:123], v[100:103], a[24:27], v[120:123]
    buffer_load_dwordx4 v8, s[36:39], s67 offen offset:2048 lds
    s_lshl_b32 s64, s60, 13
    v_mfma_f32_16x16x32_bf16 v[124:127], v[96:99], a[12:15], 0
    ds_read_b64_tr_b16 v[94:95], v12 offset:10752
    s_add_u32 s64, s64, 81920
    v_mfma_f32_16x16x32_bf16 v[124:127], v[100:103], a[28:31], v[124:127]
    v_add_u32 v11, 0xfffe0000, v11
    s_waitcnt vmcnt(19) lgkmcnt(8)
    s_barrier
    v_mfma_f32_16x16x32_bf16 v[128:131], v[104:107], a[0:3], 0
    ds_read_b64_tr_b16 v[96:97], v11 offset:0
    v_add_u32_e64 v251, s64, v28
    v_mfma_f32_16x16x32_bf16 v[128:131], v[108:111], a[16:19], v[128:131]
    buffer_load_dwordx4 v9, s[36:39], s67 offen offset:3072 lds
    s_add_u32 s67, s72, 3538944
    v_mfma_f32_16x16x32_bf16 v[132:135], v[104:107], a[4:7], 0
    ds_read_b64_tr_b16 v[98:99], v11 offset:512
    s_add_u32 m0, s70, 98304
    v_mfma_f32_16x16x32_bf16 v[132:135], v[108:111], a[20:23], v[132:135]
    v_mul_f32 v176, v176, v208
    v_mul_f32 v177, v177, v209
    v_mfma_f32_16x16x32_bf16 v[136:139], v[104:107], a[8:11], 0
    ds_read_b64_tr_b16 v[100:101], v11 offset:8192
    v_mul_f32_e64 v178, v178, v210
    v_mfma_f32_16x16x32_bf16 v[136:139], v[108:111], a[24:27], v[136:139]
    v_mul_f32 v179, v179, v211
    v_mul_f32 v192, v192, v224
    v_mfma_f32_16x16x32_bf16 v[140:143], v[104:107], a[12:15], 0
    ds_read_b64_tr_b16 v[102:103], v11 offset:8704
    v_mul_f32_e64 v193, v193, v225
    v_mfma_f32_16x16x32_bf16 v[140:143], v[108:111], a[28:31], v[140:143]
    v_add_u32 v12, 0xfffe0000, v12
    s_waitcnt lgkmcnt(8)
    v_mfma_f32_16x16x32_bf16 v[144:147], v[80:83], a[0:3], 0
    ds_read_b64_tr_b16 v[104:105], v12 offset:0
    v_mul_f32 v194, v194, v226
    v_mfma_f32_16x16x32_bf16 v[144:147], v[84:87], a[16:19], v[144:147]
    buffer_load_dwordx4 v8, s[32:35], s67 offen offset:0 lds
    v_mul_f32_e64 v195, v195, v227
    v_mfma_f32_16x16x32_bf16 v[148:151], v[80:83], a[4:7], 0
    ds_read_b64_tr_b16 v[106:107], v12 offset:512
    v_cvt_pk_bf16_f32 v208, v176, v177
    v_mfma_f32_16x16x32_bf16 v[148:151], v[84:87], a[20:23], v[148:151]
    v_cvt_pk_bf16_f32 v209, v178, v179
    v_cvt_pk_bf16_f32 v210, v192, v193
    v_mfma_f32_16x16x32_bf16 v[152:155], v[80:83], a[8:11], 0
    ds_read_b64_tr_b16 v[108:109], v12 offset:8192
    v_cvt_pk_bf16_f32 v211, v194, v195
    v_mfma_f32_16x16x32_bf16 v[152:155], v[84:87], a[24:27], v[152:155]
    buffer_store_dwordx4 v[208:211], v2, s[44:47], s68 offen offset:0 sc1
    v_mfma_f32_16x16x32_bf16 v[156:159], v[80:83], a[12:15], 0
    ds_read_b64_tr_b16 v[110:111], v12 offset:8704
    v_mfma_f32_16x16x32_bf16 v[156:159], v[84:87], a[28:31], v[156:159]
    buffer_load_dwordx4 v9, s[32:35], s67 offen offset:1024 lds
    s_waitcnt lgkmcnt(8)
    v_mfma_f32_16x16x32_bf16 v[160:163], v[88:91], a[0:3], 0
    ds_read_b64_tr_b16 v[80:81], v11 offset:2048
    v_mfma_f32_16x16x32_bf16 v[160:163], v[92:95], a[16:19], v[160:163]
    ds_write_b128 v251, v[208:211] offset:0
    v_mfma_f32_16x16x32_bf16 v[164:167], v[88:91], a[4:7], 0
    ds_read_b64_tr_b16 v[82:83], v11 offset:2560
    v_mul_f32 v180, v180, v212
    v_mfma_f32_16x16x32_bf16 v[164:167], v[92:95], a[20:23], v[164:167]
    v_mul_f32 v181, v181, v213
    v_mul_f32 v182, v182, v214
    v_mfma_f32_16x16x32_bf16 v[168:171], v[88:91], a[8:11], 0
    ds_read_b64_tr_b16 v[84:85], v11 offset:10240
    v_mul_f32_e64 v183, v183, v215
    v_mfma_f32_16x16x32_bf16 v[168:171], v[92:95], a[24:27], v[168:171]
    buffer_load_dwordx4 v8, s[36:39], s67 offen offset:2048 lds
    v_mul_f32_e64 v196, v196, v228
    v_mfma_f32_16x16x32_bf16 v[172:175], v[88:91], a[12:15], 0
    ds_read_b64_tr_b16 v[86:87], v11 offset:10752
    v_mul_f32_e64 v197, v197, v229
    v_mfma_f32_16x16x32_bf16 v[172:175], v[92:95], a[28:31], v[172:175]
    v_mul_f32 v198, v198, v230
    s_waitcnt lgkmcnt(9)
    v_mfma_f32_16x16x32_bf16 v[112:115], v[96:99], a[32:35], v[112:115]
    ds_read_b64_tr_b16 v[88:89], v12 offset:2048
    v_mul_f32_e64 v199, v199, v231
    v_mfma_f32_16x16x32_bf16 v[112:115], v[100:103], a[48:51], v[112:115]
    buffer_load_dwordx4 v9, s[36:39], s67 offen offset:3072 lds
    v_cvt_pk_bf16_f32 v212, v180, v181
    v_mfma_f32_16x16x32_bf16 v[116:119], v[96:99], a[36:39], v[116:119]
    ds_read_b64_tr_b16 v[90:91], v12 offset:2560
    v_cvt_pk_bf16_f32 v213, v182, v183
    v_mfma_f32_16x16x32_bf16 v[116:119], v[100:103], a[52:55], v[116:119]
    v_cvt_pk_bf16_f32 v214, v196, v197
    v_cvt_pk_bf16_f32 v215, v198, v199
    v_mfma_f32_16x16x32_bf16 v[120:123], v[96:99], a[40:43], v[120:123]
    ds_read_b64_tr_b16 v[92:93], v12 offset:10240
    v_mfma_f32_16x16x32_bf16 v[120:123], v[100:103], a[56:59], v[120:123]
    buffer_store_dwordx4 v[212:215], v2, s[44:47], s68 offen offset:1024 sc1
    v_mfma_f32_16x16x32_bf16 v[124:127], v[96:99], a[44:47], v[124:127]
    ds_read_b64_tr_b16 v[94:95], v12 offset:10752
    v_mfma_f32_16x16x32_bf16 v[124:127], v[100:103], a[60:63], v[124:127]
    s_waitcnt vmcnt(18) lgkmcnt(9)
    s_barrier
    v_mfma_f32_16x16x32_bf16 v[128:131], v[104:107], a[32:35], v[128:131]
    ds_read_b64_tr_b16 v[96:97], v11 offset:16384
    s_add_u32 s67, s72, 4128768
    v_mfma_f32_16x16x32_bf16 v[128:131], v[108:111], a[48:51], v[128:131]
    ds_write_b128 v251, v[212:215] offset:1024
    v_mfma_f32_16x16x32_bf16 v[132:135], v[104:107], a[36:39], v[132:135]
    ds_read_b64_tr_b16 v[98:99], v11 offset:16896
    s_add_u32 m0, s70, 131072
    v_mfma_f32_16x16x32_bf16 v[132:135], v[108:111], a[52:55], v[132:135]
    buffer_load_dwordx4 v8, s[32:35], s67 offen offset:0 lds
    v_mul_f32_e64 v184, v184, v216
    v_mfma_f32_16x16x32_bf16 v[136:139], v[104:107], a[40:43], v[136:139]
    ds_read_b64_tr_b16 v[100:101], v11 offset:24576
    v_mul_f32_e64 v185, v185, v217
    v_mfma_f32_16x16x32_bf16 v[136:139], v[108:111], a[56:59], v[136:139]
    v_mul_f32 v186, v186, v218
    v_mul_f32 v187, v187, v219
    v_mfma_f32_16x16x32_bf16 v[140:143], v[104:107], a[44:47], v[140:143]
    ds_read_b64_tr_b16 v[102:103], v11 offset:25088
    v_mul_f32_e64 v200, v200, v232
    v_mfma_f32_16x16x32_bf16 v[140:143], v[108:111], a[60:63], v[140:143]
    buffer_load_dwordx4 v9, s[32:35], s67 offen offset:1024 lds
    s_waitcnt lgkmcnt(9)
    v_mfma_f32_16x16x32_bf16 v[144:147], v[80:83], a[32:35], v[144:147]
    ds_read_b64_tr_b16 v[104:105], v12 offset:16384
    v_mul_f32 v201, v201, v233
    v_mfma_f32_16x16x32_bf16 v[144:147], v[84:87], a[48:51], v[144:147]
    v_mul_f32 v202, v202, v234
    v_mul_f32 v203, v203, v235
    v_mfma_f32_16x16x32_bf16 v[148:151], v[80:83], a[36:39], v[148:151]
    ds_read_b64_tr_b16 v[106:107], v12 offset:16896
    v_cvt_pk_bf16_f32 v216, v184, v185
    v_mfma_f32_16x16x32_bf16 v[148:151], v[84:87], a[52:55], v[148:151]
    buffer_load_dwordx4 v8, s[36:39], s67 offen offset:2048 lds
    v_cvt_pk_bf16_f32 v217, v186, v187
    v_mfma_f32_16x16x32_bf16 v[152:155], v[80:83], a[40:43], v[152:155]
    ds_read_b64_tr_b16 v[108:109], v12 offset:24576
    v_cvt_pk_bf16_f32 v218, v200, v201
    v_mfma_f32_16x16x32_bf16 v[152:155], v[84:87], a[56:59], v[152:155]
    v_cvt_pk_bf16_f32 v219, v202, v203
    v_mfma_f32_16x16x32_bf16 v[156:159], v[80:83], a[44:47], v[156:159]
    ds_read_b64_tr_b16 v[110:111], v12 offset:25088
    v_mfma_f32_16x16x32_bf16 v[156:159], v[84:87], a[60:63], v[156:159]
    s_waitcnt lgkmcnt(9)
    v_mfma_f32_16x16x32_bf16 v[160:163], v[88:91], a[32:35], v[160:163]
    ds_read_b64_tr_b16 v[80:81], v11 offset:18432
    v_mfma_f32_16x16x32_bf16 v[160:163], v[92:95], a[48:51], v[160:163]
    buffer_store_dwordx4 v[216:219], v2, s[44:47], s68 offen offset:2048 sc1
    v_mfma_f32_16x16x32_bf16 v[164:167], v[88:91], a[36:39], v[164:167]
    ds_read_b64_tr_b16 v[82:83], v11 offset:18944
    v_mfma_f32_16x16x32_bf16 v[164:167], v[92:95], a[52:55], v[164:167]
    ds_write_b128 v251, v[216:219] offset:2048
    v_mfma_f32_16x16x32_bf16 v[168:171], v[88:91], a[40:43], v[168:171]
    ds_read_b64_tr_b16 v[84:85], v11 offset:26624
    v_mul_f32 v188, v188, v220
    v_mfma_f32_16x16x32_bf16 v[168:171], v[92:95], a[56:59], v[168:171]
    buffer_load_dwordx4 v9, s[36:39], s67 offen offset:3072 lds
    v_mul_f32_e64 v189, v189, v221
    v_mfma_f32_16x16x32_bf16 v[172:175], v[88:91], a[44:47], v[172:175]
    ds_read_b64_tr_b16 v[86:87], v11 offset:27136
    v_mul_f32_e64 v190, v190, v222
    v_mfma_f32_16x16x32_bf16 v[172:175], v[92:95], a[60:63], v[172:175]
    v_mul_f32 v191, v191, v223
    s_waitcnt lgkmcnt(9)
    v_mfma_f32_16x16x32_bf16 v[112:115], v[96:99], a[64:67], v[112:115]
    ds_read_b64_tr_b16 v[88:89], v12 offset:18432
    v_mul_f32_e64 v204, v204, v236
    v_mfma_f32_16x16x32_bf16 v[112:115], v[100:103], a[80:83], v[112:115]
    v_mul_f32 v205, v205, v237
    v_mul_f32 v206, v206, v238
    v_mfma_f32_16x16x32_bf16 v[116:119], v[96:99], a[68:71], v[116:119]
    ds_read_b64_tr_b16 v[90:91], v12 offset:18944
    v_mul_f32_e64 v207, v207, v239
    v_mfma_f32_16x16x32_bf16 v[116:119], v[100:103], a[84:87], v[116:119]
    v_cvt_pk_bf16_f32 v220, v188, v189
    v_cvt_pk_bf16_f32 v221, v190, v191
    v_mfma_f32_16x16x32_bf16 v[120:123], v[96:99], a[72:75], v[120:123]
    ds_read_b64_tr_b16 v[92:93], v12 offset:26624
    v_cvt_pk_bf16_f32 v222, v204, v205
    v_mfma_f32_16x16x32_bf16 v[120:123], v[100:103], a[88:91], v[120:123]
    v_cvt_pk_bf16_f32 v223, v206, v207
    v_mfma_f32_16x16x32_bf16 v[124:127], v[96:99], a[76:79], v[124:127]
    ds_read_b64_tr_b16 v[94:95], v12 offset:27136
    v_mfma_f32_16x16x32_bf16 v[124:127], v[100:103], a[92:95], v[124:127]
    s_waitcnt vmcnt(19) lgkmcnt(9)
    s_barrier
    v_mfma_f32_16x16x32_bf16 v[128:131], v[104:107], a[64:67], v[128:131]
    ds_read_b64_tr_b16 v[96:97], v11 offset:32768
    s_add_u32 s67, s72, 4718592
    v_mfma_f32_16x16x32_bf16 v[128:131], v[108:111], a[80:83], v[128:131]
    buffer_store_dwordx4 v[220:223], v2, s[44:47], s68 offen offset:3072 sc1
    s_add_u32 m0, s70, 0
    v_mfma_f32_16x16x32_bf16 v[132:135], v[104:107], a[68:71], v[132:135]
    ds_read_b64_tr_b16 v[98:99], v11 offset:33280
    v_mfma_f32_16x16x32_bf16 v[132:135], v[108:111], a[84:87], v[132:135]
    ds_write_b128 v251, v[220:223] offset:3072
    v_mfma_f32_16x16x32_bf16 v[136:139], v[104:107], a[72:75], v[136:139]
    ds_read_b64_tr_b16 v[100:101], v11 offset:40960
    v_cndmask_b32 v244, v240, v244, vcc
    v_mfma_f32_16x16x32_bf16 v[136:139], v[108:111], a[88:91], v[136:139]
    buffer_load_dwordx4 v8, s[32:35], s67 offen offset:0 lds
    v_cndmask_b32_e64 v245, v240, v245, vcc
    v_mfma_f32_16x16x32_bf16 v[140:143], v[104:107], a[76:79], v[140:143]
    ds_read_b64_tr_b16 v[102:103], v11 offset:41472
    v_cndmask_b32_e64 v246, v240, v246, vcc
    v_mfma_f32_16x16x32_bf16 v[140:143], v[108:111], a[92:95], v[140:143]
    v_cndmask_b32 v247, v240, v247, vcc
    s_waitcnt lgkmcnt(9)
    v_mfma_f32_16x16x32_bf16 v[144:147], v[80:83], a[64:67], v[144:147]
    ds_read_b64_tr_b16 v[104:105], v12 offset:32768
    v_mfma_f32_16x16x32_bf16 v[144:147], v[84:87], a[80:83], v[144:147]
    ds_write_b128 v241, v[252:255]
    v_mfma_f32_16x16x32_bf16 v[148:151], v[80:83], a[68:71], v[148:151]
    ds_read_b64_tr_b16 v[106:107], v12 offset:33280
    v_mfma_f32_16x16x32_bf16 v[148:151], v[84:87], a[84:87], v[148:151]
    ds_write_b128 v242, v[244:247]
    v_mfma_f32_16x16x32_bf16 v[152:155], v[80:83], a[72:75], v[152:155]
    ds_read_b64_tr_b16 v[108:109], v12 offset:40960
    s_add_u32 s66, s91, 4294930432
    v_mfma_f32_16x16x32_bf16 v[152:155], v[84:87], a[88:91], v[152:155]
    buffer_load_dwordx4 v[64:67], v3, s[44:47], s66 offen sc1
    s_add_u32 s66, s91, 73728
    v_mfma_f32_16x16x32_bf16 v[156:159], v[80:83], a[76:79], v[156:159]
    ds_read_b64_tr_b16 v[110:111], v12 offset:41472
    v_mfma_f32_16x16x32_bf16 v[156:159], v[84:87], a[92:95], v[156:159]
    s_waitcnt lgkmcnt(11)
    v_mfma_f32_16x16x32_bf16 v[160:163], v[88:91], a[64:67], v[160:163]
    ds_read_b64_tr_b16 v[80:81], v11 offset:34816
    v_mfma_f32_16x16x32_bf16 v[160:163], v[92:95], a[80:83], v[160:163]
    buffer_load_dwordx4 v[68:71], v3, s[44:47], s66 offen sc1
    v_mfma_f32_16x16x32_bf16 v[164:167], v[88:91], a[68:71], v[164:167]
    ds_read_b64_tr_b16 v[82:83], v11 offset:35328
    v_mfma_f32_16x16x32_bf16 v[164:167], v[92:95], a[84:87], v[164:167]
    v_mfma_f32_16x16x32_bf16 v[168:171], v[88:91], a[72:75], v[168:171]
    ds_read_b64_tr_b16 v[84:85], v11 offset:43008
    v_mfma_f32_16x16x32_bf16 v[168:171], v[92:95], a[88:91], v[168:171]
    buffer_load_dwordx4 v9, s[32:35], s67 offen offset:1024 lds
    v_mfma_f32_16x16x32_bf16 v[172:175], v[88:91], a[76:79], v[172:175]
    ds_read_b64_tr_b16 v[86:87], v11 offset:43520
    v_mfma_f32_16x16x32_bf16 v[172:175], v[92:95], a[92:95], v[172:175]
    s_waitcnt lgkmcnt(10)
    v_mfma_f32_16x16x32_bf16 v[112:115], v[96:99], a[96:99], v[112:115]
    ds_read_b64_tr_b16 v[88:89], v12 offset:34816
    v_mfma_f32_16x16x32_bf16 v[112:115], v[100:103], a[112:115], v[112:115]
    v_mfma_f32_16x16x32_bf16 v[116:119], v[96:99], a[100:103], v[116:119]
    ds_read_b64_tr_b16 v[90:91], v12 offset:35328
    v_mfma_f32_16x16x32_bf16 v[116:119], v[100:103], a[116:119], v[116:119]
    buffer_load_dwordx4 v8, s[36:39], s67 offen offset:2048 lds
    v_mfma_f32_16x16x32_bf16 v[120:123], v[96:99], a[104:107], v[120:123]
    ds_read_b64_tr_b16 v[92:93], v12 offset:43008
    v_mfma_f32_16x16x32_bf16 v[120:123], v[100:103], a[120:123], v[120:123]
    v_mfma_f32_16x16x32_bf16 v[124:127], v[96:99], a[108:111], v[124:127]
    ds_read_b64_tr_b16 v[94:95], v12 offset:43520
    v_mfma_f32_16x16x32_bf16 v[124:127], v[100:103], a[124:127], v[124:127]
    s_waitcnt vmcnt(21) lgkmcnt(8)
    s_barrier
    v_mfma_f32_16x16x32_bf16 v[128:131], v[104:107], a[96:99], v[128:131]
    ds_read_b64_tr_b16 v[96:97], v11 offset:49152
    v_mfma_f32_16x16x32_bf16 v[128:131], v[108:111], a[112:115], v[128:131]
    buffer_load_dwordx4 v9, s[36:39], s67 offen offset:3072 lds
    s_lshl_b32 s67, s75, 7
    v_mfma_f32_16x16x32_bf16 v[132:135], v[104:107], a[100:103], v[132:135]
    ds_read_b64_tr_b16 v[98:99], v11 offset:49664
    s_add_u32 s72, s72, s67
    v_mfma_f32_16x16x32_bf16 v[132:135], v[108:111], a[116:119], v[132:135]
    s_add_u32 s67, s72, 0
    s_add_u32 m0, s70, 16384
    v_mfma_f32_16x16x32_bf16 v[136:139], v[104:107], a[104:107], v[136:139]
    ds_read_b64_tr_b16 v[100:101], v11 offset:57344
    v_mfma_f32_16x16x32_bf16 v[136:139], v[108:111], a[120:123], v[136:139]
    buffer_load_dwordx4 v8, s[32:35], s67 offen offset:0 lds
    v_mfma_f32_16x16x32_bf16 v[140:143], v[104:107], a[108:111], v[140:143]
    ds_read_b64_tr_b16 v[102:103], v11 offset:57856
    v_mfma_f32_16x16x32_bf16 v[140:143], v[108:111], a[124:127], v[140:143]
    s_waitcnt lgkmcnt(8)
    v_mfma_f32_16x16x32_bf16 v[144:147], v[80:83], a[96:99], v[144:147]
    ds_read_b64_tr_b16 v[104:105], v12 offset:49152
    v_mfma_f32_16x16x32_bf16 v[144:147], v[84:87], a[112:115], v[144:147]
    buffer_load_dwordx4 v9, s[32:35], s67 offen offset:1024 lds
    v_mfma_f32_16x16x32_bf16 v[148:151], v[80:83], a[100:103], v[148:151]
    ds_read_b64_tr_b16 v[106:107], v12 offset:49664
    v_mfma_f32_16x16x32_bf16 v[148:151], v[84:87], a[116:119], v[148:151]
    v_mfma_f32_16x16x32_bf16 v[152:155], v[80:83], a[104:107], v[152:155]
    ds_read_b64_tr_b16 v[108:109], v12 offset:57344
    v_mfma_f32_16x16x32_bf16 v[152:155], v[84:87], a[120:123], v[152:155]
    v_mfma_f32_16x16x32_bf16 v[156:159], v[80:83], a[108:111], v[156:159]
    ds_read_b64_tr_b16 v[110:111], v12 offset:57856
    v_mfma_f32_16x16x32_bf16 v[156:159], v[84:87], a[124:127], v[156:159]
    buffer_load_dwordx4 v8, s[36:39], s67 offen offset:2048 lds
    s_waitcnt lgkmcnt(8)
    v_mfma_f32_16x16x32_bf16 v[160:163], v[88:91], a[96:99], v[160:163]
    ds_read_b64_tr_b16 v[80:81], v11 offset:51200
    v_mfma_f32_16x16x32_bf16 v[160:163], v[92:95], a[112:115], v[160:163]
    v_mfma_f32_16x16x32_bf16 v[164:167], v[88:91], a[100:103], v[164:167]
    ds_read_b64_tr_b16 v[82:83], v11 offset:51712
    v_mfma_f32_16x16x32_bf16 v[164:167], v[92:95], a[116:119], v[164:167]
    buffer_load_dwordx4 v9, s[36:39], s67 offen offset:3072 lds
    v_mfma_f32_16x16x32_bf16 v[168:171], v[88:91], a[104:107], v[168:171]
    ds_read_b64_tr_b16 v[84:85], v11 offset:59392
    v_mfma_f32_16x16x32_bf16 v[168:171], v[92:95], a[120:123], v[168:171]
    v_mfma_f32_16x16x32_bf16 v[172:175], v[88:91], a[108:111], v[172:175]
    ds_read_b64_tr_b16 v[86:87], v11 offset:59904
    v_mfma_f32_16x16x32_bf16 v[172:175], v[92:95], a[124:127], v[172:175]
    s_waitcnt lgkmcnt(8)
    v_mfma_f32_16x16x32_bf16 v[112:115], v[96:99], a[128:131], v[112:115]
    ds_read_b64_tr_b16 v[88:89], v12 offset:51200
    v_mfma_f32_16x16x32_bf16 v[112:115], v[100:103], a[144:147], v[112:115]
    v_mfma_f32_16x16x32_bf16 v[116:119], v[96:99], a[132:135], v[116:119]
    ds_read_b64_tr_b16 v[90:91], v12 offset:51712
    v_mfma_f32_16x16x32_bf16 v[116:119], v[100:103], a[148:151], v[116:119]
    v_mfma_f32_16x16x32_bf16 v[120:123], v[96:99], a[136:139], v[120:123]
    ds_read_b64_tr_b16 v[92:93], v12 offset:59392
    v_mfma_f32_16x16x32_bf16 v[120:123], v[100:103], a[152:155], v[120:123]
    v_mfma_f32_16x16x32_bf16 v[124:127], v[96:99], a[140:143], v[124:127]
    ds_read_b64_tr_b16 v[94:95], v12 offset:59904
    v_mfma_f32_16x16x32_bf16 v[124:127], v[100:103], a[156:159], v[124:127]
    v_add_u32 v11, 0x10000, v11
    s_waitcnt vmcnt(22) lgkmcnt(8)
    s_barrier
    v_mfma_f32_16x16x32_bf16 v[128:131], v[104:107], a[128:131], v[128:131]
    ds_read_b64_tr_b16 v[96:97], v11 offset:0
    s_add_u32 s67, s72, 589824
    v_mfma_f32_16x16x32_bf16 v[128:131], v[108:111], a[144:147], v[128:131]
    s_add_u32 m0, s70, 32768
    v_mfma_f32_16x16x32_bf16 v[132:135], v[104:107], a[132:135], v[132:135]
    ds_read_b64_tr_b16 v[98:99], v11 offset:512
    v_mfma_f32_16x16x32_bf16 v[132:135], v[108:111], a[148:151], v[132:135]
    buffer_load_dwordx4 v8, s[32:35], s67 offen offset:0 lds
    v_mfma_f32_16x16x32_bf16 v[136:139], v[104:107], a[136:139], v[136:139]
    ds_read_b64_tr_b16 v[100:101], v11 offset:8192
    v_mfma_f32_16x16x32_bf16 v[136:139], v[108:111], a[152:155], v[136:139]
    v_mfma_f32_16x16x32_bf16 v[140:143], v[104:107], a[140:143], v[140:143]
    ds_read_b64_tr_b16 v[102:103], v11 offset:8704
    v_mfma_f32_16x16x32_bf16 v[140:143], v[108:111], a[156:159], v[140:143]
    v_add_u32 v12, 0x10000, v12
    s_waitcnt lgkmcnt(8)
    v_mfma_f32_16x16x32_bf16 v[144:147], v[80:83], a[128:131], v[144:147]
    ds_read_b64_tr_b16 v[104:105], v12 offset:0
    v_mfma_f32_16x16x32_bf16 v[144:147], v[84:87], a[144:147], v[144:147]
    buffer_load_dwordx4 v9, s[32:35], s67 offen offset:1024 lds
    v_mfma_f32_16x16x32_bf16 v[148:151], v[80:83], a[132:135], v[148:151]
    ds_read_b64_tr_b16 v[106:107], v12 offset:512
    v_mfma_f32_16x16x32_bf16 v[148:151], v[84:87], a[148:151], v[148:151]
    s_cmp_eq_u32 s18, 0
    s_cselect_b32 s21, s10, 0x10000000
    v_mfma_f32_16x16x32_bf16 v[152:155], v[80:83], a[136:139], v[152:155]
    ds_read_b64_tr_b16 v[108:109], v12 offset:8192
    v_mfma_f32_16x16x32_bf16 v[152:155], v[84:87], a[152:155], v[152:155]
    buffer_load_dwordx4 v8, s[36:39], s67 offen offset:2048 lds
    v_mfma_f32_16x16x32_bf16 v[156:159], v[80:83], a[140:143], v[156:159]
    ds_read_b64_tr_b16 v[110:111], v12 offset:8704
    v_mfma_f32_16x16x32_bf16 v[156:159], v[84:87], a[156:159], v[156:159]
    s_waitcnt lgkmcnt(8)
    v_mfma_f32_16x16x32_bf16 v[160:163], v[88:91], a[128:131], v[160:163]
    ds_read_b64_tr_b16 v[80:81], v11 offset:2048
    v_mfma_f32_16x16x32_bf16 v[160:163], v[92:95], a[144:147], v[160:163]
    buffer_load_dwordx4 v9, s[36:39], s67 offen offset:3072 lds
    v_mfma_f32_16x16x32_bf16 v[164:167], v[88:91], a[132:135], v[164:167]
    ds_read_b64_tr_b16 v[82:83], v11 offset:2560
    v_mfma_f32_16x16x32_bf16 v[164:167], v[92:95], a[148:151], v[164:167]
    v_mfma_f32_16x16x32_bf16 v[168:171], v[88:91], a[136:139], v[168:171]
    ds_read_b64_tr_b16 v[84:85], v11 offset:10240
    v_mfma_f32_16x16x32_bf16 v[168:171], v[92:95], a[152:155], v[168:171]
    v_mfma_f32_16x16x32_bf16 v[172:175], v[88:91], a[140:143], v[172:175]
    ds_read_b64_tr_b16 v[86:87], v11 offset:10752
    v_mfma_f32_16x16x32_bf16 v[172:175], v[92:95], a[156:159], v[172:175]
    s_waitcnt lgkmcnt(8)
    v_mfma_f32_16x16x32_bf16 v[112:115], v[96:99], a[160:163], v[112:115]
    ds_read_b64_tr_b16 v[88:89], v12 offset:2048
    v_mfma_f32_16x16x32_bf16 v[112:115], v[100:103], a[176:179], v[112:115]
    buffer_load_dword v0, v76, s[40:43], s21 offen offset:2048
    v_mfma_f32_16x16x32_bf16 v[116:119], v[96:99], a[164:167], v[116:119]
    ds_read_b64_tr_b16 v[90:91], v12 offset:2560
    v_mfma_f32_16x16x32_bf16 v[116:119], v[100:103], a[180:183], v[116:119]
    s_cmp_eq_u32 s18, 1
    s_cselect_b32 s21, s10, 0x10000000
    v_mfma_f32_16x16x32_bf16 v[120:123], v[96:99], a[168:171], v[120:123]
    ds_read_b64_tr_b16 v[92:93], v12 offset:10240
    v_mfma_f32_16x16x32_bf16 v[120:123], v[100:103], a[184:187], v[120:123]
    buffer_load_dword v0, v76, s[40:43], s21 offen offset:2048
    v_mfma_f32_16x16x32_bf16 v[124:127], v[96:99], a[172:175], v[124:127]
    ds_read_b64_tr_b16 v[94:95], v12 offset:10752
    v_mfma_f32_16x16x32_bf16 v[124:127], v[100:103], a[188:191], v[124:127]
    s_waitcnt vmcnt(23) lgkmcnt(8)
    s_barrier
    v_mfma_f32_16x16x32_bf16 v[128:131], v[104:107], a[160:163], v[128:131]
    ds_read_b64_tr_b16 v[96:97], v11 offset:32768
    s_add_u32 s67, s72, 1179648
    v_mfma_f32_16x16x32_bf16 v[128:131], v[108:111], a[176:179], v[128:131]
    s_add_u32 m0, s70, 49152
    v_mfma_f32_16x16x32_bf16 v[132:135], v[104:107], a[164:167], v[132:135]
    ds_read_b64_tr_b16 v[98:99], v11 offset:33280
    v_mfma_f32_16x16x32_bf16 v[132:135], v[108:111], a[180:183], v[132:135]
    v_mfma_f32_16x16x32_bf16 v[136:139], v[104:107], a[168:171], v[136:139]
    ds_read_b64_tr_b16 v[100:101], v11 offset:40960
    v_mfma_f32_16x16x32_bf16 v[136:139], v[108:111], a[184:187], v[136:139]
    v_mfma_f32_16x16x32_bf16 v[140:143], v[104:107], a[172:175], v[140:143]
    ds_read_b64_tr_b16 v[102:103], v11 offset:41472
    v_mfma_f32_16x16x32_bf16 v[140:143], v[108:111], a[188:191], v[140:143]
    s_waitcnt lgkmcnt(8)
    v_mfma_f32_16x16x32_bf16 v[144:147], v[80:83], a[160:163], v[144:147]
    ds_read_b64_tr_b16 v[104:105], v12 offset:32768
    v_mfma_f32_16x16x32_bf16 v[144:147], v[84:87], a[176:179], v[144:147]
    v_mfma_f32_16x16x32_bf16 v[148:151], v[80:83], a[164:167], v[148:151]
    ds_read_b64_tr_b16 v[106:107], v12 offset:33280
    v_mfma_f32_16x16x32_bf16 v[148:151], v[84:87], a[180:183], v[148:151]
    v_mfma_f32_16x16x32_bf16 v[152:155], v[80:83], a[168:171], v[152:155]
    ds_read_b64_tr_b16 v[108:109], v12 offset:40960
    v_mfma_f32_16x16x32_bf16 v[152:155], v[84:87], a[184:187], v[152:155]
    v_mfma_f32_16x16x32_bf16 v[156:159], v[80:83], a[172:175], v[156:159]
    ds_read_b64_tr_b16 v[110:111], v12 offset:41472
    v_mfma_f32_16x16x32_bf16 v[156:159], v[84:87], a[188:191], v[156:159]
    s_waitcnt lgkmcnt(8)
    v_mfma_f32_16x16x32_bf16 v[160:163], v[88:91], a[160:163], v[160:163]
    ds_read_b64_tr_b16 v[80:81], v11 offset:34816
    v_mfma_f32_16x16x32_bf16 v[160:163], v[92:95], a[176:179], v[160:163]
    v_mfma_f32_16x16x32_bf16 v[164:167], v[88:91], a[164:167], v[164:167]
    ds_read_b64_tr_b16 v[82:83], v11 offset:35328
    v_mfma_f32_16x16x32_bf16 v[164:167], v[92:95], a[180:183], v[164:167]
    v_mfma_f32_16x16x32_bf16 v[168:171], v[88:91], a[168:171], v[168:171]
    ds_read_b64_tr_b16 v[84:85], v11 offset:43008
    v_mfma_f32_16x16x32_bf16 v[168:171], v[92:95], a[184:187], v[168:171]
    v_mfma_f32_16x16x32_bf16 v[172:175], v[88:91], a[172:175], v[172:175]
    ds_read_b64_tr_b16 v[86:87], v11 offset:43520
    v_mfma_f32_16x16x32_bf16 v[172:175], v[92:95], a[188:191], v[172:175]
    s_waitcnt lgkmcnt(8)
    v_mfma_f32_16x16x32_bf16 v[112:115], v[96:99], a[192:195], v[112:115]
    ds_read_b64_tr_b16 v[88:89], v12 offset:34816
    v_mfma_f32_16x16x32_bf16 v[112:115], v[100:103], a[208:211], v[112:115]
    v_mfma_f32_16x16x32_bf16 v[116:119], v[96:99], a[196:199], v[116:119]
    ds_read_b64_tr_b16 v[90:91], v12 offset:35328
    v_mfma_f32_16x16x32_bf16 v[116:119], v[100:103], a[212:215], v[116:119]
    v_mfma_f32_16x16x32_bf16 v[120:123], v[96:99], a[200:203], v[120:123]
    ds_read_b64_tr_b16 v[92:93], v12 offset:43008
    v_mfma_f32_16x16x32_bf16 v[120:123], v[100:103], a[216:219], v[120:123]
    v_mfma_f32_16x16x32_bf16 v[124:127], v[96:99], a[204:207], v[124:127]
    ds_read_b64_tr_b16 v[94:95], v12 offset:43520
    v_mfma_f32_16x16x32_bf16 v[124:127], v[100:103], a[220:223], v[124:127]
    v_add_u32 v11, 0x10000, v11
    s_waitcnt vmcnt(17) lgkmcnt(8)
    s_barrier
    v_mfma_f32_16x16x32_bf16 v[128:131], v[104:107], a[192:195], v[128:131]
    ds_read_b64_tr_b16 v[96:97], v11 offset:0
    v_mfma_f32_16x16x32_bf16 v[128:131], v[108:111], a[208:211], v[128:131]
    v_mfma_f32_16x16x32_bf16 v[132:135], v[104:107], a[196:199], v[132:135]
    ds_read_b64_tr_b16 v[98:99], v11 offset:512
    v_mfma_f32_16x16x32_bf16 v[132:135], v[108:111], a[212:215], v[132:135]
    v_mfma_f32_16x16x32_bf16 v[136:139], v[104:107], a[200:203], v[136:139]
    ds_read_b64_tr_b16 v[100:101], v11 offset:8192
    v_mfma_f32_16x16x32_bf16 v[136:139], v[108:111], a[216:219], v[136:139]
    v_mfma_f32_16x16x32_bf16 v[140:143], v[104:107], a[204:207], v[140:143]
    ds_read_b64_tr_b16 v[102:103], v11 offset:8704
    v_mfma_f32_16x16x32_bf16 v[140:143], v[108:111], a[220:223], v[140:143]
    v_add_u32 v12, 0x10000, v12
    s_waitcnt lgkmcnt(8)
    v_mfma_f32_16x16x32_bf16 v[144:147], v[80:83], a[192:195], v[144:147]
    ds_read_b64_tr_b16 v[104:105], v12 offset:0
    v_mfma_f32_16x16x32_bf16 v[144:147], v[84:87], a[208:211], v[144:147]
    buffer_load_dwordx4 v8, s[32:35], s67 offen offset:0 lds
    v_mfma_f32_16x16x32_bf16 v[148:151], v[80:83], a[196:199], v[148:151]
    ds_read_b64_tr_b16 v[106:107], v12 offset:512
    v_mfma_f32_16x16x32_bf16 v[148:151], v[84:87], a[212:215], v[148:151]
    v_mfma_f32_16x16x32_bf16 v[152:155], v[80:83], a[200:203], v[152:155]
    ds_read_b64_tr_b16 v[108:109], v12 offset:8192
    v_mfma_f32_16x16x32_bf16 v[152:155], v[84:87], a[216:219], v[152:155]
    buffer_load_dwordx4 v9, s[32:35], s67 offen offset:1024 lds
    v_mfma_f32_16x16x32_bf16 v[156:159], v[80:83], a[204:207], v[156:159]
    ds_read_b64_tr_b16 v[110:111], v12 offset:8704
    v_mfma_f32_16x16x32_bf16 v[156:159], v[84:87], a[220:223], v[156:159]
    s_waitcnt lgkmcnt(8)
    v_mfma_f32_16x16x32_bf16 v[160:163], v[88:91], a[192:195], v[160:163]
    ds_read_b64_tr_b16 v[80:81], v11 offset:2048
    v_mfma_f32_16x16x32_bf16 v[160:163], v[92:95], a[208:211], v[160:163]
    buffer_load_dwordx4 v8, s[36:39], s67 offen offset:2048 lds
    v_mfma_f32_16x16x32_bf16 v[164:167], v[88:91], a[196:199], v[164:167]
    ds_read_b64_tr_b16 v[82:83], v11 offset:2560
    v_mfma_f32_16x16x32_bf16 v[164:167], v[92:95], a[212:215], v[164:167]
    v_mfma_f32_16x16x32_bf16 v[168:171], v[88:91], a[200:203], v[168:171]
    ds_read_b64_tr_b16 v[84:85], v11 offset:10240
    v_mfma_f32_16x16x32_bf16 v[168:171], v[92:95], a[216:219], v[168:171]
    v_mfma_f32_16x16x32_bf16 v[172:175], v[88:91], a[204:207], v[172:175]
    ds_read_b64_tr_b16 v[86:87], v11 offset:10752
    v_mfma_f32_16x16x32_bf16 v[172:175], v[92:95], a[220:223], v[172:175]
    buffer_load_dwordx4 v9, s[36:39], s67 offen offset:3072 lds
    s_waitcnt lgkmcnt(8)
    v_mfma_f32_16x16x32_bf16 v[112:115], v[96:99], a[224:227], v[112:115]
    ds_read_b64_tr_b16 v[88:89], v12 offset:2048
    s_add_u32 s67, s72, 1769472
    v_mfma_f32_16x16x32_bf16 v[112:115], v[100:103], a[240:243], v[112:115]
    s_add_u32 m0, s70, 65536
    v_mfma_f32_16x16x32_bf16 v[116:119], v[96:99], a[228:231], v[116:119]
    ds_read_b64_tr_b16 v[90:91], v12 offset:2560
    v_mfma_f32_16x16x32_bf16 v[116:119], v[100:103], a[244:247], v[116:119]
    buffer_load_dwordx4 v8, s[32:35], s67 offen offset:0 lds
    v_mfma_f32_16x16x32_bf16 v[120:123], v[96:99], a[232:235], v[120:123]
    ds_read_b64_tr_b16 v[92:93], v12 offset:10240
    v_mfma_f32_16x16x32_bf16 v[120:123], v[100:103], a[248:251], v[120:123]
    v_mfma_f32_16x16x32_bf16 v[124:127], v[96:99], a[236:239], v[124:127]
    ds_read_b64_tr_b16 v[94:95], v12 offset:10752
    v_mfma_f32_16x16x32_bf16 v[124:127], v[100:103], a[252:255], v[124:127]
    v_add_u32 v11, 0xfffe0000, v11
    s_waitcnt vmcnt(15) lgkmcnt(8)
    s_barrier
    v_mfma_f32_16x16x32_bf16 v[128:131], v[104:107], a[224:227], v[128:131]
    ds_read_b64_tr_b16 v[96:97], v11 offset:0
    v_mfma_f32_16x16x32_bf16 v[128:131], v[108:111], a[240:243], v[128:131]
    buffer_load_dwordx4 v9, s[32:35], s67 offen offset:1024 lds
    v_mfma_f32_16x16x32_bf16 v[132:135], v[104:107], a[228:231], v[132:135]
    ds_read_b64_tr_b16 v[98:99], v11 offset:512
    v_mfma_f32_16x16x32_bf16 v[132:135], v[108:111], a[244:247], v[132:135]
    v_mfma_f32_16x16x32_bf16 v[136:139], v[104:107], a[232:235], v[136:139]
    ds_read_b64_tr_b16 v[100:101], v11 offset:8192
    v_mfma_f32_16x16x32_bf16 v[136:139], v[108:111], a[248:251], v[136:139]
    buffer_load_dwordx4 v8, s[36:39], s67 offen offset:2048 lds
    v_mfma_f32_16x16x32_bf16 v[140:143], v[104:107], a[236:239], v[140:143]
    ds_read_b64_tr_b16 v[102:103], v11 offset:8704
    v_mfma_f32_16x16x32_bf16 v[140:143], v[108:111], a[252:255], v[140:143]
    v_add_u32 v12, 0xfffe0000, v12
    s_waitcnt lgkmcnt(8)
    v_mfma_f32_16x16x32_bf16 v[144:147], v[80:83], a[224:227], v[144:147]
    ds_read_b64_tr_b16 v[104:105], v12 offset:0
    v_mfma_f32_16x16x32_bf16 v[144:147], v[84:87], a[240:243], v[144:147]
    buffer_load_dwordx4 v9, s[36:39], s67 offen offset:3072 lds
    s_add_u32 s67, s72, 2359296
    v_mfma_f32_16x16x32_bf16 v[148:151], v[80:83], a[228:231], v[148:151]
    ds_read_b64_tr_b16 v[106:107], v12 offset:512
    s_add_u32 m0, s70, 98304
    v_mfma_f32_16x16x32_bf16 v[148:151], v[84:87], a[244:247], v[148:151]
    v_mfma_f32_16x16x32_bf16 v[152:155], v[80:83], a[232:235], v[152:155]
    ds_read_b64_tr_b16 v[108:109], v12 offset:8192
    v_mfma_f32_16x16x32_bf16 v[152:155], v[84:87], a[248:251], v[152:155]
    v_mfma_f32_16x16x32_bf16 v[156:159], v[80:83], a[236:239], v[156:159]
    ds_read_b64_tr_b16 v[110:111], v12 offset:8704
    v_mfma_f32_16x16x32_bf16 v[156:159], v[84:87], a[252:255], v[156:159]
    buffer_load_dwordx4 v8, s[32:35], s67 offen offset:0 lds
    s_waitcnt lgkmcnt(8)
    v_mfma_f32_16x16x32_bf16 v[160:163], v[88:91], a[224:227], v[160:163]
    ds_read_b64_tr_b16 v[80:81], v11 offset:2048
    v_mfma_f32_16x16x32_bf16 v[160:163], v[92:95], a[240:243], v[160:163]
    v_mfma_f32_16x16x32_bf16 v[164:167], v[88:91], a[228:231], v[164:167]
    ds_read_b64_tr_b16 v[82:83], v11 offset:2560
    v_mfma_f32_16x16x32_bf16 v[164:167], v[92:95], a[244:247], v[164:167]
    buffer_load_dwordx4 v9, s[32:35], s67 offen offset:1024 lds
    v_mfma_f32_16x16x32_bf16 v[168:171], v[88:91], a[232:235], v[168:171]
    ds_read_b64_tr_b16 v[84:85], v11 offset:10240
    v_mfma_f32_16x16x32_bf16 v[168:171], v[92:95], a[248:251], v[168:171]
    v_mfma_f32_16x16x32_bf16 v[172:175], v[88:91], a[236:239], v[172:175]
    ds_read_b64_tr_b16 v[86:87], v11 offset:10752
    v_mfma_f32_16x16x32_bf16 v[172:175], v[92:95], a[252:255], v[172:175]
    s_waitcnt lgkmcnt(8)
    v_mfma_f32_16x16x32_bf16 v[112:115], v[96:99], v[32:35], v[112:115]
    ds_read_b64_tr_b16 v[88:89], v12 offset:2048
    v_mfma_f32_16x16x32_bf16 v[112:115], v[100:103], v[48:51], v[112:115]
    ds_read_b32 v72, v248 offset:0
    v_mfma_f32_16x16x32_bf16 v[116:119], v[96:99], v[36:39], v[116:119]
    ds_read_b64_tr_b16 v[90:91], v12 offset:2560
    v_mfma_f32_16x16x32_bf16 v[116:119], v[100:103], v[52:55], v[116:119]
    ds_read_b32 v73, v248 offset:8
    v_mfma_f32_16x16x32_bf16 v[120:123], v[96:99], v[40:43], v[120:123]
    ds_read_b64_tr_b16 v[92:93], v12 offset:10240
    v_mfma_f32_16x16x32_bf16 v[120:123], v[100:103], v[56:59], v[120:123]
    ds_read_b32 v74, v248 offset:256
    v_mfma_f32_16x16x32_bf16 v[124:127], v[96:99], v[44:47], v[124:127]
    ds_read_b64_tr_b16 v[94:95], v12 offset:10752
    v_mfma_f32_16x16x32_bf16 v[124:127], v[100:103], v[60:63], v[124:127]
    s_waitcnt vmcnt(16) lgkmcnt(11)
    s_barrier
    v_mfma_f32_16x16x32_bf16 v[128:131], v[104:107], v[32:35], v[128:131]
    ds_read_b64_tr_b16 v[96:97], v11 offset:16384
    v_mfma_f32_16x16x32_bf16 v[128:131], v[108:111], v[48:51], v[128:131]
    ds_read_b32 v75, v248 offset:264
    v_mfma_f32_16x16x32_bf16 v[132:135], v[104:107], v[36:39], v[132:135]
    ds_read_b64_tr_b16 v[98:99], v11 offset:16896
    v_mfma_f32_16x16x32_bf16 v[132:135], v[108:111], v[52:55], v[132:135]
    buffer_load_dwordx4 v8, s[36:39], s67 offen offset:2048 lds
    v_mfma_f32_16x16x32_bf16 v[136:139], v[104:107], v[40:43], v[136:139]
    ds_read_b64_tr_b16 v[100:101], v11 offset:24576
    v_mfma_f32_16x16x32_bf16 v[136:139], v[108:111], v[56:59], v[136:139]
    v_mfma_f32_16x16x32_bf16 v[140:143], v[104:107], v[44:47], v[140:143]
    ds_read_b64_tr_b16 v[102:103], v11 offset:25088
    v_mfma_f32_16x16x32_bf16 v[140:143], v[108:111], v[60:63], v[140:143]
    buffer_load_dwordx4 v9, s[36:39], s67 offen offset:3072 lds
    s_waitcnt lgkmcnt(12)
    v_mfma_f32_16x16x32_bf16 v[144:147], v[80:83], v[32:35], v[144:147]
    ds_read_b64_tr_b16 v[104:105], v12 offset:16384
    v_mfma_f32_16x16x32_bf16 v[144:147], v[84:87], v[48:51], v[144:147]
    v_mfma_f32_16x16x32_bf16 v[148:151], v[80:83], v[36:39], v[148:151]
    ds_read_b64_tr_b16 v[106:107], v12 offset:16896
    v_mfma_f32_16x16x32_bf16 v[148:151], v[84:87], v[52:55], v[148:151]
    v_mfma_f32_16x16x32_bf16 v[152:155], v[80:83], v[40:43], v[152:155]
    ds_read_b64_tr_b16 v[108:109], v12 offset:24576
    v_mfma_f32_16x16x32_bf16 v[152:155], v[84:87], v[56:59], v[152:155]
    v_mfma_f32_16x16x32_bf16 v[156:159], v[80:83], v[44:47], v[156:159]
    ds_read_b64_tr_b16 v[110:111], v12 offset:25088
    v_mfma_f32_16x16x32_bf16 v[156:159], v[84:87], v[60:63], v[156:159]
    s_waitcnt lgkmcnt(9)
    v_mfma_f32_16x16x32_bf16 v[160:163], v[88:91], v[32:35], v[160:163]
    ds_read_b64_tr_b16 v[80:81], v11 offset:18432
    v_mfma_f32_16x16x32_bf16 v[160:163], v[92:95], v[48:51], v[160:163]
    v_mfma_f32_16x16x32_bf16 v[164:167], v[88:91], v[36:39], v[164:167]
    ds_read_b64_tr_b16 v[82:83], v11 offset:18944
    v_mfma_f32_16x16x32_bf16 v[164:167], v[92:95], v[52:55], v[164:167]
    v_mfma_f32_16x16x32_bf16 v[168:171], v[88:91], v[40:43], v[168:171]
    ds_read_b64_tr_b16 v[84:85], v11 offset:26624
    v_mfma_f32_16x16x32_bf16 v[168:171], v[92:95], v[56:59], v[168:171]
    v_mfma_f32_16x16x32_bf16 v[172:175], v[88:91], v[44:47], v[172:175]
    ds_read_b64_tr_b16 v[86:87], v11 offset:27136
    v_mfma_f32_16x16x32_bf16 v[172:175], v[92:95], v[60:63], v[172:175]
    s_waitcnt lgkmcnt(8)
    v_mfma_f32_16x16x32_bf16 v[176:179], v[96:99], a[0:3], 0
    ds_read_b64_tr_b16 v[88:89], v12 offset:18432
    v_mfma_f32_16x16x32_bf16 v[176:179], v[100:103], a[16:19], v[176:179]
    v_mfma_f32_16x16x32_bf16 v[180:183], v[96:99], a[4:7], 0
    ds_read_b64_tr_b16 v[90:91], v12 offset:18944
    v_mfma_f32_16x16x32_bf16 v[180:183], v[100:103], a[20:23], v[180:183]
    v_mfma_f32_16x16x32_bf16 v[184:187], v[96:99], a[8:11], 0
    ds_read_b64_tr_b16 v[92:93], v12 offset:26624
    s_add_u32 s68, s79, 32768
    v_mfma_f32_16x16x32_bf16 v[184:187], v[100:103], a[24:27], v[184:187]
    s_lshl_b32 s64, s60, 13
    s_add_u32 s64, s64, 131072
    v_mfma_f32_16x16x32_bf16 v[188:191], v[96:99], a[12:15], 0
    ds_read_b64_tr_b16 v[94:95], v12 offset:27136
    v_add_u32_e64 v251, s64, v28
    v_mfma_f32_16x16x32_bf16 v[188:191], v[100:103], a[28:31], v[188:191]
    s_waitcnt vmcnt(14) lgkmcnt(8)
    s_barrier
    v_mfma_f32_16x16x32_bf16 v[192:195], v[104:107], a[0:3], 0
    ds_read_b64_tr_b16 v[96:97], v11 offset:32768
    s_add_u32 s67, s72, 2949120
    v_mfma_f32_16x16x32_bf16 v[192:195], v[108:111], a[16:19], v[192:195]
    s_add_u32 m0, s70, 0
    v_mul_f32 v112, v112, v144
    v_mfma_f32_16x16x32_bf16 v[196:199], v[104:107], a[4:7], 0
    ds_read_b64_tr_b16 v[98:99], v11 offset:33280
    v_mul_f32_e64 v113, v113, v145
    v_mfma_f32_16x16x32_bf16 v[196:199], v[108:111], a[20:23], v[196:199]
    buffer_load_dwordx4 v8, s[32:35], s67 offen offset:0 lds
    v_mul_f32_e64 v114, v114, v146
    v_mfma_f32_16x16x32_bf16 v[200:203], v[104:107], a[8:11], 0
    ds_read_b64_tr_b16 v[100:101], v11 offset:40960
    v_mul_f32_e64 v115, v115, v147
    v_mfma_f32_16x16x32_bf16 v[200:203], v[108:111], a[24:27], v[200:203]
    v_mul_f32 v128, v128, v160
    v_mul_f32 v129, v129, v161
    v_mfma_f32_16x16x32_bf16 v[204:207], v[104:107], a[12:15], 0
    ds_read_b64_tr_b16 v[102:103], v11 offset:41472
    v_mul_f32_e64 v130, v130, v162
    v_mfma_f32_16x16x32_bf16 v[204:207], v[108:111], a[28:31], v[204:207]
    buffer_load_dwordx4 v9, s[32:35], s67 offen offset:1024 lds
    s_waitcnt lgkmcnt(8)
    v_mfma_f32_16x16x32_bf16 v[208:211], v[80:83], a[0:3], 0
    ds_read_b64_tr_b16 v[104:105], v12 offset:32768
    v_mul_f32 v131, v131, v163
    v_mfma_f32_16x16x32_bf16 v[208:211], v[84:87], a[16:19], v[208:211]
    v_cvt_pk_bf16_f32 v144, v112, v113
    v_cvt_pk_bf16_f32 v145, v114, v115
    v_mfma_f32_16x16x32_bf16 v[212:215], v[80:83], a[4:7], 0
    ds_read_b64_tr_b16 v[106:107], v12 offset:33280
    v_cvt_pk_bf16_f32 v146, v128, v129
    v_mfma_f32_16x16x32_bf16 v[212:215], v[84:87], a[20:23], v[212:215]
    buffer_load_dwordx4 v8, s[36:39], s67 offen offset:2048 lds
    v_cvt_pk_bf16_f32 v147, v130, v131
    v_mfma_f32_16x16x32_bf16 v[216:219], v[80:83], a[8:11], 0
    ds_read_b64_tr_b16 v[108:109], v12 offset:40960
    v_mfma_f32_16x16x32_bf16 v[216:219], v[84:87], a[24:27], v[216:219]
    v_mfma_f32_16x16x32_bf16 v[220:223], v[80:83], a[12:15], 0
    ds_read_b64_tr_b16 v[110:111], v12 offset:41472
    v_mfma_f32_16x16x32_bf16 v[220:223], v[84:87], a[28:31], v[220:223]
    s_waitcnt lgkmcnt(8)
    v_mfma_f32_16x16x32_bf16 v[224:227], v[88:91], a[0:3], 0
    ds_read_b64_tr_b16 v[80:81], v11 offset:34816
    v_mfma_f32_16x16x32_bf16 v[224:227], v[92:95], a[16:19], v[224:227]
    buffer_store_dwordx4 v[144:147], v2, s[44:47], s68 offen offset:0 sc1
    v_mfma_f32_16x16x32_bf16 v[228:231], v[88:91], a[4:7], 0
    ds_read_b64_tr_b16 v[82:83], v11 offset:35328
    v_mfma_f32_16x16x32_bf16 v[228:231], v[92:95], a[20:23], v[228:231]
    ds_write_b128 v251, v[144:147] offset:0
    v_mfma_f32_16x16x32_bf16 v[232:235], v[88:91], a[8:11], 0
    ds_read_b64_tr_b16 v[84:85], v11 offset:43008
    v_mul_f32 v116, v116, v148
    v_mfma_f32_16x16x32_bf16 v[232:235], v[92:95], a[24:27], v[232:235]
    buffer_load_dwordx4 v9, s[36:39], s67 offen offset:3072 lds
    v_mul_f32_e64 v117, v117, v149
    v_mfma_f32_16x16x32_bf16 v[236:239], v[88:91], a[12:15], 0
    ds_read_b64_tr_b16 v[86:87], v11 offset:43520
    v_mul_f32_e64 v118, v118, v150
    v_mfma_f32_16x16x32_bf16 v[236:239], v[92:95], a[28:31], v[236:239]
    v_mul_f32 v119, v119, v151
    s_waitcnt lgkmcnt(9)
    v_mfma_f32_16x16x32_bf16 v[176:179], v[96:99], a[32:35], v[176:179]
    ds_read_b64_tr_b16 v[88:89], v12 offset:34816
    v_mul_f32_e64 v132, v132, v164
    v_mfma_f32_16x16x32_bf16 v[176:179], v[100:103], a[48:51], v[176:179]
    v_mul_f32 v133, v133, v165
    v_mul_f32 v134, v134, v166
    v_mfma_f32_16x16x32_bf16 v[180:183], v[96:99], a[36:39], v[180:183]
    ds_read_b64_tr_b16 v[90:91], v12 offset:35328
    v_mul_f32_e64 v135, v135, v167
    v_mfma_f32_16x16x32_bf16 v[180:183], v[100:103], a[52:55], v[180:183]
    v_cvt_pk_bf16_f32 v148, v116, v117
    v_cvt_pk_bf16_f32 v149, v118, v119
    v_mfma_f32_16x16x32_bf16 v[184:187], v[96:99], a[40:43], v[184:187]
    ds_read_b64_tr_b16 v[92:93], v12 offset:43008
    v_cvt_pk_bf16_f32 v150, v132, v133
    v_mfma_f32_16x16x32_bf16 v[184:187], v[100:103], a[56:59], v[184:187]
    v_cvt_pk_bf16_f32 v151, v134, v135
    v_mfma_f32_16x16x32_bf16 v[188:191], v[96:99], a[44:47], v[188:191]
    ds_read_b64_tr_b16 v[94:95], v12 offset:43520
    v_mfma_f32_16x16x32_bf16 v[188:191], v[100:103], a[60:63], v[188:191]
    s_waitcnt vmcnt(13) lgkmcnt(9)
    s_barrier
    v_mfma_f32_16x16x32_bf16 v[192:195], v[104:107], a[32:35], v[192:195]
    ds_read_b64_tr_b16 v[96:97], v11 offset:49152
    s_add_u32 s67, s72, 3538944
    v_mfma_f32_16x16x32_bf16 v[192:195], v[108:111], a[48:51], v[192:195]
    buffer_store_dwordx4 v[148:151], v2, s[44:47], s68 offen offset:1024 sc1
    s_add_u32 m0, s70, 16384
    v_mfma_f32_16x16x32_bf16 v[196:199], v[104:107], a[36:39], v[196:199]
    ds_read_b64_tr_b16 v[98:99], v11 offset:49664
    v_mfma_f32_16x16x32_bf16 v[196:199], v[108:111], a[52:55], v[196:199]
    ds_write_b128 v251, v[148:151] offset:1024
    v_mfma_f32_16x16x32_bf16 v[200:203], v[104:107], a[40:43], v[200:203]
    ds_read_b64_tr_b16 v[100:101], v11 offset:57344
    v_mul_f32_e64 v120, v120, v152
    v_mfma_f32_16x16x32_bf16 v[200:203], v[108:111], a[56:59], v[200:203]
    buffer_load_dwordx4 v8, s[32:35], s67 offen offset:0 lds
    v_mul_f32_e64 v121, v121, v153
    v_mfma_f32_16x16x32_bf16 v[204:207], v[104:107], a[44:47], v[204:207]
    ds_read_b64_tr_b16 v[102:103], v11 offset:57856
    v_mul_f32_e64 v122, v122, v154
    v_mfma_f32_16x16x32_bf16 v[204:207], v[108:111], a[60:63], v[204:207]
    v_mul_f32 v123, v123, v155
    s_waitcnt lgkmcnt(9)
    v_mfma_f32_16x16x32_bf16 v[208:211], v[80:83], a[32:35], v[208:211]
    ds_read_b64_tr_b16 v[104:105], v12 offset:49152
    v_mul_f32_e64 v136, v136, v168
    v_mfma_f32_16x16x32_bf16 v[208:211], v[84:87], a[48:51], v[208:211]
    buffer_load_dwordx4 v9, s[32:35], s67 offen offset:1024 lds
    v_mul_f32_e64 v137, v137, v169
    v_mfma_f32_16x16x32_bf16 v[212:215], v[80:83], a[36:39], v[212:215]
    ds_read_b64_tr_b16 v[106:107], v12 offset:49664
    v_mul_f32_e64 v138, v138, v170
    v_mfma_f32_16x16x32_bf16 v[212:215], v[84:87], a[52:55], v[212:215]
    v_mul_f32_e64 v139, v139, v171
    v_cvt_pk_bf16_f32 v152, v120, v121
    v_mfma_f32_16x16x32_bf16 v[216:219], v[80:83], a[40:43], v[216:219]
    ds_read_b64_tr_b16 v[108:109], v12 offset:57344
    v_cvt_pk_bf16_f32 v153, v122, v123
    v_mfma_f32_16x16x32_bf16 v[216:219], v[84:87], a[56:59], v[216:219]
    buffer_load_dwordx4 v8, s[36:39], s67 offen offset:2048 lds
    v_cvt_pk_bf16_f32 v154, v136, v137
    v_mfma_f32_16x16x32_bf16 v[220:223], v[80:83], a[44:47], v[220:223]
    ds_read_b64_tr_b16 v[110:111], v12 offset:57856
    v_cvt_pk_bf16_f32 v155, v138, v139
    v_mfma_f32_16x16x32_bf16 v[220:223], v[84:87], a[60:63], v[220:223]
    s_waitcnt lgkmcnt(9)
    v_mfma_f32_16x16x32_bf16 v[224:227], v[88:91], a[32:35], v[224:227]
    ds_read_b64_tr_b16 v[80:81], v11 offset:51200
    v_mfma_f32_16x16x32_bf16 v[224:227], v[92:95], a[48:51], v[224:227]
    v_mfma_f32_16x16x32_bf16 v[228:231], v[88:91], a[36:39], v[228:231]
    ds_read_b64_tr_b16 v[82:83], v11 offset:51712
    v_mfma_f32_16x16x32_bf16 v[228:231], v[92:95], a[52:55], v[228:231]
    buffer_store_dwordx4 v[152:155], v2, s[44:47], s68 offen offset:2048 sc1
    v_mfma_f32_16x16x32_bf16 v[232:235], v[88:91], a[40:43], v[232:235]
    ds_read_b64_tr_b16 v[84:85], v11 offset:59392
    v_mfma_f32_16x16x32_bf16 v[232:235], v[92:95], a[56:59], v[232:235]
    ds_write_b128 v251, v[152:155] offset:2048
    v_mfma_f32_16x16x32_bf16 v[236:239], v[88:91], a[44:47], v[236:239]
    ds_read_b64_tr_b16 v[86:87], v11 offset:59904
    v_mul_f32 v124, v124, v156
    v_mfma_f32_16x16x32_bf16 v[236:239], v[92:95], a[60:63], v[236:239]
    buffer_load_dwordx4 v9, s[36:39], s67 offen offset:3072 lds
    s_waitcnt lgkmcnt(9)
    v_mfma_f32_16x16x32_bf16 v[176:179], v[96:99], a[64:67], v[176:179]
    ds_read_b64_tr_b16 v[88:89], v12 offset:51200
    v_mul_f32 v125, v125, v157
    v_mfma_f32_16x16x32_bf16 v[176:179], v[100:103], a[80:83], v[176:179]
    v_mul_f32 v126, v126, v158
    v_mul_f32 v127, v127, v159
    v_mfma_f32_16x16x32_bf16 v[180:183], v[96:99], a[68:71], v[180:183]
    ds_read_b64_tr_b16 v[90:91], v12 offset:51712
    v_mul_f32_e64 v140, v140, v172
    v_mfma_f32_16x16x32_bf16 v[180:183], v[100:103], a[84:87], v[180:183]
    v_mul_f32 v141, v141, v173
    v_mul_f32 v142, v142, v174
    v_mfma_f32_16x16x32_bf16 v[184:187], v[96:99], a[72:75], v[184:187]
    ds_read_b64_tr_b16 v[92:93], v12 offset:59392
    v_mul_f32_e64 v143, v143, v175
    v_mfma_f32_16x16x32_bf16 v[184:187], v[100:103], a[88:91], v[184:187]
    v_cvt_pk_bf16_f32 v156, v124, v125
    v_cvt_pk_bf16_f32 v157, v126, v127
    v_mfma_f32_16x16x32_bf16 v[188:191], v[96:99], a[76:79], v[188:191]
    ds_read_b64_tr_b16 v[94:95], v12 offset:59904
    v_cvt_pk_bf16_f32 v158, v140, v141
    v_mfma_f32_16x16x32_bf16 v[188:191], v[100:103], a[92:95], v[188:191]
    v_add_u32 v11, 0x10000, v11
    s_waitcnt vmcnt(15) lgkmcnt(9)
    s_barrier
    v_mfma_f32_16x16x32_bf16 v[192:195], v[104:107], a[64:67], v[192:195]
    ds_read_b64_tr_b16 v[96:97], v11 offset:0
    s_add_u32 s67, s72, 4128768
    v_mfma_f32_16x16x32_bf16 v[192:195], v[108:111], a[80:83], v[192:195]
    s_add_u32 m0, s70, 32768
    v_cvt_pk_bf16_f32 v159, v142, v143
    v_mfma_f32_16x16x32_bf16 v[196:199], v[104:107], a[68:71], v[196:199]
    ds_read_b64_tr_b16 v[98:99], v11 offset:512
    v_mfma_f32_16x16x32_bf16 v[196:199], v[108:111], a[84:87], v[196:199]
    buffer_store_dwordx4 v[156:159], v2, s[44:47], s68 offen offset:3072 sc1
    v_mfma_f32_16x16x32_bf16 v[200:203], v[104:107], a[72:75], v[200:203]
    ds_read_b64_tr_b16 v[100:101], v11 offset:8192
    v_mfma_f32_16x16x32_bf16 v[200:203], v[108:111], a[88:91], v[200:203]
    ds_write_b128 v251, v[156:159] offset:3072
    v_mfma_f32_16x16x32_bf16 v[204:207], v[104:107], a[76:79], v[204:207]
    ds_read_b64_tr_b16 v[102:103], v11 offset:8704
    v_mfma_f32_16x16x32_bf16 v[204:207], v[108:111], a[92:95], v[204:207]
    v_add_u32 v12, 0x10000, v12
    s_waitcnt lgkmcnt(9)
    v_mfma_f32_16x16x32_bf16 v[208:211], v[80:83], a[64:67], v[208:211]
    ds_read_b64_tr_b16 v[104:105], v12 offset:0
    v_mfma_f32_16x16x32_bf16 v[208:211], v[84:87], a[80:83], v[208:211]
    ds_read_b32 a0, v4 offset:0
    s_pack_ll_b32_b16 s65, s92, 0
    v_mfma_f32_16x16x32_bf16 v[212:215], v[80:83], a[68:71], v[212:215]
    ds_read_b64_tr_b16 v[106:107], v12 offset:512
    v_accvgpr_write_b32 a1, s65
    v_mfma_f32_16x16x32_bf16 v[212:215], v[84:87], a[84:87], v[212:215]
    buffer_load_dwordx4 v8, s[32:35], s67 offen offset:0 lds
    s_add_u32 s66, s87, 0
    v_mfma_f32_16x16x32_bf16 v[216:219], v[80:83], a[72:75], v[216:219]
    ds_read_b64_tr_b16 v[108:109], v12 offset:8192
    v_mfma_f32_16x16x32_bf16 v[216:219], v[84:87], a[88:91], v[216:219]
    v_mfma_f32_16x16x32_bf16 v[220:223], v[80:83], a[76:79], v[220:223]
    ds_read_b64_tr_b16 v[110:111], v12 offset:8704
    v_mfma_f32_16x16x32_bf16 v[220:223], v[84:87], a[92:95], v[220:223]
    buffer_load_dwordx4 a[2:5], v3, s[44:47], s66 offen sc1
    s_waitcnt lgkmcnt(10)
    v_mfma_f32_16x16x32_bf16 v[224:227], v[88:91], a[64:67], v[224:227]
    ds_read_b64_tr_b16 v[80:81], v11 offset:2048
    v_mfma_f32_16x16x32_bf16 v[224:227], v[92:95], a[80:83], v[224:227]
    ds_read_b32 a6, v4 offset:256
    s_pack_ll_b32_b16 s65, s92, s92
    v_mfma_f32_16x16x32_bf16 v[228:231], v[88:91], a[68:71], v[228:231]
    ds_read_b64_tr_b16 v[82:83], v11 offset:2560
    v_accvgpr_write_b32 a7, s65
    v_mfma_f32_16x16x32_bf16 v[228:231], v[92:95], a[84:87], v[228:231]
    s_add_u32 s66, s87, 110592
    v_mfma_f32_16x16x32_bf16 v[232:235], v[88:91], a[72:75], v[232:235]
    ds_read_b64_tr_b16 v[84:85], v11 offset:10240
    v_mfma_f32_16x16x32_bf16 v[232:235], v[92:95], a[88:91], v[232:235]
    buffer_load_dwordx4 a[8:11], v3, s[44:47], s66 offen sc1
    v_mfma_f32_16x16x32_bf16 v[236:239], v[88:91], a[76:79], v[236:239]
    ds_read_b64_tr_b16 v[86:87], v11 offset:10752
    v_mfma_f32_16x16x32_bf16 v[236:239], v[92:95], a[92:95], v[236:239]
    ds_read_b32 a12, v4 offset:512
    s_waitcnt lgkmcnt(11)
    v_mfma_f32_16x16x32_bf16 v[176:179], v[96:99], a[96:99], v[176:179]
    ds_read_b64_tr_b16 v[88:89], v12 offset:2048
    s_pack_ll_b32_b16 s65, s93, s92
    v_mfma_f32_16x16x32_bf16 v[176:179], v[100:103], a[112:115], v[176:179]
    v_accvgpr_write_b32 a13, s65
    s_add_u32 s66, s88, 0
    v_mfma_f32_16x16x32_bf16 v[180:183], v[96:99], a[100:103], v[180:183]
    ds_read_b64_tr_b16 v[90:91], v12 offset:2560
    v_mfma_f32_16x16x32_bf16 v[180:183], v[100:103], a[116:119], v[180:183]
    buffer_load_dwordx4 a[14:17], v3, s[44:47], s66 offen sc1
    v_mfma_f32_16x16x32_bf16 v[184:187], v[96:99], a[104:107], v[184:187]
    ds_read_b64_tr_b16 v[92:93], v12 offset:10240
    v_mfma_f32_16x16x32_bf16 v[184:187], v[100:103], a[120:123], v[184:187]
    ds_read_b32 a18, v4 offset:768
    s_pack_ll_b32_b16 s65, s93, s93
    v_mfma_f32_16x16x32_bf16 v[188:191], v[96:99], a[108:111], v[188:191]
    ds_read_b64_tr_b16 v[94:95], v12 offset:10752
    v_accvgpr_write_b32 a19, s65
    v_mfma_f32_16x16x32_bf16 v[188:191], v[100:103], a[124:127], v[188:191]
    s_waitcnt vmcnt(16) lgkmcnt(11)
    s_barrier
    v_mfma_f32_16x16x32_bf16 v[192:195], v[104:107], a[96:99], v[192:195]
    ds_read_b64_tr_b16 v[96:97], v11 offset:32768
    s_add_u32 s66, s88, 110592
    v_mfma_f32_16x16x32_bf16 v[192:195], v[108:111], a[112:115], v[192:195]
    buffer_load_dwordx4 a[20:23], v3, s[44:47], s66 offen sc1
    v_mfma_f32_16x16x32_bf16 v[196:199], v[104:107], a[100:103], v[196:199]
    ds_read_b64_tr_b16 v[98:99], v11 offset:33280
    v_mfma_f32_16x16x32_bf16 v[196:199], v[108:111], a[116:119], v[196:199]
    ds_read_b32 a24, v4 offset:1024
    s_pack_ll_b32_b16 s65, s94, s93
    v_mfma_f32_16x16x32_bf16 v[200:203], v[104:107], a[104:107], v[200:203]
    ds_read_b64_tr_b16 v[100:101], v11 offset:40960
    v_accvgpr_write_b32 a25, s65
    v_mfma_f32_16x16x32_bf16 v[200:203], v[108:111], a[120:123], v[200:203]
    buffer_load_dwordx4 v9, s[32:35], s67 offen offset:1024 lds
    s_add_u32 s66, s89, 0
    v_mfma_f32_16x16x32_bf16 v[204:207], v[104:107], a[108:111], v[204:207]
    ds_read_b64_tr_b16 v[102:103], v11 offset:41472
    v_mfma_f32_16x16x32_bf16 v[204:207], v[108:111], a[124:127], v[204:207]
    s_waitcnt lgkmcnt(11)
    v_mfma_f32_16x16x32_bf16 v[208:211], v[80:83], a[96:99], v[208:211]
    ds_read_b64_tr_b16 v[104:105], v12 offset:32768
    v_mfma_f32_16x16x32_bf16 v[208:211], v[84:87], a[112:115], v[208:211]
    v_mfma_f32_16x16x32_bf16 v[212:215], v[80:83], a[100:103], v[212:215]
    ds_read_b64_tr_b16 v[106:107], v12 offset:33280
    v_mfma_f32_16x16x32_bf16 v[212:215], v[84:87], a[116:119], v[212:215]
    buffer_load_dwordx4 a[26:29], v3, s[44:47], s66 offen sc1
    v_mfma_f32_16x16x32_bf16 v[216:219], v[80:83], a[104:107], v[216:219]
    ds_read_b64_tr_b16 v[108:109], v12 offset:40960
    v_mfma_f32_16x16x32_bf16 v[216:219], v[84:87], a[120:123], v[216:219]
    ds_read_b32 a30, v4 offset:1280
    s_pack_ll_b32_b16 s65, s94, s94
    v_mfma_f32_16x16x32_bf16 v[220:223], v[80:83], a[108:111], v[220:223]
    ds_read_b64_tr_b16 v[110:111], v12 offset:41472
    v_accvgpr_write_b32 a31, s65
    v_mfma_f32_16x16x32_bf16 v[220:223], v[84:87], a[124:127], v[220:223]
    s_add_u32 s66, s89, 110592
    s_waitcnt lgkmcnt(10)
    v_mfma_f32_16x16x32_bf16 v[224:227], v[88:91], a[96:99], v[224:227]
    ds_read_b64_tr_b16 v[80:81], v11 offset:34816
    v_mfma_f32_16x16x32_bf16 v[224:227], v[92:95], a[112:115], v[224:227]
    buffer_load_dwordx4 a[32:35], v3, s[44:47], s66 offen sc1
    v_mfma_f32_16x16x32_bf16 v[228:231], v[88:91], a[100:103], v[228:231]
    ds_read_b64_tr_b16 v[82:83], v11 offset:35328
    v_mfma_f32_16x16x32_bf16 v[228:231], v[92:95], a[116:119], v[228:231]
    ds_read_b32 a36, v4 offset:1536
    s_pack_ll_b32_b16 s65, s95, s94
    v_mfma_f32_16x16x32_bf16 v[232:235], v[88:91], a[104:107], v[232:235]
    ds_read_b64_tr_b16 v[84:85], v11 offset:43008
    v_accvgpr_write_b32 a37, s65
    v_mfma_f32_16x16x32_bf16 v[232:235], v[92:95], a[120:123], v[232:235]
    buffer_load_dwordx4 v8, s[36:39], s67 offen offset:2048 lds
    s_add_u32 s66, s90, 0
    v_mfma_f32_16x16x32_bf16 v[236:239], v[88:91], a[108:111], v[236:239]
    ds_read_b64_tr_b16 v[86:87], v11 offset:43520
    v_mfma_f32_16x16x32_bf16 v[236:239], v[92:95], a[124:127], v[236:239]
    s_waitcnt lgkmcnt(10)
    v_mfma_f32_16x16x32_bf16 v[176:179], v[96:99], a[128:131], v[176:179]
    ds_read_b64_tr_b16 v[88:89], v12 offset:34816
    v_mfma_f32_16x16x32_bf16 v[176:179], v[100:103], a[144:147], v[176:179]
    v_mfma_f32_16x16x32_bf16 v[180:183], v[96:99], a[132:135], v[180:183]
    ds_read_b64_tr_b16 v[90:91], v12 offset:35328
    v_mfma_f32_16x16x32_bf16 v[180:183], v[100:103], a[148:151], v[180:183]
    buffer_load_dwordx4 v9, s[36:39], s67 offen offset:3072 lds
    s_add_u32 s67, s72, 4718592
    v_mfma_f32_16x16x32_bf16 v[184:187], v[96:99], a[136:139], v[184:187]
    ds_read_b64_tr_b16 v[92:93], v12 offset:43008
    s_add_u32 m0, s70, 49152
    v_mfma_f32_16x16x32_bf16 v[184:187], v[100:103], a[152:155], v[184:187]
    v_mfma_f32_16x16x32_bf16 v[188:191], v[96:99], a[140:143], v[188:191]
    ds_read_b64_tr_b16 v[94:95], v12 offset:43520
    v_mfma_f32_16x16x32_bf16 v[188:191], v[100:103], a[156:159], v[188:191]
    v_add_u32 v11, 0xffff0000, v11
    s_waitcnt vmcnt(10) lgkmcnt(9)
    s_barrier
    v_mfma_f32_16x16x32_bf16 v[192:195], v[104:107], a[128:131], v[192:195]
    ds_read_b64_tr_b16 v[96:97], v11 offset:0
    v_mfma_f32_16x16x32_bf16 v[192:195], v[108:111], a[144:147], v[192:195]
    buffer_load_dwordx4 a[38:41], v3, s[44:47], s66 offen sc1
    v_mfma_f32_16x16x32_bf16 v[196:199], v[104:107], a[132:135], v[196:199]
    ds_read_b64_tr_b16 v[98:99], v11 offset:512
    v_mfma_f32_16x16x32_bf16 v[196:199], v[108:111], a[148:151], v[196:199]
    ds_read_b32 a42, v4 offset:1792
    s_pack_ll_b32_b16 s65, s95, s95
    v_mfma_f32_16x16x32_bf16 v[200:203], v[104:107], a[136:139], v[200:203]
    ds_read_b64_tr_b16 v[100:101], v11 offset:8192
    v_accvgpr_write_b32 a43, s65
    v_mfma_f32_16x16x32_bf16 v[200:203], v[108:111], a[152:155], v[200:203]
    buffer_load_dwordx4 v8, s[32:35], s67 offen offset:0 lds
    s_add_u32 s66, s90, 110592
    v_mfma_f32_16x16x32_bf16 v[204:207], v[104:107], a[140:143], v[204:207]
    ds_read_b64_tr_b16 v[102:103], v11 offset:8704
    v_mfma_f32_16x16x32_bf16 v[204:207], v[108:111], a[156:159], v[204:207]
    v_add_u32 v12, 0xffff0000, v12
    s_waitcnt lgkmcnt(9)
    v_mfma_f32_16x16x32_bf16 v[208:211], v[80:83], a[128:131], v[208:211]
    ds_read_b64_tr_b16 v[104:105], v12 offset:0
    v_mfma_f32_16x16x32_bf16 v[208:211], v[84:87], a[144:147], v[208:211]
    v_mfma_f32_16x16x32_bf16 v[212:215], v[80:83], a[132:135], v[212:215]
    ds_read_b64_tr_b16 v[106:107], v12 offset:512
    v_mfma_f32_16x16x32_bf16 v[212:215], v[84:87], a[148:151], v[212:215]
    buffer_load_dwordx4 a[44:47], v3, s[44:47], s66 offen sc1
    v_mfma_f32_16x16x32_bf16 v[216:219], v[80:83], a[136:139], v[216:219]
    ds_read_b64_tr_b16 v[108:109], v12 offset:8192
    v_mfma_f32_16x16x32_bf16 v[216:219], v[84:87], a[152:155], v[216:219]
    ds_read_b32 a48, v4 offset:2048
    s_pack_ll_b32_b16 s65, 0, s95
    v_mfma_f32_16x16x32_bf16 v[220:223], v[80:83], a[140:143], v[220:223]
    ds_read_b64_tr_b16 v[110:111], v12 offset:8704
    v_accvgpr_write_b32 a49, s65
    v_mfma_f32_16x16x32_bf16 v[220:223], v[84:87], a[156:159], v[220:223]
    s_add_u32 s66, s91, 0
    s_waitcnt lgkmcnt(10)
    v_mfma_f32_16x16x32_bf16 v[224:227], v[88:91], a[128:131], v[224:227]
    ds_read_b64_tr_b16 v[80:81], v11 offset:2048
    v_mfma_f32_16x16x32_bf16 v[224:227], v[92:95], a[144:147], v[224:227]
    buffer_load_dwordx4 a[50:53], v3, s[44:47], s66 offen sc1
    v_mfma_f32_16x16x32_bf16 v[228:231], v[88:91], a[132:135], v[228:231]
    ds_read_b64_tr_b16 v[82:83], v11 offset:2560
    v_mfma_f32_16x16x32_bf16 v[228:231], v[92:95], a[148:151], v[228:231]
    ds_read_b32 a54, v4 offset:2304
    v_accvgpr_write_b32 a55, 0
    v_mfma_f32_16x16x32_bf16 v[232:235], v[88:91], a[136:139], v[232:235]
    ds_read_b64_tr_b16 v[84:85], v11 offset:10240
    s_add_u32 s66, s91, 110592
    v_mfma_f32_16x16x32_bf16 v[232:235], v[92:95], a[152:155], v[232:235]
    buffer_load_dwordx4 a[56:59], v3, s[44:47], s66 offen sc1
    v_mfma_f32_16x16x32_bf16 v[236:239], v[88:91], a[140:143], v[236:239]
    ds_read_b64_tr_b16 v[86:87], v11 offset:10752
    v_mfma_f32_16x16x32_bf16 v[236:239], v[92:95], a[156:159], v[236:239]
    ds_read_b32 a60, v4 offset:2560
    s_waitcnt lgkmcnt(11)
    v_mfma_f32_16x16x32_bf16 v[176:179], v[96:99], a[160:163], v[176:179]
    ds_read_b64_tr_b16 v[88:89], v12 offset:2048
    v_accvgpr_write_b32 a61, 0
    v_mfma_f32_16x16x32_bf16 v[176:179], v[100:103], a[176:179], v[176:179]
    ds_read_b128 v[116:119], v6 offset:0
    s_add_u32 s66, s87, 0
    v_mfma_f32_16x16x32_bf16 v[180:183], v[96:99], a[164:167], v[180:183]
    ds_read_b64_tr_b16 v[90:91], v12 offset:2560
    v_mfma_f32_16x16x32_bf16 v[180:183], v[100:103], a[180:183], v[180:183]
    buffer_load_dwordx4 v9, s[32:35], s67 offen offset:1024 lds
    v_mfma_f32_16x16x32_bf16 v[184:187], v[96:99], a[168:171], v[184:187]
    ds_read_b64_tr_b16 v[92:93], v12 offset:10240
    v_mfma_f32_16x16x32_bf16 v[184:187], v[100:103], a[184:187], v[184:187]
    v_mfma_f32_16x16x32_bf16 v[188:191], v[96:99], a[172:175], v[188:191]
    ds_read_b64_tr_b16 v[94:95], v12 offset:10752
    v_mfma_f32_16x16x32_bf16 v[188:191], v[100:103], a[188:191], v[188:191]
    s_waitcnt lgkmcnt(11)
    s_barrier
    v_mfma_f32_16x16x32_bf16 v[192:195], v[104:107], a[160:163], v[192:195]
    ds_read_b64_tr_b16 v[96:97], v11 offset:16384
    v_mfma_f32_16x16x32_bf16 v[192:195], v[108:111], a[176:179], v[192:195]
    buffer_load_dwordx4 v8, s[36:39], s67 offen offset:2048 lds
    v_mfma_f32_16x16x32_bf16 v[196:199], v[104:107], a[164:167], v[196:199]
    ds_read_b64_tr_b16 v[98:99], v11 offset:16896
    v_mfma_f32_16x16x32_bf16 v[196:199], v[108:111], a[180:183], v[196:199]
    v_mfma_f32_16x16x32_bf16 v[200:203], v[104:107], a[168:171], v[200:203]
    ds_read_b64_tr_b16 v[100:101], v11 offset:24576
    v_mfma_f32_16x16x32_bf16 v[200:203], v[108:111], a[184:187], v[200:203]
    buffer_load_dwordx4 v9, s[36:39], s67 offen offset:3072 lds
    v_mov_b32_e64 v250, 2
    v_mfma_f32_16x16x32_bf16 v[204:207], v[104:107], a[172:175], v[204:207]
    ds_read_b64_tr_b16 v[102:103], v11 offset:25088
    v_mfma_f32_16x16x32_bf16 v[204:207], v[108:111], a[188:191], v[204:207]
    s_waitcnt lgkmcnt(10)
    v_mfma_f32_16x16x32_bf16 v[208:211], v[80:83], a[160:163], v[208:211]
    ds_read_b64_tr_b16 v[104:105], v12 offset:16384
    v_mfma_f32_16x16x32_bf16 v[208:211], v[84:87], a[176:179], v[208:211]
    buffer_store_dword v250, v29, s[44:47], s6 offen sc1
    s_mul_i32 s67, s75, 589824
    v_mfma_f32_16x16x32_bf16 v[212:215], v[80:83], a[164:167], v[212:215]
    ds_read_b64_tr_b16 v[106:107], v12 offset:16896
    s_add_u32 s67, s67, s74
    v_mfma_f32_16x16x32_bf16 v[212:215], v[84:87], a[180:183], v[212:215]
    s_add_u32 m0, s70, 65536
    v_mfma_f32_16x16x32_bf16 v[216:219], v[80:83], a[168:171], v[216:219]
    ds_read_b64_tr_b16 v[108:109], v12 offset:24576
    v_mfma_f32_16x16x32_bf16 v[216:219], v[84:87], a[184:187], v[216:219]
    buffer_load_dwordx4 v[112:115], v5, s[44:47], s66 offen sc1
    v_mfma_f32_16x16x32_bf16 v[220:223], v[80:83], a[172:175], v[220:223]
    ds_read_b64_tr_b16 v[110:111], v12 offset:25088
    v_mfma_f32_16x16x32_bf16 v[220:223], v[84:87], a[188:191], v[220:223]
    ds_read_b128 v[124:127], v6 offset:272
    s_waitcnt lgkmcnt(9)
    v_mfma_f32_16x16x32_bf16 v[224:227], v[88:91], a[160:163], v[224:227]
    ds_read_b64_tr_b16 v[80:81], v11 offset:18432
    s_add_u32 s66, s87, 110592
    v_mfma_f32_16x16x32_bf16 v[224:227], v[92:95], a[176:179], v[224:227]
    buffer_load_dwordx4 v[120:123], v5, s[44:47], s66 offen sc1
    v_mfma_f32_16x16x32_bf16 v[228:231], v[88:91], a[164:167], v[228:231]
    ds_read_b64_tr_b16 v[82:83], v11 offset:18944
    v_mfma_f32_16x16x32_bf16 v[228:231], v[92:95], a[180:183], v[228:231]
    ds_read_b128 v[132:135], v6 offset:544
    s_add_u32 s66, s88, 0
    v_mfma_f32_16x16x32_bf16 v[232:235], v[88:91], a[168:171], v[232:235]
    ds_read_b64_tr_b16 v[84:85], v11 offset:26624
    v_mfma_f32_16x16x32_bf16 v[232:235], v[92:95], a[184:187], v[232:235]
    v_mfma_f32_16x16x32_bf16 v[236:239], v[88:91], a[172:175], v[236:239]
    ds_read_b64_tr_b16 v[86:87], v11 offset:27136
    v_mfma_f32_16x16x32_bf16 v[236:239], v[92:95], a[188:191], v[236:239]
    buffer_load_dwordx4 v[128:131], v5, s[44:47], s66 offen sc1
    s_waitcnt lgkmcnt(10)
    v_mfma_f32_16x16x32_bf16 v[176:179], v[96:99], a[192:195], v[176:179]
    ds_read_b64_tr_b16 v[88:89], v12 offset:18432
    v_mfma_f32_16x16x32_bf16 v[176:179], v[100:103], a[208:211], v[176:179]
    ds_read_b128 v[140:143], v6 offset:816
    s_add_u32 s66, s88, 110592
    v_mfma_f32_16x16x32_bf16 v[180:183], v[96:99], a[196:199], v[180:183]
    ds_read_b64_tr_b16 v[90:91], v12 offset:18944
    v_mfma_f32_16x16x32_bf16 v[180:183], v[100:103], a[212:215], v[180:183]
    v_mfma_f32_16x16x32_bf16 v[184:187], v[96:99], a[200:203], v[184:187]
    ds_read_b64_tr_b16 v[92:93], v12 offset:26624
    v_mfma_f32_16x16x32_bf16 v[184:187], v[100:103], a[216:219], v[184:187]
    buffer_load_dwordx4 v[136:139], v5, s[44:47], s66 offen sc1
    v_mfma_f32_16x16x32_bf16 v[188:191], v[96:99], a[204:207], v[188:191]
    ds_read_b64_tr_b16 v[94:95], v12 offset:27136
    v_mfma_f32_16x16x32_bf16 v[188:191], v[100:103], a[220:223], v[188:191]
    s_waitcnt vmcnt(13) lgkmcnt(11)
    s_barrier
    v_mfma_f32_16x16x32_bf16 v[192:195], v[104:107], a[192:195], v[192:195]
    ds_read_b64_tr_b16 v[96:97], v11 offset:32768
    v_mfma_f32_16x16x32_bf16 v[192:195], v[108:111], a[208:211], v[192:195]
    ds_read_b128 v[148:151], v6 offset:1088
    s_add_u32 s66, s89, 0
    v_mfma_f32_16x16x32_bf16 v[196:199], v[104:107], a[196:199], v[196:199]
    ds_read_b64_tr_b16 v[98:99], v11 offset:33280
    v_mfma_f32_16x16x32_bf16 v[196:199], v[108:111], a[212:215], v[196:199]
    buffer_load_dwordx4 v[144:147], v5, s[44:47], s66 offen sc1
    v_mfma_f32_16x16x32_bf16 v[200:203], v[104:107], a[200:203], v[200:203]
    ds_read_b64_tr_b16 v[100:101], v11 offset:40960
    v_mfma_f32_16x16x32_bf16 v[200:203], v[108:111], a[216:219], v[200:203]
    ds_read_b128 v[156:159], v6 offset:1360
    s_add_u32 s66, s89, 110592
    v_mfma_f32_16x16x32_bf16 v[204:207], v[104:107], a[204:207], v[204:207]
    ds_read_b64_tr_b16 v[102:103], v11 offset:41472
    v_mfma_f32_16x16x32_bf16 v[204:207], v[108:111], a[220:223], v[204:207]
    buffer_load_dwordx4 v[152:155], v5, s[44:47], s66 offen sc1
    s_waitcnt lgkmcnt(11)
    v_mfma_f32_16x16x32_bf16 v[208:211], v[80:83], a[192:195], v[208:211]
    ds_read_b64_tr_b16 v[104:105], v12 offset:32768
    v_mfma_f32_16x16x32_bf16 v[208:211], v[84:87], a[208:211], v[208:211]
    ds_read_b128 v[164:167], v6 offset:1632
    s_add_u32 s66, s90, 0
    v_mfma_f32_16x16x32_bf16 v[212:215], v[80:83], a[196:199], v[212:215]
    ds_read_b64_tr_b16 v[106:107], v12 offset:33280
    v_mfma_f32_16x16x32_bf16 v[212:215], v[84:87], a[212:215], v[212:215]
    v_mfma_f32_16x16x32_bf16 v[216:219], v[80:83], a[200:203], v[216:219]
    ds_read_b64_tr_b16 v[108:109], v12 offset:40960
    v_mfma_f32_16x16x32_bf16 v[216:219], v[84:87], a[216:219], v[216:219]
    buffer_load_dwordx4 v[160:163], v5, s[44:47], s66 offen sc1
    v_mfma_f32_16x16x32_bf16 v[220:223], v[80:83], a[204:207], v[220:223]
    ds_read_b64_tr_b16 v[110:111], v12 offset:41472
    v_mfma_f32_16x16x32_bf16 v[220:223], v[84:87], a[220:223], v[220:223]
    ds_read_b128 v[172:175], v6 offset:1904
    s_waitcnt lgkmcnt(12)
    v_mfma_f32_16x16x32_bf16 v[224:227], v[88:91], a[192:195], v[224:227]
    ds_read_b64_tr_b16 v[80:81], v11 offset:34816
    s_add_u32 s66, s90, 110592
    v_mfma_f32_16x16x32_bf16 v[224:227], v[92:95], a[208:211], v[224:227]
    v_mfma_f32_16x16x32_bf16 v[228:231], v[88:91], a[196:199], v[228:231]
    ds_read_b64_tr_b16 v[82:83], v11 offset:35328
    v_mfma_f32_16x16x32_bf16 v[228:231], v[92:95], a[212:215], v[228:231]
    buffer_load_dwordx4 v[168:171], v5, s[44:47], s66 offen sc1
    v_mfma_f32_16x16x32_bf16 v[232:235], v[88:91], a[200:203], v[232:235]
    ds_read_b64_tr_b16 v[84:85], v11 offset:43008
    v_mfma_f32_16x16x32_bf16 v[232:235], v[92:95], a[216:219], v[232:235]
    v_mfma_f32_16x16x32_bf16 v[236:239], v[88:91], a[204:207], v[236:239]
    ds_read_b64_tr_b16 v[86:87], v11 offset:43520
    v_mfma_f32_16x16x32_bf16 v[236:239], v[92:95], a[220:223], v[236:239]
    s_waitcnt lgkmcnt(10)
    v_mfma_f32_16x16x32_bf16 v[176:179], v[96:99], a[224:227], v[176:179]
    ds_read_b64_tr_b16 v[88:89], v12 offset:34816
    v_mfma_f32_16x16x32_bf16 v[176:179], v[100:103], a[240:243], v[176:179]
    buffer_load_dwordx4 v16, s[40:43], s67 offen offset:0 lds
    v_mfma_f32_16x16x32_bf16 v[180:183], v[96:99], a[228:231], v[180:183]
    ds_read_b64_tr_b16 v[90:91], v12 offset:35328
    v_mfma_f32_16x16x32_bf16 v[180:183], v[100:103], a[244:247], v[180:183]
    v_mfma_f32_16x16x32_bf16 v[184:187], v[96:99], a[232:235], v[184:187]
    ds_read_b64_tr_b16 v[92:93], v12 offset:43008
    v_mfma_f32_16x16x32_bf16 v[184:187], v[100:103], a[248:251], v[184:187]
    buffer_load_dwordx4 v17, s[40:43], s67 offen offset:1024 lds
    v_mfma_f32_16x16x32_bf16 v[188:191], v[96:99], a[236:239], v[188:191]
    ds_read_b64_tr_b16 v[94:95], v12 offset:43520
    v_mfma_f32_16x16x32_bf16 v[188:191], v[100:103], a[252:255], v[188:191]
    s_waitcnt vmcnt(11) lgkmcnt(9)
    s_barrier
    v_mfma_f32_16x16x32_bf16 v[192:195], v[104:107], a[224:227], v[192:195]
    ds_read_b64_tr_b16 v[96:97], v11 offset:49152
    v_mfma_f32_16x16x32_bf16 v[192:195], v[108:111], a[240:243], v[192:195]
    buffer_load_dwordx4 v18, s[40:43], s67 offen offset:2048 lds
    v_mfma_f32_16x16x32_bf16 v[196:199], v[104:107], a[228:231], v[196:199]
    ds_read_b64_tr_b16 v[98:99], v11 offset:49664
    v_mfma_f32_16x16x32_bf16 v[196:199], v[108:111], a[244:247], v[196:199]
    v_mfma_f32_16x16x32_bf16 v[200:203], v[104:107], a[232:235], v[200:203]
    ds_read_b64_tr_b16 v[100:101], v11 offset:57344
    v_mfma_f32_16x16x32_bf16 v[200:203], v[108:111], a[248:251], v[200:203]
    v_mfma_f32_16x16x32_bf16 v[204:207], v[104:107], a[236:239], v[204:207]
    ds_read_b64_tr_b16 v[102:103], v11 offset:57856
    v_mfma_f32_16x16x32_bf16 v[204:207], v[108:111], a[252:255], v[204:207]
    buffer_load_dwordx4 v19, s[40:43], s67 offen offset:3072 lds
    s_waitcnt lgkmcnt(8)
    v_mfma_f32_16x16x32_bf16 v[208:211], v[80:83], a[224:227], v[208:211]
    ds_read_b64_tr_b16 v[104:105], v12 offset:49152
    s_mul_i32 s67, s75, 516096
    v_mfma_f32_16x16x32_bf16 v[208:211], v[84:87], a[240:243], v[208:211]
    s_add_u32 s67, s67, s74
    s_add_u32 m0, s70, 98304
    v_mfma_f32_16x16x32_bf16 v[212:215], v[80:83], a[228:231], v[212:215]
    ds_read_b64_tr_b16 v[106:107], v12 offset:49664
    v_mfma_f32_16x16x32_bf16 v[212:215], v[84:87], a[244:247], v[212:215]
    buffer_load_dwordx4 v16, s[40:43], s67 offen offset:0 lds
    v_mfma_f32_16x16x32_bf16 v[216:219], v[80:83], a[232:235], v[216:219]
    ds_read_b64_tr_b16 v[108:109], v12 offset:57344
    v_mfma_f32_16x16x32_bf16 v[216:219], v[84:87], a[248:251], v[216:219]
    v_mfma_f32_16x16x32_bf16 v[220:223], v[80:83], a[236:239], v[220:223]
    ds_read_b64_tr_b16 v[110:111], v12 offset:57856
    v_mfma_f32_16x16x32_bf16 v[220:223], v[84:87], a[252:255], v[220:223]
    s_waitcnt lgkmcnt(8)
    v_mfma_f32_16x16x32_bf16 v[224:227], v[88:91], a[224:227], v[224:227]
    ds_read_b64_tr_b16 v[80:81], v11 offset:51200
    v_mfma_f32_16x16x32_bf16 v[224:227], v[92:95], a[240:243], v[224:227]
    buffer_load_dwordx4 v17, s[40:43], s67 offen offset:1024 lds
    v_mfma_f32_16x16x32_bf16 v[228:231], v[88:91], a[228:231], v[228:231]
    ds_read_b64_tr_b16 v[82:83], v11 offset:51712
    v_mfma_f32_16x16x32_bf16 v[228:231], v[92:95], a[244:247], v[228:231]
    v_mfma_f32_16x16x32_bf16 v[232:235], v[88:91], a[232:235], v[232:235]
    ds_read_b64_tr_b16 v[84:85], v11 offset:59392
    v_mfma_f32_16x16x32_bf16 v[232:235], v[92:95], a[248:251], v[232:235]
    buffer_load_dwordx4 v18, s[40:43], s67 offen offset:2048 lds
    v_mfma_f32_16x16x32_bf16 v[236:239], v[88:91], a[236:239], v[236:239]
    ds_read_b64_tr_b16 v[86:87], v11 offset:59904
    v_mfma_f32_16x16x32_bf16 v[236:239], v[92:95], a[252:255], v[236:239]
    s_waitcnt lgkmcnt(8)
    v_mfma_f32_16x16x32_bf16 v[176:179], v[96:99], v[32:35], v[176:179]
    ds_read_b64_tr_b16 v[88:89], v12 offset:51200
    v_mfma_f32_16x16x32_bf16 v[176:179], v[100:103], v[48:51], v[176:179]
    buffer_load_dwordx4 v19, s[40:43], s67 offen offset:3072 lds
    s_mul_i32 s67, s75, 442368
    v_mfma_f32_16x16x32_bf16 v[180:183], v[96:99], v[36:39], v[180:183]
    ds_read_b64_tr_b16 v[90:91], v12 offset:51712
    s_add_u32 s67, s67, s74
    v_mfma_f32_16x16x32_bf16 v[180:183], v[100:103], v[52:55], v[180:183]
    s_add_u32 m0, s70, 0
    v_mfma_f32_16x16x32_bf16 v[184:187], v[96:99], v[40:43], v[184:187]
    ds_read_b64_tr_b16 v[92:93], v12 offset:59392
    v_mfma_f32_16x16x32_bf16 v[184:187], v[100:103], v[56:59], v[184:187]
    v_mfma_f32_16x16x32_bf16 v[188:191], v[96:99], v[44:47], v[188:191]
    ds_read_b64_tr_b16 v[94:95], v12 offset:59904
    v_mfma_f32_16x16x32_bf16 v[188:191], v[100:103], v[60:63], v[188:191]
    buffer_load_dwordx4 v16, s[40:43], s67 offen offset:0 lds
    s_waitcnt lgkmcnt(8)
    v_mfma_f32_16x16x32_bf16 v[192:195], v[104:107], v[32:35], v[192:195]
    buffer_load_dword v26, off, s[44:47], s7 sc1
    v_mfma_f32_16x16x32_bf16 v[192:195], v[108:111], v[48:51], v[192:195]
    v_mfma_f32_16x16x32_bf16 v[196:199], v[104:107], v[36:39], v[196:199]
    v_mfma_f32_16x16x32_bf16 v[196:199], v[108:111], v[52:55], v[196:199]
    v_mfma_f32_16x16x32_bf16 v[200:203], v[104:107], v[40:43], v[200:203]
    v_mfma_f32_16x16x32_bf16 v[200:203], v[108:111], v[56:59], v[200:203]
    v_mfma_f32_16x16x32_bf16 v[204:207], v[104:107], v[44:47], v[204:207]
    v_mfma_f32_16x16x32_bf16 v[204:207], v[108:111], v[60:63], v[204:207]
    s_waitcnt lgkmcnt(4)
    v_mfma_f32_16x16x32_bf16 v[208:211], v[80:83], v[32:35], v[208:211]
    v_mfma_f32_16x16x32_bf16 v[208:211], v[84:87], v[48:51], v[208:211]
    v_mfma_f32_16x16x32_bf16 v[212:215], v[80:83], v[36:39], v[212:215]
    v_mfma_f32_16x16x32_bf16 v[212:215], v[84:87], v[52:55], v[212:215]
    v_mfma_f32_16x16x32_bf16 v[216:219], v[80:83], v[40:43], v[216:219]
    v_mfma_f32_16x16x32_bf16 v[216:219], v[84:87], v[56:59], v[216:219]
    v_mfma_f32_16x16x32_bf16 v[220:223], v[80:83], v[44:47], v[220:223]
    v_mfma_f32_16x16x32_bf16 v[220:223], v[84:87], v[60:63], v[220:223]
    s_waitcnt lgkmcnt(0)
    v_mfma_f32_16x16x32_bf16 v[224:227], v[88:91], v[32:35], v[224:227]
    v_mfma_f32_16x16x32_bf16 v[224:227], v[92:95], v[48:51], v[224:227]
    v_mfma_f32_16x16x32_bf16 v[228:231], v[88:91], v[36:39], v[228:231]
    v_mfma_f32_16x16x32_bf16 v[228:231], v[92:95], v[52:55], v[228:231]
    v_mfma_f32_16x16x32_bf16 v[232:235], v[88:91], v[40:43], v[232:235]
    v_mfma_f32_16x16x32_bf16 v[232:235], v[92:95], v[56:59], v[232:235]
    v_mfma_f32_16x16x32_bf16 v[236:239], v[88:91], v[44:47], v[236:239]
    v_mfma_f32_16x16x32_bf16 v[236:239], v[92:95], v[60:63], v[236:239]
    v_mov_b32 v23, 0xf149f2ca
    v_mov_b32 v9, 0x3f80
    v_mov_b32 v13, 0x3f800000
    v_mov_b32 v10, v64
    v_mov_b32 v11, v65
    v_cndmask_b32 v8, 0, v72, s[96:97]
    v_cndmask_b32 v12, 0, v72, s[98:99]
    v_cmp_lt_i32 vcc, 0, v30
    s_add_u32 s68, s79, 49152
    s_lshl_b32 s64, s60, 13
    v_cndmask_b32 v104, v23, 0, vcc
    v_cndmask_b32 v108, 0, v23, vcc
    v_cmp_lt_i32 vcc, -1, v30
    s_add_u32 s64, s64, 16384
    v_add_u32_e64 v251, s64, v28
    v_cndmask_b32 v105, v23, 0, vcc
    v_cndmask_b32 v109, 0, v23, vcc
    v_cmp_lt_i32 vcc, -2, v30
    v_mul_f32 v176, v176, v208
    v_mul_f32 v177, v177, v209
    v_cndmask_b32 v106, v23, 0, vcc
    v_cndmask_b32 v110, 0, v23, vcc
    v_cmp_lt_i32 vcc, -3, v30
    v_mul_f32 v178, v178, v210
    v_mul_f32 v179, v179, v211
    v_cndmask_b32 v107, v23, 0, vcc
    v_cndmask_b32_e64 v111, 0, v23, vcc
    s_cmp_eq_u32 s60, 0
    s_cselect_b64 vcc, -1, 0
    s_xor_b32 s85, s84, 0x80000000
    v_mfma_f32_16x16x32_bf16 v[80:83], a[0:3], v[8:11], v[104:107]
    v_mul_f32 v192, v192, v224
    v_mul_f32 v193, v193, v225
    v_mul_f32 v194, v194, v226
    v_mul_f32 v195, v195, v227
    v_cvt_pk_bf16_f32 v208, v176, v177
    v_cvt_pk_bf16_f32 v209, v178, v179
    v_cvt_pk_bf16_f32 v210, v192, v193
    v_cvt_pk_bf16_f32 v211, v194, v195
    buffer_store_dwordx4 v[208:211], v2, s[44:47], s68 offen offset:0 sc1
    ds_write_b128 v251, v[208:211] offset:0
    v_mul_f32 v180, v180, v212
    v_mul_f32 v181, v181, v213
    v_mfma_f32_16x16x32_bf16 v[176:179], a[4:7], v[10:13], 0
    v_mul_f32 v182, v182, v214
    v_mul_f32 v183, v183, v215
    v_mfma_f32_16x16x32_bf16 v[192:195], a[6:9], v[8:11], 0
    v_mul_f32 v196, v196, v228
    v_mul_f32 v197, v197, v229
    v_mfma_f32_16x16x32_bf16 v[224:227], a[10:13], v[10:13], 0
    v_mul_f32 v198, v198, v230
    v_mul_f32 v199, v199, v231
    v_mfma_f32_16x16x32_bf16 v[208:211], a[12:15], v[8:11], 0
    v_cvt_pk_bf16_f32 v212, v180, v181
    v_cvt_pk_bf16_f32 v213, v182, v183
    v_cvt_pk_bf16_f32 v214, v196, v197
    v_cvt_pk_bf16_f32 v215, v198, v199
    buffer_store_dwordx4 v[212:215], v2, s[44:47], s68 offen offset:1024 sc1
    ds_write_b128 v251, v[212:215] offset:1024
    v_mul_f32 v184, v184, v216
    v_mul_f32 v185, v185, v217
    v_mfma_f32_16x16x32_bf16 v[180:183], a[16:19], v[10:13], 0
    v_mul_f32 v186, v186, v218
    v_mul_f32 v187, v187, v219
    v_mfma_f32_16x16x32_bf16 v[196:199], a[18:21], v[8:11], 0
    v_mul_f32 v200, v200, v232
    v_mul_f32 v201, v201, v233
    v_mfma_f32_16x16x32_bf16 v[228:231], a[22:25], v[10:13], 0
    v_mul_f32 v202, v202, v234
    v_mul_f32 v203, v203, v235
    v_mfma_f32_16x16x32_bf16 v[212:215], a[24:27], v[8:11], 0
    v_cvt_pk_bf16_f32 v216, v184, v185
    v_cvt_pk_bf16_f32 v217, v186, v187
    v_cvt_pk_bf16_f32 v218, v200, v201
    v_cvt_pk_bf16_f32 v219, v202, v203
    buffer_store_dwordx4 v[216:219], v2, s[44:47], s68 offen offset:2048 sc1
    ds_write_b128 v251, v[216:219] offset:2048
    v_mul_f32 v188, v188, v220
    v_mul_f32 v189, v189, v221
    v_mfma_f32_16x16x32_bf16 v[184:187], a[28:31], v[10:13], 0
    v_mul_f32 v190, v190, v222
    v_mul_f32 v191, v191, v223
    v_mfma_f32_16x16x32_bf16 v[200:203], a[30:33], v[8:11], 0
    v_mul_f32 v204, v204, v236
    v_mul_f32 v205, v205, v237
    v_mfma_f32_16x16x32_bf16 v[232:235], a[34:37], v[10:13], 0
    v_mul_f32 v206, v206, v238
    v_mul_f32 v207, v207, v239
    v_mfma_f32_16x16x32_bf16 v[216:219], a[36:39], v[8:11], 0
    v_cvt_pk_bf16_f32 v220, v188, v189
    v_cvt_pk_bf16_f32 v221, v190, v191
    v_cvt_pk_bf16_f32 v222, v204, v205
    v_cvt_pk_bf16_f32 v223, v206, v207
    buffer_store_dwordx4 v[220:223], v2, s[44:47], s68 offen offset:3072 sc1
    ds_write_b128 v251, v[220:223] offset:3072
    v_mfma_f32_16x16x32_bf16 v[188:191], a[40:43], v[10:13], 0
    v_max3_f32 v15, v80, v81, v82
    v_max_f32_e64 v15, v15, v83
    v_mfma_f32_16x16x32_bf16 v[204:207], a[42:45], v[8:11], 0
    v_max3_f32 v15, v15, v176, v177
    v_max3_f32 v15, v15, v178, v179
    v_mfma_f32_16x16x32_bf16 v[236:239], a[46:49], v[10:13], 0
    v_max3_f32 v15, v15, v192, v193
    v_max3_f32 v15, v15, v194, v195
    v_mfma_f32_16x16x32_bf16 v[220:223], a[48:51], v[8:11], v[108:111]
    v_max3_f32 v15, v15, v224, v225
    v_max3_f32 v15, v15, v226, v227
    v_max3_f32 v15, v15, v208, v209
    v_max3_f32 v15, v15, v210, v211
    v_max3_f32 v15, v15, v180, v181
    v_max3_f32 v15, v15, v182, v183
    v_max3_f32 v15, v15, v196, v197
    v_max3_f32 v15, v15, v198, v199
    v_max3_f32 v15, v15, v228, v229
    v_max3_f32 v15, v15, v230, v231
    v_max3_f32 v15, v15, v212, v213
    v_max3_f32 v15, v15, v214, v215
    v_max3_f32 v15, v15, v184, v185
    v_max3_f32 v15, v15, v186, v187
    v_max3_f32 v15, v15, v200, v201
    v_max3_f32 v15, v15, v202, v203
    v_max3_f32 v15, v15, v232, v233
    v_max3_f32 v15, v15, v234, v235
    v_max3_f32 v15, v15, v216, v217
    v_max3_f32 v15, v15, v218, v219
    v_max3_f32 v15, v15, v188, v189
    v_max3_f32 v15, v15, v190, v191
    v_max3_f32 v15, v15, v204, v205
    v_max3_f32 v15, v15, v206, v207
    v_max3_f32 v15, v15, v236, v237
    v_max3_f32 v15, v15, v238, v239
    v_max3_f32 v15, v15, v220, v221
    v_max3_f32 v15, v15, v222, v223
    v_mov_b32 v10, v66
    v_mov_b32 v11, v67
    v_cndmask_b32 v8, 0, v73, s[96:97]
    v_cndmask_b32 v12, 0, v73, s[98:99]
    s_waitcnt vmcnt(4)
    v_readfirstlane_b32 s65, v26
    s_nop 0
    s_cmp_ge_u32 s65, 2
    s_cbranch_scc0 h2_slow
h2_ok:
    v_mov_b32 v23, v15
    s_nop 1
    v_permlane16_swap_b32 v23, v15
    v_max_f32 v15, v15, v23
    v_mov_b32 v23, v15
    s_nop 1
    v_permlane32_swap_b32 v23, v15
    v_max_f32 v15, v15, v23
    v_mul_f32 v14, s85, v15
    v_pk_fma_f32 v[80:81], v[80:81], s[84:85], v[14:15] op_sel_hi:[1,0,0]
    v_pk_fma_f32 v[82:83], v[82:83], s[84:85], v[14:15] op_sel_hi:[1,0,0]
    v_pk_fma_f32 v[176:177], v[176:177], s[84:85], v[14:15] op_sel_hi:[1,0,0]
    v_pk_fma_f32 v[178:179], v[178:179], s[84:85], v[14:15] op_sel_hi:[1,0,0]
    v_exp_f32 v80, v80
    v_exp_f32 v81, v81
    v_exp_f32 v82, v82
    v_exp_f32 v83, v83
    v_exp_f32 v176, v176
    v_exp_f32 v177, v177
    v_exp_f32 v178, v178
    v_exp_f32 v179, v179
    v_cvt_pk_bf16_f32 v84, v80, v81
    v_cvt_pk_bf16_f32 v85, v82, v83
    v_cvt_pk_bf16_f32 v86, v176, v177
    v_cvt_pk_bf16_f32 v87, v178, v179
    ds_read_b128 v[244:247], v6 offset:2176
    s_add_u32 s65, s81, 8192
    buffer_load_dwordx4 a[160:163], v2, s[44:47], s65 offen offset:0 sc1
    s_add_u32 s66, s91, 0
    buffer_load_dwordx4 v[240:243], v5, s[44:47], s66 offen sc1
    buffer_load_dwordx4 a[164:167], v2, s[44:47], s65 offen offset:1024 sc1
    v_pk_fma_f32 v[192:193], v[192:193], s[84:85], v[14:15] op_sel_hi:[1,0,0]
    v_pk_fma_f32 v[194:195], v[194:195], s[84:85], v[14:15] op_sel_hi:[1,0,0]
    v_pk_fma_f32 v[224:225], v[224:225], s[84:85], v[14:15] op_sel_hi:[1,0,0]
    v_pk_fma_f32 v[226:227], v[226:227], s[84:85], v[14:15] op_sel_hi:[1,0,0]
    v_exp_f32 v192, v192
    v_mfma_f32_16x16x32_bf16 v[96:99], v[112:115], v[84:87], 0
    ds_read_b128 v[252:255], v6 offset:2448
    v_exp_f32 v193, v193
    v_exp_f32 v194, v194
    v_mfma_f32_16x16x32_bf16 v[100:103], v[116:119], v[84:87], 0
    buffer_load_dwordx4 a[168:171], v2, s[44:47], s65 offen offset:2048 sc1
    v_exp_f32 v195, v195
    v_exp_f32 v224, v224
    s_add_u32 s66, s91, 110592
    v_mfma_f32_16x16x32_bf16 v[80:83], a[4:7], v[10:13], v[104:107]
    buffer_load_dwordx4 v[248:251], v5, s[44:47], s66 offen sc1
    v_exp_f32 v225, v225
    v_exp_f32 v226, v226
    v_mfma_f32_16x16x32_bf16 v[176:179], a[6:9], v[8:11], 0
    buffer_load_dwordx4 a[172:175], v2, s[44:47], s65 offen offset:3072 sc1
    v_exp_f32_e64 v227, v227
    v_cvt_pk_bf16_f32 v88, v192, v193
    v_cvt_pk_bf16_f32 v89, v194, v195
    v_cvt_pk_bf16_f32 v90, v224, v225
    v_cvt_pk_bf16_f32 v91, v226, v227
    v_pk_fma_f32 v[208:209], v[208:209], s[84:85], v[14:15] op_sel_hi:[1,0,0]
    v_pk_fma_f32 v[210:211], v[210:211], s[84:85], v[14:15] op_sel_hi:[1,0,0]
    v_pk_fma_f32 v[180:181], v[180:181], s[84:85], v[14:15] op_sel_hi:[1,0,0]
    v_pk_fma_f32 v[182:183], v[182:183], s[84:85], v[14:15] op_sel_hi:[1,0,0]
    v_exp_f32_e64 v208, v208
    v_mfma_f32_16x16x32_bf16 v[96:99], v[120:123], v[88:91], v[96:99]
    buffer_load_dwordx4 v17, s[40:43], s67 offen offset:1024 lds
    v_exp_f32 v209, v209
    v_exp_f32 v210, v210
    v_add_u32 v25, 114688, v28
    v_mfma_f32_16x16x32_bf16 v[100:103], v[124:127], v[88:91], v[100:103]
    ds_read_b128 a[64:67], v25 offset:0
    ds_read_b128 a[68:71], v25 offset:1024
    v_exp_f32 v211, v211
    v_exp_f32 v180, v180
    v_mfma_f32_16x16x32_bf16 v[192:195], a[10:13], v[10:13], 0
    buffer_load_dwordx4 v18, s[40:43], s67 offen offset:2048 lds
    v_exp_f32 v181, v181
    v_exp_f32 v182, v182
    v_mfma_f32_16x16x32_bf16 v[224:227], a[12:15], v[8:11], 0
    ds_read_b128 a[72:75], v25 offset:2048
    ds_read_b128 a[76:79], v25 offset:3072
    v_exp_f32_e64 v183, v183
    v_max3_f32 v15, v80, v81, v82
    v_max_f32_e64 v15, v15, v83
    v_max3_f32 v15, v15, v176, v177
    v_max3_f32 v15, v15, v178, v179
    v_cvt_pk_bf16_f32 v84, v208, v209
    v_cvt_pk_bf16_f32 v85, v210, v211
    v_cvt_pk_bf16_f32 v86, v180, v181
    v_cvt_pk_bf16_f32 v87, v182, v183
    v_pk_fma_f32 v[196:197], v[196:197], s[84:85], v[14:15] op_sel_hi:[1,0,0]
    v_pk_fma_f32 v[198:199], v[198:199], s[84:85], v[14:15] op_sel_hi:[1,0,0]
    v_pk_fma_f32 v[228:229], v[228:229], s[84:85], v[14:15] op_sel_hi:[1,0,0]
    v_pk_fma_f32 v[230:231], v[230:231], s[84:85], v[14:15] op_sel_hi:[1,0,0]
    v_exp_f32_e64 v196, v196
    v_mfma_f32_16x16x32_bf16 v[96:99], v[128:131], v[84:87], v[96:99]
    buffer_load_dwordx4 v19, s[40:43], s67 offen offset:3072 lds
    v_exp_f32 v197, v197
    v_exp_f32 v198, v198
    v_add_u32 v25, 122880, v28
    v_mfma_f32_16x16x32_bf16 v[100:103], v[132:135], v[84:87], v[100:103]
    ds_read_b128 a[80:83], v25 offset:0
    ds_read_b128 a[84:87], v25 offset:1024
    v_exp_f32 v199, v199
    v_exp_f32 v228, v228
    v_mfma_f32_16x16x32_bf16 v[208:211], a[16:19], v[10:13], 0
    ds_read_b128 a[88:91], v25 offset:2048
    ds_read_b128 a[92:95], v25 offset:3072
    v_exp_f32_e64 v229, v229
    v_exp_f32 v230, v230
    s_add_u32 s65, s81, 0
    v_mfma_f32_16x16x32_bf16 v[180:183], a[18:21], v[8:11], 0
    buffer_load_dwordx4 a[176:179], v2, s[44:47], s65 offen offset:0 sc1
    v_exp_f32_e64 v231, v231
    v_max3_f32 v15, v15, v192, v193
    v_max3_f32 v15, v15, v194, v195
    v_max3_f32 v15, v15, v224, v225
    v_max3_f32 v15, v15, v226, v227
    v_cvt_pk_bf16_f32 v88, v196, v197
    v_cvt_pk_bf16_f32 v89, v198, v199
    v_cvt_pk_bf16_f32 v90, v228, v229
    v_cvt_pk_bf16_f32 v91, v230, v231
    v_pk_fma_f32 v[212:213], v[212:213], s[84:85], v[14:15] op_sel_hi:[1,0,0]
    v_pk_fma_f32 v[214:215], v[214:215], s[84:85], v[14:15] op_sel_hi:[1,0,0]
    v_pk_fma_f32 v[184:185], v[184:185], s[84:85], v[14:15] op_sel_hi:[1,0,0]
    v_pk_fma_f32 v[186:187], v[186:187], s[84:85], v[14:15] op_sel_hi:[1,0,0]
    v_exp_f32_e64 v212, v212
    v_mfma_f32_16x16x32_bf16 v[96:99], v[136:139], v[88:91], v[96:99]
    buffer_load_dwordx4 a[180:183], v2, s[44:47], s65 offen offset:1024 sc1
    v_exp_f32 v213, v213
    v_exp_f32 v214, v214
    v_mfma_f32_16x16x32_bf16 v[100:103], v[140:143], v[88:91], v[100:103]
    buffer_load_dwordx4 a[184:187], v2, s[44:47], s65 offen offset:2048 sc1
    v_exp_f32 v215, v215
    v_exp_f32 v184, v184
    v_mfma_f32_16x16x32_bf16 v[196:199], a[22:25], v[10:13], 0
    buffer_load_dwordx4 a[188:191], v2, s[44:47], s65 offen offset:3072 sc1
    v_exp_f32 v185, v185
    v_exp_f32 v186, v186
    v_mfma_f32_16x16x32_bf16 v[228:231], a[24:27], v[8:11], 0
    v_exp_f32_e64 v187, v187
    v_max3_f32 v15, v15, v208, v209
    v_max3_f32 v15, v15, v210, v211
    v_max3_f32 v15, v15, v180, v181
    v_max3_f32 v15, v15, v182, v183
    v_cvt_pk_bf16_f32 v84, v212, v213
    v_cvt_pk_bf16_f32 v85, v214, v215
    v_cvt_pk_bf16_f32 v86, v184, v185
    v_cvt_pk_bf16_f32 v87, v186, v187
    v_pk_fma_f32 v[200:201], v[200:201], s[84:85], v[14:15] op_sel_hi:[1,0,0]
    v_pk_fma_f32 v[202:203], v[202:203], s[84:85], v[14:15] op_sel_hi:[1,0,0]
    v_pk_fma_f32 v[232:233], v[232:233], s[84:85], v[14:15] op_sel_hi:[1,0,0]
    v_pk_fma_f32 v[234:235], v[234:235], s[84:85], v[14:15] op_sel_hi:[1,0,0]
    v_exp_f32_e64 v200, v200
    v_add_u32 v25, 81920, v28
    v_mfma_f32_16x16x32_bf16 v[96:99], v[144:147], v[84:87], v[96:99]
    ds_read_b128 a[96:99], v25 offset:0
    ds_read_b128 a[100:103], v25 offset:1024
    v_exp_f32 v201, v201
    v_exp_f32 v202, v202
    v_mfma_f32_16x16x32_bf16 v[100:103], v[148:151], v[84:87], v[100:103]
    ds_read_b128 a[104:107], v25 offset:2048
    ds_read_b128 a[108:111], v25 offset:3072
    v_exp_f32 v203, v203
    v_exp_f32 v232, v232
    v_add_u32 v25, 90112, v28
    v_mfma_f32_16x16x32_bf16 v[212:215], a[28:31], v[10:13], 0
    ds_read_b128 a[112:115], v25 offset:0
    ds_read_b128 a[116:119], v25 offset:1024
    v_exp_f32 v233, v233
    v_exp_f32 v234, v234
    v_mfma_f32_16x16x32_bf16 v[184:187], a[30:33], v[8:11], 0
    v_exp_f32_e64 v235, v235
    v_max3_f32 v15, v15, v196, v197
    v_max3_f32 v15, v15, v198, v199
    v_max3_f32 v15, v15, v228, v229
    v_max3_f32 v15, v15, v230, v231
    v_cvt_pk_bf16_f32 v88, v200, v201
    v_cvt_pk_bf16_f32 v89, v202, v203
    v_cvt_pk_bf16_f32 v90, v232, v233
    v_cvt_pk_bf16_f32 v91, v234, v235
    v_pk_fma_f32 v[216:217], v[216:217], s[84:85], v[14:15] op_sel_hi:[1,0,0]
    v_pk_fma_f32 v[218:219], v[218:219], s[84:85], v[14:15] op_sel_hi:[1,0,0]
    v_pk_fma_f32 v[188:189], v[188:189], s[84:85], v[14:15] op_sel_hi:[1,0,0]
    v_pk_fma_f32 v[190:191], v[190:191], s[84:85], v[14:15] op_sel_hi:[1,0,0]
    v_exp_f32_e64 v216, v216
    v_mfma_f32_16x16x32_bf16 v[96:99], v[152:155], v[88:91], v[96:99]
    ds_read_b128 a[120:123], v25 offset:2048
    ds_read_b128 a[124:127], v25 offset:3072
    v_exp_f32 v217, v217
    v_exp_f32 v218, v218
    s_add_u32 s65, s81, 24576
    v_mfma_f32_16x16x32_bf16 v[100:103], v[156:159], v[88:91], v[100:103]
    buffer_load_dwordx4 a[192:195], v2, s[44:47], s65 offen offset:0 sc1
    v_exp_f32 v219, v219
    v_exp_f32 v188, v188
    v_mfma_f32_16x16x32_bf16 v[200:203], a[34:37], v[10:13], 0
    buffer_load_dwordx4 a[196:199], v2, s[44:47], s65 offen offset:1024 sc1
    v_exp_f32 v189, v189
    v_exp_f32 v190, v190
    v_mfma_f32_16x16x32_bf16 v[232:235], a[36:39], v[8:11], 0
    v_exp_f32_e64 v191, v191
    v_max3_f32 v15, v15, v212, v213
    v_max3_f32 v15, v15, v214, v215
    v_max3_f32 v15, v15, v184, v185
    v_max3_f32 v15, v15, v186, v187
    v_cvt_pk_bf16_f32 v84, v216, v217
    v_cvt_pk_bf16_f32 v85, v218, v219
    v_cvt_pk_bf16_f32 v86, v188, v189
    v_cvt_pk_bf16_f32 v87, v190, v191
    v_pk_fma_f32 v[204:205], v[204:205], s[84:85], v[14:15] op_sel_hi:[1,0,0]
    v_pk_fma_f32 v[206:207], v[206:207], s[84:85], v[14:15] op_sel_hi:[1,0,0]
    v_pk_fma_f32 v[236:237], v[236:237], s[84:85], v[14:15] op_sel_hi:[1,0,0]
    v_pk_fma_f32 v[238:239], v[238:239], s[84:85], v[14:15] op_sel_hi:[1,0,0]
    v_exp_f32_e64 v204, v204
    v_mfma_f32_16x16x32_bf16 v[96:99], v[160:163], v[84:87], v[96:99]
    buffer_load_dwordx4 a[200:203], v2, s[44:47], s65 offen offset:2048 sc1
    v_exp_f32 v205, v205
    v_exp_f32 v206, v206
    v_mfma_f32_16x16x32_bf16 v[100:103], v[164:167], v[84:87], v[100:103]
    buffer_load_dwordx4 a[204:207], v2, s[44:47], s65 offen offset:3072 sc1
    v_exp_f32 v207, v207
    v_exp_f32 v236, v236
    v_add_u32 v25, 131072, v28
    v_mfma_f32_16x16x32_bf16 v[216:219], a[40:43], v[10:13], 0
    ds_read_b128 a[128:131], v25 offset:0
    ds_read_b128 a[132:135], v25 offset:1024
    v_exp_f32 v237, v237
    v_exp_f32 v238, v238
    v_mfma_f32_16x16x32_bf16 v[188:191], a[42:45], v[8:11], 0
    v_exp_f32_e64 v239, v239
    v_max3_f32 v15, v15, v200, v201
    v_max3_f32 v15, v15, v202, v203
    v_max3_f32 v15, v15, v232, v233
    v_max3_f32 v15, v15, v234, v235
    v_cvt_pk_bf16_f32 v88, v204, v205
    v_cvt_pk_bf16_f32 v89, v206, v207
    v_cvt_pk_bf16_f32 v90, v236, v237
    v_cvt_pk_bf16_f32 v91, v238, v239
    v_pk_fma_f32 v[220:221], v[220:221], s[84:85], v[14:15] op_sel_hi:[1,0,0]
    v_pk_fma_f32 v[222:223], v[222:223], s[84:85], v[14:15] op_sel_hi:[1,0,0]
    v_exp_f32_e64 v220, v220
    v_mfma_f32_16x16x32_bf16 v[96:99], v[168:171], v[88:91], v[96:99]
    ds_read_b128 a[136:139], v25 offset:2048
    ds_read_b128 a[140:143], v25 offset:3072
    v_exp_f32_e64 v221, v221
    v_add_u32 v25, 139264, v28
    v_mfma_f32_16x16x32_bf16 v[100:103], v[172:175], v[88:91], v[100:103]
    ds_read_b128 a[144:147], v25 offset:0
    ds_read_b128 a[148:151], v25 offset:1024
    v_exp_f32_e64 v222, v222
    v_mfma_f32_16x16x32_bf16 v[204:207], a[46:49], v[10:13], 0
    ds_read_b128 a[152:155], v25 offset:2048
    ds_read_b128 a[156:159], v25 offset:3072
    v_exp_f32_e64 v223, v223
    v_mfma_f32_16x16x32_bf16 v[236:239], a[48:51], v[8:11], 0
    v_max3_f32 v15, v15, v216, v217
    v_max3_f32 v15, v15, v218, v219
    v_max3_f32 v15, v15, v188, v189
    v_max3_f32 v15, v15, v190, v191
    v_cvt_pk_bf16_f32 v84, v220, v221
    v_cvt_pk_bf16_f32 v85, v222, v223
    v_mov_b32 v86, 0
    v_mov_b32 v87, 0
    v_mfma_f32_16x16x32_bf16 v[220:223], a[52:55], v[10:13], v[108:111]
    v_max3_f32 v15, v15, v204, v205
    s_waitcnt vmcnt(15)
    v_mfma_f32_16x16x32_bf16 v[96:99], v[240:243], v[84:87], v[96:99]
    v_max3_f32 v15, v15, v206, v207
    s_waitcnt lgkmcnt(15)
    v_mfma_f32_16x16x32_bf16 v[100:103], v[244:247], v[84:87], v[100:103]
    v_max3_f32 v15, v15, v236, v237
    v_max3_f32 v15, v15, v238, v239
    v_mov_b32 v10, v68
    v_mov_b32 v11, v69
    v_cndmask_b32 v8, 0, v74, s[96:97]
    v_cndmask_b32 v12, 0, v74, s[98:99]
    v_max3_f32 v15, v15, v220, v221
    v_max3_f32 v15, v15, v222, v223
    v_rcp_f32 v23, v102
    s_nop 0
    v_mul_f32 v96, v96, v23
    v_mul_f32 v97, v97, v23
    v_mul_f32 v98, v98, v23
    v_mul_f32 v99, v99, v23
    v_mul_f32 v100, v100, v23
    v_mul_f32 v101, v101, v23
    v_cvt_pk_bf16_f32 v64, v96, v97
    v_cvt_pk_bf16_f32 v65, v98, v99
    v_cvt_pk_bf16_f32 v72, v100, v101
    v_mov_b32 v23, v15
    s_nop 1
    v_permlane16_swap_b32 v23, v15
    v_max_f32 v15, v15, v23
    v_mov_b32 v23, v15
    s_nop 1
    v_permlane32_swap_b32 v23, v15
    v_max_f32 v15, v15, v23
    v_mul_f32 v14, s85, v15
    s_waitcnt lgkmcnt(0)
    s_barrier
    v_mov_b32 v27, 3
    buffer_store_dword v27, v29, s[44:47], s6 offen sc1
    v_pk_fma_f32 v[80:81], v[80:81], s[84:85], v[14:15] op_sel_hi:[1,0,0]
    v_pk_fma_f32 v[82:83], v[82:83], s[84:85], v[14:15] op_sel_hi:[1,0,0]
    v_exp_f32 v80, v80
    v_exp_f32 v81, v81
    v_exp_f32 v82, v82
    v_exp_f32 v83, v83
    v_mov_b32 v84, 0
    v_mov_b32 v85, 0
    v_cvt_pk_bf16_f32 v86, v80, v81
    v_cvt_pk_bf16_f32 v87, v82, v83
    s_add_u32 s65, s81, 16384
    buffer_load_dwordx4 a[208:211], v2, s[44:47], s65 offen offset:0 sc1
    s_add_u32 s67, s74, 0
    s_add_u32 m0, s70, 32768
    s_nop 0
    buffer_load_dwordx4 v16, s[40:43], s67 offen offset:0 lds
    v_pk_fma_f32 v[176:177], v[176:177], s[84:85], v[14:15] op_sel_hi:[1,0,0]
    v_pk_fma_f32 v[178:179], v[178:179], s[84:85], v[14:15] op_sel_hi:[1,0,0]
    v_pk_fma_f32 v[192:193], v[192:193], s[84:85], v[14:15] op_sel_hi:[1,0,0]
    v_pk_fma_f32 v[194:195], v[194:195], s[84:85], v[14:15] op_sel_hi:[1,0,0]
    v_exp_f32_e64 v176, v176
    v_mfma_f32_16x16x32_bf16 v[96:99], v[112:115], v[84:87], 0
    buffer_load_dwordx4 a[212:215], v2, s[44:47], s65 offen offset:1024 sc1
    v_exp_f32 v177, v177
    v_exp_f32 v178, v178
    v_mfma_f32_16x16x32_bf16 v[100:103], v[116:119], v[84:87], 0
    buffer_load_dwordx4 v17, s[40:43], s67 offen offset:1024 lds
    v_exp_f32 v179, v179
    v_exp_f32 v192, v192
    v_mfma_f32_16x16x32_bf16 v[80:83], a[6:9], v[8:11], v[104:107]
    v_exp_f32 v193, v193
    v_exp_f32 v194, v194
    v_exp_f32_e64 v195, v195
    v_cvt_pk_bf16_f32 v88, v176, v177
    v_cvt_pk_bf16_f32 v89, v178, v179
    v_cvt_pk_bf16_f32 v90, v192, v193
    v_cvt_pk_bf16_f32 v91, v194, v195
    v_pk_fma_f32 v[224:225], v[224:225], s[84:85], v[14:15] op_sel_hi:[1,0,0]
    v_pk_fma_f32 v[226:227], v[226:227], s[84:85], v[14:15] op_sel_hi:[1,0,0]
    v_pk_fma_f32 v[208:209], v[208:209], s[84:85], v[14:15] op_sel_hi:[1,0,0]
    v_pk_fma_f32 v[210:211], v[210:211], s[84:85], v[14:15] op_sel_hi:[1,0,0]
    v_exp_f32_e64 v224, v224
    v_mfma_f32_16x16x32_bf16 v[96:99], v[120:123], v[88:91], v[96:99]
    buffer_load_dwordx4 a[216:219], v2, s[44:47], s65 offen offset:2048 sc1
    v_exp_f32 v225, v225
    v_exp_f32 v226, v226
    v_mfma_f32_16x16x32_bf16 v[100:103], v[124:127], v[88:91], v[100:103]
    buffer_load_dwordx4 v18, s[40:43], s67 offen offset:2048 lds
    v_exp_f32 v227, v227
    v_exp_f32 v208, v208
    v_mfma_f32_16x16x32_bf16 v[176:179], a[10:13], v[10:13], 0
    v_exp_f32 v209, v209
    v_exp_f32 v210, v210
    v_mfma_f32_16x16x32_bf16 v[192:195], a[12:15], v[8:11], 0
    v_exp_f32_e64 v211, v211
    v_max3_f32 v15, v80, v81, v82
    v_max_f32_e64 v15, v15, v83
    v_cvt_pk_bf16_f32 v84, v224, v225
    v_cvt_pk_bf16_f32 v85, v226, v227
    v_cvt_pk_bf16_f32 v86, v208, v209
    v_cvt_pk_bf16_f32 v87, v210, v211
    v_pk_fma_f32 v[180:181], v[180:181], s[84:85], v[14:15] op_sel_hi:[1,0,0]
    v_pk_fma_f32 v[182:183], v[182:183], s[84:85], v[14:15] op_sel_hi:[1,0,0]
    v_pk_fma_f32 v[196:197], v[196:197], s[84:85], v[14:15] op_sel_hi:[1,0,0]
    v_pk_fma_f32 v[198:199], v[198:199], s[84:85], v[14:15] op_sel_hi:[1,0,0]
    v_exp_f32_e64 v180, v180
    v_mfma_f32_16x16x32_bf16 v[96:99], v[128:131], v[84:87], v[96:99]
    buffer_load_dwordx4 a[220:223], v2, s[44:47], s65 offen offset:3072 sc1
    v_exp_f32 v181, v181
    v_exp_f32 v182, v182
    v_mfma_f32_16x16x32_bf16 v[100:103], v[132:135], v[84:87], v[100:103]
    buffer_load_dwordx4 v19, s[40:43], s67 offen offset:3072 lds
    v_exp_f32 v183, v183
    v_exp_f32 v196, v196
    v_mfma_f32_16x16x32_bf16 v[224:227], a[16:19], v[10:13], 0
    v_exp_f32 v197, v197
    v_exp_f32 v198, v198
    v_mfma_f32_16x16x32_bf16 v[208:211], a[18:21], v[8:11], 0
    v_exp_f32_e64 v199, v199
    v_max3_f32 v15, v15, v176, v177
    v_max3_f32 v15, v15, v178, v179
    v_max3_f32 v15, v15, v192, v193
    v_max3_f32 v15, v15, v194, v195
    v_cvt_pk_bf16_f32 v88, v180, v181
    v_cvt_pk_bf16_f32 v89, v182, v183
    v_cvt_pk_bf16_f32 v90, v196, v197
    v_cvt_pk_bf16_f32 v91, v198, v199
    v_pk_fma_f32 v[228:229], v[228:229], s[84:85], v[14:15] op_sel_hi:[1,0,0]
    v_pk_fma_f32 v[230:231], v[230:231], s[84:85], v[14:15] op_sel_hi:[1,0,0]
    v_pk_fma_f32 v[212:213], v[212:213], s[84:85], v[14:15] op_sel_hi:[1,0,0]
    v_pk_fma_f32 v[214:215], v[214:215], s[84:85], v[14:15] op_sel_hi:[1,0,0]
    v_exp_f32_e64 v228, v228
    s_add_u32 s65, s81, 40960
    v_mfma_f32_16x16x32_bf16 v[96:99], v[136:139], v[88:91], v[96:99]
    buffer_load_dwordx4 a[224:227], v2, s[44:47], s65 offen offset:0 sc1
    v_exp_f32 v229, v229
    v_exp_f32 v230, v230
    s_mul_i32 s67, s75, 73728
    s_add_u32 s67, s67, s74
    s_add_u32 m0, s70, 49152
    v_mfma_f32_16x16x32_bf16 v[100:103], v[140:143], v[88:91], v[100:103]
    buffer_load_dwordx4 v16, s[40:43], s67 offen offset:0 lds
    v_exp_f32 v231, v231
    v_exp_f32_e64 v212, v212
    v_mfma_f32_16x16x32_bf16 v[180:183], a[22:25], v[10:13], 0
    v_exp_f32 v213, v213
    v_exp_f32 v214, v214
    v_mfma_f32_16x16x32_bf16 v[196:199], a[24:27], v[8:11], 0
    v_exp_f32_e64 v215, v215
    v_max3_f32 v15, v15, v224, v225
    v_max3_f32 v15, v15, v226, v227
    v_max3_f32 v15, v15, v208, v209
    v_max3_f32 v15, v15, v210, v211
    v_cvt_pk_bf16_f32 v84, v228, v229
    v_cvt_pk_bf16_f32 v85, v230, v231
    v_cvt_pk_bf16_f32 v86, v212, v213
    v_cvt_pk_bf16_f32 v87, v214, v215
    v_pk_fma_f32 v[184:185], v[184:185], s[84:85], v[14:15] op_sel_hi:[1,0,0]
    v_pk_fma_f32 v[186:187], v[186:187], s[84:85], v[14:15] op_sel_hi:[1,0,0]
    v_pk_fma_f32 v[200:201], v[200:201], s[84:85], v[14:15] op_sel_hi:[1,0,0]
    v_pk_fma_f32 v[202:203], v[202:203], s[84:85], v[14:15] op_sel_hi:[1,0,0]
    v_exp_f32_e64 v184, v184
    v_mfma_f32_16x16x32_bf16 v[96:99], v[144:147], v[84:87], v[96:99]
    buffer_load_dwordx4 a[228:231], v2, s[44:47], s65 offen offset:1024 sc1
    v_exp_f32 v185, v185
    v_exp_f32 v186, v186
    v_mfma_f32_16x16x32_bf16 v[100:103], v[148:151], v[84:87], v[100:103]
    buffer_load_dwordx4 v17, s[40:43], s67 offen offset:1024 lds
    v_exp_f32 v187, v187
    v_exp_f32 v200, v200
    v_mfma_f32_16x16x32_bf16 v[228:231], a[28:31], v[10:13], 0
    v_exp_f32 v201, v201
    v_exp_f32 v202, v202
    v_mfma_f32_16x16x32_bf16 v[212:215], a[30:33], v[8:11], 0
    v_exp_f32_e64 v203, v203
    v_max3_f32 v15, v15, v180, v181
    v_max3_f32 v15, v15, v182, v183
    v_max3_f32 v15, v15, v196, v197
    v_max3_f32 v15, v15, v198, v199
    v_cvt_pk_bf16_f32 v88, v184, v185
    v_cvt_pk_bf16_f32 v89, v186, v187
    v_cvt_pk_bf16_f32 v90, v200, v201
    v_cvt_pk_bf16_f32 v91, v202, v203
    v_pk_fma_f32 v[232:233], v[232:233], s[84:85], v[14:15] op_sel_hi:[1,0,0]
    v_pk_fma_f32 v[234:235], v[234:235], s[84:85], v[14:15] op_sel_hi:[1,0,0]
    v_pk_fma_f32 v[216:217], v[216:217], s[84:85], v[14:15] op_sel_hi:[1,0,0]
    v_pk_fma_f32 v[218:219], v[218:219], s[84:85], v[14:15] op_sel_hi:[1,0,0]
    v_exp_f32_e64 v232, v232
    v_mfma_f32_16x16x32_bf16 v[96:99], v[152:155], v[88:91], v[96:99]
    buffer_load_dwordx4 a[232:235], v2, s[44:47], s65 offen offset:2048 sc1
    v_exp_f32 v233, v233
    v_exp_f32 v234, v234
    v_mfma_f32_16x16x32_bf16 v[100:103], v[156:159], v[88:91], v[100:103]
    buffer_load_dwordx4 v18, s[40:43], s67 offen offset:2048 lds
    v_exp_f32 v235, v235
    v_exp_f32 v216, v216
    v_mfma_f32_16x16x32_bf16 v[184:187], a[34:37], v[10:13], 0
    v_exp_f32 v217, v217
    v_exp_f32 v218, v218
    v_mfma_f32_16x16x32_bf16 v[200:203], a[36:39], v[8:11], 0
    v_exp_f32_e64 v219, v219
    v_max3_f32 v15, v15, v228, v229
    v_max3_f32 v15, v15, v230, v231
    v_max3_f32 v15, v15, v212, v213
    v_max3_f32 v15, v15, v214, v215
    v_cvt_pk_bf16_f32 v84, v232, v233
    v_cvt_pk_bf16_f32 v85, v234, v235
    v_cvt_pk_bf16_f32 v86, v216, v217
    v_cvt_pk_bf16_f32 v87, v218, v219
    v_pk_fma_f32 v[188:189], v[188:189], s[84:85], v[14:15] op_sel_hi:[1,0,0]
    v_pk_fma_f32 v[190:191], v[190:191], s[84:85], v[14:15] op_sel_hi:[1,0,0]
    v_pk_fma_f32 v[204:205], v[204:205], s[84:85], v[14:15] op_sel_hi:[1,0,0]
    v_pk_fma_f32 v[206:207], v[206:207], s[84:85], v[14:15] op_sel_hi:[1,0,0]
    v_exp_f32_e64 v188, v188
    v_mfma_f32_16x16x32_bf16 v[96:99], v[160:163], v[84:87], v[96:99]
    buffer_load_dwordx4 a[236:239], v2, s[44:47], s65 offen offset:3072 sc1
    v_exp_f32 v189, v189
    v_exp_f32 v190, v190
    v_mfma_f32_16x16x32_bf16 v[100:103], v[164:167], v[84:87], v[100:103]
    v_exp_f32 v191, v191
    v_exp_f32 v204, v204
    v_mfma_f32_16x16x32_bf16 v[232:235], a[40:43], v[10:13], 0
    v_exp_f32 v205, v205
    v_exp_f32 v206, v206
    v_mfma_f32_16x16x32_bf16 v[216:219], a[42:45], v[8:11], 0
    v_exp_f32_e64 v207, v207
    v_max3_f32 v15, v15, v184, v185
    v_max3_f32 v15, v15, v186, v187
    v_max3_f32 v15, v15, v200, v201
    v_max3_f32 v15, v15, v202, v203
    v_cvt_pk_bf16_f32 v88, v188, v189
    v_cvt_pk_bf16_f32 v89, v190, v191
    v_cvt_pk_bf16_f32 v90, v204, v205
    v_cvt_pk_bf16_f32 v91, v206, v207
    v_pk_fma_f32 v[236:237], v[236:237], s[84:85], v[14:15] op_sel_hi:[1,0,0]
    v_pk_fma_f32 v[238:239], v[238:239], s[84:85], v[14:15] op_sel_hi:[1,0,0]
    v_pk_fma_f32 v[220:221], v[220:221], s[84:85], v[14:15] op_sel_hi:[1,0,0]
    v_pk_fma_f32 v[222:223], v[222:223], s[84:85], v[14:15] op_sel_hi:[1,0,0]
    v_exp_f32_e64 v236, v236
    v_mfma_f32_16x16x32_bf16 v[96:99], v[168:171], v[88:91], v[96:99]
    buffer_load_dwordx4 v19, s[40:43], s67 offen offset:3072 lds
    v_exp_f32 v237, v237
    v_exp_f32 v238, v238
    v_mfma_f32_16x16x32_bf16 v[100:103], v[172:175], v[88:91], v[100:103]
    v_exp_f32 v239, v239
    v_exp_f32 v220, v220
    v_mfma_f32_16x16x32_bf16 v[188:191], a[46:49], v[10:13], 0
    v_exp_f32 v221, v221
    v_exp_f32 v222, v222
    v_mfma_f32_16x16x32_bf16 v[204:207], a[48:51], v[8:11], 0
    v_exp_f32_e64 v223, v223
    v_max3_f32 v15, v15, v232, v233
    v_max3_f32 v15, v15, v234, v235
    v_max3_f32 v15, v15, v216, v217
    v_max3_f32 v15, v15, v218, v219
    v_cvt_pk_bf16_f32 v84, v236, v237
    v_cvt_pk_bf16_f32 v85, v238, v239
    v_cvt_pk_bf16_f32 v86, v220, v221
    v_cvt_pk_bf16_f32 v87, v222, v223
    v_mfma_f32_16x16x32_bf16 v[236:239], a[52:55], v[10:13], 0
    v_max3_f32 v15, v15, v188, v189
    v_mfma_f32_16x16x32_bf16 v[220:223], a[54:57], v[8:11], v[108:111]
    v_max3_f32 v15, v15, v190, v191
    v_mfma_f32_16x16x32_bf16 v[96:99], v[240:243], v[84:87], v[96:99]
    v_max3_f32 v15, v15, v204, v205
    v_mfma_f32_16x16x32_bf16 v[100:103], v[244:247], v[84:87], v[100:103]
    v_max3_f32 v15, v15, v206, v207
    v_mov_b32 v10, v70
    v_mov_b32 v11, v71
    v_cndmask_b32 v8, 0, v75, s[96:97]
    v_cndmask_b32 v12, 0, v75, s[98:99]
    v_max3_f32 v15, v15, v236, v237
    v_max3_f32 v15, v15, v238, v239
    v_max3_f32 v15, v15, v220, v221
    v_max3_f32 v15, v15, v222, v223
    v_rcp_f32 v23, v102
    s_nop 0
    v_mul_f32 v96, v96, v23
    v_mul_f32 v97, v97, v23
    v_mul_f32 v98, v98, v23
    v_mul_f32 v99, v99, v23
    v_mul_f32 v100, v100, v23
    v_mul_f32 v101, v101, v23
    v_cvt_pk_bf16_f32 v66, v96, v97
    v_cvt_pk_bf16_f32 v67, v98, v99
    v_cvt_pk_bf16_f32 v73, v100, v101
    v_mov_b32 v23, v15
    s_nop 1
    v_permlane16_swap_b32 v23, v15
    v_max_f32 v15, v15, v23
    v_mov_b32 v23, v15
    s_nop 1
    v_permlane32_swap_b32 v23, v15
    v_max_f32 v15, v15, v23
    v_mul_f32_e64 v14, s85, v15
    v_pk_fma_f32 v[80:81], v[80:81], s[84:85], v[14:15] op_sel_hi:[1,0,0]
    v_pk_fma_f32 v[82:83], v[82:83], s[84:85], v[14:15] op_sel_hi:[1,0,0]
    v_pk_fma_f32 v[176:177], v[176:177], s[84:85], v[14:15] op_sel_hi:[1,0,0]
    v_pk_fma_f32 v[178:179], v[178:179], s[84:85], v[14:15] op_sel_hi:[1,0,0]
    v_exp_f32 v80, v80
    v_exp_f32 v81, v81
    v_exp_f32 v82, v82
    v_exp_f32 v83, v83
    v_exp_f32 v176, v176
    v_exp_f32 v177, v177
    v_exp_f32 v178, v178
    v_exp_f32 v179, v179
    v_cvt_pk_bf16_f32 v84, v80, v81
    v_cvt_pk_bf16_f32 v85, v82, v83
    v_cvt_pk_bf16_f32 v86, v176, v177
    v_cvt_pk_bf16_f32 v87, v178, v179
    s_add_u32 s65, s81, 32768
    buffer_load_dwordx4 a[240:243], v2, s[44:47], s65 offen offset:0 sc1
    s_mul_i32 s67, s75, 147456
    s_add_u32 s67, s67, s74
    s_add_u32 m0, s70, 114688
    s_nop 0
    buffer_load_dwordx4 v16, s[40:43], s67 offen offset:0 lds
    v_pk_fma_f32 v[192:193], v[192:193], s[84:85], v[14:15] op_sel_hi:[1,0,0]
    v_pk_fma_f32 v[194:195], v[194:195], s[84:85], v[14:15] op_sel_hi:[1,0,0]
    v_pk_fma_f32 v[224:225], v[224:225], s[84:85], v[14:15] op_sel_hi:[1,0,0]
    v_pk_fma_f32 v[226:227], v[226:227], s[84:85], v[14:15] op_sel_hi:[1,0,0]
    v_exp_f32_e64 v192, v192
    v_mfma_f32_16x16x32_bf16 v[96:99], v[120:123], v[84:87], 0
    buffer_load_dwordx4 a[244:247], v2, s[44:47], s65 offen offset:1024 sc1
    v_exp_f32 v193, v193
    v_exp_f32 v194, v194
    v_mfma_f32_16x16x32_bf16 v[100:103], v[124:127], v[84:87], 0
    buffer_load_dwordx4 v17, s[40:43], s67 offen offset:1024 lds
    v_exp_f32 v195, v195
    v_exp_f32 v224, v224
    v_mfma_f32_16x16x32_bf16 v[80:83], a[10:13], v[10:13], v[104:107]
    v_exp_f32 v225, v225
    v_exp_f32 v226, v226
    v_mfma_f32_16x16x32_bf16 v[176:179], a[12:15], v[8:11], 0
    v_exp_f32_e64 v227, v227
    v_cvt_pk_bf16_f32 v88, v192, v193
    v_cvt_pk_bf16_f32 v89, v194, v195
    v_cvt_pk_bf16_f32 v90, v224, v225
    v_cvt_pk_bf16_f32 v91, v226, v227
    v_pk_fma_f32 v[208:209], v[208:209], s[84:85], v[14:15] op_sel_hi:[1,0,0]
    v_pk_fma_f32 v[210:211], v[210:211], s[84:85], v[14:15] op_sel_hi:[1,0,0]
    v_pk_fma_f32 v[180:181], v[180:181], s[84:85], v[14:15] op_sel_hi:[1,0,0]
    v_pk_fma_f32 v[182:183], v[182:183], s[84:85], v[14:15] op_sel_hi:[1,0,0]
    v_exp_f32_e64 v208, v208
    v_mfma_f32_16x16x32_bf16 v[96:99], v[128:131], v[88:91], v[96:99]
    buffer_load_dwordx4 a[248:251], v2, s[44:47], s65 offen offset:2048 sc1
    v_exp_f32 v209, v209
    v_exp_f32 v210, v210
    v_mfma_f32_16x16x32_bf16 v[100:103], v[132:135], v[88:91], v[100:103]
    buffer_load_dwordx4 v18, s[40:43], s67 offen offset:2048 lds
    v_exp_f32 v211, v211
    v_exp_f32 v180, v180
    v_mfma_f32_16x16x32_bf16 v[192:195], a[16:19], v[10:13], 0
    v_exp_f32 v181, v181
    v_exp_f32 v182, v182
    v_mfma_f32_16x16x32_bf16 v[224:227], a[18:21], v[8:11], 0
    v_exp_f32_e64 v183, v183
    v_max3_f32 v15, v80, v81, v82
    v_max_f32_e64 v15, v15, v83
    v_max3_f32 v15, v15, v176, v177
    v_max3_f32 v15, v15, v178, v179
    v_cvt_pk_bf16_f32 v84, v208, v209
    v_cvt_pk_bf16_f32 v85, v210, v211
    v_cvt_pk_bf16_f32 v86, v180, v181
    v_cvt_pk_bf16_f32 v87, v182, v183
    v_pk_fma_f32 v[196:197], v[196:197], s[84:85], v[14:15] op_sel_hi:[1,0,0]
    v_pk_fma_f32 v[198:199], v[198:199], s[84:85], v[14:15] op_sel_hi:[1,0,0]
    v_pk_fma_f32 v[228:229], v[228:229], s[84:85], v[14:15] op_sel_hi:[1,0,0]
    v_pk_fma_f32 v[230:231], v[230:231], s[84:85], v[14:15] op_sel_hi:[1,0,0]
    v_exp_f32_e64 v196, v196
    v_mfma_f32_16x16x32_bf16 v[96:99], v[136:139], v[84:87], v[96:99]
    buffer_load_dwordx4 a[252:255], v2, s[44:47], s65 offen offset:3072 sc1
    v_exp_f32 v197, v197
    v_exp_f32 v198, v198
    v_mfma_f32_16x16x32_bf16 v[100:103], v[140:143], v[84:87], v[100:103]
    buffer_load_dwordx4 v19, s[40:43], s67 offen offset:3072 lds
    v_exp_f32 v199, v199
    v_exp_f32 v228, v228
    v_mfma_f32_16x16x32_bf16 v[208:211], a[22:25], v[10:13], 0
    v_exp_f32 v229, v229
    v_exp_f32 v230, v230
    v_mfma_f32_16x16x32_bf16 v[180:183], a[24:27], v[8:11], 0
    v_exp_f32_e64 v231, v231
    v_max3_f32 v15, v15, v192, v193
    v_max3_f32 v15, v15, v194, v195
    v_max3_f32 v15, v15, v224, v225
    v_max3_f32 v15, v15, v226, v227
    v_cvt_pk_bf16_f32 v88, v196, v197
    v_cvt_pk_bf16_f32 v89, v198, v199
    v_cvt_pk_bf16_f32 v90, v228, v229
    v_cvt_pk_bf16_f32 v91, v230, v231
    v_pk_fma_f32 v[212:213], v[212:213], s[84:85], v[14:15] op_sel_hi:[1,0,0]
    v_pk_fma_f32 v[214:215], v[214:215], s[84:85], v[14:15] op_sel_hi:[1,0,0]
    v_pk_fma_f32 v[184:185], v[184:185], s[84:85], v[14:15] op_sel_hi:[1,0,0]
    v_pk_fma_f32 v[186:187], v[186:187], s[84:85], v[14:15] op_sel_hi:[1,0,0]
    v_exp_f32_e64 v212, v212
    s_add_u32 s65, s81, 65536
    v_mfma_f32_16x16x32_bf16 v[96:99], v[144:147], v[88:91], v[96:99]
    buffer_load_dwordx4 v[32:35], v2, s[44:47], s65 offen offset:0 sc1
    v_exp_f32 v213, v213
    v_exp_f32 v214, v214
    s_mul_i32 s67, s75, 294912
    s_add_u32 s67, s67, s74
    s_add_u32 m0, s70, 81920
    v_mfma_f32_16x16x32_bf16 v[100:103], v[148:151], v[88:91], v[100:103]
    buffer_load_dwordx4 v16, s[40:43], s67 offen offset:0 lds
    v_exp_f32 v215, v215
    v_exp_f32_e64 v184, v184
    v_mfma_f32_16x16x32_bf16 v[196:199], a[28:31], v[10:13], 0
    v_exp_f32 v185, v185
    v_exp_f32 v186, v186
    v_mfma_f32_16x16x32_bf16 v[228:231], a[30:33], v[8:11], 0
    v_exp_f32_e64 v187, v187
    v_max3_f32 v15, v15, v208, v209
    v_max3_f32 v15, v15, v210, v211
    v_max3_f32 v15, v15, v180, v181
    v_max3_f32 v15, v15, v182, v183
    v_cvt_pk_bf16_f32 v84, v212, v213
    v_cvt_pk_bf16_f32 v85, v214, v215
    v_cvt_pk_bf16_f32 v86, v184, v185
    v_cvt_pk_bf16_f32 v87, v186, v187
    v_pk_fma_f32 v[200:201], v[200:201], s[84:85], v[14:15] op_sel_hi:[1,0,0]
    v_pk_fma_f32 v[202:203], v[202:203], s[84:85], v[14:15] op_sel_hi:[1,0,0]
    v_pk_fma_f32 v[232:233], v[232:233], s[84:85], v[14:15] op_sel_hi:[1,0,0]
    v_pk_fma_f32 v[234:235], v[234:235], s[84:85], v[14:15] op_sel_hi:[1,0,0]
    v_exp_f32_e64 v200, v200
    v_mfma_f32_16x16x32_bf16 v[96:99], v[152:155], v[84:87], v[96:99]
    buffer_load_dwordx4 v[36:39], v2, s[44:47], s65 offen offset:1024 sc1
    v_exp_f32 v201, v201
    v_exp_f32 v202, v202
    v_mfma_f32_16x16x32_bf16 v[100:103], v[156:159], v[84:87], v[100:103]
    buffer_load_dwordx4 v17, s[40:43], s67 offen offset:1024 lds
    v_exp_f32 v203, v203
    v_exp_f32 v232, v232
    v_mfma_f32_16x16x32_bf16 v[212:215], a[34:37], v[10:13], 0
    v_exp_f32 v233, v233
    v_exp_f32 v234, v234
    v_mfma_f32_16x16x32_bf16 v[184:187], a[36:39], v[8:11], 0
    v_exp_f32_e64 v235, v235
    v_max3_f32 v15, v15, v196, v197
    v_max3_f32 v15, v15, v198, v199
    v_max3_f32 v15, v15, v228, v229
    v_max3_f32 v15, v15, v230, v231
    v_cvt_pk_bf16_f32 v88, v200, v201
    v_cvt_pk_bf16_f32 v89, v202, v203
    v_cvt_pk_bf16_f32 v90, v232, v233
    v_cvt_pk_bf16_f32 v91, v234, v235
    buffer_load_dword v26, off, s[44:47], s7 sc1
    v_pk_fma_f32 v[216:217], v[216:217], s[84:85], v[14:15] op_sel_hi:[1,0,0]
    v_pk_fma_f32 v[218:219], v[218:219], s[84:85], v[14:15] op_sel_hi:[1,0,0]
    v_pk_fma_f32 v[188:189], v[188:189], s[84:85], v[14:15] op_sel_hi:[1,0,0]
    v_pk_fma_f32 v[190:191], v[190:191], s[84:85], v[14:15] op_sel_hi:[1,0,0]
    v_exp_f32_e64 v216, v216
    v_mfma_f32_16x16x32_bf16 v[96:99], v[160:163], v[88:91], v[96:99]
    buffer_load_dwordx4 v[40:43], v2, s[44:47], s65 offen offset:2048 sc1
    v_exp_f32 v217, v217
    v_exp_f32 v218, v218
    v_mfma_f32_16x16x32_bf16 v[100:103], v[164:167], v[88:91], v[100:103]
    buffer_load_dwordx4 v18, s[40:43], s67 offen offset:2048 lds
    v_exp_f32 v219, v219
    v_exp_f32 v188, v188
    v_mfma_f32_16x16x32_bf16 v[200:203], a[40:43], v[10:13], 0
    v_exp_f32 v189, v189
    v_exp_f32 v190, v190
    v_mfma_f32_16x16x32_bf16 v[232:235], a[42:45], v[8:11], 0
    v_exp_f32_e64 v191, v191
    v_max3_f32 v15, v15, v212, v213
    v_max3_f32 v15, v15, v214, v215
    v_max3_f32 v15, v15, v184, v185
    v_max3_f32 v15, v15, v186, v187
    v_cvt_pk_bf16_f32 v84, v216, v217
    v_cvt_pk_bf16_f32 v85, v218, v219
    v_cvt_pk_bf16_f32 v86, v188, v189
    v_cvt_pk_bf16_f32 v87, v190, v191
    v_pk_fma_f32 v[204:205], v[204:205], s[84:85], v[14:15] op_sel_hi:[1,0,0]
    v_pk_fma_f32 v[206:207], v[206:207], s[84:85], v[14:15] op_sel_hi:[1,0,0]
    v_pk_fma_f32 v[236:237], v[236:237], s[84:85], v[14:15] op_sel_hi:[1,0,0]
    v_pk_fma_f32 v[238:239], v[238:239], s[84:85], v[14:15] op_sel_hi:[1,0,0]
    v_exp_f32_e64 v204, v204
    v_mfma_f32_16x16x32_bf16 v[96:99], v[168:171], v[84:87], v[96:99]
    buffer_load_dwordx4 v[44:47], v2, s[44:47], s65 offen offset:3072 sc1
    v_exp_f32 v205, v205
    v_exp_f32 v206, v206
    v_mfma_f32_16x16x32_bf16 v[100:103], v[172:175], v[84:87], v[100:103]
    buffer_load_dwordx4 v19, s[40:43], s67 offen offset:3072 lds
    v_exp_f32 v207, v207
    v_exp_f32 v236, v236
    v_mfma_f32_16x16x32_bf16 v[216:219], a[46:49], v[10:13], 0
    v_exp_f32 v237, v237
    v_exp_f32 v238, v238
    v_mfma_f32_16x16x32_bf16 v[188:191], a[48:51], v[8:11], 0
    v_exp_f32_e64 v239, v239
    v_max3_f32 v15, v15, v200, v201
    v_max3_f32 v15, v15, v202, v203
    v_max3_f32 v15, v15, v232, v233
    v_max3_f32 v15, v15, v234, v235
    v_cvt_pk_bf16_f32 v88, v204, v205
    v_cvt_pk_bf16_f32 v89, v206, v207
    v_cvt_pk_bf16_f32 v90, v236, v237
    v_cvt_pk_bf16_f32 v91, v238, v239
    v_pk_fma_f32 v[220:221], v[220:221], s[84:85], v[14:15] op_sel_hi:[1,0,0]
    v_pk_fma_f32 v[222:223], v[222:223], s[84:85], v[14:15] op_sel_hi:[1,0,0]
    v_exp_f32_e64 v220, v220
    v_add_u32 v25, 147456, v28
    v_mfma_f32_16x16x32_bf16 v[96:99], v[240:243], v[88:91], v[96:99]
    ds_read_b128 v[48:51], v25 offset:0
    ds_read_b128 v[52:55], v25 offset:1024
    v_exp_f32_e64 v221, v221
    v_mfma_f32_16x16x32_bf16 v[100:103], v[244:247], v[88:91], v[100:103]
    ds_read_b128 v[56:59], v25 offset:2048
    ds_read_b128 v[60:63], v25 offset:3072
    v_exp_f32_e64 v222, v222
    v_mfma_f32_16x16x32_bf16 v[204:207], a[52:55], v[10:13], 0
    v_exp_f32_e64 v223, v223
    v_mfma_f32_16x16x32_bf16 v[236:239], a[54:57], v[8:11], 0
    v_max3_f32 v15, v15, v216, v217
    v_max3_f32 v15, v15, v218, v219
    v_max3_f32 v15, v15, v188, v189
    v_max3_f32 v15, v15, v190, v191
    v_cvt_pk_bf16_f32 v84, v220, v221
    v_cvt_pk_bf16_f32 v85, v222, v223
    v_mov_b32 v86, 0
    v_mov_b32 v87, 0
    v_mfma_f32_16x16x32_bf16 v[220:223], a[58:61], v[10:13], v[108:111]
    v_max3_f32 v15, v15, v204, v205
    s_waitcnt vmcnt(46)
    v_mfma_f32_16x16x32_bf16 v[96:99], v[248:251], v[84:87], v[96:99]
    v_max3_f32 v15, v15, v206, v207
    v_mfma_f32_16x16x32_bf16 v[100:103], v[252:255], v[84:87], v[100:103]
    v_max3_f32 v15, v15, v236, v237
    v_max3_f32 v15, v15, v238, v239
    s_nop 0
    v_max3_f32 v15, v15, v220, v221
    v_max3_f32 v15, v15, v222, v223
    s_nop 2
    v_rcp_f32 v23, v102
    s_nop 0
    v_mul_f32 v96, v96, v23
    v_mul_f32 v97, v97, v23
    v_mul_f32 v98, v98, v23
    v_mul_f32 v99, v99, v23
    v_mul_f32 v100, v100, v23
    v_mul_f32_e64 v101, v101, v23
    v_cvt_pk_bf16_f32 v68, v96, v97
    v_cvt_pk_bf16_f32 v69, v98, v99
    v_cvt_pk_bf16_f32 v74, v100, v101
    v_mov_b32 v23, v15
    s_nop 1
    v_permlane16_swap_b32 v23, v15
    v_max_f32 v15, v15, v23
    v_mov_b32 v23, v15
    s_nop 1
    v_permlane32_swap_b32 v23, v15
    v_max_f32 v15, v15, v23
    v_mul_f32 v14, s85, v15
    s_waitcnt lgkmcnt(0)
    s_barrier
    s_waitcnt vmcnt(4)
    v_readfirstlane_b32 s65, v26
    s_nop 0
    s_cmp_ge_u32 s65, 3
    s_cbranch_scc0 h3_slow
h3_ok:
    v_pk_fma_f32 v[80:81], v[80:81], s[84:85], v[14:15] op_sel_hi:[1,0,0]
    v_pk_fma_f32 v[82:83], v[82:83], s[84:85], v[14:15] op_sel_hi:[1,0,0]
    v_exp_f32 v80, v80
    v_exp_f32 v81, v81
    v_exp_f32 v82, v82
    v_exp_f32 v83, v83
    v_mov_b32 v84, 0
    v_mov_b32 v85, 0
    v_cvt_pk_bf16_f32 v86, v80, v81
    v_cvt_pk_bf16_f32 v87, v82, v83
    s_add_u32 s65, s81, 57344
    buffer_load_dwordx4 a[48:51], v2, s[44:47], s65 offen offset:0 sc1
    s_mul_i32 s67, s75, 221184
    s_add_u32 s67, s67, s74
    s_add_u32 m0, s70, 131072
    s_nop 0
    buffer_load_dwordx4 v16, s[40:43], s67 offen offset:0 lds
    v_pk_fma_f32 v[176:177], v[176:177], s[84:85], v[14:15] op_sel_hi:[1,0,0]
    v_pk_fma_f32 v[178:179], v[178:179], s[84:85], v[14:15] op_sel_hi:[1,0,0]
    v_pk_fma_f32 v[192:193], v[192:193], s[84:85], v[14:15] op_sel_hi:[1,0,0]
    v_pk_fma_f32 v[194:195], v[194:195], s[84:85], v[14:15] op_sel_hi:[1,0,0]
    v_exp_f32_e64 v176, v176
    v_mfma_f32_16x16x32_bf16 v[96:99], v[120:123], v[84:87], 0
    buffer_load_dwordx4 a[52:55], v2, s[44:47], s65 offen offset:1024 sc1
    v_exp_f32 v177, v177
    v_exp_f32 v178, v178
    v_mfma_f32_16x16x32_bf16 v[100:103], v[124:127], v[84:87], 0
    buffer_load_dwordx4 v17, s[40:43], s67 offen offset:1024 lds
    v_exp_f32 v179, v179
    v_exp_f32 v192, v192
    v_exp_f32 v193, v193
    v_exp_f32 v194, v194
    v_exp_f32_e64 v195, v195
    v_cvt_pk_bf16_f32 v88, v176, v177
    v_cvt_pk_bf16_f32 v89, v178, v179
    v_cvt_pk_bf16_f32 v90, v192, v193
    v_cvt_pk_bf16_f32 v91, v194, v195
    v_pk_fma_f32 v[224:225], v[224:225], s[84:85], v[14:15] op_sel_hi:[1,0,0]
    v_pk_fma_f32 v[226:227], v[226:227], s[84:85], v[14:15] op_sel_hi:[1,0,0]
    v_pk_fma_f32 v[208:209], v[208:209], s[84:85], v[14:15] op_sel_hi:[1,0,0]
    v_pk_fma_f32 v[210:211], v[210:211], s[84:85], v[14:15] op_sel_hi:[1,0,0]
    v_exp_f32_e64 v224, v224
    v_mfma_f32_16x16x32_bf16 v[96:99], v[128:131], v[88:91], v[96:99]
    buffer_load_dwordx4 a[56:59], v2, s[44:47], s65 offen offset:2048 sc1
    v_exp_f32 v225, v225
    v_exp_f32 v226, v226
    v_mfma_f32_16x16x32_bf16 v[100:103], v[132:135], v[88:91], v[100:103]
    buffer_load_dwordx4 v18, s[40:43], s67 offen offset:2048 lds
    v_exp_f32 v227, v227
    v_exp_f32 v208, v208
    v_exp_f32 v209, v209
    v_exp_f32 v210, v210
    v_exp_f32_e64 v211, v211
    v_cvt_pk_bf16_f32 v84, v224, v225
    v_cvt_pk_bf16_f32 v85, v226, v227
    v_cvt_pk_bf16_f32 v86, v208, v209
    v_cvt_pk_bf16_f32 v87, v210, v211
    v_pk_fma_f32 v[180:181], v[180:181], s[84:85], v[14:15] op_sel_hi:[1,0,0]
    v_pk_fma_f32 v[182:183], v[182:183], s[84:85], v[14:15] op_sel_hi:[1,0,0]
    v_pk_fma_f32 v[196:197], v[196:197], s[84:85], v[14:15] op_sel_hi:[1,0,0]
    v_pk_fma_f32 v[198:199], v[198:199], s[84:85], v[14:15] op_sel_hi:[1,0,0]
    v_exp_f32_e64 v180, v180
    v_mfma_f32_16x16x32_bf16 v[96:99], v[136:139], v[84:87], v[96:99]
    buffer_load_dwordx4 a[60:63], v2, s[44:47], s65 offen offset:3072 sc1
    v_exp_f32 v181, v181
    v_exp_f32 v182, v182
    v_mfma_f32_16x16x32_bf16 v[100:103], v[140:143], v[84:87], v[100:103]
    v_exp_f32 v183, v183
    v_exp_f32 v196, v196
    v_exp_f32 v197, v197
    v_exp_f32 v198, v198
    v_exp_f32_e64 v199, v199
    v_cvt_pk_bf16_f32 v88, v180, v181
    v_cvt_pk_bf16_f32 v89, v182, v183
    v_cvt_pk_bf16_f32 v90, v196, v197
    v_cvt_pk_bf16_f32 v91, v198, v199
    v_pk_fma_f32 v[228:229], v[228:229], s[84:85], v[14:15] op_sel_hi:[1,0,0]
    v_pk_fma_f32 v[230:231], v[230:231], s[84:85], v[14:15] op_sel_hi:[1,0,0]
    v_pk_fma_f32 v[212:213], v[212:213], s[84:85], v[14:15] op_sel_hi:[1,0,0]
    v_pk_fma_f32 v[214:215], v[214:215], s[84:85], v[14:15] op_sel_hi:[1,0,0]
    v_exp_f32_e64 v228, v228
    v_mfma_f32_16x16x32_bf16 v[96:99], v[144:147], v[88:91], v[96:99]
    buffer_load_dwordx4 v19, s[40:43], s67 offen offset:3072 lds
    v_exp_f32 v229, v229
    v_exp_f32 v230, v230
    v_mfma_f32_16x16x32_bf16 v[100:103], v[148:151], v[88:91], v[100:103]
    v_exp_f32 v231, v231
    v_exp_f32 v212, v212
    v_exp_f32 v213, v213
    v_exp_f32 v214, v214
    v_exp_f32_e64 v215, v215
    v_cvt_pk_bf16_f32 v84, v228, v229
    v_cvt_pk_bf16_f32 v85, v230, v231
    v_cvt_pk_bf16_f32 v86, v212, v213
    v_cvt_pk_bf16_f32 v87, v214, v215
    v_pk_fma_f32 v[184:185], v[184:185], s[84:85], v[14:15] op_sel_hi:[1,0,0]
    v_pk_fma_f32 v[186:187], v[186:187], s[84:85], v[14:15] op_sel_hi:[1,0,0]
    v_pk_fma_f32 v[200:201], v[200:201], s[84:85], v[14:15] op_sel_hi:[1,0,0]
    v_pk_fma_f32 v[202:203], v[202:203], s[84:85], v[14:15] op_sel_hi:[1,0,0]
    v_exp_f32_e64 v184, v184
    s_add_u32 s65, s81, 49152
    v_mfma_f32_16x16x32_bf16 v[96:99], v[152:155], v[84:87], v[96:99]
    buffer_load_dwordx4 a[32:35], v2, s[44:47], s65 offen offset:0 sc1
    v_exp_f32 v185, v185
    v_exp_f32 v186, v186
    v_mfma_f32_16x16x32_bf16 v[100:103], v[156:159], v[84:87], v[100:103]
    v_exp_f32 v187, v187
    v_exp_f32 v200, v200
    v_exp_f32 v201, v201
    v_exp_f32 v202, v202
    v_exp_f32_e64 v203, v203
    v_cvt_pk_bf16_f32 v88, v184, v185
    v_cvt_pk_bf16_f32 v89, v186, v187
    v_cvt_pk_bf16_f32 v90, v200, v201
    v_cvt_pk_bf16_f32 v91, v202, v203
    v_pk_fma_f32 v[232:233], v[232:233], s[84:85], v[14:15] op_sel_hi:[1,0,0]
    v_pk_fma_f32 v[234:235], v[234:235], s[84:85], v[14:15] op_sel_hi:[1,0,0]
    v_pk_fma_f32 v[216:217], v[216:217], s[84:85], v[14:15] op_sel_hi:[1,0,0]
    v_pk_fma_f32 v[218:219], v[218:219], s[84:85], v[14:15] op_sel_hi:[1,0,0]
    v_exp_f32_e64 v232, v232
    v_mfma_f32_16x16x32_bf16 v[96:99], v[160:163], v[88:91], v[96:99]
    buffer_load_dwordx4 a[36:39], v2, s[44:47], s65 offen offset:1024 sc1
    v_exp_f32 v233, v233
    v_exp_f32 v234, v234
    v_mfma_f32_16x16x32_bf16 v[100:103], v[164:167], v[88:91], v[100:103]
    v_exp_f32 v235, v235
    v_exp_f32 v216, v216
    v_exp_f32 v217, v217
    v_exp_f32 v218, v218
    v_exp_f32_e64 v219, v219
    v_cvt_pk_bf16_f32 v84, v232, v233
    v_cvt_pk_bf16_f32 v85, v234, v235
    v_cvt_pk_bf16_f32 v86, v216, v217
    v_cvt_pk_bf16_f32 v87, v218, v219
    v_pk_fma_f32 v[188:189], v[188:189], s[84:85], v[14:15] op_sel_hi:[1,0,0]
    v_pk_fma_f32 v[190:191], v[190:191], s[84:85], v[14:15] op_sel_hi:[1,0,0]
    v_pk_fma_f32 v[204:205], v[204:205], s[84:85], v[14:15] op_sel_hi:[1,0,0]
    v_pk_fma_f32 v[206:207], v[206:207], s[84:85], v[14:15] op_sel_hi:[1,0,0]
    v_exp_f32_e64 v188, v188
    v_mfma_f32_16x16x32_bf16 v[96:99], v[168:171], v[84:87], v[96:99]
    buffer_load_dwordx4 a[40:43], v2, s[44:47], s65 offen offset:2048 sc1
    v_exp_f32 v189, v189
    v_exp_f32 v190, v190
    v_mfma_f32_16x16x32_bf16 v[100:103], v[172:175], v[84:87], v[100:103]
    v_exp_f32 v191, v191
    v_exp_f32 v204, v204
    v_exp_f32 v205, v205
    v_exp_f32 v206, v206
    v_exp_f32_e64 v207, v207
    v_cvt_pk_bf16_f32 v88, v188, v189
    v_cvt_pk_bf16_f32 v89, v190, v191
    v_cvt_pk_bf16_f32 v90, v204, v205
    v_cvt_pk_bf16_f32 v91, v206, v207
    v_pk_fma_f32 v[236:237], v[236:237], s[84:85], v[14:15] op_sel_hi:[1,0,0]
    v_pk_fma_f32 v[238:239], v[238:239], s[84:85], v[14:15] op_sel_hi:[1,0,0]
    v_pk_fma_f32 v[220:221], v[220:221], s[84:85], v[14:15] op_sel_hi:[1,0,0]
    v_pk_fma_f32 v[222:223], v[222:223], s[84:85], v[14:15] op_sel_hi:[1,0,0]
    v_exp_f32_e64 v236, v236
    v_mfma_f32_16x16x32_bf16 v[96:99], v[240:243], v[88:91], v[96:99]
    buffer_load_dwordx4 a[44:47], v2, s[44:47], s65 offen offset:3072 sc1
    v_exp_f32 v237, v237
    v_exp_f32 v238, v238
    v_mfma_f32_16x16x32_bf16 v[100:103], v[244:247], v[88:91], v[100:103]
    v_exp_f32 v239, v239
    v_exp_f32 v220, v220
    v_exp_f32 v221, v221
    v_exp_f32 v222, v222
    v_exp_f32_e64 v223, v223
    v_cvt_pk_bf16_f32 v84, v236, v237
    v_cvt_pk_bf16_f32 v85, v238, v239
    v_cvt_pk_bf16_f32 v86, v220, v221
    v_cvt_pk_bf16_f32 v87, v222, v223
    s_nop 1
    v_mfma_f32_16x16x32_bf16 v[96:99], v[248:251], v[84:87], v[96:99]
    v_mfma_f32_16x16x32_bf16 v[100:103], v[252:255], v[84:87], v[100:103]
    s_nop 0
    v_add_u32 v20, 0x10000, v20
    ds_read_b64_tr_b16 v[80:81], v20 offset:0
    ds_read_b64_tr_b16 v[82:83], v20 offset:4096
    ds_read_b64_tr_b16 v[84:85], v20 offset:8192
    ds_read_b64_tr_b16 v[86:87], v20 offset:12288
    v_add_u32 v21, 0x10000, v21
    ds_read_b64_tr_b16 v[88:89], v21 offset:0
    ds_read_b64_tr_b16 v[90:91], v21 offset:4096
    ds_read_b64_tr_b16 v[92:93], v21 offset:8192
    ds_read_b64_tr_b16 v[94:95], v21 offset:12288
    v_rcp_f32 v23, v102
    s_nop 0
    v_mul_f32 v96, v96, v23
    v_mul_f32 v97, v97, v23
    v_mul_f32 v98, v98, v23
    v_mul_f32 v99, v99, v23
    v_mul_f32 v100, v100, v23
    v_mul_f32 v101, v101, v23
    v_cvt_pk_bf16_f32 v70, v96, v97
    v_cvt_pk_bf16_f32 v71, v98, v99
    v_cvt_pk_bf16_f32 v75, v100, v101
    s_waitcnt lgkmcnt(4)
    v_mfma_f32_16x16x32_bf16 v[112:115], v[80:83], a[160:163], 0
    ds_read_b64_tr_b16 v[96:97], v20 offset:2048
    s_lshl_b32 s65, s60, 3
    v_mfma_f32_16x16x32_bf16 v[112:115], v[84:87], a[176:179], v[112:115]
    ds_read_b64_tr_b16 v[98:99], v20 offset:6144
    s_add_u32 s65, s65, 147456
    v_mfma_f32_16x16x32_bf16 v[116:119], v[80:83], a[164:167], 0
    ds_read_b64_tr_b16 v[100:101], v20 offset:10240
    v_add_u32_e64 v24, s65, v28
    v_mfma_f32_16x16x32_bf16 v[116:119], v[84:87], a[180:183], v[116:119]
    ds_read_b64_tr_b16 v[102:103], v20 offset:14336
    s_lshl_b32 s65, s59, 9
    v_mfma_f32_16x16x32_bf16 v[120:123], v[80:83], a[168:171], 0
    ds_read_b64_tr_b16 v[104:105], v21 offset:2048
    s_lshl_b32 s66, s60, 2
    v_mfma_f32_16x16x32_bf16 v[120:123], v[84:87], a[184:187], v[120:123]
    ds_read_b64_tr_b16 v[106:107], v21 offset:6144
    s_add_u32 s65, s65, s66
    v_mfma_f32_16x16x32_bf16 v[124:127], v[80:83], a[172:175], 0
    ds_read_b64_tr_b16 v[108:109], v21 offset:10240
    s_add_u32 s65, s65, 155648
    v_mfma_f32_16x16x32_bf16 v[124:127], v[84:87], a[188:191], v[124:127]
    ds_read_b64_tr_b16 v[110:111], v21 offset:14336
    s_waitcnt lgkmcnt(8)
    s_barrier
    v_mfma_f32_16x16x32_bf16 v[128:131], v[88:91], a[160:163], 0
    ds_read_b64_tr_b16 v[80:81], v20 offset:32768
    v_lshlrev_b32 v23, 3, v1
    v_mfma_f32_16x16x32_bf16 v[128:131], v[92:95], a[176:179], v[128:131]
    v_add_u32 v14, 4096, v23
    v_cndmask_b32 v23, v14, v23, s[96:97]
    v_mfma_f32_16x16x32_bf16 v[132:135], v[88:91], a[164:167], 0
    ds_read_b64_tr_b16 v[82:83], v20 offset:36864
    v_add_u32_e64 v23, s65, v23
    v_mfma_f32_16x16x32_bf16 v[132:135], v[92:95], a[180:183], v[132:135]
    ds_write_b64 v24, v[64:65] offset:0
    v_add_u32 v25, 16384, v28
    v_mfma_f32_16x16x32_bf16 v[136:139], v[88:91], a[168:171], 0
    ds_read_b64_tr_b16 v[84:85], v20 offset:40960
    v_mfma_f32_16x16x32_bf16 v[136:139], v[92:95], a[184:187], v[136:139]
    ds_write_b32 v23, v72 offset:0
    v_mfma_f32_16x16x32_bf16 v[140:143], v[88:91], a[172:175], 0
    ds_read_b64_tr_b16 v[86:87], v20 offset:45056
    v_mfma_f32_16x16x32_bf16 v[140:143], v[92:95], a[188:191], v[140:143]
    ds_write_b64 v24, v[66:67] offset:1024
    s_waitcnt lgkmcnt(11)
    v_mfma_f32_16x16x32_bf16 v[144:147], v[96:99], a[160:163], 0
    ds_read_b64_tr_b16 v[88:89], v21 offset:32768
    v_mfma_f32_16x16x32_bf16 v[144:147], v[100:103], a[176:179], v[144:147]
    ds_write_b32 v23, v73 offset:128
    v_mfma_f32_16x16x32_bf16 v[148:151], v[96:99], a[164:167], 0
    ds_read_b64_tr_b16 v[90:91], v21 offset:36864
    v_mfma_f32_16x16x32_bf16 v[148:151], v[100:103], a[180:183], v[148:151]
    ds_write_b64 v24, v[68:69] offset:2048
    v_mfma_f32_16x16x32_bf16 v[152:155], v[96:99], a[168:171], 0
    ds_read_b64_tr_b16 v[92:93], v21 offset:40960
    v_mfma_f32_16x16x32_bf16 v[152:155], v[100:103], a[184:187], v[152:155]
    ds_write_b32 v23, v74 offset:256
    v_mfma_f32_16x16x32_bf16 v[156:159], v[96:99], a[172:175], 0
    ds_read_b64_tr_b16 v[94:95], v21 offset:45056
    v_mfma_f32_16x16x32_bf16 v[156:159], v[100:103], a[188:191], v[156:159]
    ds_write_b64 v24, v[70:71] offset:3072
    s_waitcnt lgkmcnt(15)
    v_mfma_f32_16x16x32_bf16 v[160:163], v[104:107], a[160:163], 0
    ds_read_b64_tr_b16 v[96:97], v20 offset:34816
    v_mfma_f32_16x16x32_bf16 v[160:163], v[108:111], a[176:179], v[160:163]
    ds_write_b32 v23, v75 offset:384
    v_mfma_f32_16x16x32_bf16 v[164:167], v[104:107], a[164:167], 0
    ds_read_b64_tr_b16 v[98:99], v20 offset:38912
    v_mfma_f32_16x16x32_bf16 v[164:167], v[108:111], a[180:183], v[164:167]
    ds_read_b128 a[0:3], v25 offset:0
    v_mfma_f32_16x16x32_bf16 v[168:171], v[104:107], a[168:171], 0
    ds_read_b64_tr_b16 v[100:101], v20 offset:43008
    v_mfma_f32_16x16x32_bf16 v[168:171], v[108:111], a[184:187], v[168:171]
    ds_read_b128 a[4:7], v25 offset:1024
    v_mfma_f32_16x16x32_bf16 v[172:175], v[104:107], a[172:175], 0
    ds_read_b64_tr_b16 v[102:103], v20 offset:47104
    v_mfma_f32_16x16x32_bf16 v[172:175], v[108:111], a[188:191], v[172:175]
    ds_read_b128 a[8:11], v25 offset:2048
    s_waitcnt lgkmcnt(15)
    v_mfma_f32_16x16x32_bf16 v[112:115], v[80:83], a[192:195], v[112:115]
    ds_read_b64_tr_b16 v[104:105], v21 offset:34816
    v_mfma_f32_16x16x32_bf16 v[112:115], v[84:87], a[208:211], v[112:115]
    ds_read_b128 a[12:15], v25 offset:3072
    v_add_u32 v25, 24576, v28
    v_mfma_f32_16x16x32_bf16 v[116:119], v[80:83], a[196:199], v[116:119]
    ds_read_b64_tr_b16 v[106:107], v21 offset:38912
    v_mfma_f32_16x16x32_bf16 v[116:119], v[84:87], a[212:215], v[116:119]
    ds_read_b128 a[16:19], v25 offset:0
    v_mfma_f32_16x16x32_bf16 v[120:123], v[80:83], a[200:203], v[120:123]
    ds_read_b64_tr_b16 v[108:109], v21 offset:43008
    v_mfma_f32_16x16x32_bf16 v[120:123], v[84:87], a[216:219], v[120:123]
    ds_read_b128 a[20:23], v25 offset:1024
    v_mfma_f32_16x16x32_bf16 v[124:127], v[80:83], a[204:207], v[124:127]
    ds_read_b64_tr_b16 v[110:111], v21 offset:47104
    v_mfma_f32_16x16x32_bf16 v[124:127], v[84:87], a[220:223], v[124:127]
    v_add_u32 v20, 0xffff0000, v20
    s_waitcnt lgkmcnt(13)
    s_barrier
    v_mfma_f32_16x16x32_bf16 v[128:131], v[88:91], a[192:195], v[128:131]
    ds_read_b64_tr_b16 v[80:81], v20 offset:0
    s_mul_i32 s67, s75, 368640
    v_mfma_f32_16x16x32_bf16 v[128:131], v[92:95], a[208:211], v[128:131]
    ds_read_b128 a[24:27], v25 offset:2048
    s_add_u32 s67, s67, s74
    v_mfma_f32_16x16x32_bf16 v[132:135], v[88:91], a[196:199], v[132:135]
    ds_read_b64_tr_b16 v[82:83], v20 offset:4096
    s_add_u32 m0, s70, 65536
    v_mfma_f32_16x16x32_bf16 v[132:135], v[92:95], a[212:215], v[132:135]
    ds_read_b128 a[28:31], v25 offset:3072
    v_mfma_f32_16x16x32_bf16 v[136:139], v[88:91], a[200:203], v[136:139]
    ds_read_b64_tr_b16 v[84:85], v20 offset:8192
    v_mfma_f32_16x16x32_bf16 v[136:139], v[92:95], a[216:219], v[136:139]
    buffer_load_dwordx4 v16, s[40:43], s67 offen offset:0 lds
    v_mfma_f32_16x16x32_bf16 v[140:143], v[88:91], a[204:207], v[140:143]
    ds_read_b64_tr_b16 v[86:87], v20 offset:12288
    v_mfma_f32_16x16x32_bf16 v[140:143], v[92:95], a[220:223], v[140:143]
    v_add_u32 v21, 0xffff0000, v21
    s_waitcnt lgkmcnt(14)
    v_mfma_f32_16x16x32_bf16 v[144:147], v[96:99], a[192:195], v[144:147]
    ds_read_b64_tr_b16 v[88:89], v21 offset:0
    v_mfma_f32_16x16x32_bf16 v[144:147], v[100:103], a[208:211], v[144:147]
    buffer_load_dwordx4 v17, s[40:43], s67 offen offset:1024 lds
    v_mfma_f32_16x16x32_bf16 v[148:151], v[96:99], a[196:199], v[148:151]
    ds_read_b64_tr_b16 v[90:91], v21 offset:4096
    v_mfma_f32_16x16x32_bf16 v[148:151], v[100:103], a[212:215], v[148:151]
    v_mfma_f32_16x16x32_bf16 v[152:155], v[96:99], a[200:203], v[152:155]
    ds_read_b64_tr_b16 v[92:93], v21 offset:8192
    v_mfma_f32_16x16x32_bf16 v[152:155], v[100:103], a[216:219], v[152:155]
    buffer_load_dwordx4 v18, s[40:43], s67 offen offset:2048 lds
    v_mfma_f32_16x16x32_bf16 v[156:159], v[96:99], a[204:207], v[156:159]
    ds_read_b64_tr_b16 v[94:95], v21 offset:12288
    v_mfma_f32_16x16x32_bf16 v[156:159], v[100:103], a[220:223], v[156:159]
    s_waitcnt lgkmcnt(10)
    v_mfma_f32_16x16x32_bf16 v[160:163], v[104:107], a[192:195], v[160:163]
    ds_read_b64_tr_b16 v[96:97], v20 offset:2048
    v_mfma_f32_16x16x32_bf16 v[160:163], v[108:111], a[208:211], v[160:163]
    v_mfma_f32_16x16x32_bf16 v[164:167], v[104:107], a[196:199], v[164:167]
    ds_read_b64_tr_b16 v[98:99], v20 offset:6144
    v_mfma_f32_16x16x32_bf16 v[164:167], v[108:111], a[212:215], v[164:167]
    buffer_load_dwordx4 v19, s[40:43], s67 offen offset:3072 lds
    v_mfma_f32_16x16x32_bf16 v[168:171], v[104:107], a[200:203], v[168:171]
    ds_read_b64_tr_b16 v[100:101], v20 offset:10240
    v_mfma_f32_16x16x32_bf16 v[168:171], v[108:111], a[216:219], v[168:171]
    v_mfma_f32_16x16x32_bf16 v[172:175], v[104:107], a[204:207], v[172:175]
    ds_read_b64_tr_b16 v[102:103], v20 offset:14336
    v_mfma_f32_16x16x32_bf16 v[172:175], v[108:111], a[220:223], v[172:175]
    s_waitcnt lgkmcnt(8)
    v_mfma_f32_16x16x32_bf16 v[112:115], v[80:83], a[224:227], v[112:115]
    ds_read_b64_tr_b16 v[104:105], v21 offset:2048
    s_lshl_b32 s66, s60, 11
    v_mfma_f32_16x16x32_bf16 v[112:115], v[84:87], a[240:243], v[112:115]
    s_add_u32 s66, s66, 147456
    v_add_u32_e64 v24, s66, v28
    v_mfma_f32_16x16x32_bf16 v[116:119], v[80:83], a[228:231], v[116:119]
    ds_read_b64_tr_b16 v[106:107], v21 offset:6144
    v_mfma_f32_16x16x32_bf16 v[116:119], v[84:87], a[244:247], v[116:119]
    ds_read_b128 v[64:67], v24 offset:0
    v_mfma_f32_16x16x32_bf16 v[120:123], v[80:83], a[232:235], v[120:123]
    ds_read_b64_tr_b16 v[108:109], v21 offset:10240
    v_mfma_f32_16x16x32_bf16 v[120:123], v[84:87], a[248:251], v[120:123]
    ds_read_b128 v[68:71], v24 offset:1024
    s_add_u32 s66, s4, 18432
    v_mfma_f32_16x16x32_bf16 v[124:127], v[80:83], a[236:239], v[124:127]
    ds_read_b64_tr_b16 v[110:111], v21 offset:14336
    v_mfma_f32_16x16x32_bf16 v[124:127], v[84:87], a[252:255], v[124:127]
    s_waitcnt lgkmcnt(10)
    s_barrier
    v_mfma_f32_16x16x32_bf16 v[128:131], v[88:91], a[224:227], v[128:131]
    ds_read_b64_tr_b16 v[80:81], v20 offset:32768
    s_add_u32 m0, s71, 16384
    v_mfma_f32_16x16x32_bf16 v[128:131], v[92:95], a[240:243], v[128:131]
    s_mul_i32 s67, s75, 0
    s_add_u32 s67, s67, s76
    v_mfma_f32_16x16x32_bf16 v[132:135], v[88:91], a[228:231], v[132:135]
    ds_read_b64_tr_b16 v[82:83], v20 offset:36864
    v_mfma_f32_16x16x32_bf16 v[132:135], v[92:95], a[244:247], v[132:135]
    buffer_load_dwordx4 v7, s[40:43], s67 offen offset:0 lds
    s_mul_i32 s67, s75, 0
    v_mfma_f32_16x16x32_bf16 v[136:139], v[88:91], a[232:235], v[136:139]
    ds_read_b64_tr_b16 v[84:85], v20 offset:40960
    s_add_u32 s67, s67, s77
    v_mfma_f32_16x16x32_bf16 v[136:139], v[92:95], a[248:251], v[136:139]
    v_mfma_f32_16x16x32_bf16 v[140:143], v[88:91], a[236:239], v[140:143]
    ds_read_b64_tr_b16 v[86:87], v20 offset:45056
    v_mfma_f32_16x16x32_bf16 v[140:143], v[92:95], a[252:255], v[140:143]
    s_waitcnt lgkmcnt(10)
    v_mfma_f32_16x16x32_bf16 v[144:147], v[96:99], a[224:227], v[144:147]
    ds_read_b64_tr_b16 v[88:89], v21 offset:32768
    v_mfma_f32_16x16x32_bf16 v[144:147], v[100:103], a[240:243], v[144:147]
    v_mfma_f32_16x16x32_bf16 v[148:151], v[96:99], a[228:231], v[148:151]
    ds_read_b64_tr_b16 v[90:91], v21 offset:36864
    v_mfma_f32_16x16x32_bf16 v[148:151], v[100:103], a[244:247], v[148:151]
    s_waitcnt lgkmcnt(9)
    buffer_store_dwordx4 v[64:67], v2, s[44:47], s4 offen sc1
    v_mfma_f32_16x16x32_bf16 v[152:155], v[96:99], a[232:235], v[152:155]
    ds_read_b64_tr_b16 v[92:93], v21 offset:40960
    v_mfma_f32_16x16x32_bf16 v[152:155], v[100:103], a[248:251], v[152:155]
    v_mfma_f32_16x16x32_bf16 v[156:159], v[96:99], a[236:239], v[156:159]
    ds_read_b64_tr_b16 v[94:95], v21 offset:45056
    v_mfma_f32_16x16x32_bf16 v[156:159], v[100:103], a[252:255], v[156:159]
    s_waitcnt lgkmcnt(9)
    buffer_store_dwordx4 v[68:71], v2, s[44:47], s66 offen sc1
    s_waitcnt lgkmcnt(8)
    v_mfma_f32_16x16x32_bf16 v[160:163], v[104:107], a[224:227], v[160:163]
    ds_read_b64_tr_b16 v[96:97], v20 offset:34816
    v_add_u32 v23, 155648, v2
    v_mfma_f32_16x16x32_bf16 v[160:163], v[108:111], a[240:243], v[160:163]
    ds_read_b128 v[72:75], v23
    v_lshrrev_b32_e64 v23, 3, v1
    v_mfma_f32_16x16x32_bf16 v[164:167], v[104:107], a[228:231], v[164:167]
    ds_read_b64_tr_b16 v[98:99], v20 offset:38912
    v_mul_u32_u24 v23, 18304, v23
    v_mfma_f32_16x16x32_bf16 v[164:167], v[108:111], a[244:247], v[164:167]
    buffer_load_dwordx4 v7, s[40:43], s67 offen offset:1024 lds
    s_mul_i32 s67, s75, 0
    v_mfma_f32_16x16x32_bf16 v[168:171], v[104:107], a[232:235], v[168:171]
    ds_read_b64_tr_b16 v[100:101], v20 offset:43008
    s_add_u32 s67, s67, s78
    v_mfma_f32_16x16x32_bf16 v[168:171], v[108:111], a[248:251], v[168:171]
    v_add_u32_e64 v23, v23, v2
    v_mfma_f32_16x16x32_bf16 v[172:175], v[104:107], a[236:239], v[172:175]
    ds_read_b64_tr_b16 v[102:103], v20 offset:47104
    v_mfma_f32_16x16x32_bf16 v[172:175], v[108:111], a[252:255], v[172:175]
    s_waitcnt lgkmcnt(9)
    v_mfma_f32_16x16x32_bf16 v[112:115], v[80:83], a[64:67], v[112:115]
    ds_read_b64_tr_b16 v[104:105], v21 offset:34816
    v_mfma_f32_16x16x32_bf16 v[112:115], v[84:87], a[80:83], v[112:115]
    v_mfma_f32_16x16x32_bf16 v[116:119], v[80:83], a[68:71], v[116:119]
    ds_read_b64_tr_b16 v[106:107], v21 offset:38912
    v_mfma_f32_16x16x32_bf16 v[116:119], v[84:87], a[84:87], v[116:119]
    buffer_load_dwordx4 v7, s[40:43], s67 offen offset:2048 lds
    s_add_u32 m0, s71, 98304
    v_mfma_f32_16x16x32_bf16 v[120:123], v[80:83], a[72:75], v[120:123]
    ds_read_b64_tr_b16 v[108:109], v21 offset:43008
    s_mul_i32 s67, s75, 221184
    v_mfma_f32_16x16x32_bf16 v[120:123], v[84:87], a[88:91], v[120:123]
    s_add_u32 s67, s67, s76
    v_mfma_f32_16x16x32_bf16 v[124:127], v[80:83], a[76:79], v[124:127]
    ds_read_b64_tr_b16 v[110:111], v21 offset:47104
    v_mfma_f32_16x16x32_bf16 v[124:127], v[84:87], a[92:95], v[124:127]
    s_waitcnt lgkmcnt(9)
    s_barrier
    v_mfma_f32_16x16x32_bf16 v[128:131], v[88:91], a[64:67], v[128:131]
    ds_read_b64_tr_b16 v[80:81], v20 offset:49152
    v_mfma_f32_16x16x32_bf16 v[128:131], v[92:95], a[80:83], v[128:131]
    v_mfma_f32_16x16x32_bf16 v[132:135], v[88:91], a[68:71], v[132:135]
    ds_read_b64_tr_b16 v[82:83], v20 offset:53248
    v_mfma_f32_16x16x32_bf16 v[132:135], v[92:95], a[84:87], v[132:135]
    v_mfma_f32_16x16x32_bf16 v[136:139], v[88:91], a[72:75], v[136:139]
    ds_read_b64_tr_b16 v[84:85], v20 offset:57344
    v_mfma_f32_16x16x32_bf16 v[136:139], v[92:95], a[88:91], v[136:139]
    s_waitcnt lgkmcnt(10)
    buffer_store_dwordx4 v[72:75], v23, s[44:47], s5 offen sc1
    s_mov_b32 s32, s8
    v_mfma_f32_16x16x32_bf16 v[140:143], v[88:91], a[76:79], v[140:143]
    ds_read_b64_tr_b16 v[86:87], v20 offset:61440
    s_mov_b32 s33, s9
    v_mfma_f32_16x16x32_bf16 v[140:143], v[92:95], a[92:95], v[140:143]
    buffer_load_dwordx4 v7, s[40:43], s67 offen offset:0 lds
    s_waitcnt lgkmcnt(8)
    v_mfma_f32_16x16x32_bf16 v[144:147], v[96:99], a[64:67], v[144:147]
    ds_read_b64_tr_b16 v[88:89], v21 offset:49152
    s_mul_i32 s67, s75, 221184
    v_mfma_f32_16x16x32_bf16 v[144:147], v[100:103], a[80:83], v[144:147]
    s_add_u32 s67, s67, s77
    s_mov_b32 s34, 0xa2000
    v_mfma_f32_16x16x32_bf16 v[148:151], v[96:99], a[68:71], v[148:151]
    ds_read_b64_tr_b16 v[90:91], v21 offset:53248
    s_mov_b32 s36, s0
    v_mfma_f32_16x16x32_bf16 v[148:151], v[100:103], a[84:87], v[148:151]
    s_mov_b32 s37, s1
    s_mov_b32 s38, 0x240000
    v_mfma_f32_16x16x32_bf16 v[152:155], v[96:99], a[72:75], v[152:155]
    ds_read_b64_tr_b16 v[92:93], v21 offset:57344
    s_lshl_b32 s93, s56, 11
    v_mfma_f32_16x16x32_bf16 v[152:155], v[100:103], a[88:91], v[152:155]
    s_add_u32 s93, s93, 0x2f10000
    s_mov_b32 s94, 0x00003f80
    v_mfma_f32_16x16x32_bf16 v[156:159], v[96:99], a[76:79], v[156:159]
    ds_read_b64_tr_b16 v[94:95], v21 offset:61440
    s_mov_b32 s95, 0x3f800000
    v_mfma_f32_16x16x32_bf16 v[156:159], v[100:103], a[92:95], v[156:159]
    s_lshl_b32 s65, s62, 2
    s_waitcnt lgkmcnt(8)
    v_mfma_f32_16x16x32_bf16 v[160:163], v[104:107], a[64:67], v[160:163]
    ds_read_b64_tr_b16 v[96:97], v20 offset:51200
    s_lshr_b32 s64, 0x40518732, s65
    v_mfma_f32_16x16x32_bf16 v[160:163], v[108:111], a[80:83], v[160:163]
    buffer_load_dwordx4 v7, s[40:43], s67 offen offset:1024 lds
    s_mul_i32 s67, s75, 221184
    v_mfma_f32_16x16x32_bf16 v[164:167], v[104:107], a[68:71], v[164:167]
    ds_read_b64_tr_b16 v[98:99], v20 offset:55296
    s_add_u32 s67, s67, s78
    v_mfma_f32_16x16x32_bf16 v[164:167], v[108:111], a[84:87], v[164:167]
    s_and_b32 s64, s64, 15
    s_lshr_b32 s91, 0x65557777, s65
    v_mfma_f32_16x16x32_bf16 v[168:171], v[104:107], a[72:75], v[168:171]
    ds_read_b64_tr_b16 v[100:101], v20 offset:59392
    s_and_b32 s91, s91, 15
    v_mfma_f32_16x16x32_bf16 v[168:171], v[108:111], a[88:91], v[168:171]
    s_movk_i32 s90, 0x5555
    v_mfma_f32_16x16x32_bf16 v[172:175], v[104:107], a[76:79], v[172:175]
    ds_read_b64_tr_b16 v[102:103], v20 offset:63488
    v_mfma_f32_16x16x32_bf16 v[172:175], v[108:111], a[92:95], v[172:175]
    s_waitcnt lgkmcnt(8)
    v_mfma_f32_16x16x32_bf16 v[112:115], v[80:83], a[96:99], v[112:115]
    ds_read_b64_tr_b16 v[104:105], v21 offset:51200
    v_mfma_f32_16x16x32_bf16 v[112:115], v[84:87], a[112:115], v[112:115]
    s_cmp_gt_u32 s64, 4
    s_cselect_b32 s65, 1, 0
    v_mfma_f32_16x16x32_bf16 v[116:119], v[80:83], a[100:103], v[116:119]
    ds_read_b64_tr_b16 v[106:107], v21 offset:55296
    s_lshl_b32 s90, s90, s65
    v_mfma_f32_16x16x32_bf16 v[116:119], v[84:87], a[116:119], v[116:119]
    buffer_load_dwordx4 v7, s[40:43], s67 offen offset:2048 lds
    s_add_u32 m0, s71, 0
    v_mfma_f32_16x16x32_bf16 v[120:123], v[80:83], a[104:107], v[120:123]
    ds_read_b64_tr_b16 v[108:109], v21 offset:59392
    s_mul_i32 s67, s75, 442368
    v_mfma_f32_16x16x32_bf16 v[120:123], v[84:87], a[120:123], v[120:123]
    s_add_u32 s67, s67, s76
    v_mfma_f32_16x16x32_bf16 v[124:127], v[80:83], a[108:111], v[124:127]
    ds_read_b64_tr_b16 v[110:111], v21 offset:63488
    v_mfma_f32_16x16x32_bf16 v[124:127], v[84:87], a[124:127], v[124:127]
    v_add_u32 v20, 0x10000, v20
    s_waitcnt lgkmcnt(8)
    s_barrier
    v_mfma_f32_16x16x32_bf16 v[128:131], v[88:91], a[96:99], v[128:131]
    ds_read_b64_tr_b16 v[80:81], v20 offset:49152
    v_mfma_f32_16x16x32_bf16 v[128:131], v[92:95], a[112:115], v[128:131]
    s_cmp_eq_u32 s64, 4
    s_cselect_b32 s90, 0xffff, s90
    v_mfma_f32_16x16x32_bf16 v[132:135], v[88:91], a[100:103], v[132:135]
    ds_read_b64_tr_b16 v[82:83], v20 offset:53248
    s_bitset0_b32 s90, s57
    v_mfma_f32_16x16x32_bf16 v[132:135], v[92:95], a[116:119], v[132:135]
    s_lshl_b32 s87, s64, 7
    s_lshl_b32 s65, s61, 2
    v_mfma_f32_16x16x32_bf16 v[136:139], v[88:91], a[104:107], v[136:139]
    ds_read_b64_tr_b16 v[84:85], v20 offset:57344
    s_add_u32 s65, s65, s58
    v_mfma_f32_16x16x32_bf16 v[136:139], v[92:95], a[120:123], v[136:139]
    buffer_load_dwordx4 v7, s[40:43], s67 offen offset:0 lds
    s_mul_i32 s67, s75, 442368
    v_mfma_f32_16x16x32_bf16 v[140:143], v[88:91], a[108:111], v[140:143]
    ds_read_b64_tr_b16 v[86:87], v20 offset:61440
    s_add_u32 s67, s67, s77
    v_mfma_f32_16x16x32_bf16 v[140:143], v[92:95], a[124:127], v[140:143]
    v_add_u32 v21, 0x10000, v21
    s_waitcnt lgkmcnt(8)
    v_mfma_f32_16x16x32_bf16 v[144:147], v[96:99], a[96:99], v[144:147]
    ds_read_b64_tr_b16 v[88:89], v21 offset:49152
    s_lshl_b32 s88, s65, 10
    v_mfma_f32_16x16x32_bf16 v[144:147], v[100:103], a[112:115], v[144:147]
    s_lshl_b32 s64, s64, 14
    s_sub_u32 s88, s88, s64
    v_mfma_f32_16x16x32_bf16 v[148:151], v[96:99], a[100:103], v[148:151]
    ds_read_b64_tr_b16 v[90:91], v21 offset:53248
    s_mul_i32 s64, s56, 1179648
    v_mfma_f32_16x16x32_bf16 v[148:151], v[100:103], a[116:119], v[148:151]
    s_add_u32 s88, s88, s64
    s_lshl_b32 s64, s56, 3
    v_mfma_f32_16x16x32_bf16 v[152:155], v[96:99], a[104:107], v[152:155]
    ds_read_b64_tr_b16 v[92:93], v21 offset:57344
    s_add_u32 s65, s65, s64
    v_mfma_f32_16x16x32_bf16 v[152:155], v[100:103], a[120:123], v[152:155]
    buffer_load_dwordx4 v7, s[40:43], s67 offen offset:1024 lds
    s_mul_i32 s67, s75, 442368
    v_mfma_f32_16x16x32_bf16 v[156:159], v[96:99], a[108:111], v[156:159]
    ds_read_b64_tr_b16 v[94:95], v21 offset:61440
    s_add_u32 s67, s67, s78
    v_mfma_f32_16x16x32_bf16 v[156:159], v[100:103], a[124:127], v[156:159]
    s_mul_i32 s92, s65, 18432
    s_waitcnt lgkmcnt(8)
    v_mfma_f32_16x16x32_bf16 v[160:163], v[104:107], a[96:99], v[160:163]
    ds_read_b64_tr_b16 v[96:97], v20 offset:51200
    s_add_u32 s89, s92, s87
    v_mfma_f32_16x16x32_bf16 v[160:163], v[108:111], a[112:115], v[160:163]
    s_mul_i32 s64, s58, 41472
    s_add_u32 s87, s87, s64
    v_mfma_f32_16x16x32_bf16 v[164:167], v[104:107], a[100:103], v[164:167]
    ds_read_b64_tr_b16 v[98:99], v20 offset:55296
    v_add_u32 v3, 4294965248, v16
    v_mfma_f32_16x16x32_bf16 v[164:167], v[108:111], a[116:119], v[164:167]
    v_add_u32 v4, 6144, v16
    v_add_u32 v5, 18944, v16
    v_mfma_f32_16x16x32_bf16 v[168:171], v[104:107], a[104:107], v[168:171]
    ds_read_b64_tr_b16 v[100:101], v20 offset:59392
    v_add_u32 v6, 27136, v16
    v_mfma_f32_16x16x32_bf16 v[168:171], v[108:111], a[120:123], v[168:171]
    v_lshrrev_b32_e64 v8, 5, v1
    v_mul_u32_u24 v8, 36864, v8
    v_mfma_f32_16x16x32_bf16 v[172:175], v[104:107], a[108:111], v[172:175]
    ds_read_b64_tr_b16 v[102:103], v20 offset:63488
    v_add_u32_e64 v8, v8, v3
    v_mfma_f32_16x16x32_bf16 v[172:175], v[108:111], a[124:127], v[172:175]
    buffer_load_dwordx4 v7, s[40:43], s67 offen offset:2048 lds
    s_waitcnt lgkmcnt(8)
    v_mfma_f32_16x16x32_bf16 v[112:115], v[80:83], a[128:131], v[112:115]
    ds_read_b64_tr_b16 v[104:105], v21 offset:51200
    s_add_u32 s74, s74, 256
    v_mfma_f32_16x16x32_bf16 v[112:115], v[84:87], a[144:147], v[112:115]
    s_mul_i32 s67, s75, 589824
    s_add_u32 s67, s67, s74
    v_mfma_f32_16x16x32_bf16 v[116:119], v[80:83], a[132:135], v[116:119]
    ds_read_b64_tr_b16 v[106:107], v21 offset:55296
    s_add_u32 m0, s70, 32768
    v_mfma_f32_16x16x32_bf16 v[116:119], v[84:87], a[148:151], v[116:119]
    v_add_u32 v8, 18432, v8
    v_and_b32 v9, 0xffff, v20
    v_mfma_f32_16x16x32_bf16 v[120:123], v[80:83], a[136:139], v[120:123]
    ds_read_b64_tr_b16 v[108:109], v21 offset:59392
    s_lshl_b32 s65, s60, 6
    v_mfma_f32_16x16x32_bf16 v[120:123], v[84:87], a[152:155], v[120:123]
    v_xor_b32 v9, s65, v9
    v_xor_b32_e64 v10, 32, v9
    v_mfma_f32_16x16x32_bf16 v[124:127], v[80:83], a[140:143], v[124:127]
    ds_read_b64_tr_b16 v[110:111], v21 offset:63488
    v_xor_b32_e64 v11, 64, v9
    v_mfma_f32_16x16x32_bf16 v[124:127], v[84:87], a[156:159], v[124:127]
    s_waitcnt vmcnt(28) lgkmcnt(8)
    s_barrier
    v_mfma_f32_16x16x32_bf16 v[128:131], v[88:91], a[128:131], v[128:131]
    ds_read_b64_tr_b16 v[80:81], v20 offset:16384
    v_xor_b32 v12, 0x60, v9
    v_mfma_f32_16x16x32_bf16 v[128:131], v[92:95], a[144:147], v[128:131]
    buffer_load_dwordx4 v16, s[40:43], s67 offen offset:0 lds
    v_lshlrev_b32_e64 v13, 3, v31
    v_mfma_f32_16x16x32_bf16 v[132:135], v[88:91], a[132:135], v[132:135]
    ds_read_b64_tr_b16 v[82:83], v20 offset:20480
    v_and_b32_e64 v14, 15, v1
    v_mfma_f32_16x16x32_bf16 v[132:135], v[92:95], a[148:151], v[132:135]
    v_mul_u32_u24 v30, 1152, v14
    v_bfe_u32 v15, v1, 4, 1
    v_mfma_f32_16x16x32_bf16 v[136:139], v[88:91], a[136:139], v[136:139]
    ds_read_b64_tr_b16 v[84:85], v20 offset:24576
    v_lshl_add_u32 v30, v15, 5, v30
    v_mfma_f32_16x16x32_bf16 v[136:139], v[92:95], a[152:155], v[136:139]
    buffer_load_dwordx4 v17, s[40:43], s67 offen offset:1024 lds
    v_lshrrev_b32_e64 v15, 5, v1
    v_mfma_f32_16x16x32_bf16 v[140:143], v[88:91], a[140:143], v[140:143]
    ds_read_b64_tr_b16 v[86:87], v20 offset:28672
    v_lshl_add_u32 v30, v15, 4, v30
    v_mfma_f32_16x16x32_bf16 v[140:143], v[92:95], a[156:159], v[140:143]
    s_lshl_b32 s65, s61, 2
    s_waitcnt lgkmcnt(8)
    v_mfma_f32_16x16x32_bf16 v[144:147], v[96:99], a[128:131], v[144:147]
    ds_read_b64_tr_b16 v[88:89], v21 offset:16384
    s_add_u32 s65, s65, s58
    v_mfma_f32_16x16x32_bf16 v[144:147], v[100:103], a[144:147], v[144:147]
    s_lshl_b32 s65, s65, 6
    s_lshr_b32 s66, s3, 4
    v_mfma_f32_16x16x32_bf16 v[148:151], v[96:99], a[132:135], v[148:151]
    ds_read_b64_tr_b16 v[90:91], v21 offset:20480
    s_xor_b32 s65, s65, s66
    v_mfma_f32_16x16x32_bf16 v[148:151], v[100:103], a[148:151], v[148:151]
    buffer_load_dwordx4 v18, s[40:43], s67 offen offset:2048 lds
    s_add_u32 s65, s65, 163328
    v_mfma_f32_16x16x32_bf16 v[152:155], v[96:99], a[136:139], v[152:155]
    ds_read_b64_tr_b16 v[92:93], v21 offset:24576
    v_lshlrev_b32_e64 v14, 2, v14
    v_mfma_f32_16x16x32_bf16 v[152:155], v[100:103], a[152:155], v[152:155]
    v_add_u32_e64 v14, s65, v14
    v_mfma_f32_16x16x32_bf16 v[156:159], v[96:99], a[140:143], v[156:159]
    ds_read_b64_tr_b16 v[94:95], v21 offset:28672
    v_mfma_f32_16x16x32_bf16 v[156:159], v[100:103], a[156:159], v[156:159]
    ds_read_b32 v14, v14
    s_waitcnt lgkmcnt(9)
    v_mfma_f32_16x16x32_bf16 v[160:163], v[104:107], a[128:131], v[160:163]
    ds_read_b64_tr_b16 v[96:97], v20 offset:18432
    v_mfma_f32_16x16x32_bf16 v[160:163], v[108:111], a[144:147], v[160:163]
    buffer_load_dwordx4 v19, s[40:43], s67 offen offset:3072 lds
    s_mul_i32 s67, s75, 516096
    v_mfma_f32_16x16x32_bf16 v[164:167], v[104:107], a[132:135], v[164:167]
    ds_read_b64_tr_b16 v[98:99], v20 offset:22528
    s_add_u32 s67, s67, s74
    v_mfma_f32_16x16x32_bf16 v[164:167], v[108:111], a[148:151], v[164:167]
    s_add_u32 m0, s70, 49152
    v_mfma_f32_16x16x32_bf16 v[168:171], v[104:107], a[136:139], v[168:171]
    ds_read_b64_tr_b16 v[100:101], v20 offset:26624
    v_mfma_f32_16x16x32_bf16 v[168:171], v[108:111], a[152:155], v[168:171]
    buffer_load_dwordx4 v16, s[40:43], s67 offen offset:0 lds
    v_mfma_f32_16x16x32_bf16 v[172:175], v[104:107], a[140:143], v[172:175]
    ds_read_b64_tr_b16 v[102:103], v20 offset:30720
    v_mfma_f32_16x16x32_bf16 v[172:175], v[108:111], a[156:159], v[172:175]
    s_waitcnt lgkmcnt(4)
    v_mul_f32 v14, v14, v14
    v_mfma_f32_16x16x32_bf16 v[112:115], v[80:83], v[48:51], v[112:115]
    ds_read_b64_tr_b16 v[104:105], v21 offset:18432
    v_mul_f32 v15, 0xbfb8aa3b, v14
    v_mfma_f32_16x16x32_bf16 v[112:115], v[84:87], v[32:35], v[112:115]
    buffer_load_dwordx4 v17, s[40:43], s67 offen offset:1024 lds
    v_mfma_f32_16x16x32_bf16 v[116:119], v[80:83], v[52:55], v[116:119]
    ds_read_b64_tr_b16 v[106:107], v21 offset:22528
    v_mfma_f32_16x16x32_bf16 v[116:119], v[84:87], v[36:39], v[116:119]
    s_getpc_b64 s[48:49]
K1_pc3:
    v_mfma_f32_16x16x32_bf16 v[120:123], v[80:83], v[56:59], v[120:123]
    ds_read_b64_tr_b16 v[108:109], v21 offset:26624
    s_mov_b32 s50, code_end-K1_pc3
    v_mfma_f32_16x16x32_bf16 v[120:123], v[84:87], v[40:43], v[120:123]
    s_and_b32 s65, s101, 7
    s_lshl_b32 s65, s65, 2
    v_mfma_f32_16x16x32_bf16 v[124:127], v[80:83], v[60:63], v[124:127]
    ds_read_b64_tr_b16 v[110:111], v21 offset:30720
    s_add_u32 s65, s65, s58
    v_mfma_f32_16x16x32_bf16 v[124:127], v[84:87], v[44:47], v[124:127]
    v_add_u32 v20, 0x10000, v20
    s_waitcnt vmcnt(12)
    s_barrier
    v_mfma_f32_16x16x32_bf16 v[128:131], v[88:91], v[48:51], v[128:131]
    ds_read_b64_tr_b16 v[80:81], v20 offset:0
    s_mul_i32 s65, s65, 1152
    v_mfma_f32_16x16x32_bf16 v[128:131], v[92:95], v[32:35], v[128:131]
    buffer_load_dwordx4 v18, s[40:43], s67 offen offset:2048 lds
    v_cmp_gt_u32 vcc, 9, v1
    v_mfma_f32_16x16x32_bf16 v[132:135], v[88:91], v[52:55], v[132:135]
    ds_read_b64_tr_b16 v[82:83], v20 offset:4096
    v_mov_b32 v23, 0x10000000
    v_mfma_f32_16x16x32_bf16 v[132:135], v[92:95], v[36:39], v[132:135]
    s_nop 0
    v_cndmask_b32_e64 v23, v23, v13, vcc
    v_mfma_f32_16x16x32_bf16 v[136:139], v[88:91], v[56:59], v[136:139]
    ds_read_b64_tr_b16 v[84:85], v20 offset:8192
    v_mfma_f32_16x16x32_bf16 v[136:139], v[92:95], v[40:43], v[136:139]
    buffer_load_dword v0, v23, s[48:51], s65 offen
    v_mfma_f32_16x16x32_bf16 v[140:143], v[88:91], v[60:63], v[140:143]
    ds_read_b64_tr_b16 v[86:87], v20 offset:12288
    v_mfma_f32_16x16x32_bf16 v[140:143], v[92:95], v[44:47], v[140:143]
    v_add_u32 v21, 0x10000, v21
    s_waitcnt lgkmcnt(8)
    v_mfma_f32_16x16x32_bf16 v[144:147], v[96:99], v[48:51], v[144:147]
    ds_read_b64_tr_b16 v[88:89], v21 offset:0
    v_mfma_f32_16x16x32_bf16 v[144:147], v[100:103], v[32:35], v[144:147]
    v_mfma_f32_16x16x32_bf16 v[148:151], v[96:99], v[52:55], v[148:151]
    ds_read_b64_tr_b16 v[90:91], v21 offset:4096
    v_mfma_f32_16x16x32_bf16 v[148:151], v[100:103], v[36:39], v[148:151]
    v_mfma_f32_16x16x32_bf16 v[152:155], v[96:99], v[56:59], v[152:155]
    ds_read_b64_tr_b16 v[92:93], v21 offset:8192
    v_mfma_f32_16x16x32_bf16 v[152:155], v[100:103], v[40:43], v[152:155]
    v_mfma_f32_16x16x32_bf16 v[156:159], v[96:99], v[60:63], v[156:159]
    ds_read_b64_tr_b16 v[94:95], v21 offset:12288
    v_mfma_f32_16x16x32_bf16 v[156:159], v[100:103], v[44:47], v[156:159]
    s_waitcnt lgkmcnt(8)
    v_mfma_f32_16x16x32_bf16 v[160:163], v[104:107], v[48:51], v[160:163]
    ds_read_b64_tr_b16 v[96:97], v20 offset:2048
    v_mfma_f32_16x16x32_bf16 v[160:163], v[108:111], v[32:35], v[160:163]
    v_mfma_f32_16x16x32_bf16 v[164:167], v[104:107], v[52:55], v[164:167]
    ds_read_b64_tr_b16 v[98:99], v20 offset:6144
    v_mfma_f32_16x16x32_bf16 v[164:167], v[108:111], v[36:39], v[164:167]
    v_mfma_f32_16x16x32_bf16 v[168:171], v[104:107], v[56:59], v[168:171]
    ds_read_b64_tr_b16 v[100:101], v20 offset:10240
    v_mfma_f32_16x16x32_bf16 v[168:171], v[108:111], v[40:43], v[168:171]
    v_mfma_f32_16x16x32_bf16 v[172:175], v[104:107], v[60:63], v[172:175]
    ds_read_b64_tr_b16 v[102:103], v20 offset:14336
    v_mfma_f32_16x16x32_bf16 v[172:175], v[108:111], v[44:47], v[172:175]
    s_waitcnt lgkmcnt(8)
    v_mfma_f32_16x16x32_bf16 v[112:115], v[80:83], a[0:3], v[112:115]
    ds_read_b64_tr_b16 v[104:105], v21 offset:2048
    v_mfma_f32_16x16x32_bf16 v[112:115], v[84:87], a[16:19], v[112:115]
    v_mfma_f32_16x16x32_bf16 v[116:119], v[80:83], a[4:7], v[116:119]
    ds_read_b64_tr_b16 v[106:107], v21 offset:6144
    v_mfma_f32_16x16x32_bf16 v[116:119], v[84:87], a[20:23], v[116:119]
    v_mfma_f32_16x16x32_bf16 v[120:123], v[80:83], a[8:11], v[120:123]
    ds_read_b64_tr_b16 v[108:109], v21 offset:10240
    v_mfma_f32_16x16x32_bf16 v[120:123], v[84:87], a[24:27], v[120:123]
    buffer_load_dwordx4 v19, s[40:43], s67 offen offset:3072 lds
    v_mov_b32 v27, 4
    v_mfma_f32_16x16x32_bf16 v[124:127], v[80:83], a[12:15], v[124:127]
    ds_read_b64_tr_b16 v[110:111], v21 offset:14336
    v_mfma_f32_16x16x32_bf16 v[124:127], v[84:87], a[28:31], v[124:127]
    v_add_u32 v20, 0xffff0000, v20
    s_waitcnt lgkmcnt(8)
    s_barrier
    v_mfma_f32_16x16x32_bf16 v[128:131], v[88:91], a[0:3], v[128:131]
    ds_read_b64_tr_b16 v[80:81], v20 offset:0
    v_mfma_f32_16x16x32_bf16 v[128:131], v[92:95], a[16:19], v[128:131]
    buffer_store_dword v27, v29, s[44:47], s6 offen sc1
    s_mul_i32 s67, s75, 442368
    v_mfma_f32_16x16x32_bf16 v[132:135], v[88:91], a[4:7], v[132:135]
    ds_read_b64_tr_b16 v[82:83], v20 offset:4096
    s_add_u32 s67, s67, s74
    v_mfma_f32_16x16x32_bf16 v[132:135], v[92:95], a[20:23], v[132:135]
    s_add_u32 m0, s70, 114688
    v_mfma_f32_16x16x32_bf16 v[136:139], v[88:91], a[8:11], v[136:139]
    ds_read_b64_tr_b16 v[84:85], v20 offset:8192
    v_mfma_f32_16x16x32_bf16 v[136:139], v[92:95], a[24:27], v[136:139]
    buffer_load_dwordx4 v16, s[40:43], s67 offen offset:0 lds
    v_mfma_f32_16x16x32_bf16 v[140:143], v[88:91], a[12:15], v[140:143]
    ds_read_b64_tr_b16 v[86:87], v20 offset:12288
    v_mfma_f32_16x16x32_bf16 v[140:143], v[92:95], a[28:31], v[140:143]
    v_add_u32 v21, 0xffff0000, v21
    s_waitcnt lgkmcnt(8)
    v_mfma_f32_16x16x32_bf16 v[144:147], v[96:99], a[0:3], v[144:147]
    ds_read_b64_tr_b16 v[88:89], v21 offset:0
    v_mfma_f32_16x16x32_bf16 v[144:147], v[100:103], a[16:19], v[144:147]
    buffer_load_dwordx4 v17, s[40:43], s67 offen offset:1024 lds
    v_mfma_f32_16x16x32_bf16 v[148:151], v[96:99], a[4:7], v[148:151]
    ds_read_b64_tr_b16 v[90:91], v21 offset:4096
    v_mfma_f32_16x16x32_bf16 v[148:151], v[100:103], a[20:23], v[148:151]
    v_mfma_f32_16x16x32_bf16 v[152:155], v[96:99], a[8:11], v[152:155]
    ds_read_b64_tr_b16 v[92:93], v21 offset:8192
    v_mfma_f32_16x16x32_bf16 v[152:155], v[100:103], a[24:27], v[152:155]
    buffer_load_dwordx4 v18, s[40:43], s67 offen offset:2048 lds
    v_mfma_f32_16x16x32_bf16 v[156:159], v[96:99], a[12:15], v[156:159]
    ds_read_b64_tr_b16 v[94:95], v21 offset:12288
    v_mfma_f32_16x16x32_bf16 v[156:159], v[100:103], a[28:31], v[156:159]
    s_waitcnt lgkmcnt(8)
    v_mfma_f32_16x16x32_bf16 v[160:163], v[104:107], a[0:3], v[160:163]
    ds_read_b64_tr_b16 v[96:97], v20 offset:2048
    v_mfma_f32_16x16x32_bf16 v[160:163], v[108:111], a[16:19], v[160:163]
    v_mfma_f32_16x16x32_bf16 v[164:167], v[104:107], a[4:7], v[164:167]
    ds_read_b64_tr_b16 v[98:99], v20 offset:6144
    v_mfma_f32_16x16x32_bf16 v[164:167], v[108:111], a[20:23], v[164:167]
    buffer_load_dwordx4 v19, s[40:43], s67 offen offset:3072 lds
    s_add_u32 s67, s74, 0
    v_mfma_f32_16x16x32_bf16 v[168:171], v[104:107], a[8:11], v[168:171]
    ds_read_b64_tr_b16 v[100:101], v20 offset:10240
    s_add_u32 m0, s70, 81920
    v_mfma_f32_16x16x32_bf16 v[168:171], v[108:111], a[24:27], v[168:171]
    v_mfma_f32_16x16x32_bf16 v[172:175], v[104:107], a[12:15], v[172:175]
    ds_read_b64_tr_b16 v[102:103], v20 offset:14336
    v_mfma_f32_16x16x32_bf16 v[172:175], v[108:111], a[28:31], v[172:175]
    buffer_load_dwordx4 v16, s[40:43], s67 offen offset:0 lds
    s_waitcnt lgkmcnt(8)
    v_mfma_f32_16x16x32_bf16 v[112:115], v[80:83], a[48:51], v[112:115]
    ds_read_b64_tr_b16 v[104:105], v21 offset:2048
    v_mfma_f32_16x16x32_bf16 v[112:115], v[84:87], a[32:35], v[112:115]
    v_mfma_f32_16x16x32_bf16 v[116:119], v[80:83], a[52:55], v[116:119]
    ds_read_b64_tr_b16 v[106:107], v21 offset:6144
    v_mfma_f32_16x16x32_bf16 v[116:119], v[84:87], a[36:39], v[116:119]
    v_mfma_f32_16x16x32_bf16 v[120:123], v[80:83], a[56:59], v[120:123]
    ds_read_b64_tr_b16 v[108:109], v21 offset:10240
    v_mfma_f32_16x16x32_bf16 v[120:123], v[84:87], a[40:43], v[120:123]
    buffer_load_dwordx4 v17, s[40:43], s67 offen offset:1024 lds
    v_mfma_f32_16x16x32_bf16 v[124:127], v[80:83], a[60:63], v[124:127]
    ds_read_b64_tr_b16 v[110:111], v21 offset:14336
    v_mfma_f32_16x16x32_bf16 v[124:127], v[84:87], a[44:47], v[124:127]
    s_waitcnt lgkmcnt(8)
    s_barrier
    v_mfma_f32_16x16x32_bf16 v[128:131], v[88:91], a[48:51], v[128:131]
    ds_read_b64_tr_b16 v[80:81], v22 offset:16384
    v_mfma_f32_16x16x32_bf16 v[128:131], v[92:95], a[32:35], v[128:131]
    buffer_load_dwordx4 v18, s[40:43], s67 offen offset:2048 lds
    v_mfma_f32_16x16x32_bf16 v[132:135], v[88:91], a[52:55], v[132:135]
    ds_read_b64_tr_b16 v[82:83], v22 offset:17408
    v_mfma_f32_16x16x32_bf16 v[132:135], v[92:95], a[36:39], v[132:135]
    v_mfma_f32_16x16x32_bf16 v[136:139], v[88:91], a[56:59], v[136:139]
    ds_read_b64_tr_b16 v[84:85], v22 offset:18432
    v_mfma_f32_16x16x32_bf16 v[136:139], v[92:95], a[40:43], v[136:139]
    buffer_load_dwordx4 v19, s[40:43], s67 offen offset:3072 lds
    s_mul_i32 s67, s75, 73728
    v_mfma_f32_16x16x32_bf16 v[140:143], v[88:91], a[60:63], v[140:143]
    ds_read_b64_tr_b16 v[86:87], v22 offset:19456
    s_add_u32 s67, s67, s74
    v_mfma_f32_16x16x32_bf16 v[140:143], v[92:95], a[44:47], v[140:143]
    s_add_u32 m0, s70, 131072
    s_waitcnt lgkmcnt(8)
    v_mfma_f32_16x16x32_bf16 v[144:147], v[96:99], a[48:51], v[144:147]
    ds_read_b64_tr_b16 v[88:89], v22 offset:20480
    v_mfma_f32_16x16x32_bf16 v[144:147], v[100:103], a[32:35], v[144:147]
    v_mfma_f32_16x16x32_bf16 v[148:151], v[96:99], a[52:55], v[148:151]
    ds_read_b64_tr_b16 v[90:91], v22 offset:21504
    v_mfma_f32_16x16x32_bf16 v[148:151], v[100:103], a[36:39], v[148:151]
    buffer_load_dwordx4 v16, s[40:43], s67 offen offset:0 lds
    v_mfma_f32_16x16x32_bf16 v[152:155], v[96:99], a[56:59], v[152:155]
    ds_read_b64_tr_b16 v[92:93], v22 offset:22528
    v_mfma_f32_16x16x32_bf16 v[152:155], v[100:103], a[40:43], v[152:155]
    v_mfma_f32_16x16x32_bf16 v[156:159], v[96:99], a[60:63], v[156:159]
    ds_read_b64_tr_b16 v[94:95], v22 offset:23552
    v_mfma_f32_16x16x32_bf16 v[156:159], v[100:103], a[44:47], v[156:159]
    buffer_load_dwordx4 v17, s[40:43], s67 offen offset:1024 lds
    s_waitcnt lgkmcnt(8)
    v_mfma_f32_16x16x32_bf16 v[160:163], v[104:107], a[48:51], v[160:163]
    ds_read_b64_tr_b16 v[96:97], v22 offset:24576
    v_mfma_f32_16x16x32_bf16 v[160:163], v[108:111], a[32:35], v[160:163]
    v_mfma_f32_16x16x32_bf16 v[164:167], v[104:107], a[52:55], v[164:167]
    ds_read_b64_tr_b16 v[98:99], v22 offset:25600
    v_mfma_f32_16x16x32_bf16 v[164:167], v[108:111], a[36:39], v[164:167]
    v_mfma_f32_16x16x32_bf16 v[168:171], v[104:107], a[56:59], v[168:171]
    ds_read_b64_tr_b16 v[100:101], v22 offset:26624
    v_mfma_f32_16x16x32_bf16 v[168:171], v[108:111], a[40:43], v[168:171]
    buffer_load_dwordx4 v18, s[40:43], s67 offen offset:2048 lds
    v_mfma_f32_16x16x32_bf16 v[172:175], v[104:107], a[60:63], v[172:175]
    ds_read_b64_tr_b16 v[102:103], v22 offset:27648
    v_mfma_f32_16x16x32_bf16 v[172:175], v[108:111], a[44:47], v[172:175]
    v_add_u32 v22, 0x10000, v22
    s_waitcnt vmcnt(24) lgkmcnt(8)
    s_barrier
    v_mfma_f32_16x16x32_bf16 v[240:243], v[80:83], a[64:67], 0
    ds_read_b64_tr_b16 v[104:105], v22 offset:32768
    v_mfma_f32_16x16x32_bf16 v[240:243], v[84:87], a[80:83], v[240:243]
    buffer_load_dwordx4 v19, s[40:43], s67 offen offset:3072 lds
    s_mul_i32 s67, s75, 147456
    v_mfma_f32_16x16x32_bf16 v[244:247], v[80:83], a[68:71], 0
    ds_read_b64_tr_b16 v[106:107], v22 offset:33792
    s_add_u32 s67, s67, s74
    v_mfma_f32_16x16x32_bf16 v[244:247], v[84:87], a[84:87], v[244:247]
    s_add_u32 m0, s70, 65536
    v_mfma_f32_16x16x32_bf16 v[248:251], v[80:83], a[72:75], 0
    ds_read_b64_tr_b16 v[108:109], v22 offset:34816
    s_sub_u32 s68, s82, 0
    v_mfma_f32_16x16x32_bf16 v[248:251], v[84:87], a[88:91], v[248:251]
    buffer_load_dwordx4 v16, s[40:43], s67 offen offset:0 lds
    v_cvt_pk_bf16_f32 v112, v112, v113
    v_mfma_f32_16x16x32_bf16 v[252:255], v[80:83], a[76:79], 0
    ds_read_b64_tr_b16 v[110:111], v22 offset:35840
    v_cvt_pk_bf16_f32 v113, v114, v115
    v_mfma_f32_16x16x32_bf16 v[252:255], v[84:87], a[92:95], v[252:255]
    v_cvt_pk_bf16_f32 v114, v128, v129
    s_waitcnt lgkmcnt(8)
    v_mfma_f32_16x16x32_bf16 v[240:243], v[88:91], a[96:99], v[240:243]
    ds_read_b64_tr_b16 v[80:81], v22 offset:36864
    v_cvt_pk_bf16_f32 v115, v130, v131
    v_mfma_f32_16x16x32_bf16 v[240:243], v[92:95], a[112:115], v[240:243]
    v_mfma_f32_16x16x32_bf16 v[244:247], v[88:91], a[100:103], v[244:247]
    ds_read_b64_tr_b16 v[82:83], v22 offset:37888
    v_mfma_f32_16x16x32_bf16 v[244:247], v[92:95], a[116:119], v[244:247]
    buffer_store_dwordx4 v[112:115], v2, s[44:47], s68 offen offset:0 sc1
    v_cvt_pk_bf16_f32 v116, v116, v117
    v_mfma_f32_16x16x32_bf16 v[248:251], v[88:91], a[104:107], v[248:251]
    ds_read_b64_tr_b16 v[84:85], v22 offset:38912
    v_cvt_pk_bf16_f32 v117, v118, v119
    v_mfma_f32_16x16x32_bf16 v[248:251], v[92:95], a[120:123], v[248:251]
    buffer_load_dwordx4 v17, s[40:43], s67 offen offset:1024 lds
    v_cvt_pk_bf16_f32 v118, v132, v133
    v_mfma_f32_16x16x32_bf16 v[252:255], v[88:91], a[108:111], v[252:255]
    ds_read_b64_tr_b16 v[86:87], v22 offset:39936
    v_cvt_pk_bf16_f32 v119, v134, v135
    v_mfma_f32_16x16x32_bf16 v[252:255], v[92:95], a[124:127], v[252:255]
    s_waitcnt lgkmcnt(8)
    v_mfma_f32_16x16x32_bf16 v[240:243], v[96:99], a[128:131], v[240:243]
    ds_read_b64_tr_b16 v[88:89], v22 offset:40960
    v_mfma_f32_16x16x32_bf16 v[240:243], v[100:103], a[144:147], v[240:243]
    buffer_store_dwordx4 v[116:119], v2, s[44:47], s68 offen offset:1024 sc1
    s_xor_b32 s68, s68, 2048
    v_mfma_f32_16x16x32_bf16 v[244:247], v[96:99], a[132:135], v[244:247]
    ds_read_b64_tr_b16 v[90:91], v22 offset:41984
    v_cvt_pk_bf16_f32 v120, v120, v121
    v_mfma_f32_16x16x32_bf16 v[244:247], v[100:103], a[148:151], v[244:247]
    v_cvt_pk_bf16_f32 v121, v122, v123
    v_cvt_pk_bf16_f32 v122, v136, v137
    v_mfma_f32_16x16x32_bf16 v[248:251], v[96:99], a[136:139], v[248:251]
    ds_read_b64_tr_b16 v[92:93], v22 offset:43008
    v_cvt_pk_bf16_f32 v123, v138, v139
    v_mfma_f32_16x16x32_bf16 v[248:251], v[100:103], a[152:155], v[248:251]
    buffer_store_dwordx4 v[120:123], v2, s[44:47], s68 offen offset:0 sc1
    v_cvt_pk_bf16_f32 v124, v124, v125
    v_mfma_f32_16x16x32_bf16 v[252:255], v[96:99], a[140:143], v[252:255]
    ds_read_b64_tr_b16 v[94:95], v22 offset:44032
    v_cvt_pk_bf16_f32 v125, v126, v127
    v_mfma_f32_16x16x32_bf16 v[252:255], v[100:103], a[156:159], v[252:255]
    v_add_u32 v22, 0xffff0000, v22
    s_waitcnt vmcnt(27) lgkmcnt(8)
    s_barrier
    v_mfma_f32_16x16x32_bf16 v[240:243], v[104:107], a[0:3], v[240:243]
    ds_read_b64_tr_b16 v[96:97], v22 offset:0
    v_cvt_pk_bf16_f32 v126, v140, v141
    v_mfma_f32_16x16x32_bf16 v[240:243], v[108:111], a[16:19], v[240:243]
    buffer_load_dwordx4 v18, s[40:43], s67 offen offset:2048 lds
    v_cvt_pk_bf16_f32 v127, v142, v143
    v_mfma_f32_16x16x32_bf16 v[244:247], v[104:107], a[4:7], v[244:247]
    ds_read_b64_tr_b16 v[98:99], v22 offset:1024
    v_mfma_f32_16x16x32_bf16 v[244:247], v[108:111], a[20:23], v[244:247]
    v_mfma_f32_16x16x32_bf16 v[248:251], v[104:107], a[8:11], v[248:251]
    ds_read_b64_tr_b16 v[100:101], v22 offset:2048
    v_mfma_f32_16x16x32_bf16 v[248:251], v[108:111], a[24:27], v[248:251]
    buffer_store_dwordx4 v[124:127], v2, s[44:47], s68 offen offset:1024 sc1
    s_sub_u32 s68, s82, 16384
    v_mfma_f32_16x16x32_bf16 v[252:255], v[104:107], a[12:15], v[252:255]
    ds_read_b64_tr_b16 v[102:103], v22 offset:3072
    v_cvt_pk_bf16_f32 v144, v144, v145
    v_mfma_f32_16x16x32_bf16 v[252:255], v[108:111], a[28:31], v[252:255]
    buffer_load_dwordx4 v19, s[40:43], s67 offen offset:3072 lds
    s_waitcnt lgkmcnt(8)
    v_mfma_f32_16x16x32_bf16 v[240:243], v[80:83], v[48:51], v[240:243]
    ds_read_b64_tr_b16 v[104:105], v22 offset:4096
    s_mul_i32 s67, s75, 294912
    v_mfma_f32_16x16x32_bf16 v[240:243], v[84:87], v[32:35], v[240:243]
    s_add_u32 s67, s67, s74
    s_add_u32 m0, s70, 16384
    v_mfma_f32_16x16x32_bf16 v[244:247], v[80:83], v[52:55], v[244:247]
    ds_read_b64_tr_b16 v[106:107], v22 offset:5120
    v_cvt_pk_bf16_f32 v145, v146, v147
    v_mfma_f32_16x16x32_bf16 v[244:247], v[84:87], v[36:39], v[244:247]
    v_cvt_pk_bf16_f32 v146, v160, v161
    v_cvt_pk_bf16_f32 v147, v162, v163
    v_mfma_f32_16x16x32_bf16 v[248:251], v[80:83], v[56:59], v[248:251]
    ds_read_b64_tr_b16 v[108:109], v22 offset:6144
    v_mfma_f32_16x16x32_bf16 v[248:251], v[84:87], v[40:43], v[248:251]
    buffer_store_dwordx4 v[144:147], v2, s[44:47], s68 offen offset:0 sc1
    v_cvt_pk_bf16_f32 v148, v148, v149
    v_mfma_f32_16x16x32_bf16 v[252:255], v[80:83], v[60:63], v[252:255]
    ds_read_b64_tr_b16 v[110:111], v22 offset:7168
    v_cvt_pk_bf16_f32 v149, v150, v151
    v_mfma_f32_16x16x32_bf16 v[252:255], v[84:87], v[44:47], v[252:255]
    buffer_load_dwordx4 v16, s[40:43], s67 offen offset:0 lds
    s_waitcnt lgkmcnt(8)
    v_mfma_f32_16x16x32_bf16 v[240:243], v[88:91], a[48:51], v[240:243]
    ds_read_b64_tr_b16 v[80:81], v22 offset:8192
    v_cvt_pk_bf16_f32 v150, v164, v165
    v_mfma_f32_16x16x32_bf16 v[240:243], v[92:95], a[32:35], v[240:243]
    v_cvt_pk_bf16_f32 v151, v166, v167
    v_mfma_f32_16x16x32_bf16 v[244:247], v[88:91], a[52:55], v[244:247]
    ds_read_b64_tr_b16 v[82:83], v22 offset:9216
    v_mfma_f32_16x16x32_bf16 v[244:247], v[92:95], a[36:39], v[244:247]
    buffer_store_dwordx4 v[148:151], v2, s[44:47], s68 offen offset:1024 sc1
    s_xor_b32 s68, s68, 2048
    v_mfma_f32_16x16x32_bf16 v[248:251], v[88:91], a[56:59], v[248:251]
    ds_read_b64_tr_b16 v[84:85], v22 offset:10240
    v_cvt_pk_bf16_f32 v152, v152, v153
    v_mfma_f32_16x16x32_bf16 v[248:251], v[92:95], a[40:43], v[248:251]
    v_cvt_pk_bf16_f32 v153, v154, v155
    v_cvt_pk_bf16_f32 v154, v168, v169
    v_mfma_f32_16x16x32_bf16 v[252:255], v[88:91], a[60:63], v[252:255]
    ds_read_b64_tr_b16 v[86:87], v22 offset:11264
    v_cvt_pk_bf16_f32 v155, v170, v171
    v_mfma_f32_16x16x32_bf16 v[252:255], v[92:95], a[44:47], v[252:255]
    v_add_u32 v20, 0xffff0000, v20
    s_waitcnt vmcnt(29) lgkmcnt(8)
    s_barrier
    v_mfma_f32_16x16x32_bf16 v[240:243], v[96:99], a[224:227], v[240:243]
    ds_read_b64_tr_b16 v[88:89], v20 offset:32768
    v_mfma_f32_16x16x32_bf16 v[240:243], v[100:103], a[240:243], v[240:243]
    buffer_store_dwordx4 v[152:155], v2, s[44:47], s68 offen offset:0 sc1
    v_cvt_pk_bf16_f32 v156, v156, v157
    v_mfma_f32_16x16x32_bf16 v[244:247], v[96:99], a[228:231], v[244:247]
    ds_read_b64_tr_b16 v[90:91], v20 offset:36864
    v_cvt_pk_bf16_f32 v157, v158, v159
    v_mfma_f32_16x16x32_bf16 v[244:247], v[100:103], a[244:247], v[244:247]
    buffer_load_dwordx4 v17, s[40:43], s67 offen offset:1024 lds
    v_cvt_pk_bf16_f32 v158, v172, v173
    v_mfma_f32_16x16x32_bf16 v[248:251], v[96:99], a[232:235], v[248:251]
    ds_read_b64_tr_b16 v[92:93], v20 offset:40960
    v_cvt_pk_bf16_f32 v159, v174, v175
    v_mfma_f32_16x16x32_bf16 v[248:251], v[100:103], a[248:251], v[248:251]
    v_mfma_f32_16x16x32_bf16 v[252:255], v[96:99], a[236:239], v[252:255]
    ds_read_b64_tr_b16 v[94:95], v20 offset:45056
    v_mfma_f32_16x16x32_bf16 v[252:255], v[100:103], a[252:255], v[252:255]
    v_add_u32 v21, 0xffff0000, v21
    s_waitcnt lgkmcnt(8)
    v_mfma_f32_16x16x32_bf16 v[240:243], v[104:107], a[192:195], v[240:243]
    ds_read_b64_tr_b16 v[96:97], v21 offset:32768
    v_mfma_f32_16x16x32_bf16 v[240:243], v[108:111], a[208:211], v[240:243]
    buffer_store_dwordx4 v[156:159], v2, s[44:47], s68 offen offset:1024 sc1
    v_mfma_f32_16x16x32_bf16 v[244:247], v[104:107], a[196:199], v[244:247]
    ds_read_b64_tr_b16 v[98:99], v21 offset:36864
    v_mfma_f32_16x16x32_bf16 v[244:247], v[108:111], a[212:215], v[244:247]
    buffer_load_dword v26, v13, s[44:47], s93 offen sc1
    v_mfma_f32_16x16x32_bf16 v[248:251], v[104:107], a[200:203], v[248:251]
    ds_read_b64_tr_b16 v[100:101], v21 offset:40960
    v_mfma_f32_16x16x32_bf16 v[248:251], v[108:111], a[216:219], v[248:251]
    v_mfma_f32_16x16x32_bf16 v[252:255], v[104:107], a[204:207], v[252:255]
    ds_read_b64_tr_b16 v[102:103], v21 offset:45056
    v_mfma_f32_16x16x32_bf16 v[252:255], v[108:111], a[220:223], v[252:255]
    s_waitcnt lgkmcnt(8)
    v_mfma_f32_16x16x32_bf16 v[240:243], v[80:83], a[160:163], v[240:243]
    ds_read_b64_tr_b16 v[104:105], v20 offset:34816
    v_mfma_f32_16x16x32_bf16 v[240:243], v[84:87], a[176:179], v[240:243]
    v_mfma_f32_16x16x32_bf16 v[244:247], v[80:83], a[164:167], v[244:247]
    ds_read_b64_tr_b16 v[106:107], v20 offset:38912
    v_mfma_f32_16x16x32_bf16 v[244:247], v[84:87], a[180:183], v[244:247]
    v_mfma_f32_16x16x32_bf16 v[248:251], v[80:83], a[168:171], v[248:251]
    ds_read_b64_tr_b16 v[108:109], v20 offset:43008
    v_mfma_f32_16x16x32_bf16 v[248:251], v[84:87], a[184:187], v[248:251]
    v_mfma_f32_16x16x32_bf16 v[252:255], v[80:83], a[172:175], v[252:255]
    ds_read_b64_tr_b16 v[110:111], v20 offset:47104
    v_mfma_f32_16x16x32_bf16 v[252:255], v[84:87], a[188:191], v[252:255]
    s_waitcnt lgkmcnt(8)
    v_mfma_f32_16x16x32_bf16 v[176:179], v[88:91], a[160:163], 0
    ds_read_b64_tr_b16 v[80:81], v21 offset:34816
    v_mfma_f32_16x16x32_bf16 v[176:179], v[92:95], a[176:179], v[176:179]
    v_mfma_f32_16x16x32_bf16 v[180:183], v[88:91], a[164:167], 0
    ds_read_b64_tr_b16 v[82:83], v21 offset:38912
    v_mfma_f32_16x16x32_bf16 v[180:183], v[92:95], a[180:183], v[180:183]
    v_mfma_f32_16x16x32_bf16 v[184:187], v[88:91], a[168:171], 0
    ds_read_b64_tr_b16 v[84:85], v21 offset:43008
    s_lshl_b32 s66, s60, 3
    v_mfma_f32_16x16x32_bf16 v[184:187], v[92:95], a[184:187], v[184:187]
    s_add_u32 s66, s66, 147456
    v_add_u32 v24, s66, v28
    v_mfma_f32_16x16x32_bf16 v[188:191], v[88:91], a[172:175], 0
    ds_read_b64_tr_b16 v[86:87], v21 offset:47104
    v_cvt_pk_bf16_f32 v240, v240, v241
    v_mfma_f32_16x16x32_bf16 v[188:191], v[92:95], a[188:191], v[188:191]
    s_waitcnt vmcnt(28) lgkmcnt(8)
    s_barrier
    v_mfma_f32_16x16x32_bf16 v[192:195], v[96:99], a[160:163], 0
    ds_read_b64_tr_b16 v[88:89], v20 offset:49152
    v_cvt_pk_bf16_f32 v241, v242, v243
    v_mfma_f32_16x16x32_bf16 v[192:195], v[100:103], a[176:179], v[192:195]
    ds_write_b64 v24, v[240:241] offset:0
    v_cvt_pk_bf16_f32 v244, v244, v245
    v_mfma_f32_16x16x32_bf16 v[196:199], v[96:99], a[164:167], 0
    ds_read_b64_tr_b16 v[90:91], v20 offset:53248
    v_cvt_pk_bf16_f32 v245, v246, v247
    v_mfma_f32_16x16x32_bf16 v[196:199], v[100:103], a[180:183], v[196:199]
    ds_write_b64 v24, v[244:245] offset:1024
    v_cvt_pk_bf16_f32 v248, v248, v249
    v_mfma_f32_16x16x32_bf16 v[200:203], v[96:99], a[168:171], 0
    ds_read_b64_tr_b16 v[92:93], v20 offset:57344
    v_cvt_pk_bf16_f32 v249, v250, v251
    v_mfma_f32_16x16x32_bf16 v[200:203], v[100:103], a[184:187], v[200:203]
    ds_write_b64 v24, v[248:249] offset:2048
    v_cvt_pk_bf16_f32 v252, v252, v253
    v_mfma_f32_16x16x32_bf16 v[204:207], v[96:99], a[172:175], 0
    ds_read_b64_tr_b16 v[94:95], v20 offset:61440
    v_cvt_pk_bf16_f32 v253, v254, v255
    v_mfma_f32_16x16x32_bf16 v[204:207], v[100:103], a[188:191], v[204:207]
    ds_write_b64 v24, v[252:253] offset:3072
    s_waitcnt lgkmcnt(12)
    v_mfma_f32_16x16x32_bf16 v[208:211], v[104:107], a[160:163], 0
    ds_read_b64_tr_b16 v[96:97], v21 offset:49152
    v_mfma_f32_16x16x32_bf16 v[208:211], v[108:111], a[176:179], v[208:211]
    buffer_load_dwordx4 v18, s[40:43], s67 offen offset:2048 lds
    v_mfma_f32_16x16x32_bf16 v[212:215], v[104:107], a[164:167], 0
    ds_read_b64_tr_b16 v[98:99], v21 offset:53248
    v_mfma_f32_16x16x32_bf16 v[212:215], v[108:111], a[180:183], v[212:215]
    v_mfma_f32_16x16x32_bf16 v[216:219], v[104:107], a[168:171], 0
    ds_read_b64_tr_b16 v[100:101], v21 offset:57344
    v_mfma_f32_16x16x32_bf16 v[216:219], v[108:111], a[184:187], v[216:219]
    buffer_load_dwordx4 v19, s[40:43], s67 offen offset:3072 lds
    s_mul_i32 s67, s75, 221184
    v_mfma_f32_16x16x32_bf16 v[220:223], v[104:107], a[172:175], 0
    ds_read_b64_tr_b16 v[102:103], v21 offset:61440
    s_add_u32 s67, s67, s74
    v_mfma_f32_16x16x32_bf16 v[220:223], v[108:111], a[188:191], v[220:223]
    s_add_u32 m0, s70, 98304
    s_waitcnt lgkmcnt(12)
    v_mfma_f32_16x16x32_bf16 v[224:227], v[80:83], a[160:163], 0
    ds_read_b64_tr_b16 v[104:105], v20 offset:51200
    v_mfma_f32_16x16x32_bf16 v[224:227], v[84:87], a[176:179], v[224:227]
    buffer_load_dwordx4 v16, s[40:43], s67 offen offset:0 lds
    v_mfma_f32_16x16x32_bf16 v[228:231], v[80:83], a[164:167], 0
    ds_read_b64_tr_b16 v[106:107], v20 offset:55296
    v_mfma_f32_16x16x32_bf16 v[228:231], v[84:87], a[180:183], v[228:231]
    v_mfma_f32_16x16x32_bf16 v[232:235], v[80:83], a[168:171], 0
    ds_read_b64_tr_b16 v[108:109], v20 offset:59392
    v_mfma_f32_16x16x32_bf16 v[232:235], v[84:87], a[184:187], v[232:235]
    v_mfma_f32_16x16x32_bf16 v[236:239], v[80:83], a[172:175], 0
    ds_read_b64_tr_b16 v[110:111], v20 offset:63488
    v_mfma_f32_16x16x32_bf16 v[236:239], v[84:87], a[188:191], v[236:239]
    buffer_load_dwordx4 v17, s[40:43], s67 offen offset:1024 lds
    s_waitcnt lgkmcnt(9)
    v_mfma_f32_16x16x32_bf16 v[176:179], v[88:91], a[192:195], v[176:179]
    ds_read_b64_tr_b16 v[80:81], v21 offset:51200
    v_mfma_f32_16x16x32_bf16 v[176:179], v[92:95], a[208:211], v[176:179]
    s_waitcnt vmcnt(4)
    v_cmp_le_u32 vcc, 4, v26
    s_nop 1
    s_cmp_eq_u32 vcc_lo, 0xffff
    s_cbranch_scc0 o3_slow
o3_ok:
    v_mfma_f32_16x16x32_bf16 v[180:183], v[88:91], a[196:199], v[180:183]
    ds_read_b64_tr_b16 v[82:83], v21 offset:55296
    v_lshlrev_b32_e64 v23, 3, v1
    v_mfma_f32_16x16x32_bf16 v[180:183], v[92:95], a[212:215], v[180:183]
    buffer_load_dwordx4 v18, s[40:43], s67 offen offset:2048 lds
    s_add_u32 s66, s92, 0x2c00000
    v_mfma_f32_16x16x32_bf16 v[184:187], v[88:91], a[200:203], v[184:187]
    ds_read_b64_tr_b16 v[84:85], v21 offset:59392
    v_mfma_f32_16x16x32_bf16 v[184:187], v[92:95], a[216:219], v[184:187]
    v_mfma_f32_16x16x32_bf16 v[188:191], v[88:91], a[204:207], v[188:191]
    ds_read_b64_tr_b16 v[86:87], v21 offset:63488
    v_mfma_f32_16x16x32_bf16 v[188:191], v[92:95], a[220:223], v[188:191]
    v_add_u32 v20, 0x10000, v20
    s_waitcnt lgkmcnt(8)
    s_barrier
    v_mfma_f32_16x16x32_bf16 v[192:195], v[96:99], a[192:195], v[192:195]
    ds_read_b64_tr_b16 v[88:89], v20 offset:49152
    v_mfma_f32_16x16x32_bf16 v[192:195], v[100:103], a[208:211], v[192:195]
    buffer_load_dwordx4 a[160:163], v2, s[44:47], s66 offen offset:0 sc1
    v_mfma_f32_16x16x32_bf16 v[196:199], v[96:99], a[196:199], v[196:199]
    ds_read_b64_tr_b16 v[90:91], v20 offset:53248
    v_mfma_f32_16x16x32_bf16 v[196:199], v[100:103], a[212:215], v[196:199]
    v_mfma_f32_16x16x32_bf16 v[200:203], v[96:99], a[200:203], v[200:203]
    ds_read_b64_tr_b16 v[92:93], v20 offset:57344
    v_mfma_f32_16x16x32_bf16 v[200:203], v[100:103], a[216:219], v[200:203]
    buffer_load_dwordx4 a[164:167], v2, s[44:47], s66 offen offset:1024 sc1
    v_mfma_f32_16x16x32_bf16 v[204:207], v[96:99], a[204:207], v[204:207]
    ds_read_b64_tr_b16 v[94:95], v20 offset:61440
    v_mfma_f32_16x16x32_bf16 v[204:207], v[100:103], a[220:223], v[204:207]
    v_add_u32 v21, 0x10000, v21
    s_waitcnt lgkmcnt(8)
    v_mfma_f32_16x16x32_bf16 v[208:211], v[104:107], a[192:195], v[208:211]
    ds_read_b64_tr_b16 v[96:97], v21 offset:49152
    v_mfma_f32_16x16x32_bf16 v[208:211], v[108:111], a[208:211], v[208:211]
    buffer_load_dwordx4 a[168:171], v2, s[44:47], s66 offen offset:2048 sc1
    v_mfma_f32_16x16x32_bf16 v[212:215], v[104:107], a[196:199], v[212:215]
    ds_read_b64_tr_b16 v[98:99], v21 offset:53248
    v_mfma_f32_16x16x32_bf16 v[212:215], v[108:111], a[212:215], v[212:215]
    v_mfma_f32_16x16x32_bf16 v[216:219], v[104:107], a[200:203], v[216:219]
    ds_read_b64_tr_b16 v[100:101], v21 offset:57344
    v_mfma_f32_16x16x32_bf16 v[216:219], v[108:111], a[216:219], v[216:219]
    v_mfma_f32_16x16x32_bf16 v[220:223], v[104:107], a[204:207], v[220:223]
    ds_read_b64_tr_b16 v[102:103], v21 offset:61440
    v_mfma_f32_16x16x32_bf16 v[220:223], v[108:111], a[220:223], v[220:223]
    buffer_load_dwordx4 a[172:175], v2, s[44:47], s66 offen offset:3072 sc1
    s_waitcnt lgkmcnt(8)
    v_mfma_f32_16x16x32_bf16 v[224:227], v[80:83], a[192:195], v[224:227]
    ds_read_b64_tr_b16 v[104:105], v20 offset:51200
    s_add_u32 s66, s92, 0x2c01000
    v_mfma_f32_16x16x32_bf16 v[224:227], v[84:87], a[208:211], v[224:227]
    v_mfma_f32_16x16x32_bf16 v[228:231], v[80:83], a[196:199], v[228:231]
    ds_read_b64_tr_b16 v[106:107], v20 offset:55296
    v_mfma_f32_16x16x32_bf16 v[228:231], v[84:87], a[212:215], v[228:231]
    buffer_load_dwordx4 a[176:179], v2, s[44:47], s66 offen offset:0 sc1
    v_mfma_f32_16x16x32_bf16 v[232:235], v[80:83], a[200:203], v[232:235]
    ds_read_b64_tr_b16 v[108:109], v20 offset:59392
    v_mfma_f32_16x16x32_bf16 v[232:235], v[84:87], a[216:219], v[232:235]
    v_mfma_f32_16x16x32_bf16 v[236:239], v[80:83], a[204:207], v[236:239]
    ds_read_b64_tr_b16 v[110:111], v20 offset:63488
    v_mfma_f32_16x16x32_bf16 v[236:239], v[84:87], a[220:223], v[236:239]
    s_waitcnt lgkmcnt(8)
    v_mfma_f32_16x16x32_bf16 v[176:179], v[88:91], a[224:227], v[176:179]
    ds_read_b64_tr_b16 v[80:81], v21 offset:51200
    v_mfma_f32_16x16x32_bf16 v[176:179], v[92:95], a[240:243], v[176:179]
    buffer_load_dwordx4 a[180:183], v2, s[44:47], s66 offen offset:1024 sc1
    v_mfma_f32_16x16x32_bf16 v[180:183], v[88:91], a[228:231], v[180:183]
    ds_read_b64_tr_b16 v[82:83], v21 offset:55296
    v_mfma_f32_16x16x32_bf16 v[180:183], v[92:95], a[244:247], v[180:183]
    v_mfma_f32_16x16x32_bf16 v[184:187], v[88:91], a[232:235], v[184:187]
    ds_read_b64_tr_b16 v[84:85], v21 offset:59392
    v_mfma_f32_16x16x32_bf16 v[184:187], v[92:95], a[248:251], v[184:187]
    buffer_load_dwordx4 a[184:187], v2, s[44:47], s66 offen offset:2048 sc1
    v_mfma_f32_16x16x32_bf16 v[188:191], v[88:91], a[236:239], v[188:191]
    ds_read_b64_tr_b16 v[86:87], v21 offset:63488
    v_mfma_f32_16x16x32_bf16 v[188:191], v[92:95], a[252:255], v[188:191]
    s_waitcnt lgkmcnt(8)
    s_barrier
    v_mfma_f32_16x16x32_bf16 v[192:195], v[96:99], a[224:227], v[192:195]
    ds_read_b64_tr_b16 v[88:89], v20 offset:16384
    v_mfma_f32_16x16x32_bf16 v[192:195], v[100:103], a[240:243], v[192:195]
    buffer_load_dwordx4 a[188:191], v2, s[44:47], s66 offen offset:3072 sc1
    s_add_u32 s66, s92, 0x2c02000
    v_mfma_f32_16x16x32_bf16 v[196:199], v[96:99], a[228:231], v[196:199]
    ds_read_b64_tr_b16 v[90:91], v20 offset:20480
    v_mfma_f32_16x16x32_bf16 v[196:199], v[100:103], a[244:247], v[196:199]
    v_mfma_f32_16x16x32_bf16 v[200:203], v[96:99], a[232:235], v[200:203]
    ds_read_b64_tr_b16 v[92:93], v20 offset:24576
    v_mfma_f32_16x16x32_bf16 v[200:203], v[100:103], a[248:251], v[200:203]
    v_mfma_f32_16x16x32_bf16 v[204:207], v[96:99], a[236:239], v[204:207]
    ds_read_b64_tr_b16 v[94:95], v20 offset:28672
    v_mfma_f32_16x16x32_bf16 v[204:207], v[100:103], a[252:255], v[204:207]
    buffer_load_dwordx4 a[192:195], v2, s[44:47], s66 offen offset:0 sc1
    s_waitcnt lgkmcnt(8)
    v_mfma_f32_16x16x32_bf16 v[208:211], v[104:107], a[224:227], v[208:211]
    ds_read_b64_tr_b16 v[96:97], v21 offset:16384
    v_mfma_f32_16x16x32_bf16 v[208:211], v[108:111], a[240:243], v[208:211]
    v_mfma_f32_16x16x32_bf16 v[212:215], v[104:107], a[228:231], v[212:215]
    ds_read_b64_tr_b16 v[98:99], v21 offset:20480
    v_mfma_f32_16x16x32_bf16 v[212:215], v[108:111], a[244:247], v[212:215]
    buffer_load_dwordx4 a[196:199], v2, s[44:47], s66 offen offset:1024 sc1
    v_mfma_f32_16x16x32_bf16 v[216:219], v[104:107], a[232:235], v[216:219]
    ds_read_b64_tr_b16 v[100:101], v21 offset:24576
    v_mfma_f32_16x16x32_bf16 v[216:219], v[108:111], a[248:251], v[216:219]
    v_mfma_f32_16x16x32_bf16 v[220:223], v[104:107], a[236:239], v[220:223]
    ds_read_b64_tr_b16 v[102:103], v21 offset:28672
    v_mfma_f32_16x16x32_bf16 v[220:223], v[108:111], a[252:255], v[220:223]
    s_waitcnt lgkmcnt(8)
    v_mfma_f32_16x16x32_bf16 v[224:227], v[80:83], a[224:227], v[224:227]
    ds_read_b64_tr_b16 v[104:105], v20 offset:18432
    v_mfma_f32_16x16x32_bf16 v[224:227], v[84:87], a[240:243], v[224:227]
    buffer_load_dwordx4 a[200:203], v2, s[44:47], s66 offen offset:2048 sc1
    v_mfma_f32_16x16x32_bf16 v[228:231], v[80:83], a[228:231], v[228:231]
    ds_read_b64_tr_b16 v[106:107], v20 offset:22528
    v_mfma_f32_16x16x32_bf16 v[228:231], v[84:87], a[244:247], v[228:231]
    v_mfma_f32_16x16x32_bf16 v[232:235], v[80:83], a[232:235], v[232:235]
    ds_read_b64_tr_b16 v[108:109], v20 offset:26624
    v_mfma_f32_16x16x32_bf16 v[232:235], v[84:87], a[248:251], v[232:235]
    buffer_load_dwordx4 a[204:207], v2, s[44:47], s66 offen offset:3072 sc1
    s_add_u32 s66, s92, 0x2c03000
    v_mfma_f32_16x16x32_bf16 v[236:239], v[80:83], a[236:239], v[236:239]
    ds_read_b64_tr_b16 v[110:111], v20 offset:30720
    v_mfma_f32_16x16x32_bf16 v[236:239], v[84:87], a[252:255], v[236:239]
    s_waitcnt lgkmcnt(8)
    v_mfma_f32_16x16x32_bf16 v[176:179], v[88:91], a[64:67], v[176:179]
    ds_read_b64_tr_b16 v[80:81], v21 offset:18432
    s_lshl_b32 s64, s60, 11
    v_mfma_f32_16x16x32_bf16 v[176:179], v[92:95], a[80:83], v[176:179]
    buffer_load_dwordx4 a[208:211], v2, s[44:47], s66 offen offset:0 sc1
    s_add_u32 s64, s64, 147456
    v_mfma_f32_16x16x32_bf16 v[180:183], v[88:91], a[68:71], v[180:183]
    ds_read_b64_tr_b16 v[82:83], v21 offset:22528
    v_add_u32 v24, s64, v28
    v_mfma_f32_16x16x32_bf16 v[180:183], v[92:95], a[84:87], v[180:183]
    ds_read_b128 v[240:243], v24 offset:0
    v_mfma_f32_16x16x32_bf16 v[184:187], v[88:91], a[72:75], v[184:187]
    ds_read_b64_tr_b16 v[84:85], v21 offset:26624
    v_mfma_f32_16x16x32_bf16 v[184:187], v[92:95], a[88:91], v[184:187]
    ds_read_b128 v[244:247], v24 offset:1024
    s_add_u32 s64, s83, 1024
    v_mfma_f32_16x16x32_bf16 v[188:191], v[88:91], a[76:79], v[188:191]
    ds_read_b64_tr_b16 v[86:87], v21 offset:30720
    v_mfma_f32_16x16x32_bf16 v[188:191], v[92:95], a[92:95], v[188:191]
    v_add_u32 v20, 0x10000, v20
    s_waitcnt lgkmcnt(10)
    s_barrier
    v_mfma_f32_16x16x32_bf16 v[192:195], v[96:99], a[64:67], v[192:195]
    ds_read_b64_tr_b16 v[88:89], v20 offset:0
    v_mfma_f32_16x16x32_bf16 v[192:195], v[100:103], a[80:83], v[192:195]
    buffer_load_dwordx4 a[212:215], v2, s[44:47], s66 offen offset:1024 sc1
    v_mfma_f32_16x16x32_bf16 v[196:199], v[96:99], a[68:71], v[196:199]
    ds_read_b64_tr_b16 v[90:91], v20 offset:4096
    v_mfma_f32_16x16x32_bf16 v[196:199], v[100:103], a[84:87], v[196:199]
    v_mfma_f32_16x16x32_bf16 v[200:203], v[96:99], a[72:75], v[200:203]
    ds_read_b64_tr_b16 v[92:93], v20 offset:8192
    v_mfma_f32_16x16x32_bf16 v[200:203], v[100:103], a[88:91], v[200:203]
    buffer_load_dwordx4 a[216:219], v2, s[44:47], s66 offen offset:2048 sc1
    v_mfma_f32_16x16x32_bf16 v[204:207], v[96:99], a[76:79], v[204:207]
    ds_read_b64_tr_b16 v[94:95], v20 offset:12288
    v_mfma_f32_16x16x32_bf16 v[204:207], v[100:103], a[92:95], v[204:207]
    v_add_u32 v21, 0x10000, v21
    s_waitcnt lgkmcnt(10)
    v_mfma_f32_16x16x32_bf16 v[208:211], v[104:107], a[64:67], v[208:211]
    ds_read_b64_tr_b16 v[96:97], v21 offset:0
    v_mfma_f32_16x16x32_bf16 v[208:211], v[108:111], a[80:83], v[208:211]
    buffer_load_dwordx4 a[220:223], v2, s[44:47], s66 offen offset:3072 sc1
    s_add_u32 s66, s92, 0x2c04000
    v_mfma_f32_16x16x32_bf16 v[212:215], v[104:107], a[68:71], v[212:215]
    ds_read_b64_tr_b16 v[98:99], v21 offset:4096
    v_mfma_f32_16x16x32_bf16 v[212:215], v[108:111], a[84:87], v[212:215]
    s_waitcnt lgkmcnt(9)
    buffer_store_dwordx4 v[240:243], v2, s[44:47], s83 offen sc1
    v_mfma_f32_16x16x32_bf16 v[216:219], v[104:107], a[72:75], v[216:219]
    ds_read_b64_tr_b16 v[100:101], v21 offset:8192
    v_mfma_f32_16x16x32_bf16 v[216:219], v[108:111], a[88:91], v[216:219]
    s_waitcnt lgkmcnt(8)
    buffer_store_dwordx4 v[244:247], v2, s[44:47], s64 offen sc1
    v_mfma_f32_16x16x32_bf16 v[220:223], v[104:107], a[76:79], v[220:223]
    ds_read_b64_tr_b16 v[102:103], v21 offset:12288
    v_mfma_f32_16x16x32_bf16 v[220:223], v[108:111], a[92:95], v[220:223]
    buffer_load_dwordx2 a[224:225], v23, s[44:47], s66 offen offset:0 sc1
    s_waitcnt lgkmcnt(8)
    v_mfma_f32_16x16x32_bf16 v[224:227], v[80:83], a[64:67], v[224:227]
    ds_read_b64_tr_b16 v[104:105], v20 offset:2048
    v_mfma_f32_16x16x32_bf16 v[224:227], v[84:87], a[80:83], v[224:227]
    v_mfma_f32_16x16x32_bf16 v[228:231], v[80:83], a[68:71], v[228:231]
    ds_read_b64_tr_b16 v[106:107], v20 offset:6144
    v_mfma_f32_16x16x32_bf16 v[228:231], v[84:87], a[84:87], v[228:231]
    v_mfma_f32_16x16x32_bf16 v[232:235], v[80:83], a[72:75], v[232:235]
    ds_read_b64_tr_b16 v[108:109], v20 offset:10240
    v_mfma_f32_16x16x32_bf16 v[232:235], v[84:87], a[88:91], v[232:235]
    buffer_load_dwordx2 a[226:227], v23, s[44:47], s66 offen offset:512 sc1
    v_mfma_f32_16x16x32_bf16 v[236:239], v[80:83], a[76:79], v[236:239]
    ds_read_b64_tr_b16 v[110:111], v20 offset:14336
    v_mfma_f32_16x16x32_bf16 v[236:239], v[84:87], a[92:95], v[236:239]
    s_waitcnt lgkmcnt(8)
    v_mfma_f32_16x16x32_bf16 v[176:179], v[88:91], a[96:99], v[176:179]
    ds_read_b64_tr_b16 v[80:81], v21 offset:2048
    v_mfma_f32_16x16x32_bf16 v[176:179], v[92:95], a[112:115], v[176:179]
    buffer_load_dwordx4 v19, s[40:43], s67 offen offset:3072 lds
    s_mul_i32 s67, s75, 368640
    v_mfma_f32_16x16x32_bf16 v[180:183], v[88:91], a[100:103], v[180:183]
    ds_read_b64_tr_b16 v[82:83], v21 offset:6144
    s_add_u32 s67, s67, s74
    v_mfma_f32_16x16x32_bf16 v[180:183], v[92:95], a[116:119], v[180:183]
    s_add_u32 m0, s70, 0
    v_mfma_f32_16x16x32_bf16 v[184:187], v[88:91], a[104:107], v[184:187]
    ds_read_b64_tr_b16 v[84:85], v21 offset:10240
    v_mfma_f32_16x16x32_bf16 v[184:187], v[92:95], a[120:123], v[184:187]
    buffer_load_dwordx2 a[228:229], v23, s[44:47], s66 offen offset:1024 sc1
    v_mfma_f32_16x16x32_bf16 v[188:191], v[88:91], a[108:111], v[188:191]
    ds_read_b64_tr_b16 v[86:87], v21 offset:14336
    v_mfma_f32_16x16x32_bf16 v[188:191], v[92:95], a[124:127], v[188:191]
    v_add_u32 v20, 0xffff0000, v20
    s_waitcnt lgkmcnt(8)
    s_barrier
    v_mfma_f32_16x16x32_bf16 v[192:195], v[96:99], a[96:99], v[192:195]
    ds_read_b64_tr_b16 v[88:89], v20 offset:0
    v_mfma_f32_16x16x32_bf16 v[192:195], v[100:103], a[112:115], v[192:195]
    v_mfma_f32_16x16x32_bf16 v[196:199], v[96:99], a[100:103], v[196:199]
    ds_read_b64_tr_b16 v[90:91], v20 offset:4096
    v_mfma_f32_16x16x32_bf16 v[196:199], v[100:103], a[116:119], v[196:199]
    buffer_load_dwordx2 a[230:231], v23, s[44:47], s66 offen offset:1536 sc1
    v_mfma_f32_16x16x32_bf16 v[200:203], v[96:99], a[104:107], v[200:203]
    ds_read_b64_tr_b16 v[92:93], v20 offset:8192
    v_mfma_f32_16x16x32_bf16 v[200:203], v[100:103], a[120:123], v[200:203]
    v_mfma_f32_16x16x32_bf16 v[204:207], v[96:99], a[108:111], v[204:207]
    ds_read_b64_tr_b16 v[94:95], v20 offset:12288
    v_mfma_f32_16x16x32_bf16 v[204:207], v[100:103], a[124:127], v[204:207]
    v_add_u32 v21, 0xffff0000, v21
    s_waitcnt lgkmcnt(8)
    v_mfma_f32_16x16x32_bf16 v[208:211], v[104:107], a[96:99], v[208:211]
    ds_read_b64_tr_b16 v[96:97], v21 offset:0
    v_mfma_f32_16x16x32_bf16 v[208:211], v[108:111], a[112:115], v[208:211]
    buffer_load_dwordx4 v16, s[40:43], s67 offen offset:0 lds
    v_mfma_f32_16x16x32_bf16 v[212:215], v[104:107], a[100:103], v[212:215]
    ds_read_b64_tr_b16 v[98:99], v21 offset:4096
    v_mfma_f32_16x16x32_bf16 v[212:215], v[108:111], a[116:119], v[212:215]
    v_mfma_f32_16x16x32_bf16 v[216:219], v[104:107], a[104:107], v[216:219]
    ds_read_b64_tr_b16 v[100:101], v21 offset:8192
    v_mfma_f32_16x16x32_bf16 v[216:219], v[108:111], a[120:123], v[216:219]
    buffer_load_dwordx4 v17, s[40:43], s67 offen offset:1024 lds
    v_mfma_f32_16x16x32_bf16 v[220:223], v[104:107], a[108:111], v[220:223]
    ds_read_b64_tr_b16 v[102:103], v21 offset:12288
    v_mfma_f32_16x16x32_bf16 v[220:223], v[108:111], a[124:127], v[220:223]
    s_waitcnt lgkmcnt(8)
    v_mfma_f32_16x16x32_bf16 v[224:227], v[80:83], a[96:99], v[224:227]
    ds_read_b64_tr_b16 v[104:105], v20 offset:2048
    v_mfma_f32_16x16x32_bf16 v[224:227], v[84:87], a[112:115], v[224:227]
    buffer_load_dwordx4 v18, s[40:43], s67 offen offset:2048 lds
    v_mfma_f32_16x16x32_bf16 v[228:231], v[80:83], a[100:103], v[228:231]
    ds_read_b64_tr_b16 v[106:107], v20 offset:6144
    v_mfma_f32_16x16x32_bf16 v[228:231], v[84:87], a[116:119], v[228:231]
    v_mfma_f32_16x16x32_bf16 v[232:235], v[80:83], a[104:107], v[232:235]
    ds_read_b64_tr_b16 v[108:109], v20 offset:10240
    v_mfma_f32_16x16x32_bf16 v[232:235], v[84:87], a[120:123], v[232:235]
    v_mfma_f32_16x16x32_bf16 v[236:239], v[80:83], a[108:111], v[236:239]
    ds_read_b64_tr_b16 v[110:111], v20 offset:14336
    v_mfma_f32_16x16x32_bf16 v[236:239], v[84:87], a[124:127], v[236:239]
    buffer_load_dwordx4 v19, s[40:43], s67 offen offset:3072 lds
    s_waitcnt lgkmcnt(8)
    v_mfma_f32_16x16x32_bf16 v[176:179], v[88:91], a[128:131], v[176:179]
    ds_read_b64_tr_b16 v[80:81], v21 offset:2048
    s_add_u32 s67, s87, 0
    v_mfma_f32_16x16x32_bf16 v[176:179], v[92:95], a[144:147], v[176:179]
    s_add_u32 m0, s70, 32768
    v_mfma_f32_16x16x32_bf16 v[180:183], v[88:91], a[132:135], v[180:183]
    ds_read_b64_tr_b16 v[82:83], v21 offset:6144
    v_mfma_f32_16x16x32_bf16 v[180:183], v[92:95], a[148:151], v[180:183]
    buffer_load_dwordx4 v3, s[32:35], s67 offen offset:0 lds
    v_mfma_f32_16x16x32_bf16 v[184:187], v[88:91], a[136:139], v[184:187]
    ds_read_b64_tr_b16 v[84:85], v21 offset:10240
    v_mfma_f32_16x16x32_bf16 v[184:187], v[92:95], a[152:155], v[184:187]
    v_mfma_f32_16x16x32_bf16 v[188:191], v[88:91], a[140:143], v[188:191]
    ds_read_b64_tr_b16 v[86:87], v21 offset:14336
    v_mfma_f32_16x16x32_bf16 v[188:191], v[92:95], a[156:159], v[188:191]
    v_add_u32 v20, 0xffff0000, v20
    s_waitcnt vmcnt(10) lgkmcnt(8)
    s_barrier
    v_mfma_f32_16x16x32_bf16 v[192:195], v[96:99], a[128:131], v[192:195]
    ds_read_b64_tr_b16 v[88:89], v20 offset:16384
    v_mfma_f32_16x16x32_bf16 v[192:195], v[100:103], a[144:147], v[192:195]
    buffer_load_dwordx4 v4, s[32:35], s67 offen offset:1024 lds
    v_mfma_f32_16x16x32_bf16 v[196:199], v[96:99], a[132:135], v[196:199]
    ds_read_b64_tr_b16 v[90:91], v20 offset:20480
    v_mfma_f32_16x16x32_bf16 v[196:199], v[100:103], a[148:151], v[196:199]
    v_mfma_f32_16x16x32_bf16 v[200:203], v[96:99], a[136:139], v[200:203]
    ds_read_b64_tr_b16 v[92:93], v20 offset:24576
    v_mfma_f32_16x16x32_bf16 v[200:203], v[100:103], a[152:155], v[200:203]
    buffer_load_dwordx4 v5, s[32:35], s67 offen offset:2048 lds
    v_mfma_f32_16x16x32_bf16 v[204:207], v[96:99], a[140:143], v[204:207]
    ds_read_b64_tr_b16 v[94:95], v20 offset:28672
    v_mfma_f32_16x16x32_bf16 v[204:207], v[100:103], a[156:159], v[204:207]
    v_add_u32 v21, 0xffff0000, v21
    s_waitcnt lgkmcnt(8)
    v_mfma_f32_16x16x32_bf16 v[208:211], v[104:107], a[128:131], v[208:211]
    ds_read_b64_tr_b16 v[96:97], v21 offset:16384
    v_mfma_f32_16x16x32_bf16 v[208:211], v[108:111], a[144:147], v[208:211]
    buffer_load_dwordx4 v6, s[32:35], s67 offen offset:3072 lds
    v_mov_b32_e64 v27, 5
    v_mfma_f32_16x16x32_bf16 v[212:215], v[104:107], a[132:135], v[212:215]
    ds_read_b64_tr_b16 v[98:99], v21 offset:20480
    v_mfma_f32_16x16x32_bf16 v[212:215], v[108:111], a[148:151], v[212:215]
    v_mfma_f32_16x16x32_bf16 v[216:219], v[104:107], a[136:139], v[216:219]
    ds_read_b64_tr_b16 v[100:101], v21 offset:24576
    v_mfma_f32_16x16x32_bf16 v[216:219], v[108:111], a[152:155], v[216:219]
    v_mfma_f32_16x16x32_bf16 v[220:223], v[104:107], a[140:143], v[220:223]
    ds_read_b64_tr_b16 v[102:103], v21 offset:28672
    v_mfma_f32_16x16x32_bf16 v[220:223], v[108:111], a[156:159], v[220:223]
    buffer_store_dword v27, v29, s[44:47], s6 offen sc1
    s_waitcnt lgkmcnt(8)
    v_mfma_f32_16x16x32_bf16 v[224:227], v[80:83], a[128:131], v[224:227]
    ds_read_b64_tr_b16 v[104:105], v20 offset:18432
    s_add_u32 s67, s87, 165888
    v_mfma_f32_16x16x32_bf16 v[224:227], v[84:87], a[144:147], v[224:227]
    s_add_u32 m0, s70, 49152
    v_mfma_f32_16x16x32_bf16 v[228:231], v[80:83], a[132:135], v[228:231]
    ds_read_b64_tr_b16 v[106:107], v20 offset:22528
    v_mfma_f32_16x16x32_bf16 v[228:231], v[84:87], a[148:151], v[228:231]
    buffer_load_dwordx4 v3, s[32:35], s67 offen offset:0 lds
    v_mfma_f32_16x16x32_bf16 v[232:235], v[80:83], a[136:139], v[232:235]
    ds_read_b64_tr_b16 v[108:109], v20 offset:26624
    v_mfma_f32_16x16x32_bf16 v[232:235], v[84:87], a[152:155], v[232:235]
    v_mfma_f32_16x16x32_bf16 v[236:239], v[80:83], a[140:143], v[236:239]
    ds_read_b64_tr_b16 v[110:111], v20 offset:30720
    v_mfma_f32_16x16x32_bf16 v[236:239], v[84:87], a[156:159], v[236:239]
    buffer_load_dwordx4 v4, s[32:35], s67 offen offset:1024 lds
    s_waitcnt lgkmcnt(8)
    v_mfma_f32_16x16x32_bf16 v[176:179], v[88:91], v[48:51], v[176:179]
    ds_read_b64_tr_b16 v[80:81], v21 offset:18432
    v_mfma_f32_16x16x32_bf16 v[176:179], v[92:95], v[32:35], v[176:179]
    v_mfma_f32_16x16x32_bf16 v[180:183], v[88:91], v[52:55], v[180:183]
    ds_read_b64_tr_b16 v[82:83], v21 offset:22528
    v_mfma_f32_16x16x32_bf16 v[180:183], v[92:95], v[36:39], v[180:183]
    buffer_load_dwordx4 v5, s[32:35], s67 offen offset:2048 lds
    v_mfma_f32_16x16x32_bf16 v[184:187], v[88:91], v[56:59], v[184:187]
    ds_read_b64_tr_b16 v[84:85], v21 offset:26624
    v_mfma_f32_16x16x32_bf16 v[184:187], v[92:95], v[40:43], v[184:187]
    v_mfma_f32_16x16x32_bf16 v[188:191], v[88:91], v[60:63], v[188:191]
    ds_read_b64_tr_b16 v[86:87], v21 offset:30720
    v_mfma_f32_16x16x32_bf16 v[188:191], v[92:95], v[44:47], v[188:191]
    v_add_u32 v20, 0x10000, v20
    s_waitcnt vmcnt(14) lgkmcnt(8)
    s_barrier
    v_mfma_f32_16x16x32_bf16 v[192:195], v[96:99], v[48:51], v[192:195]
    ds_read_b64_tr_b16 v[88:89], v20 offset:32768
    v_mfma_f32_16x16x32_bf16 v[192:195], v[100:103], v[32:35], v[192:195]
    buffer_load_dwordx4 v6, s[32:35], s67 offen offset:3072 lds
    s_add_u32 s67, s87, 331776
    v_mfma_f32_16x16x32_bf16 v[196:199], v[96:99], v[52:55], v[196:199]
    ds_read_b64_tr_b16 v[90:91], v20 offset:36864
    s_add_u32 m0, s70, 114688
    v_mfma_f32_16x16x32_bf16 v[196:199], v[100:103], v[36:39], v[196:199]
    v_mfma_f32_16x16x32_bf16 v[200:203], v[96:99], v[56:59], v[200:203]
    ds_read_b64_tr_b16 v[92:93], v20 offset:40960
    v_mfma_f32_16x16x32_bf16 v[200:203], v[100:103], v[40:43], v[200:203]
    buffer_load_dwordx4 v3, s[32:35], s67 offen offset:0 lds
    v_mfma_f32_16x16x32_bf16 v[204:207], v[96:99], v[60:63], v[204:207]
    ds_read_b64_tr_b16 v[94:95], v20 offset:45056
    v_mfma_f32_16x16x32_bf16 v[204:207], v[100:103], v[44:47], v[204:207]
    v_add_u32 v21, 0x10000, v21
    s_waitcnt lgkmcnt(8)
    v_mfma_f32_16x16x32_bf16 v[208:211], v[104:107], v[48:51], v[208:211]
    ds_read_b64_tr_b16 v[96:97], v21 offset:32768
    v_mfma_f32_16x16x32_bf16 v[208:211], v[108:111], v[32:35], v[208:211]
    v_mfma_f32_16x16x32_bf16 v[212:215], v[104:107], v[52:55], v[212:215]
    ds_read_b64_tr_b16 v[98:99], v21 offset:36864
    v_mfma_f32_16x16x32_bf16 v[212:215], v[108:111], v[36:39], v[212:215]
    buffer_load_dwordx4 v4, s[32:35], s67 offen offset:1024 lds
    v_mfma_f32_16x16x32_bf16 v[216:219], v[104:107], v[56:59], v[216:219]
    ds_read_b64_tr_b16 v[100:101], v21 offset:40960
    v_mfma_f32_16x16x32_bf16 v[216:219], v[108:111], v[40:43], v[216:219]
    v_mfma_f32_16x16x32_bf16 v[220:223], v[104:107], v[60:63], v[220:223]
    ds_read_b64_tr_b16 v[102:103], v21 offset:45056
    v_mfma_f32_16x16x32_bf16 v[220:223], v[108:111], v[44:47], v[220:223]
    buffer_load_dwordx4 v5, s[32:35], s67 offen offset:2048 lds
    s_waitcnt lgkmcnt(8)
    v_mfma_f32_16x16x32_bf16 v[224:227], v[80:83], v[48:51], v[224:227]
    ds_read_b64_tr_b16 v[104:105], v20 offset:34816
    v_mfma_f32_16x16x32_bf16 v[224:227], v[84:87], v[32:35], v[224:227]
    v_mfma_f32_16x16x32_bf16 v[228:231], v[80:83], v[52:55], v[228:231]
    ds_read_b64_tr_b16 v[106:107], v20 offset:38912
    v_mfma_f32_16x16x32_bf16 v[228:231], v[84:87], v[36:39], v[228:231]
    buffer_load_dwordx4 v6, s[32:35], s67 offen offset:3072 lds
    s_add_u32 s67, s87, 497664
    v_mfma_f32_16x16x32_bf16 v[232:235], v[80:83], v[56:59], v[232:235]
    ds_read_b64_tr_b16 v[108:109], v20 offset:43008
    s_add_u32 m0, s70, 81920
    v_mfma_f32_16x16x32_bf16 v[232:235], v[84:87], v[40:43], v[232:235]
    v_mfma_f32_16x16x32_bf16 v[236:239], v[80:83], v[60:63], v[236:239]
    ds_read_b64_tr_b16 v[110:111], v20 offset:47104
    v_mfma_f32_16x16x32_bf16 v[236:239], v[84:87], v[44:47], v[236:239]
    s_waitcnt lgkmcnt(8)
    v_mfma_f32_16x16x32_bf16 v[176:179], v[88:91], a[0:3], v[176:179]
    ds_read_b64_tr_b16 v[80:81], v21 offset:34816
    v_mfma_f32_16x16x32_bf16 v[176:179], v[92:95], a[16:19], v[176:179]
    buffer_load_dwordx4 v3, s[32:35], s67 offen offset:0 lds
    v_mfma_f32_16x16x32_bf16 v[180:183], v[88:91], a[4:7], v[180:183]
    ds_read_b64_tr_b16 v[82:83], v21 offset:38912
    v_mfma_f32_16x16x32_bf16 v[180:183], v[92:95], a[20:23], v[180:183]
    v_mfma_f32_16x16x32_bf16 v[184:187], v[88:91], a[8:11], v[184:187]
    ds_read_b64_tr_b16 v[84:85], v21 offset:43008
    v_mfma_f32_16x16x32_bf16 v[184:187], v[92:95], a[24:27], v[184:187]
    buffer_load_dwordx4 v4, s[32:35], s67 offen offset:1024 lds
    v_mfma_f32_16x16x32_bf16 v[188:191], v[88:91], a[12:15], v[188:191]
    ds_read_b64_tr_b16 v[86:87], v21 offset:47104
    v_mfma_f32_16x16x32_bf16 v[188:191], v[92:95], a[28:31], v[188:191]
    v_add_u32 v20, 0xffff0000, v20
    s_waitcnt vmcnt(15) lgkmcnt(8)
    s_barrier
    v_mfma_f32_16x16x32_bf16 v[192:195], v[96:99], a[0:3], v[192:195]
    ds_read_b64_tr_b16 v[88:89], v20 offset:0
    v_mfma_f32_16x16x32_bf16 v[192:195], v[100:103], a[16:19], v[192:195]
    v_mfma_f32_16x16x32_bf16 v[196:199], v[96:99], a[4:7], v[196:199]
    ds_read_b64_tr_b16 v[90:91], v20 offset:4096
    v_mfma_f32_16x16x32_bf16 v[196:199], v[100:103], a[20:23], v[196:199]
    buffer_load_dwordx4 v5, s[32:35], s67 offen offset:2048 lds
    v_mfma_f32_16x16x32_bf16 v[200:203], v[96:99], a[8:11], v[200:203]
    ds_read_b64_tr_b16 v[92:93], v20 offset:8192
    v_mfma_f32_16x16x32_bf16 v[200:203], v[100:103], a[24:27], v[200:203]
    v_mfma_f32_16x16x32_bf16 v[204:207], v[96:99], a[12:15], v[204:207]
    ds_read_b64_tr_b16 v[94:95], v20 offset:12288
    v_mfma_f32_16x16x32_bf16 v[204:207], v[100:103], a[28:31], v[204:207]
    v_add_u32 v21, 0xffff0000, v21
    s_waitcnt lgkmcnt(8)
    v_mfma_f32_16x16x32_bf16 v[208:211], v[104:107], a[0:3], v[208:211]
    ds_read_b64_tr_b16 v[96:97], v21 offset:0
    v_mfma_f32_16x16x32_bf16 v[208:211], v[108:111], a[16:19], v[208:211]
    buffer_load_dwordx4 v6, s[32:35], s67 offen offset:3072 lds
    v_mov_b32_e64 v27, 6
    v_mfma_f32_16x16x32_bf16 v[212:215], v[104:107], a[4:7], v[212:215]
    ds_read_b64_tr_b16 v[98:99], v21 offset:4096
    v_mfma_f32_16x16x32_bf16 v[212:215], v[108:111], a[20:23], v[212:215]
    v_mfma_f32_16x16x32_bf16 v[216:219], v[104:107], a[8:11], v[216:219]
    ds_read_b64_tr_b16 v[100:101], v21 offset:8192
    v_mfma_f32_16x16x32_bf16 v[216:219], v[108:111], a[24:27], v[216:219]
    buffer_store_dword v27, v29, s[44:47], s6 offen sc1
    s_mul_i32 s67, s58, 124416
    v_mfma_f32_16x16x32_bf16 v[220:223], v[104:107], a[12:15], v[220:223]
    ds_read_b64_tr_b16 v[102:103], v21 offset:12288
    s_add_u32 s67, s67, s87
    v_mfma_f32_16x16x32_bf16 v[220:223], v[108:111], a[28:31], v[220:223]
    s_lshr_b32 m0, s70, 1
    s_waitcnt lgkmcnt(8)
    v_mfma_f32_16x16x32_bf16 v[224:227], v[80:83], a[0:3], v[224:227]
    ds_read_b64_tr_b16 v[104:105], v20 offset:2048
    s_add_u32 m0, m0, 131072
    v_mfma_f32_16x16x32_bf16 v[224:227], v[84:87], a[16:19], v[224:227]
    buffer_load_dwordx4 v8, s[32:35], s67 offen lds
    s_add_u32 s67, s67, 81920
    v_mfma_f32_16x16x32_bf16 v[228:231], v[80:83], a[4:7], v[228:231]
    ds_read_b64_tr_b16 v[106:107], v20 offset:6144
    v_mfma_f32_16x16x32_bf16 v[228:231], v[84:87], a[20:23], v[228:231]
    v_mfma_f32_16x16x32_bf16 v[232:235], v[80:83], a[8:11], v[232:235]
    ds_read_b64_tr_b16 v[108:109], v20 offset:10240
    v_mfma_f32_16x16x32_bf16 v[232:235], v[84:87], a[24:27], v[232:235]
    buffer_load_dwordx4 v8, s[32:35], s67 offen offset:1024 lds
    v_mfma_f32_16x16x32_bf16 v[236:239], v[80:83], a[12:15], v[236:239]
    ds_read_b64_tr_b16 v[110:111], v20 offset:14336
    v_mfma_f32_16x16x32_bf16 v[236:239], v[84:87], a[28:31], v[236:239]
    s_waitcnt lgkmcnt(8)
    v_mfma_f32_16x16x32_bf16 v[176:179], v[88:91], a[48:51], v[176:179]
    ds_read_b64_tr_b16 v[80:81], v21 offset:2048
    v_mfma_f32_16x16x32_bf16 v[176:179], v[92:95], a[32:35], v[176:179]
    v_mfma_f32_16x16x32_bf16 v[180:183], v[88:91], a[52:55], v[180:183]
    ds_read_b64_tr_b16 v[82:83], v21 offset:6144
    v_mfma_f32_16x16x32_bf16 v[180:183], v[92:95], a[36:39], v[180:183]
    v_mfma_f32_16x16x32_bf16 v[184:187], v[88:91], a[56:59], v[184:187]
    ds_read_b64_tr_b16 v[84:85], v21 offset:10240
    v_mfma_f32_16x16x32_bf16 v[184:187], v[92:95], a[40:43], v[184:187]
    v_mfma_f32_16x16x32_bf16 v[188:191], v[88:91], a[60:63], v[188:191]
    ds_read_b64_tr_b16 v[86:87], v21 offset:14336
    v_mfma_f32_16x16x32_bf16 v[188:191], v[92:95], a[44:47], v[188:191]
    s_waitcnt lgkmcnt(8)
    v_mfma_f32_16x16x32_bf16 v[192:195], v[96:99], a[48:51], v[192:195]
    v_mfma_f32_16x16x32_bf16 v[192:195], v[100:103], a[32:35], v[192:195]
    v_mfma_f32_16x16x32_bf16 v[196:199], v[96:99], a[52:55], v[196:199]
    v_mfma_f32_16x16x32_bf16 v[196:199], v[100:103], a[36:39], v[196:199]
    v_mfma_f32_16x16x32_bf16 v[200:203], v[96:99], a[56:59], v[200:203]
    v_mfma_f32_16x16x32_bf16 v[200:203], v[100:103], a[40:43], v[200:203]
    v_mfma_f32_16x16x32_bf16 v[204:207], v[96:99], a[60:63], v[204:207]
    v_mfma_f32_16x16x32_bf16 v[204:207], v[100:103], a[44:47], v[204:207]
    s_waitcnt lgkmcnt(4)
    v_mfma_f32_16x16x32_bf16 v[208:211], v[104:107], a[48:51], v[208:211]
    v_mfma_f32_16x16x32_bf16 v[208:211], v[108:111], a[32:35], v[208:211]
    v_mfma_f32_16x16x32_bf16 v[212:215], v[104:107], a[52:55], v[212:215]
    v_mfma_f32_16x16x32_bf16 v[212:215], v[108:111], a[36:39], v[212:215]
    s_sub_u32 s68, s82, 32768
    v_cvt_pk_bf16_f32 v176, v176, v177
    v_mfma_f32_16x16x32_bf16 v[216:219], v[104:107], a[56:59], v[216:219]
    v_cvt_pk_bf16_f32 v177, v178, v179
    v_cvt_pk_bf16_f32 v178, v192, v193
    v_mfma_f32_16x16x32_bf16 v[216:219], v[108:111], a[40:43], v[216:219]
    v_cvt_pk_bf16_f32 v179, v194, v195
    v_mfma_f32_16x16x32_bf16 v[220:223], v[104:107], a[60:63], v[220:223]
    buffer_store_dwordx4 v[176:179], v2, s[44:47], s68 offen offset:0 sc1
    v_cvt_pk_bf16_f32 v180, v180, v181
    v_mfma_f32_16x16x32_bf16 v[220:223], v[108:111], a[44:47], v[220:223]
    v_cvt_pk_bf16_f32 v181, v182, v183
    s_waitcnt lgkmcnt(0)
    v_mfma_f32_16x16x32_bf16 v[224:227], v[80:83], a[48:51], v[224:227]
    v_cvt_pk_bf16_f32 v182, v196, v197
    v_cvt_pk_bf16_f32 v183, v198, v199
    v_mfma_f32_16x16x32_bf16 v[224:227], v[84:87], a[32:35], v[224:227]
    buffer_store_dwordx4 v[180:183], v2, s[44:47], s68 offen offset:1024 sc1
    s_xor_b32 s68, s68, 2048
    v_mfma_f32_16x16x32_bf16 v[228:231], v[80:83], a[52:55], v[228:231]
    v_cvt_pk_bf16_f32 v184, v184, v185
    v_cvt_pk_bf16_f32 v185, v186, v187
    v_mfma_f32_16x16x32_bf16 v[228:231], v[84:87], a[36:39], v[228:231]
    v_cvt_pk_bf16_f32 v186, v200, v201
    v_cvt_pk_bf16_f32 v187, v202, v203
    v_mfma_f32_16x16x32_bf16 v[232:235], v[80:83], a[56:59], v[232:235]
    buffer_store_dwordx4 v[184:187], v2, s[44:47], s68 offen offset:0 sc1
    v_cvt_pk_bf16_f32 v188, v188, v189
    v_mfma_f32_16x16x32_bf16 v[232:235], v[84:87], a[40:43], v[232:235]
    v_cvt_pk_bf16_f32 v189, v190, v191
    v_cvt_pk_bf16_f32 v190, v204, v205
    v_mfma_f32_16x16x32_bf16 v[236:239], v[80:83], a[60:63], v[236:239]
    v_cvt_pk_bf16_f32 v191, v206, v207
    v_mfma_f32_16x16x32_bf16 v[236:239], v[84:87], a[44:47], v[236:239]
    buffer_store_dwordx4 v[188:191], v2, s[44:47], s68 offen offset:1024 sc1
    s_waitcnt vmcnt(4)
    s_barrier
    s_and_b32 s65, s57, 12
    s_cmp_eq_u32 s65, 8
    s_cbranch_scc1 dbl
    ds_read_b64_tr_b16 v[80:81], v9 offset:32768
    ds_read_b64_tr_b16 v[82:83], v9 offset:34816
    ds_read_b64_tr_b16 v[84:85], v10 offset:32768
    ds_read_b64_tr_b16 v[86:87], v10 offset:34816
    ds_read_b64_tr_b16 v[88:89], v11 offset:32768
    ds_read_b64_tr_b16 v[90:91], v11 offset:34816
    ds_read_b64_tr_b16 v[92:93], v12 offset:32768
    ds_read_b64_tr_b16 v[94:95], v12 offset:34816
    ds_read_b64_tr_b16 v[96:97], v9 offset:36864
    ds_read_b64_tr_b16 v[98:99], v9 offset:38912
    ds_read_b64_tr_b16 v[100:101], v10 offset:36864
    ds_read_b64_tr_b16 v[102:103], v10 offset:38912
    ds_read_b64_tr_b16 v[104:105], v11 offset:36864
    ds_read_b64_tr_b16 v[106:107], v11 offset:38912
    s_waitcnt lgkmcnt(10)
    v_mfma_f32_16x16x32_bf16 v[32:35], v[80:83], a[160:163], 0
    ds_read_b64_tr_b16 v[108:109], v12 offset:36864
    ds_read_b64_tr_b16 v[110:111], v12 offset:38912
    s_sub_u32 s68, s82, 49152
    v_cvt_pk_bf16_f32 v208, v208, v209
    v_mfma_f32_16x16x32_bf16 v[36:39], v[84:87], a[160:163], 0
    ds_read_b64_tr_b16 v[80:81], v9 offset:40960
    ds_read_b64_tr_b16 v[82:83], v9 offset:43008
    v_cvt_pk_bf16_f32 v209, v210, v211
    v_cvt_pk_bf16_f32 v210, v224, v225
    s_waitcnt lgkmcnt(10)
    v_mfma_f32_16x16x32_bf16 v[40:43], v[88:91], a[160:163], 0
    ds_read_b64_tr_b16 v[84:85], v10 offset:40960
    ds_read_b64_tr_b16 v[86:87], v10 offset:43008
    v_cvt_pk_bf16_f32 v211, v226, v227
    buffer_store_dwordx4 v[208:211], v2, s[44:47], s68 offen offset:0 sc1
    v_mfma_f32_16x16x32_bf16 v[44:47], v[92:95], a[160:163], 0
    ds_read_b64_tr_b16 v[88:89], v11 offset:40960
    ds_read_b64_tr_b16 v[90:91], v11 offset:43008
    v_cvt_pk_bf16_f32 v212, v212, v213
    v_cvt_pk_bf16_f32 v213, v214, v215
    s_waitcnt lgkmcnt(10)
    v_mfma_f32_16x16x32_bf16 v[32:35], v[96:99], a[164:167], v[32:35]
    ds_read_b64_tr_b16 v[92:93], v12 offset:40960
    ds_read_b64_tr_b16 v[94:95], v12 offset:43008
    v_cvt_pk_bf16_f32 v214, v228, v229
    v_cvt_pk_bf16_f32 v215, v230, v231
    v_mfma_f32_16x16x32_bf16 v[36:39], v[100:103], a[164:167], v[36:39]
    ds_read_b64_tr_b16 v[96:97], v9 offset:45056
    ds_read_b64_tr_b16 v[98:99], v9 offset:47104
    buffer_store_dwordx4 v[212:215], v2, s[44:47], s68 offen offset:1024 sc1
    s_xor_b32 s68, s68, 2048
    s_waitcnt lgkmcnt(10)
    v_mfma_f32_16x16x32_bf16 v[40:43], v[104:107], a[164:167], v[40:43]
    ds_read_b64_tr_b16 v[100:101], v10 offset:45056
    ds_read_b64_tr_b16 v[102:103], v10 offset:47104
    v_cvt_pk_bf16_f32 v216, v216, v217
    v_cvt_pk_bf16_f32 v217, v218, v219
    v_mfma_f32_16x16x32_bf16 v[44:47], v[108:111], a[164:167], v[44:47]
    ds_read_b64_tr_b16 v[104:105], v11 offset:45056
    ds_read_b64_tr_b16 v[106:107], v11 offset:47104
    v_cvt_pk_bf16_f32 v218, v232, v233
    v_cvt_pk_bf16_f32 v219, v234, v235
    s_waitcnt lgkmcnt(10)
    v_mfma_f32_16x16x32_bf16 v[32:35], v[80:83], a[168:171], v[32:35]
    ds_read_b64_tr_b16 v[108:109], v12 offset:45056
    ds_read_b64_tr_b16 v[110:111], v12 offset:47104
    buffer_store_dwordx4 v[216:219], v2, s[44:47], s68 offen offset:0 sc1
    v_cvt_pk_bf16_f32 v220, v220, v221
    v_mfma_f32_16x16x32_bf16 v[36:39], v[84:87], a[168:171], v[36:39]
    ds_read_b64_tr_b16 v[80:81], v9 offset:49152
    ds_read_b64_tr_b16 v[82:83], v9 offset:51200
    v_cvt_pk_bf16_f32 v221, v222, v223
    v_cvt_pk_bf16_f32 v222, v236, v237
    s_waitcnt lgkmcnt(10)
    v_mfma_f32_16x16x32_bf16 v[40:43], v[88:91], a[168:171], v[40:43]
    ds_read_b64_tr_b16 v[84:85], v10 offset:49152
    ds_read_b64_tr_b16 v[86:87], v10 offset:51200
    v_cvt_pk_bf16_f32 v223, v238, v239
    buffer_store_dwordx4 v[220:223], v2, s[44:47], s68 offen offset:1024 sc1
    v_mfma_f32_16x16x32_bf16 v[44:47], v[92:95], a[168:171], v[44:47]
    ds_read_b64_tr_b16 v[88:89], v11 offset:49152
    ds_read_b64_tr_b16 v[90:91], v11 offset:51200
    buffer_load_dwordx4 v[248:251], v30, s[24:27], s89 offen offset:0
    buffer_load_dwordx4 v[252:255], v30, s[24:27], s89 offen offset:64
    s_waitcnt lgkmcnt(10)
    v_mfma_f32_16x16x32_bf16 v[32:35], v[96:99], a[172:175], v[32:35]
    ds_read_b64_tr_b16 v[92:93], v12 offset:49152
    ds_read_b64_tr_b16 v[94:95], v12 offset:51200
    v_mfma_f32_16x16x32_bf16 v[36:39], v[100:103], a[172:175], v[36:39]
    ds_read_b64_tr_b16 v[96:97], v9 offset:53248
    ds_read_b64_tr_b16 v[98:99], v9 offset:55296
    s_waitcnt lgkmcnt(10)
    v_mfma_f32_16x16x32_bf16 v[40:43], v[104:107], a[172:175], v[40:43]
    ds_read_b64_tr_b16 v[100:101], v10 offset:53248
    ds_read_b64_tr_b16 v[102:103], v10 offset:55296
    v_mfma_f32_16x16x32_bf16 v[44:47], v[108:111], a[172:175], v[44:47]
    ds_read_b64_tr_b16 v[104:105], v11 offset:53248
    ds_read_b64_tr_b16 v[106:107], v11 offset:55296
    s_waitcnt lgkmcnt(10)
    v_mfma_f32_16x16x32_bf16 v[32:35], v[80:83], a[176:179], v[32:35]
    ds_read_b64_tr_b16 v[108:109], v12 offset:53248
    ds_read_b64_tr_b16 v[110:111], v12 offset:55296
    v_mfma_f32_16x16x32_bf16 v[36:39], v[84:87], a[176:179], v[36:39]
    ds_read_b64_tr_b16 v[80:81], v9 offset:57344
    ds_read_b64_tr_b16 v[82:83], v9 offset:59392
    s_waitcnt lgkmcnt(10)
    v_mfma_f32_16x16x32_bf16 v[40:43], v[88:91], a[176:179], v[40:43]
    ds_read_b64_tr_b16 v[84:85], v10 offset:57344
    ds_read_b64_tr_b16 v[86:87], v10 offset:59392
    v_mfma_f32_16x16x32_bf16 v[44:47], v[92:95], a[176:179], v[44:47]
    ds_read_b64_tr_b16 v[88:89], v11 offset:57344
    ds_read_b64_tr_b16 v[90:91], v11 offset:59392
    s_waitcnt lgkmcnt(10)
    v_mfma_f32_16x16x32_bf16 v[32:35], v[96:99], a[180:183], v[32:35]
    ds_read_b64_tr_b16 v[92:93], v12 offset:57344
    ds_read_b64_tr_b16 v[94:95], v12 offset:59392
    v_mfma_f32_16x16x32_bf16 v[36:39], v[100:103], a[180:183], v[36:39]
    ds_read_b64_tr_b16 v[96:97], v9 offset:61440
    ds_read_b64_tr_b16 v[98:99], v9 offset:63488
    s_waitcnt lgkmcnt(10)
    v_mfma_f32_16x16x32_bf16 v[40:43], v[104:107], a[180:183], v[40:43]
    ds_read_b64_tr_b16 v[100:101], v10 offset:61440
    ds_read_b64_tr_b16 v[102:103], v10 offset:63488
    v_mfma_f32_16x16x32_bf16 v[44:47], v[108:111], a[180:183], v[44:47]
    ds_read_b64_tr_b16 v[104:105], v11 offset:61440
    ds_read_b64_tr_b16 v[106:107], v11 offset:63488
    s_waitcnt lgkmcnt(10)
    v_mfma_f32_16x16x32_bf16 v[32:35], v[80:83], a[184:187], v[32:35]
    ds_read_b64_tr_b16 v[108:109], v12 offset:61440
    ds_read_b64_tr_b16 v[110:111], v12 offset:63488
    v_mfma_f32_16x16x32_bf16 v[36:39], v[84:87], a[184:187], v[36:39]
    v_add_u32 v9, 0x10000, v9
    v_add_u32 v10, 0x10000, v10
    v_add_u32 v11, 0x10000, v11
    v_add_u32 v12, 0x10000, v12
    ds_read_b64_tr_b16 v[80:81], v9 offset:49152
    ds_read_b64_tr_b16 v[82:83], v9 offset:51200
    s_waitcnt lgkmcnt(10)
    v_mfma_f32_16x16x32_bf16 v[40:43], v[88:91], a[184:187], v[40:43]
    ds_read_b64_tr_b16 v[84:85], v10 offset:49152
    ds_read_b64_tr_b16 v[86:87], v10 offset:51200
    v_mfma_f32_16x16x32_bf16 v[44:47], v[92:95], a[184:187], v[44:47]
    ds_read_b64_tr_b16 v[88:89], v11 offset:49152
    ds_read_b64_tr_b16 v[90:91], v11 offset:51200
    s_waitcnt lgkmcnt(10)
    v_mfma_f32_16x16x32_bf16 v[32:35], v[96:99], a[188:191], v[32:35]
    ds_read_b64_tr_b16 v[92:93], v12 offset:49152
    ds_read_b64_tr_b16 v[94:95], v12 offset:51200
    v_mfma_f32_16x16x32_bf16 v[36:39], v[100:103], a[188:191], v[36:39]
    ds_read_b64_tr_b16 v[96:97], v9 offset:53248
    ds_read_b64_tr_b16 v[98:99], v9 offset:55296
    s_waitcnt lgkmcnt(10)
    v_mfma_f32_16x16x32_bf16 v[40:43], v[104:107], a[188:191], v[40:43]
    ds_read_b64_tr_b16 v[100:101], v10 offset:53248
    ds_read_b64_tr_b16 v[102:103], v10 offset:55296
    v_mfma_f32_16x16x32_bf16 v[44:47], v[108:111], a[188:191], v[44:47]
    ds_read_b64_tr_b16 v[104:105], v11 offset:53248
    ds_read_b64_tr_b16 v[106:107], v11 offset:55296
    s_waitcnt lgkmcnt(10)
    v_mfma_f32_16x16x32_bf16 v[32:35], v[80:83], a[192:195], v[32:35]
    ds_read_b64_tr_b16 v[108:109], v12 offset:53248
    ds_read_b64_tr_b16 v[110:111], v12 offset:55296
    v_mfma_f32_16x16x32_bf16 v[36:39], v[84:87], a[192:195], v[36:39]
    ds_read_b64_tr_b16 v[80:81], v9 offset:57344
    ds_read_b64_tr_b16 v[82:83], v9 offset:59392
    s_waitcnt lgkmcnt(10)
    v_mfma_f32_16x16x32_bf16 v[40:43], v[88:91], a[192:195], v[40:43]
    ds_read_b64_tr_b16 v[84:85], v10 offset:57344
    ds_read_b64_tr_b16 v[86:87], v10 offset:59392
    v_mfma_f32_16x16x32_bf16 v[44:47], v[92:95], a[192:195], v[44:47]
    ds_read_b64_tr_b16 v[88:89], v11 offset:57344
    ds_read_b64_tr_b16 v[90:91], v11 offset:59392
    s_waitcnt lgkmcnt(10)
    v_mfma_f32_16x16x32_bf16 v[32:35], v[96:99], a[196:199], v[32:35]
    ds_read_b64_tr_b16 v[92:93], v12 offset:57344
    ds_read_b64_tr_b16 v[94:95], v12 offset:59392
    v_mfma_f32_16x16x32_bf16 v[36:39], v[100:103], a[196:199], v[36:39]
    ds_read_b64_tr_b16 v[96:97], v9 offset:61440
    ds_read_b64_tr_b16 v[98:99], v9 offset:63488
    s_waitcnt lgkmcnt(10)
    v_mfma_f32_16x16x32_bf16 v[40:43], v[104:107], a[196:199], v[40:43]
    ds_read_b64_tr_b16 v[100:101], v10 offset:61440
    ds_read_b64_tr_b16 v[102:103], v10 offset:63488
    v_mfma_f32_16x16x32_bf16 v[44:47], v[108:111], a[196:199], v[44:47]
    ds_read_b64_tr_b16 v[104:105], v11 offset:61440
    ds_read_b64_tr_b16 v[106:107], v11 offset:63488
    s_waitcnt lgkmcnt(10)
    v_mfma_f32_16x16x32_bf16 v[32:35], v[80:83], a[200:203], v[32:35]
    ds_read_b64_tr_b16 v[108:109], v12 offset:61440
    ds_read_b64_tr_b16 v[110:111], v12 offset:63488
    v_mfma_f32_16x16x32_bf16 v[36:39], v[84:87], a[200:203], v[36:39]
    ds_read_b64_tr_b16 v[80:81], v9 offset:16384
    ds_read_b64_tr_b16 v[82:83], v9 offset:18432
    s_waitcnt lgkmcnt(10)
    v_mfma_f32_16x16x32_bf16 v[40:43], v[88:91], a[200:203], v[40:43]
    ds_read_b64_tr_b16 v[84:85], v10 offset:16384
    ds_read_b64_tr_b16 v[86:87], v10 offset:18432
    v_mfma_f32_16x16x32_bf16 v[44:47], v[92:95], a[200:203], v[44:47]
    ds_read_b64_tr_b16 v[88:89], v11 offset:16384
    ds_read_b64_tr_b16 v[90:91], v11 offset:18432
    s_waitcnt lgkmcnt(10)
    v_mfma_f32_16x16x32_bf16 v[32:35], v[96:99], a[204:207], v[32:35]
    ds_read_b64_tr_b16 v[92:93], v12 offset:16384
    ds_read_b64_tr_b16 v[94:95], v12 offset:18432
    v_mfma_f32_16x16x32_bf16 v[36:39], v[100:103], a[204:207], v[36:39]
    ds_read_b64_tr_b16 v[96:97], v9 offset:20480
    ds_read_b64_tr_b16 v[98:99], v9 offset:22528
    s_waitcnt lgkmcnt(10)
    v_mfma_f32_16x16x32_bf16 v[40:43], v[104:107], a[204:207], v[40:43]
    ds_read_b64_tr_b16 v[100:101], v10 offset:20480
    ds_read_b64_tr_b16 v[102:103], v10 offset:22528
    v_mfma_f32_16x16x32_bf16 v[44:47], v[108:111], a[204:207], v[44:47]
    ds_read_b64_tr_b16 v[104:105], v11 offset:20480
    ds_read_b64_tr_b16 v[106:107], v11 offset:22528
    s_waitcnt lgkmcnt(10)
    v_mfma_f32_16x16x32_bf16 v[32:35], v[80:83], a[208:211], v[32:35]
    ds_read_b64_tr_b16 v[108:109], v12 offset:20480
    ds_read_b64_tr_b16 v[110:111], v12 offset:22528
    s_waitcnt vmcnt(2)
    s_barrier
    buffer_load_dword v26, v13, s[44:47], s93 offen sc1
    v_mov_b32 v27, 7
    buffer_store_dword v27, v29, s[44:47], s6 offen sc1
    v_mfma_f32_16x16x32_bf16 v[36:39], v[84:87], a[208:211], v[36:39]
    ds_read_b64_tr_b16 v[80:81], v9 offset:24576
    ds_read_b64_tr_b16 v[82:83], v9 offset:26624
    s_waitcnt lgkmcnt(10)
    v_mfma_f32_16x16x32_bf16 v[40:43], v[88:91], a[208:211], v[40:43]
    ds_read_b64_tr_b16 v[84:85], v10 offset:24576
    ds_read_b64_tr_b16 v[86:87], v10 offset:26624
    v_mfma_f32_16x16x32_bf16 v[44:47], v[92:95], a[208:211], v[44:47]
    ds_read_b64_tr_b16 v[88:89], v11 offset:24576
    ds_read_b64_tr_b16 v[90:91], v11 offset:26624
    s_waitcnt lgkmcnt(10)
    v_mfma_f32_16x16x32_bf16 v[32:35], v[96:99], a[212:215], v[32:35]
    ds_read_b64_tr_b16 v[92:93], v12 offset:24576
    ds_read_b64_tr_b16 v[94:95], v12 offset:26624
    v_mfma_f32_16x16x32_bf16 v[36:39], v[100:103], a[212:215], v[36:39]
    ds_read_b64_tr_b16 v[96:97], v9 offset:28672
    ds_read_b64_tr_b16 v[98:99], v9 offset:30720
    s_waitcnt lgkmcnt(10)
    v_mfma_f32_16x16x32_bf16 v[40:43], v[104:107], a[212:215], v[40:43]
    ds_read_b64_tr_b16 v[100:101], v10 offset:28672
    ds_read_b64_tr_b16 v[102:103], v10 offset:30720
    v_mfma_f32_16x16x32_bf16 v[44:47], v[108:111], a[212:215], v[44:47]
    ds_read_b64_tr_b16 v[104:105], v11 offset:28672
    ds_read_b64_tr_b16 v[106:107], v11 offset:30720
    s_waitcnt lgkmcnt(10)
    v_mfma_f32_16x16x32_bf16 v[32:35], v[80:83], a[216:219], v[32:35]
    ds_read_b64_tr_b16 v[108:109], v12 offset:28672
    ds_read_b64_tr_b16 v[110:111], v12 offset:30720
    v_mfma_f32_16x16x32_bf16 v[36:39], v[84:87], a[216:219], v[36:39]
    v_add_u32 v9, 0x10000, v9
    v_add_u32 v10, 0x10000, v10
    v_add_u32 v11, 0x10000, v11
    v_add_u32 v12, 0x10000, v12
    ds_read_b64_tr_b16 v[80:81], v9 offset:0
    ds_read_b64_tr_b16 v[82:83], v9 offset:2048
    s_waitcnt lgkmcnt(10)
    v_mfma_f32_16x16x32_bf16 v[40:43], v[88:91], a[216:219], v[40:43]
    ds_read_b64_tr_b16 v[84:85], v10 offset:0
    ds_read_b64_tr_b16 v[86:87], v10 offset:2048
    v_mfma_f32_16x16x32_bf16 v[44:47], v[92:95], a[216:219], v[44:47]
    ds_read_b64_tr_b16 v[88:89], v11 offset:0
    ds_read_b64_tr_b16 v[90:91], v11 offset:2048
    s_waitcnt lgkmcnt(10)
    v_mfma_f32_16x16x32_bf16 v[32:35], v[96:99], a[220:223], v[32:35]
    ds_read_b64_tr_b16 v[92:93], v12 offset:0
    ds_read_b64_tr_b16 v[94:95], v12 offset:2048
    v_mfma_f32_16x16x32_bf16 v[36:39], v[100:103], a[220:223], v[36:39]
    ds_read_b64_tr_b16 v[96:97], v9 offset:4096
    ds_read_b64_tr_b16 v[98:99], v9 offset:6144
    s_waitcnt lgkmcnt(10)
    v_mfma_f32_16x16x32_bf16 v[40:43], v[104:107], a[220:223], v[40:43]
    ds_read_b64_tr_b16 v[100:101], v10 offset:4096
    ds_read_b64_tr_b16 v[102:103], v10 offset:6144
    v_mfma_f32_16x16x32_bf16 v[44:47], v[108:111], a[220:223], v[44:47]
    ds_read_b64_tr_b16 v[104:105], v11 offset:4096
    ds_read_b64_tr_b16 v[106:107], v11 offset:6144
    s_waitcnt lgkmcnt(10)
    v_mfma_f32_16x16x32_bf16 v[32:35], v[80:83], a[224:227], v[32:35]
    ds_read_b64_tr_b16 v[108:109], v12 offset:4096
    ds_read_b64_tr_b16 v[110:111], v12 offset:6144
    v_mfma_f32_16x16x32_bf16 v[36:39], v[84:87], a[224:227], v[36:39]
    s_waitcnt lgkmcnt(8)
    v_mfma_f32_16x16x32_bf16 v[40:43], v[88:91], a[224:227], v[40:43]
    v_mfma_f32_16x16x32_bf16 v[44:47], v[92:95], a[224:227], v[44:47]
    s_waitcnt lgkmcnt(4)
    v_mfma_f32_16x16x32_bf16 v[32:35], v[96:99], a[228:231], v[32:35]
    v_mfma_f32_16x16x32_bf16 v[36:39], v[100:103], a[228:231], v[36:39]
    s_waitcnt lgkmcnt(0)
    v_mfma_f32_16x16x32_bf16 v[40:43], v[104:107], a[228:231], v[40:43]
    v_mfma_f32_16x16x32_bf16 v[44:47], v[108:111], a[228:231], v[44:47]
    s_nop 0
    v_add_u32 v9, 0xfffe0000, v9
    v_add_u32 v10, 0xfffe0000, v10
    v_add_u32 v11, 0xfffe0000, v11
    v_add_u32 v12, 0xfffe0000, v12
    v_pk_mul_f32 v[32:33], v[32:33], v[14:15] op_sel_hi:[1,0]
    v_pk_mul_f32 v[34:35], v[34:35], v[14:15] op_sel_hi:[1,0]
    v_pk_mul_f32 v[36:37], v[36:37], v[14:15] op_sel_hi:[1,0]
    v_pk_mul_f32 v[38:39], v[38:39], v[14:15] op_sel_hi:[1,0]
    v_pk_mul_f32 v[40:41], v[40:41], v[14:15] op_sel_hi:[1,0]
    v_pk_mul_f32 v[42:43], v[42:43], v[14:15] op_sel_hi:[1,0]
    v_pk_mul_f32 v[44:45], v[44:45], v[14:15] op_sel_hi:[1,0]
    v_pk_mul_f32 v[46:47], v[46:47], v[14:15] op_sel_hi:[1,0]
    s_waitcnt vmcnt(1)
    v_cmp_le_u32 vcc, s91, v26
    s_nop 1
    s_andn2_b32 s65, s90, vcc_lo
    s_and_b32 s65, s65, 49152
    s_cbranch_scc1 fp7_slow
fp7_ok:
    s_add_u32 s66, s88, 0x11e000
    buffer_load_dwordx4 v[112:115], v2, s[44:47], s66 offen sc1
    s_add_u32 s66, s88, 0x11c000
    buffer_load_dwordx4 v[116:119], v2, s[44:47], s66 offen sc1
    s_andn2_b32 s65, s90, vcc_lo
    s_and_b32 s65, s65, 12288
    s_cbranch_scc1 fp6_slow
fp6_ok:
    s_add_u32 s66, s88, 0xfa000
    buffer_load_dwordx4 v[120:123], v2, s[44:47], s66 offen sc1
    s_add_u32 s66, s88, 0xf8000
    buffer_load_dwordx4 v[124:127], v2, s[44:47], s66 offen sc1
    s_andn2_b32 s65, s90, vcc_lo
    s_and_b32 s65, s65, 3072
    s_cbranch_scc1 fp5_slow
fp5_ok:
    s_add_u32 s66, s88, 0xd6000
    buffer_load_dwordx4 v[128:131], v2, s[44:47], s66 offen sc1
    s_add_u32 s66, s88, 0xd4000
    buffer_load_dwordx4 v[132:135], v2, s[44:47], s66 offen sc1
    s_andn2_b32 s65, s90, vcc_lo
    s_and_b32 s65, s65, 768
    s_cbranch_scc1 fp4_slow
fp4_ok:
    s_add_u32 s66, s88, 0xb2000
    buffer_load_dwordx4 v[136:139], v2, s[44:47], s66 offen sc1
    s_add_u32 s66, s88, 0xb0000
    buffer_load_dwordx4 v[140:143], v2, s[44:47], s66 offen sc1
    s_andn2_b32 s65, s90, vcc_lo
    s_and_b32 s65, s65, 3
    s_cbranch_scc1 fp0_slow
fp0_ok:
    s_add_u32 s66, s88, 0x22000
    buffer_load_dwordx4 v[144:147], v2, s[44:47], s66 offen sc1
    s_add_u32 s66, s88, 0x20000
    buffer_load_dwordx4 v[148:151], v2, s[44:47], s66 offen sc1
    s_andn2_b32 s65, s90, vcc_lo
    s_and_b32 s65, s65, 12
    s_cbranch_scc1 fp1_slow
fp1_ok:
    s_add_u32 s66, s88, 0x46000
    buffer_load_dwordx4 v[152:155], v2, s[44:47], s66 offen sc1
    s_add_u32 s66, s88, 0x44000
    buffer_load_dwordx4 v[156:159], v2, s[44:47], s66 offen sc1
    s_andn2_b32 s65, s90, vcc_lo
    s_and_b32 s65, s65, 48
    s_cbranch_scc1 fp2_slow
fp2_ok:
    s_add_u32 s66, s88, 0x6a000
    buffer_load_dwordx4 v[160:163], v2, s[44:47], s66 offen sc1
    s_add_u32 s66, s88, 0x68000
    buffer_load_dwordx4 v[164:167], v2, s[44:47], s66 offen sc1
    s_andn2_b32 s65, s90, vcc_lo
    s_and_b32 s65, s65, 192
    s_cbranch_scc1 fp3_slow
fp3_ok:
    s_add_u32 s66, s88, 0x8e000
    buffer_load_dwordx4 v[168:171], v2, s[44:47], s66 offen sc1
    s_add_u32 s66, s88, 0x8c000
    buffer_load_dwordx4 v[172:175], v2, s[44:47], s66 offen sc1
    s_waitcnt vmcnt(15)
    s_nop 0
    v_dot2_f32_bf16 v80, v112, s94, 0
    v_dot2_f32_bf16 v81, v112, s95, 0
    v_dot2_f32_bf16 v82, v113, s94, 0
    v_dot2_f32_bf16 v83, v113, s95, 0
    v_dot2_f32_bf16 v84, v114, s94, 0
    v_dot2_f32_bf16 v85, v114, s95, 0
    v_dot2_f32_bf16 v86, v115, s94, 0
    v_dot2_f32_bf16 v87, v115, s95, 0
    s_waitcnt vmcnt(14)
    s_nop 0
    v_dot2_f32_bf16 v88, v116, s94, 0
    v_dot2_f32_bf16 v89, v116, s95, 0
    v_dot2_f32_bf16 v90, v117, s94, 0
    v_dot2_f32_bf16 v91, v117, s95, 0
    v_dot2_f32_bf16 v92, v118, s94, 0
    v_dot2_f32_bf16 v93, v118, s95, 0
    v_dot2_f32_bf16 v94, v119, s94, 0
    v_dot2_f32_bf16 v95, v119, s95, 0
    s_waitcnt vmcnt(13)
    s_nop 0
    v_dot2_f32_bf16 v80, v120, s94, v80
    v_dot2_f32_bf16 v81, v120, s95, v81
    v_dot2_f32_bf16 v82, v121, s94, v82
    v_dot2_f32_bf16 v83, v121, s95, v83
    v_dot2_f32_bf16 v84, v122, s94, v84
    v_dot2_f32_bf16 v85, v122, s95, v85
    v_dot2_f32_bf16 v86, v123, s94, v86
    v_dot2_f32_bf16 v87, v123, s95, v87
    s_waitcnt vmcnt(12)
    s_nop 0
    v_dot2_f32_bf16 v88, v124, s94, v88
    v_dot2_f32_bf16 v89, v124, s95, v89
    v_dot2_f32_bf16 v90, v125, s94, v90
    v_dot2_f32_bf16 v91, v125, s95, v91
    v_dot2_f32_bf16 v92, v126, s94, v92
    v_dot2_f32_bf16 v93, v126, s95, v93
    v_dot2_f32_bf16 v94, v127, s94, v94
    v_dot2_f32_bf16 v95, v127, s95, v95
    s_waitcnt vmcnt(11)
    s_nop 0
    v_dot2_f32_bf16 v80, v128, s94, v80
    v_dot2_f32_bf16 v81, v128, s95, v81
    v_dot2_f32_bf16 v82, v129, s94, v82
    v_dot2_f32_bf16 v83, v129, s95, v83
    v_dot2_f32_bf16 v84, v130, s94, v84
    v_dot2_f32_bf16 v85, v130, s95, v85
    v_dot2_f32_bf16 v86, v131, s94, v86
    v_dot2_f32_bf16 v87, v131, s95, v87
    s_waitcnt vmcnt(10)
    s_nop 0
    v_dot2_f32_bf16 v88, v132, s94, v88
    v_dot2_f32_bf16 v89, v132, s95, v89
    v_dot2_f32_bf16 v90, v133, s94, v90
    v_dot2_f32_bf16 v91, v133, s95, v91
    v_dot2_f32_bf16 v92, v134, s94, v92
    v_dot2_f32_bf16 v93, v134, s95, v93
    v_dot2_f32_bf16 v94, v135, s94, v94
    v_dot2_f32_bf16 v95, v135, s95, v95
    s_waitcnt vmcnt(9)
    s_nop 0
    v_dot2_f32_bf16 v80, v136, s94, v80
    v_dot2_f32_bf16 v81, v136, s95, v81
    v_dot2_f32_bf16 v82, v137, s94, v82
    v_dot2_f32_bf16 v83, v137, s95, v83
    v_dot2_f32_bf16 v84, v138, s94, v84
    v_dot2_f32_bf16 v85, v138, s95, v85
    v_dot2_f32_bf16 v86, v139, s94, v86
    v_dot2_f32_bf16 v87, v139, s95, v87
    s_waitcnt vmcnt(8)
    s_nop 0
    v_dot2_f32_bf16 v88, v140, s94, v88
    v_dot2_f32_bf16 v89, v140, s95, v89
    v_dot2_f32_bf16 v90, v141, s94, v90
    v_dot2_f32_bf16 v91, v141, s95, v91
    v_dot2_f32_bf16 v92, v142, s94, v92
    v_dot2_f32_bf16 v93, v142, s95, v93
    v_dot2_f32_bf16 v94, v143, s94, v94
    v_dot2_f32_bf16 v95, v143, s95, v95
    s_waitcnt vmcnt(7)
    s_nop 0
    v_dot2_f32_bf16 v80, v144, s94, v80
    v_dot2_f32_bf16 v81, v144, s95, v81
    v_dot2_f32_bf16 v82, v145, s94, v82
    v_dot2_f32_bf16 v83, v145, s95, v83
    v_dot2_f32_bf16 v84, v146, s94, v84
    v_dot2_f32_bf16 v85, v146, s95, v85
    v_dot2_f32_bf16 v86, v147, s94, v86
    v_dot2_f32_bf16 v87, v147, s95, v87
    s_waitcnt vmcnt(6)
    s_nop 0
    v_dot2_f32_bf16 v88, v148, s94, v88
    v_dot2_f32_bf16 v89, v148, s95, v89
    v_dot2_f32_bf16 v90, v149, s94, v90
    v_dot2_f32_bf16 v91, v149, s95, v91
    v_dot2_f32_bf16 v92, v150, s94, v92
    v_dot2_f32_bf16 v93, v150, s95, v93
    v_dot2_f32_bf16 v94, v151, s94, v94
    v_dot2_f32_bf16 v95, v151, s95, v95
    s_waitcnt vmcnt(5)
    s_nop 0
    v_dot2_f32_bf16 v80, v152, s94, v80
    v_dot2_f32_bf16 v81, v152, s95, v81
    v_dot2_f32_bf16 v82, v153, s94, v82
    v_dot2_f32_bf16 v83, v153, s95, v83
    v_dot2_f32_bf16 v84, v154, s94, v84
    v_dot2_f32_bf16 v85, v154, s95, v85
    v_dot2_f32_bf16 v86, v155, s94, v86
    v_dot2_f32_bf16 v87, v155, s95, v87
    s_waitcnt vmcnt(4)
    s_nop 0
    v_dot2_f32_bf16 v88, v156, s94, v88
    v_dot2_f32_bf16 v89, v156, s95, v89
    v_dot2_f32_bf16 v90, v157, s94, v90
    v_dot2_f32_bf16 v91, v157, s95, v91
    v_dot2_f32_bf16 v92, v158, s94, v92
    v_dot2_f32_bf16 v93, v158, s95, v93
    v_dot2_f32_bf16 v94, v159, s94, v94
    v_dot2_f32_bf16 v95, v159, s95, v95
    s_waitcnt vmcnt(3)
    s_nop 0
    v_dot2_f32_bf16 v80, v160, s94, v80
    v_dot2_f32_bf16 v81, v160, s95, v81
    v_dot2_f32_bf16 v82, v161, s94, v82
    v_dot2_f32_bf16 v83, v161, s95, v83
    v_dot2_f32_bf16 v84, v162, s94, v84
    v_dot2_f32_bf16 v85, v162, s95, v85
    v_dot2_f32_bf16 v86, v163, s94, v86
    v_dot2_f32_bf16 v87, v163, s95, v87
    s_waitcnt vmcnt(2)
    s_nop 0
    v_dot2_f32_bf16 v88, v164, s94, v88
    v_dot2_f32_bf16 v89, v164, s95, v89
    v_dot2_f32_bf16 v90, v165, s94, v90
    v_dot2_f32_bf16 v91, v165, s95, v91
    v_dot2_f32_bf16 v92, v166, s94, v92
    v_dot2_f32_bf16 v93, v166, s95, v93
    v_dot2_f32_bf16 v94, v167, s94, v94
    v_dot2_f32_bf16 v95, v167, s95, v95
    s_waitcnt vmcnt(1)
    s_nop 0
    v_dot2_f32_bf16 v80, v168, s94, v80
    v_dot2_f32_bf16 v81, v168, s95, v81
    v_dot2_f32_bf16 v82, v169, s94, v82
    v_dot2_f32_bf16 v83, v169, s95, v83
    v_dot2_f32_bf16 v84, v170, s94, v84
    v_dot2_f32_bf16 v85, v170, s95, v85
    v_dot2_f32_bf16 v86, v171, s94, v86
    v_dot2_f32_bf16 v87, v171, s95, v87
    s_waitcnt vmcnt(0)
    s_nop 0
    v_dot2_f32_bf16 v88, v172, s94, v88
    v_dot2_f32_bf16 v89, v172, s95, v89
    v_dot2_f32_bf16 v90, v173, s94, v90
    v_dot2_f32_bf16 v91, v173, s95, v91
    v_dot2_f32_bf16 v92, v174, s94, v92
    v_dot2_f32_bf16 v93, v174, s95, v93
    v_dot2_f32_bf16 v94, v175, s94, v94
    v_dot2_f32_bf16 v95, v175, s95, v95
    v_pk_mul_f32 v[96:97], v[80:81], v[14:15] op_sel:[0,1] op_sel_hi:[1,1]
    v_pk_mul_f32 v[98:99], v[82:83], v[14:15] op_sel:[0,1] op_sel_hi:[1,1]
    v_pk_mul_f32 v[100:101], v[84:85], v[14:15] op_sel:[0,1] op_sel_hi:[1,1]
    v_pk_mul_f32 v[102:103], v[86:87], v[14:15] op_sel:[0,1] op_sel_hi:[1,1]
    v_pk_mul_f32 v[104:105], v[88:89], v[14:15] op_sel:[0,1] op_sel_hi:[1,1]
    v_pk_mul_f32 v[106:107], v[90:91], v[14:15] op_sel:[0,1] op_sel_hi:[1,1]
    v_pk_mul_f32 v[108:109], v[92:93], v[14:15] op_sel:[0,1] op_sel_hi:[1,1]
    v_pk_mul_f32 v[110:111], v[94:95], v[14:15] op_sel:[0,1] op_sel_hi:[1,1]
    v_exp_f32 v96, v96
    v_exp_f32 v97, v97
    v_exp_f32 v98, v98
    v_exp_f32 v99, v99
    v_exp_f32 v100, v100
    v_exp_f32 v101, v101
    v_exp_f32 v102, v102
    v_exp_f32 v103, v103
    v_exp_f32 v104, v104
    v_exp_f32 v105, v105
    v_exp_f32 v106, v106
    v_exp_f32 v107, v107
    v_exp_f32 v108, v108
    v_exp_f32 v109, v109
    v_exp_f32 v110, v110
    v_exp_f32 v111, v111
    v_pk_mul_f32 v[32:33], v[32:33], v[80:81]
    v_pk_mul_f32 v[34:35], v[34:35], v[82:83]
    v_pk_mul_f32 v[36:37], v[36:37], v[84:85]
    v_pk_mul_f32 v[38:39], v[38:39], v[86:87]
    v_pk_mul_f32 v[40:41], v[40:41], v[88:89]
    v_pk_mul_f32 v[42:43], v[42:43], v[90:91]
    v_pk_mul_f32 v[44:45], v[44:45], v[92:93]
    v_pk_mul_f32 v[46:47], v[46:47], v[94:95]
    v_pk_add_f32 v[96:97], v[96:97], 1.0 op_sel_hi:[1,0]
    v_pk_add_f32 v[98:99], v[98:99], 1.0 op_sel_hi:[1,0]
    v_pk_add_f32 v[100:101], v[100:101], 1.0 op_sel_hi:[1,0]
    v_pk_add_f32 v[102:103], v[102:103], 1.0 op_sel_hi:[1,0]
    v_pk_add_f32 v[104:105], v[104:105], 1.0 op_sel_hi:[1,0]
    v_pk_add_f32 v[106:107], v[106:107], 1.0 op_sel_hi:[1,0]
    v_pk_add_f32 v[108:109], v[108:109], 1.0 op_sel_hi:[1,0]
    v_pk_add_f32 v[110:111], v[110:111], 1.0 op_sel_hi:[1,0]
    v_rcp_f32 v96, v96
    v_rcp_f32 v97, v97
    v_rcp_f32 v98, v98
    v_rcp_f32 v99, v99
    v_rcp_f32 v100, v100
    v_rcp_f32 v101, v101
    v_rcp_f32 v102, v102
    v_rcp_f32 v103, v103
    v_rcp_f32 v104, v104
    v_rcp_f32 v105, v105
    v_rcp_f32 v106, v106
    v_rcp_f32 v107, v107
    v_rcp_f32 v108, v108
    v_rcp_f32 v109, v109
    v_rcp_f32 v110, v110
    v_rcp_f32 v111, v111
    v_pk_mul_f32 v[32:33], v[32:33], v[96:97]
    v_pk_mul_f32 v[34:35], v[34:35], v[98:99]
    v_pk_mul_f32 v[36:37], v[36:37], v[100:101]
    v_pk_mul_f32 v[38:39], v[38:39], v[102:103]
    v_pk_mul_f32 v[40:41], v[40:41], v[104:105]
    v_pk_mul_f32 v[42:43], v[42:43], v[106:107]
    v_pk_mul_f32 v[44:45], v[44:45], v[108:109]
    v_pk_mul_f32 v[46:47], v[46:47], v[110:111]
    v_permlane16_swap_b32 v32, v36
    v_permlane16_swap_b32 v33, v37
    v_permlane16_swap_b32 v34, v38
    v_permlane16_swap_b32 v35, v39
    v_permlane16_swap_b32 v40, v44
    v_permlane16_swap_b32 v41, v45
    v_permlane16_swap_b32 v42, v46
    v_permlane16_swap_b32 v43, v47
    v_dot2c_f32_bf16 v32, s94, v248
    v_dot2c_f32_bf16 v33, s95, v248
    v_dot2c_f32_bf16 v34, s94, v249
    v_dot2c_f32_bf16 v35, s95, v249
    v_dot2c_f32_bf16 v36, s94, v250
    v_dot2c_f32_bf16 v37, s95, v250
    v_dot2c_f32_bf16 v38, s94, v251
    v_dot2c_f32_bf16 v39, s95, v251
    v_dot2c_f32_bf16 v40, s94, v252
    v_dot2c_f32_bf16 v41, s95, v252
    v_dot2c_f32_bf16 v42, s94, v253
    v_dot2c_f32_bf16 v43, s95, v253
    v_dot2c_f32_bf16 v44, s94, v254
    v_dot2c_f32_bf16 v45, s95, v254
    v_dot2c_f32_bf16 v46, s94, v255
    v_dot2c_f32_bf16 v47, s95, v255
    v_cvt_pk_bf16_f32 v248, v32, v33
    v_cvt_pk_bf16_f32 v249, v34, v35
    v_cvt_pk_bf16_f32 v250, v36, v37
    v_cvt_pk_bf16_f32 v251, v38, v39
    buffer_store_dwordx4 v[248:251], v30, s[36:39], s89 offen offset:0 sc1
    v_cvt_pk_bf16_f32 v252, v40, v41
    v_cvt_pk_bf16_f32 v253, v42, v43
    v_cvt_pk_bf16_f32 v254, v44, v45
    v_cvt_pk_bf16_f32 v255, v46, v47
    buffer_store_dwordx4 v[252:255], v30, s[36:39], s89 offen offset:64 sc1
dbl_e:
K1_end:
    s_endpgm
dbl:
    s_bfe_u32 s98, s57, 0x10001
    s_lshl_b32 s65, s98, 9
    s_sub_u32 s65, 640, s65
    s_add_u32 s87, s87, s65
    s_lshl_b32 s98, s98, 6
    s_add_u32 s65, s65, s98
    s_add_u32 s97, s89, s65
    s_lshl_b32 s65, s65, 7
    s_sub_u32 s96, s88, s65
    s_mov_b32 s90, 0xffff
    ds_read_b64_tr_b16 v[80:81], v9 offset:32768
    ds_read_b64_tr_b16 v[82:83], v9 offset:34816
    ds_read_b64_tr_b16 v[84:85], v10 offset:32768
    ds_read_b64_tr_b16 v[86:87], v10 offset:34816
    ds_read_b64_tr_b16 v[88:89], v11 offset:32768
    ds_read_b64_tr_b16 v[90:91], v11 offset:34816
    ds_read_b64_tr_b16 v[92:93], v12 offset:32768
    ds_read_b64_tr_b16 v[94:95], v12 offset:34816
    ds_read_b64_tr_b16 v[96:97], v9 offset:36864
    ds_read_b64_tr_b16 v[98:99], v9 offset:38912
    ds_read_b64_tr_b16 v[100:101], v10 offset:36864
    ds_read_b64_tr_b16 v[102:103], v10 offset:38912
    ds_read_b64_tr_b16 v[104:105], v11 offset:36864
    ds_read_b64_tr_b16 v[106:107], v11 offset:38912
    s_waitcnt lgkmcnt(10)
    v_mfma_f32_16x16x32_bf16 v[32:35], v[80:83], a[160:163], 0
    ds_read_b64_tr_b16 v[108:109], v12 offset:36864
    ds_read_b64_tr_b16 v[110:111], v12 offset:38912
    s_sub_u32 s68, s82, 49152
    v_cvt_pk_bf16_f32 v208, v208, v209
    v_mfma_f32_16x16x32_bf16 v[36:39], v[84:87], a[160:163], 0
    ds_read_b64_tr_b16 v[80:81], v9 offset:40960
    ds_read_b64_tr_b16 v[82:83], v9 offset:43008
    v_cvt_pk_bf16_f32 v209, v210, v211
    v_cvt_pk_bf16_f32 v210, v224, v225
    s_waitcnt lgkmcnt(10)
    v_mfma_f32_16x16x32_bf16 v[40:43], v[88:91], a[160:163], 0
    ds_read_b64_tr_b16 v[84:85], v10 offset:40960
    ds_read_b64_tr_b16 v[86:87], v10 offset:43008
    v_cvt_pk_bf16_f32 v211, v226, v227
    buffer_store_dwordx4 v[208:211], v2, s[44:47], s68 offen offset:0 sc1
    v_mfma_f32_16x16x32_bf16 v[44:47], v[92:95], a[160:163], 0
    ds_read_b64_tr_b16 v[88:89], v11 offset:40960
    ds_read_b64_tr_b16 v[90:91], v11 offset:43008
    v_cvt_pk_bf16_f32 v212, v212, v213
    v_cvt_pk_bf16_f32 v213, v214, v215
    s_waitcnt lgkmcnt(10)
    v_mfma_f32_16x16x32_bf16 v[32:35], v[96:99], a[164:167], v[32:35]
    ds_read_b64_tr_b16 v[92:93], v12 offset:40960
    ds_read_b64_tr_b16 v[94:95], v12 offset:43008
    v_cvt_pk_bf16_f32 v214, v228, v229
    v_cvt_pk_bf16_f32 v215, v230, v231
    v_mfma_f32_16x16x32_bf16 v[36:39], v[100:103], a[164:167], v[36:39]
    ds_read_b64_tr_b16 v[96:97], v9 offset:45056
    ds_read_b64_tr_b16 v[98:99], v9 offset:47104
    buffer_store_dwordx4 v[212:215], v2, s[44:47], s68 offen offset:1024 sc1
    s_xor_b32 s68, s68, 2048
    s_waitcnt lgkmcnt(10)
    v_mfma_f32_16x16x32_bf16 v[40:43], v[104:107], a[164:167], v[40:43]
    ds_read_b64_tr_b16 v[100:101], v10 offset:45056
    ds_read_b64_tr_b16 v[102:103], v10 offset:47104
    v_cvt_pk_bf16_f32 v216, v216, v217
    v_cvt_pk_bf16_f32 v217, v218, v219
    v_mfma_f32_16x16x32_bf16 v[44:47], v[108:111], a[164:167], v[44:47]
    ds_read_b64_tr_b16 v[104:105], v11 offset:45056
    ds_read_b64_tr_b16 v[106:107], v11 offset:47104
    v_cvt_pk_bf16_f32 v218, v232, v233
    v_cvt_pk_bf16_f32 v219, v234, v235
    s_waitcnt lgkmcnt(10)
    v_mfma_f32_16x16x32_bf16 v[32:35], v[80:83], a[168:171], v[32:35]
    ds_read_b64_tr_b16 v[108:109], v12 offset:45056
    ds_read_b64_tr_b16 v[110:111], v12 offset:47104
    buffer_store_dwordx4 v[216:219], v2, s[44:47], s68 offen offset:0 sc1
    v_cvt_pk_bf16_f32 v220, v220, v221
    v_mfma_f32_16x16x32_bf16 v[36:39], v[84:87], a[168:171], v[36:39]
    ds_read_b64_tr_b16 v[80:81], v9 offset:49152
    ds_read_b64_tr_b16 v[82:83], v9 offset:51200
    v_cvt_pk_bf16_f32 v221, v222, v223
    v_cvt_pk_bf16_f32 v222, v236, v237
    s_waitcnt lgkmcnt(10)
    v_mfma_f32_16x16x32_bf16 v[40:43], v[88:91], a[168:171], v[40:43]
    ds_read_b64_tr_b16 v[84:85], v10 offset:49152
    ds_read_b64_tr_b16 v[86:87], v10 offset:51200
    v_cvt_pk_bf16_f32 v223, v238, v239
    buffer_store_dwordx4 v[220:223], v2, s[44:47], s68 offen offset:1024 sc1
    v_mfma_f32_16x16x32_bf16 v[44:47], v[92:95], a[168:171], v[44:47]
    ds_read_b64_tr_b16 v[88:89], v11 offset:49152
    ds_read_b64_tr_b16 v[90:91], v11 offset:51200
    buffer_load_dwordx4 v[248:251], v30, s[24:27], s89 offen offset:0
    buffer_load_dwordx4 v[252:255], v30, s[24:27], s89 offen offset:64
    s_waitcnt lgkmcnt(10)
    v_mfma_f32_16x16x32_bf16 v[32:35], v[96:99], a[172:175], v[32:35]
    ds_read_b64_tr_b16 v[92:93], v12 offset:49152
    ds_read_b64_tr_b16 v[94:95], v12 offset:51200
    s_add_u32 s67, s87, 0
    s_add_u32 m0, s70, 0
    s_nop 0
    buffer_load_dwordx4 v3, s[32:35], s67 offen offset:0 lds
    v_mfma_f32_16x16x32_bf16 v[36:39], v[100:103], a[172:175], v[36:39]
    ds_read_b64_tr_b16 v[96:97], v9 offset:53248
    ds_read_b64_tr_b16 v[98:99], v9 offset:55296
    s_waitcnt lgkmcnt(10)
    v_mfma_f32_16x16x32_bf16 v[40:43], v[104:107], a[172:175], v[40:43]
    ds_read_b64_tr_b16 v[100:101], v10 offset:53248
    ds_read_b64_tr_b16 v[102:103], v10 offset:55296
    v_mfma_f32_16x16x32_bf16 v[44:47], v[108:111], a[172:175], v[44:47]
    ds_read_b64_tr_b16 v[104:105], v11 offset:53248
    ds_read_b64_tr_b16 v[106:107], v11 offset:55296
    buffer_load_dwordx4 v4, s[32:35], s67 offen offset:1024 lds
    s_waitcnt lgkmcnt(10)
    v_mfma_f32_16x16x32_bf16 v[32:35], v[80:83], a[176:179], v[32:35]
    ds_read_b64_tr_b16 v[108:109], v12 offset:53248
    ds_read_b64_tr_b16 v[110:111], v12 offset:55296
    v_mfma_f32_16x16x32_bf16 v[36:39], v[84:87], a[176:179], v[36:39]
    ds_read_b64_tr_b16 v[80:81], v9 offset:57344
    ds_read_b64_tr_b16 v[82:83], v9 offset:59392
    s_waitcnt lgkmcnt(10)
    v_mfma_f32_16x16x32_bf16 v[40:43], v[88:91], a[176:179], v[40:43]
    ds_read_b64_tr_b16 v[84:85], v10 offset:57344
    ds_read_b64_tr_b16 v[86:87], v10 offset:59392
    buffer_load_dwordx4 v5, s[32:35], s67 offen offset:2048 lds
    v_mfma_f32_16x16x32_bf16 v[44:47], v[92:95], a[176:179], v[44:47]
    ds_read_b64_tr_b16 v[88:89], v11 offset:57344
    ds_read_b64_tr_b16 v[90:91], v11 offset:59392
    s_waitcnt lgkmcnt(10)
    v_mfma_f32_16x16x32_bf16 v[32:35], v[96:99], a[180:183], v[32:35]
    ds_read_b64_tr_b16 v[92:93], v12 offset:57344
    ds_read_b64_tr_b16 v[94:95], v12 offset:59392
    v_mfma_f32_16x16x32_bf16 v[36:39], v[100:103], a[180:183], v[36:39]
    ds_read_b64_tr_b16 v[96:97], v9 offset:61440
    ds_read_b64_tr_b16 v[98:99], v9 offset:63488
    buffer_load_dwordx4 v6, s[32:35], s67 offen offset:3072 lds
    s_waitcnt lgkmcnt(10)
    v_mfma_f32_16x16x32_bf16 v[40:43], v[104:107], a[180:183], v[40:43]
    ds_read_b64_tr_b16 v[100:101], v10 offset:61440
    ds_read_b64_tr_b16 v[102:103], v10 offset:63488
    v_mfma_f32_16x16x32_bf16 v[44:47], v[108:111], a[180:183], v[44:47]
    ds_read_b64_tr_b16 v[104:105], v11 offset:61440
    ds_read_b64_tr_b16 v[106:107], v11 offset:63488
    s_waitcnt lgkmcnt(10)
    v_mfma_f32_16x16x32_bf16 v[32:35], v[80:83], a[184:187], v[32:35]
    ds_read_b64_tr_b16 v[108:109], v12 offset:61440
    ds_read_b64_tr_b16 v[110:111], v12 offset:63488
    s_add_u32 s67, s87, 165888
    s_add_u32 m0, s70, 16384
    s_nop 0
    buffer_load_dwordx4 v3, s[32:35], s67 offen offset:0 lds
    v_mfma_f32_16x16x32_bf16 v[36:39], v[84:87], a[184:187], v[36:39]
    v_add_u32 v9, 0x10000, v9
    v_add_u32 v10, 0x10000, v10
    v_add_u32 v11, 0x10000, v11
    v_add_u32 v12, 0x10000, v12
    ds_read_b64_tr_b16 v[80:81], v9 offset:49152
    ds_read_b64_tr_b16 v[82:83], v9 offset:51200
    s_waitcnt lgkmcnt(10)
    v_mfma_f32_16x16x32_bf16 v[40:43], v[88:91], a[184:187], v[40:43]
    ds_read_b64_tr_b16 v[84:85], v10 offset:49152
    ds_read_b64_tr_b16 v[86:87], v10 offset:51200
    v_mfma_f32_16x16x32_bf16 v[44:47], v[92:95], a[184:187], v[44:47]
    ds_read_b64_tr_b16 v[88:89], v11 offset:49152
    ds_read_b64_tr_b16 v[90:91], v11 offset:51200
    buffer_load_dwordx4 v4, s[32:35], s67 offen offset:1024 lds
    s_waitcnt lgkmcnt(10)
    v_mfma_f32_16x16x32_bf16 v[32:35], v[96:99], a[188:191], v[32:35]
    ds_read_b64_tr_b16 v[92:93], v12 offset:49152
    ds_read_b64_tr_b16 v[94:95], v12 offset:51200
    s_waitcnt vmcnt(8)
    s_barrier
    v_mov_b32 v27, 7
    buffer_store_dword v27, v29, s[44:47], s6 offen sc1
    v_mfma_f32_16x16x32_bf16 v[36:39], v[100:103], a[188:191], v[36:39]
    ds_read_b64_tr_b16 v[96:97], v9 offset:53248
    ds_read_b64_tr_b16 v[98:99], v9 offset:55296
    s_waitcnt lgkmcnt(10)
    v_mfma_f32_16x16x32_bf16 v[40:43], v[104:107], a[188:191], v[40:43]
    ds_read_b64_tr_b16 v[100:101], v10 offset:53248
    ds_read_b64_tr_b16 v[102:103], v10 offset:55296
    buffer_load_dwordx4 v5, s[32:35], s67 offen offset:2048 lds
    v_mfma_f32_16x16x32_bf16 v[44:47], v[108:111], a[188:191], v[44:47]
    ds_read_b64_tr_b16 v[104:105], v11 offset:53248
    ds_read_b64_tr_b16 v[106:107], v11 offset:55296
    s_waitcnt lgkmcnt(10)
    v_mfma_f32_16x16x32_bf16 v[32:35], v[80:83], a[192:195], v[32:35]
    ds_read_b64_tr_b16 v[108:109], v12 offset:53248
    ds_read_b64_tr_b16 v[110:111], v12 offset:55296
    v_mfma_f32_16x16x32_bf16 v[36:39], v[84:87], a[192:195], v[36:39]
    ds_read_b64_tr_b16 v[80:81], v9 offset:57344
    ds_read_b64_tr_b16 v[82:83], v9 offset:59392
    buffer_load_dwordx4 v6, s[32:35], s67 offen offset:3072 lds
    s_waitcnt lgkmcnt(10)
    v_mfma_f32_16x16x32_bf16 v[40:43], v[88:91], a[192:195], v[40:43]
    ds_read_b64_tr_b16 v[84:85], v10 offset:57344
    ds_read_b64_tr_b16 v[86:87], v10 offset:59392
    v_mfma_f32_16x16x32_bf16 v[44:47], v[92:95], a[192:195], v[44:47]
    ds_read_b64_tr_b16 v[88:89], v11 offset:57344
    ds_read_b64_tr_b16 v[90:91], v11 offset:59392
    s_waitcnt lgkmcnt(10)
    v_mfma_f32_16x16x32_bf16 v[32:35], v[96:99], a[196:199], v[32:35]
    ds_read_b64_tr_b16 v[92:93], v12 offset:57344
    ds_read_b64_tr_b16 v[94:95], v12 offset:59392
    s_add_u32 s67, s87, 331776
    s_add_u32 m0, s70, 65536
    s_nop 0
    buffer_load_dwordx4 v3, s[32:35], s67 offen offset:0 lds
    v_mfma_f32_16x16x32_bf16 v[36:39], v[100:103], a[196:199], v[36:39]
    ds_read_b64_tr_b16 v[96:97], v9 offset:61440
    ds_read_b64_tr_b16 v[98:99], v9 offset:63488
    s_waitcnt lgkmcnt(10)
    v_mfma_f32_16x16x32_bf16 v[40:43], v[104:107], a[196:199], v[40:43]
    ds_read_b64_tr_b16 v[100:101], v10 offset:61440
    ds_read_b64_tr_b16 v[102:103], v10 offset:63488
    v_mfma_f32_16x16x32_bf16 v[44:47], v[108:111], a[196:199], v[44:47]
    ds_read_b64_tr_b16 v[104:105], v11 offset:61440
    ds_read_b64_tr_b16 v[106:107], v11 offset:63488
    buffer_load_dwordx4 v4, s[32:35], s67 offen offset:1024 lds
    s_waitcnt lgkmcnt(10)
    v_mfma_f32_16x16x32_bf16 v[32:35], v[80:83], a[200:203], v[32:35]
    ds_read_b64_tr_b16 v[108:109], v12 offset:61440
    ds_read_b64_tr_b16 v[110:111], v12 offset:63488
    v_mfma_f32_16x16x32_bf16 v[36:39], v[84:87], a[200:203], v[36:39]
    ds_read_b64_tr_b16 v[80:81], v9 offset:16384
    ds_read_b64_tr_b16 v[82:83], v9 offset:18432
    s_waitcnt lgkmcnt(10)
    v_mfma_f32_16x16x32_bf16 v[40:43], v[88:91], a[200:203], v[40:43]
    ds_read_b64_tr_b16 v[84:85], v10 offset:16384
    ds_read_b64_tr_b16 v[86:87], v10 offset:18432
    buffer_load_dword v26, v13, s[44:47], s93 offen sc1
    v_mfma_f32_16x16x32_bf16 v[44:47], v[92:95], a[200:203], v[44:47]
    ds_read_b64_tr_b16 v[88:89], v11 offset:16384
    ds_read_b64_tr_b16 v[90:91], v11 offset:18432
    s_waitcnt lgkmcnt(10)
    v_mfma_f32_16x16x32_bf16 v[32:35], v[96:99], a[204:207], v[32:35]
    ds_read_b64_tr_b16 v[92:93], v12 offset:16384
    ds_read_b64_tr_b16 v[94:95], v12 offset:18432
    v_mfma_f32_16x16x32_bf16 v[36:39], v[100:103], a[204:207], v[36:39]
    ds_read_b64_tr_b16 v[96:97], v9 offset:20480
    ds_read_b64_tr_b16 v[98:99], v9 offset:22528
    buffer_load_dwordx4 v5, s[32:35], s67 offen offset:2048 lds
    s_waitcnt lgkmcnt(10)
    v_mfma_f32_16x16x32_bf16 v[40:43], v[104:107], a[204:207], v[40:43]
    ds_read_b64_tr_b16 v[100:101], v10 offset:20480
    ds_read_b64_tr_b16 v[102:103], v10 offset:22528
    v_mfma_f32_16x16x32_bf16 v[44:47], v[108:111], a[204:207], v[44:47]
    ds_read_b64_tr_b16 v[104:105], v11 offset:20480
    ds_read_b64_tr_b16 v[106:107], v11 offset:22528
    s_waitcnt lgkmcnt(10)
    v_mfma_f32_16x16x32_bf16 v[32:35], v[80:83], a[208:211], v[32:35]
    ds_read_b64_tr_b16 v[108:109], v12 offset:20480
    ds_read_b64_tr_b16 v[110:111], v12 offset:22528
    buffer_load_dwordx4 v6, s[32:35], s67 offen offset:3072 lds
    v_mfma_f32_16x16x32_bf16 v[36:39], v[84:87], a[208:211], v[36:39]
    ds_read_b64_tr_b16 v[80:81], v9 offset:24576
    ds_read_b64_tr_b16 v[82:83], v9 offset:26624
    s_waitcnt lgkmcnt(10)
    v_mfma_f32_16x16x32_bf16 v[40:43], v[88:91], a[208:211], v[40:43]
    ds_read_b64_tr_b16 v[84:85], v10 offset:24576
    ds_read_b64_tr_b16 v[86:87], v10 offset:26624
    v_mfma_f32_16x16x32_bf16 v[44:47], v[92:95], a[208:211], v[44:47]
    ds_read_b64_tr_b16 v[88:89], v11 offset:24576
    ds_read_b64_tr_b16 v[90:91], v11 offset:26624
    s_add_u32 s67, s87, 497664
    s_add_u32 m0, s70, 98304
    s_nop 0
    buffer_load_dwordx4 v3, s[32:35], s67 offen offset:0 lds
    s_waitcnt lgkmcnt(10)
    v_mfma_f32_16x16x32_bf16 v[32:35], v[96:99], a[212:215], v[32:35]
    ds_read_b64_tr_b16 v[92:93], v12 offset:24576
    ds_read_b64_tr_b16 v[94:95], v12 offset:26624
    v_mfma_f32_16x16x32_bf16 v[36:39], v[100:103], a[212:215], v[36:39]
    ds_read_b64_tr_b16 v[96:97], v9 offset:28672
    ds_read_b64_tr_b16 v[98:99], v9 offset:30720
    s_waitcnt lgkmcnt(10)
    v_mfma_f32_16x16x32_bf16 v[40:43], v[104:107], a[212:215], v[40:43]
    ds_read_b64_tr_b16 v[100:101], v10 offset:28672
    ds_read_b64_tr_b16 v[102:103], v10 offset:30720
    buffer_load_dwordx4 v4, s[32:35], s67 offen offset:1024 lds
    v_mfma_f32_16x16x32_bf16 v[44:47], v[108:111], a[212:215], v[44:47]
    ds_read_b64_tr_b16 v[104:105], v11 offset:28672
    ds_read_b64_tr_b16 v[106:107], v11 offset:30720
    s_waitcnt lgkmcnt(10)
    v_mfma_f32_16x16x32_bf16 v[32:35], v[80:83], a[216:219], v[32:35]
    ds_read_b64_tr_b16 v[108:109], v12 offset:28672
    ds_read_b64_tr_b16 v[110:111], v12 offset:30720
    v_mfma_f32_16x16x32_bf16 v[36:39], v[84:87], a[216:219], v[36:39]
    v_add_u32 v9, 0x10000, v9
    v_add_u32 v10, 0x10000, v10
    v_add_u32 v11, 0x10000, v11
    v_add_u32 v12, 0x10000, v12
    ds_read_b64_tr_b16 v[80:81], v9 offset:0
    ds_read_b64_tr_b16 v[82:83], v9 offset:2048
    buffer_load_dwordx4 v5, s[32:35], s67 offen offset:2048 lds
    s_waitcnt lgkmcnt(10)
    v_mfma_f32_16x16x32_bf16 v[40:43], v[88:91], a[216:219], v[40:43]
    ds_read_b64_tr_b16 v[84:85], v10 offset:0
    ds_read_b64_tr_b16 v[86:87], v10 offset:2048
    v_mfma_f32_16x16x32_bf16 v[44:47], v[92:95], a[216:219], v[44:47]
    ds_read_b64_tr_b16 v[88:89], v11 offset:0
    ds_read_b64_tr_b16 v[90:91], v11 offset:2048
    s_waitcnt lgkmcnt(10)
    v_mfma_f32_16x16x32_bf16 v[32:35], v[96:99], a[220:223], v[32:35]
    ds_read_b64_tr_b16 v[92:93], v12 offset:0
    ds_read_b64_tr_b16 v[94:95], v12 offset:2048
    buffer_load_dwordx4 v6, s[32:35], s67 offen offset:3072 lds
    v_mfma_f32_16x16x32_bf16 v[36:39], v[100:103], a[220:223], v[36:39]
    ds_read_b64_tr_b16 v[96:97], v9 offset:4096
    ds_read_b64_tr_b16 v[98:99], v9 offset:6144
    s_waitcnt lgkmcnt(10)
    v_mfma_f32_16x16x32_bf16 v[40:43], v[104:107], a[220:223], v[40:43]
    ds_read_b64_tr_b16 v[100:101], v10 offset:4096
    ds_read_b64_tr_b16 v[102:103], v10 offset:6144
    v_mfma_f32_16x16x32_bf16 v[44:47], v[108:111], a[220:223], v[44:47]
    ds_read_b64_tr_b16 v[104:105], v11 offset:4096
    ds_read_b64_tr_b16 v[106:107], v11 offset:6144
    s_mul_i32 s67, s58, 124416
    s_add_u32 s67, s67, s87
    s_lshr_b32 m0, s70, 1
    s_add_u32 m0, m0, 147456
    s_nop 0
    buffer_load_dwordx4 v8, s[32:35], s67 offen lds
    s_waitcnt lgkmcnt(10)
    v_mfma_f32_16x16x32_bf16 v[32:35], v[80:83], a[224:227], v[32:35]
    ds_read_b64_tr_b16 v[108:109], v12 offset:4096
    ds_read_b64_tr_b16 v[110:111], v12 offset:6144
    v_mfma_f32_16x16x32_bf16 v[36:39], v[84:87], a[224:227], v[36:39]
    s_waitcnt lgkmcnt(8)
    v_mfma_f32_16x16x32_bf16 v[40:43], v[88:91], a[224:227], v[40:43]
    s_add_u32 s67, s67, 81920
    buffer_load_dwordx4 v8, s[32:35], s67 offen offset:1024 lds
    v_mfma_f32_16x16x32_bf16 v[44:47], v[92:95], a[224:227], v[44:47]
    s_waitcnt lgkmcnt(4)
    v_mfma_f32_16x16x32_bf16 v[32:35], v[96:99], a[228:231], v[32:35]
    v_mfma_f32_16x16x32_bf16 v[36:39], v[100:103], a[228:231], v[36:39]
    buffer_load_dwordx4 v[240:243], v30, s[24:27], s97 offen
    s_waitcnt lgkmcnt(0)
    v_mfma_f32_16x16x32_bf16 v[40:43], v[104:107], a[228:231], v[40:43]
    v_mfma_f32_16x16x32_bf16 v[44:47], v[108:111], a[228:231], v[44:47]
    v_add_u32 v9, 0xfffe0000, v9
    v_add_u32 v10, 0xfffe0000, v10
    v_add_u32 v11, 0xfffe0000, v11
    v_add_u32 v12, 0xfffe0000, v12
    s_waitcnt vmcnt(9)
    v_cmp_le_u32 vcc, s91, v26
    s_nop 1
    s_and_b32 s65, vcc_lo, s90
    s_cmp_eq_u32 s65, s90
    s_cbranch_scc0 d5_slow
d5_ok:
    s_add_u32 s66, s88, 0x22000
    buffer_load_dwordx4 v[112:115], v2, s[44:47], s66 offen sc1
    s_add_u32 s66, s88, 0x20000
    buffer_load_dwordx4 v[116:119], v2, s[44:47], s66 offen sc1
    s_add_u32 s66, s88, 0x46000
    buffer_load_dwordx4 v[120:123], v2, s[44:47], s66 offen sc1
    s_add_u32 s66, s88, 0x44000
    buffer_load_dwordx4 v[124:127], v2, s[44:47], s66 offen sc1
    s_waitcnt vmcnt(5)
    s_barrier
    v_xor_b32 v9, s98, v9
    v_xor_b32 v10, s98, v10
    ds_read_b64_tr_b16 v[80:81], v9 offset:0
    ds_read_b64_tr_b16 v[82:83], v9 offset:2048
    ds_read_b64_tr_b16 v[84:85], v10 offset:0
    ds_read_b64_tr_b16 v[86:87], v10 offset:2048
    ds_read_b64_tr_b16 v[88:89], v9 offset:4096
    ds_read_b64_tr_b16 v[90:91], v9 offset:6144
    ds_read_b64_tr_b16 v[92:93], v10 offset:4096
    ds_read_b64_tr_b16 v[94:95], v10 offset:6144
    ds_read_b64_tr_b16 v[96:97], v9 offset:8192
    ds_read_b64_tr_b16 v[98:99], v9 offset:10240
    ds_read_b64_tr_b16 v[100:101], v10 offset:8192
    ds_read_b64_tr_b16 v[102:103], v10 offset:10240
    ds_read_b64_tr_b16 v[104:105], v9 offset:12288
    ds_read_b64_tr_b16 v[106:107], v9 offset:14336
    s_waitcnt lgkmcnt(10)
    v_mfma_f32_16x16x32_bf16 v[48:51], v[80:83], a[160:163], 0
    ds_read_b64_tr_b16 v[108:109], v10 offset:12288
    ds_read_b64_tr_b16 v[110:111], v10 offset:14336
    s_add_u32 s66, s88, 0x6a000
    buffer_load_dwordx4 v[128:131], v2, s[44:47], s66 offen sc1
    v_mfma_f32_16x16x32_bf16 v[52:55], v[84:87], a[160:163], 0
    ds_read_b64_tr_b16 v[80:81], v9 offset:16384
    ds_read_b64_tr_b16 v[82:83], v9 offset:18432
    s_waitcnt lgkmcnt(10)
    v_mfma_f32_16x16x32_bf16 v[48:51], v[88:91], a[164:167], v[48:51]
    ds_read_b64_tr_b16 v[84:85], v10 offset:16384
    ds_read_b64_tr_b16 v[86:87], v10 offset:18432
    s_add_u32 s66, s88, 0x68000
    buffer_load_dwordx4 v[132:135], v2, s[44:47], s66 offen sc1
    v_mfma_f32_16x16x32_bf16 v[52:55], v[92:95], a[164:167], v[52:55]
    ds_read_b64_tr_b16 v[88:89], v9 offset:20480
    ds_read_b64_tr_b16 v[90:91], v9 offset:22528
    s_waitcnt lgkmcnt(10)
    v_mfma_f32_16x16x32_bf16 v[48:51], v[96:99], a[168:171], v[48:51]
    ds_read_b64_tr_b16 v[92:93], v10 offset:20480
    ds_read_b64_tr_b16 v[94:95], v10 offset:22528
    s_add_u32 s66, s88, 0x8e000
    buffer_load_dwordx4 v[136:139], v2, s[44:47], s66 offen sc1
    v_mfma_f32_16x16x32_bf16 v[52:55], v[100:103], a[168:171], v[52:55]
    ds_read_b64_tr_b16 v[96:97], v9 offset:24576
    ds_read_b64_tr_b16 v[98:99], v9 offset:26624
    s_waitcnt lgkmcnt(10)
    v_mfma_f32_16x16x32_bf16 v[48:51], v[104:107], a[172:175], v[48:51]
    ds_read_b64_tr_b16 v[100:101], v10 offset:24576
    ds_read_b64_tr_b16 v[102:103], v10 offset:26624
    s_add_u32 s66, s88, 0x8c000
    buffer_load_dwordx4 v[140:143], v2, s[44:47], s66 offen sc1
    v_mfma_f32_16x16x32_bf16 v[52:55], v[108:111], a[172:175], v[52:55]
    ds_read_b64_tr_b16 v[104:105], v9 offset:28672
    ds_read_b64_tr_b16 v[106:107], v9 offset:30720
    s_waitcnt lgkmcnt(10)
    v_mfma_f32_16x16x32_bf16 v[48:51], v[80:83], a[176:179], v[48:51]
    ds_read_b64_tr_b16 v[108:109], v10 offset:28672
    ds_read_b64_tr_b16 v[110:111], v10 offset:30720
    s_add_u32 s66, s88, 0xb2000
    buffer_load_dwordx4 v[144:147], v2, s[44:47], s66 offen sc1
    v_mfma_f32_16x16x32_bf16 v[52:55], v[84:87], a[176:179], v[52:55]
    v_add_u32 v9, 0x10000, v9
    v_add_u32 v10, 0x10000, v10
    v_add_u32 v11, 0x10000, v11
    v_add_u32 v12, 0x10000, v12
    ds_read_b64_tr_b16 v[80:81], v9 offset:0
    ds_read_b64_tr_b16 v[82:83], v9 offset:2048
    s_waitcnt lgkmcnt(10)
    v_mfma_f32_16x16x32_bf16 v[48:51], v[88:91], a[180:183], v[48:51]
    ds_read_b64_tr_b16 v[84:85], v10 offset:0
    ds_read_b64_tr_b16 v[86:87], v10 offset:2048
    s_add_u32 s66, s88, 0xb0000
    buffer_load_dwordx4 v[148:151], v2, s[44:47], s66 offen sc1
    v_mfma_f32_16x16x32_bf16 v[52:55], v[92:95], a[180:183], v[52:55]
    ds_read_b64_tr_b16 v[88:89], v9 offset:4096
    ds_read_b64_tr_b16 v[90:91], v9 offset:6144
    s_waitcnt lgkmcnt(10)
    v_mfma_f32_16x16x32_bf16 v[48:51], v[96:99], a[184:187], v[48:51]
    ds_read_b64_tr_b16 v[92:93], v10 offset:4096
    ds_read_b64_tr_b16 v[94:95], v10 offset:6144
    s_add_u32 s66, s88, 0xd6000
    buffer_load_dwordx4 v[152:155], v2, s[44:47], s66 offen sc1
    v_mfma_f32_16x16x32_bf16 v[52:55], v[100:103], a[184:187], v[52:55]
    ds_read_b64_tr_b16 v[96:97], v9 offset:8192
    ds_read_b64_tr_b16 v[98:99], v9 offset:10240
    s_waitcnt lgkmcnt(10)
    v_mfma_f32_16x16x32_bf16 v[48:51], v[104:107], a[188:191], v[48:51]
    ds_read_b64_tr_b16 v[100:101], v10 offset:8192
    ds_read_b64_tr_b16 v[102:103], v10 offset:10240
    s_add_u32 s66, s88, 0xd4000
    buffer_load_dwordx4 v[156:159], v2, s[44:47], s66 offen sc1
    v_mfma_f32_16x16x32_bf16 v[52:55], v[108:111], a[188:191], v[52:55]
    ds_read_b64_tr_b16 v[104:105], v9 offset:12288
    ds_read_b64_tr_b16 v[106:107], v9 offset:14336
    s_waitcnt lgkmcnt(10)
    v_mfma_f32_16x16x32_bf16 v[48:51], v[80:83], a[192:195], v[48:51]
    ds_read_b64_tr_b16 v[108:109], v10 offset:12288
    ds_read_b64_tr_b16 v[110:111], v10 offset:14336
    s_add_u32 s66, s88, 0xfa000
    buffer_load_dwordx4 v[160:163], v2, s[44:47], s66 offen sc1
    v_mfma_f32_16x16x32_bf16 v[52:55], v[84:87], a[192:195], v[52:55]
    ds_read_b64_tr_b16 v[80:81], v9 offset:32768
    ds_read_b64_tr_b16 v[82:83], v9 offset:34816
    s_waitcnt lgkmcnt(10)
    v_mfma_f32_16x16x32_bf16 v[48:51], v[88:91], a[196:199], v[48:51]
    ds_read_b64_tr_b16 v[84:85], v10 offset:32768
    ds_read_b64_tr_b16 v[86:87], v10 offset:34816
    s_add_u32 s66, s88, 0xf8000
    buffer_load_dwordx4 v[164:167], v2, s[44:47], s66 offen sc1
    v_mfma_f32_16x16x32_bf16 v[52:55], v[92:95], a[196:199], v[52:55]
    ds_read_b64_tr_b16 v[88:89], v9 offset:36864
    ds_read_b64_tr_b16 v[90:91], v9 offset:38912
    s_waitcnt lgkmcnt(10)
    v_mfma_f32_16x16x32_bf16 v[48:51], v[96:99], a[200:203], v[48:51]
    ds_read_b64_tr_b16 v[92:93], v10 offset:36864
    ds_read_b64_tr_b16 v[94:95], v10 offset:38912
    s_add_u32 s66, s88, 0x11e000
    buffer_load_dwordx4 v[168:171], v2, s[44:47], s66 offen sc1
    v_mfma_f32_16x16x32_bf16 v[52:55], v[100:103], a[200:203], v[52:55]
    ds_read_b64_tr_b16 v[96:97], v9 offset:40960
    ds_read_b64_tr_b16 v[98:99], v9 offset:43008
    s_waitcnt lgkmcnt(10)
    v_mfma_f32_16x16x32_bf16 v[48:51], v[104:107], a[204:207], v[48:51]
    ds_read_b64_tr_b16 v[100:101], v10 offset:40960
    ds_read_b64_tr_b16 v[102:103], v10 offset:43008
    s_add_u32 s66, s88, 0x11c000
    buffer_load_dwordx4 v[172:175], v2, s[44:47], s66 offen sc1
    v_mfma_f32_16x16x32_bf16 v[52:55], v[108:111], a[204:207], v[52:55]
    ds_read_b64_tr_b16 v[104:105], v9 offset:45056
    ds_read_b64_tr_b16 v[106:107], v9 offset:47104
    s_waitcnt lgkmcnt(10)
    v_mfma_f32_16x16x32_bf16 v[48:51], v[80:83], a[208:211], v[48:51]
    ds_read_b64_tr_b16 v[108:109], v10 offset:45056
    ds_read_b64_tr_b16 v[110:111], v10 offset:47104
    s_add_u32 s66, s96, 0x22000
    buffer_load_dwordx4 v[176:179], v2, s[44:47], s66 offen sc1
    v_mfma_f32_16x16x32_bf16 v[52:55], v[84:87], a[208:211], v[52:55]
    v_add_u32 v9, 0x10000, v9
    v_add_u32 v10, 0x10000, v10
    v_add_u32 v11, 0x10000, v11
    v_add_u32 v12, 0x10000, v12
    ds_read_b64_tr_b16 v[80:81], v9 offset:16384
    ds_read_b64_tr_b16 v[82:83], v9 offset:18432
    s_waitcnt lgkmcnt(10)
    v_mfma_f32_16x16x32_bf16 v[48:51], v[88:91], a[212:215], v[48:51]
    ds_read_b64_tr_b16 v[84:85], v10 offset:16384
    ds_read_b64_tr_b16 v[86:87], v10 offset:18432
    s_add_u32 s66, s96, 0x46000
    buffer_load_dwordx4 v[184:187], v2, s[44:47], s66 offen sc1
    v_mfma_f32_16x16x32_bf16 v[52:55], v[92:95], a[212:215], v[52:55]
    ds_read_b64_tr_b16 v[88:89], v9 offset:20480
    ds_read_b64_tr_b16 v[90:91], v9 offset:22528
    s_waitcnt lgkmcnt(10)
    v_mfma_f32_16x16x32_bf16 v[48:51], v[96:99], a[216:219], v[48:51]
    ds_read_b64_tr_b16 v[92:93], v10 offset:20480
    ds_read_b64_tr_b16 v[94:95], v10 offset:22528
    s_add_u32 s66, s96, 0x6a000
    buffer_load_dwordx4 v[192:195], v2, s[44:47], s66 offen sc1
    v_mfma_f32_16x16x32_bf16 v[52:55], v[100:103], a[216:219], v[52:55]
    s_waitcnt lgkmcnt(8)
    v_mfma_f32_16x16x32_bf16 v[48:51], v[104:107], a[220:223], v[48:51]
    s_add_u32 s66, s96, 0x8e000
    buffer_load_dwordx4 v[200:203], v2, s[44:47], s66 offen sc1
    v_mfma_f32_16x16x32_bf16 v[52:55], v[108:111], a[220:223], v[52:55]
    s_waitcnt lgkmcnt(4)
    v_mfma_f32_16x16x32_bf16 v[48:51], v[80:83], a[224:227], v[48:51]
    s_add_u32 s66, s96, 0xb2000
    buffer_load_dwordx4 v[208:211], v2, s[44:47], s66 offen sc1
    v_mfma_f32_16x16x32_bf16 v[52:55], v[84:87], a[224:227], v[52:55]
    s_waitcnt lgkmcnt(0)
    v_mfma_f32_16x16x32_bf16 v[48:51], v[88:91], a[228:231], v[48:51]
    s_add_u32 s66, s96, 0xd6000
    buffer_load_dwordx4 v[216:219], v2, s[44:47], s66 offen sc1
    v_mfma_f32_16x16x32_bf16 v[52:55], v[92:95], a[228:231], v[52:55]
    v_add_u32 v9, 0xfffe0000, v9
    v_add_u32 v10, 0xfffe0000, v10
    v_add_u32 v11, 0xfffe0000, v11
    v_add_u32 v12, 0xfffe0000, v12
    v_pk_mul_f32 v[32:33], v[32:33], v[14:15] op_sel_hi:[1,0]
    v_pk_mul_f32 v[34:35], v[34:35], v[14:15] op_sel_hi:[1,0]
    v_pk_mul_f32 v[36:37], v[36:37], v[14:15] op_sel_hi:[1,0]
    v_pk_mul_f32 v[38:39], v[38:39], v[14:15] op_sel_hi:[1,0]
    v_pk_mul_f32 v[40:41], v[40:41], v[14:15] op_sel_hi:[1,0]
    v_pk_mul_f32 v[42:43], v[42:43], v[14:15] op_sel_hi:[1,0]
    v_pk_mul_f32 v[44:45], v[44:45], v[14:15] op_sel_hi:[1,0]
    v_pk_mul_f32 v[46:47], v[46:47], v[14:15] op_sel_hi:[1,0]
    s_waitcnt vmcnt(21)
    s_nop 0
    v_dot2_f32_bf16 v80, v112, s94, 0
    v_dot2_f32_bf16 v81, v112, s95, 0
    v_dot2_f32_bf16 v82, v113, s94, 0
    v_dot2_f32_bf16 v83, v113, s95, 0
    v_dot2_f32_bf16 v84, v114, s94, 0
    v_dot2_f32_bf16 v85, v114, s95, 0
    v_dot2_f32_bf16 v86, v115, s94, 0
    v_dot2_f32_bf16 v87, v115, s95, 0
    s_add_u32 s66, s96, 0xfa000
    buffer_load_dwordx4 v[224:227], v2, s[44:47], s66 offen sc1
    s_waitcnt vmcnt(21)
    s_nop 0
    v_dot2_f32_bf16 v88, v116, s94, 0
    v_dot2_f32_bf16 v89, v116, s95, 0
    v_dot2_f32_bf16 v90, v117, s94, 0
    v_dot2_f32_bf16 v91, v117, s95, 0
    v_dot2_f32_bf16 v92, v118, s94, 0
    v_dot2_f32_bf16 v93, v118, s95, 0
    v_dot2_f32_bf16 v94, v119, s94, 0
    v_dot2_f32_bf16 v95, v119, s95, 0
    s_add_u32 s66, s96, 0x11e000
    buffer_load_dwordx4 v[232:235], v2, s[44:47], s66 offen sc1
    s_waitcnt vmcnt(21)
    s_nop 0
    v_dot2_f32_bf16 v80, v120, s94, v80
    v_dot2_f32_bf16 v81, v120, s95, v81
    v_dot2_f32_bf16 v82, v121, s94, v82
    v_dot2_f32_bf16 v83, v121, s95, v83
    v_dot2_f32_bf16 v84, v122, s94, v84
    v_dot2_f32_bf16 v85, v122, s95, v85
    v_dot2_f32_bf16 v86, v123, s94, v86
    v_dot2_f32_bf16 v87, v123, s95, v87
    s_waitcnt vmcnt(20)
    s_nop 0
    v_dot2_f32_bf16 v88, v124, s94, v88
    v_dot2_f32_bf16 v89, v124, s95, v89
    v_dot2_f32_bf16 v90, v125, s94, v90
    v_dot2_f32_bf16 v91, v125, s95, v91
    v_dot2_f32_bf16 v92, v126, s94, v92
    v_dot2_f32_bf16 v93, v126, s95, v93
    v_dot2_f32_bf16 v94, v127, s94, v94
    v_dot2_f32_bf16 v95, v127, s95, v95
    s_waitcnt vmcnt(19)
    s_nop 0
    v_dot2_f32_bf16 v80, v128, s94, v80
    v_dot2_f32_bf16 v81, v128, s95, v81
    v_dot2_f32_bf16 v82, v129, s94, v82
    v_dot2_f32_bf16 v83, v129, s95, v83
    v_dot2_f32_bf16 v84, v130, s94, v84
    v_dot2_f32_bf16 v85, v130, s95, v85
    v_dot2_f32_bf16 v86, v131, s94, v86
    v_dot2_f32_bf16 v87, v131, s95, v87
    s_waitcnt vmcnt(18)
    s_nop 0
    v_dot2_f32_bf16 v88, v132, s94, v88
    v_dot2_f32_bf16 v89, v132, s95, v89
    v_dot2_f32_bf16 v90, v133, s94, v90
    v_dot2_f32_bf16 v91, v133, s95, v91
    v_dot2_f32_bf16 v92, v134, s94, v92
    v_dot2_f32_bf16 v93, v134, s95, v93
    v_dot2_f32_bf16 v94, v135, s94, v94
    v_dot2_f32_bf16 v95, v135, s95, v95
    s_waitcnt vmcnt(17)
    s_nop 0
    v_dot2_f32_bf16 v80, v136, s94, v80
    v_dot2_f32_bf16 v81, v136, s95, v81
    v_dot2_f32_bf16 v82, v137, s94, v82
    v_dot2_f32_bf16 v83, v137, s95, v83
    v_dot2_f32_bf16 v84, v138, s94, v84
    v_dot2_f32_bf16 v85, v138, s95, v85
    v_dot2_f32_bf16 v86, v139, s94, v86
    v_dot2_f32_bf16 v87, v139, s95, v87
    s_waitcnt vmcnt(16)
    s_nop 0
    v_dot2_f32_bf16 v88, v140, s94, v88
    v_dot2_f32_bf16 v89, v140, s95, v89
    v_dot2_f32_bf16 v90, v141, s94, v90
    v_dot2_f32_bf16 v91, v141, s95, v91
    v_dot2_f32_bf16 v92, v142, s94, v92
    v_dot2_f32_bf16 v93, v142, s95, v93
    v_dot2_f32_bf16 v94, v143, s94, v94
    v_dot2_f32_bf16 v95, v143, s95, v95
    s_waitcnt vmcnt(15)
    s_nop 0
    v_dot2_f32_bf16 v80, v144, s94, v80
    v_dot2_f32_bf16 v81, v144, s95, v81
    v_dot2_f32_bf16 v82, v145, s94, v82
    v_dot2_f32_bf16 v83, v145, s95, v83
    v_dot2_f32_bf16 v84, v146, s94, v84
    v_dot2_f32_bf16 v85, v146, s95, v85
    v_dot2_f32_bf16 v86, v147, s94, v86
    v_dot2_f32_bf16 v87, v147, s95, v87
    s_waitcnt vmcnt(14)
    s_nop 0
    v_dot2_f32_bf16 v88, v148, s94, v88
    v_dot2_f32_bf16 v89, v148, s95, v89
    v_dot2_f32_bf16 v90, v149, s94, v90
    v_dot2_f32_bf16 v91, v149, s95, v91
    v_dot2_f32_bf16 v92, v150, s94, v92
    v_dot2_f32_bf16 v93, v150, s95, v93
    v_dot2_f32_bf16 v94, v151, s94, v94
    v_dot2_f32_bf16 v95, v151, s95, v95
    s_waitcnt vmcnt(13)
    s_nop 0
    v_dot2_f32_bf16 v80, v152, s94, v80
    v_dot2_f32_bf16 v81, v152, s95, v81
    v_dot2_f32_bf16 v82, v153, s94, v82
    v_dot2_f32_bf16 v83, v153, s95, v83
    v_dot2_f32_bf16 v84, v154, s94, v84
    v_dot2_f32_bf16 v85, v154, s95, v85
    v_dot2_f32_bf16 v86, v155, s94, v86
    v_dot2_f32_bf16 v87, v155, s95, v87
    s_waitcnt vmcnt(12)
    s_nop 0
    v_dot2_f32_bf16 v88, v156, s94, v88
    v_dot2_f32_bf16 v89, v156, s95, v89
    v_dot2_f32_bf16 v90, v157, s94, v90
    v_dot2_f32_bf16 v91, v157, s95, v91
    v_dot2_f32_bf16 v92, v158, s94, v92
    v_dot2_f32_bf16 v93, v158, s95, v93
    v_dot2_f32_bf16 v94, v159, s94, v94
    v_dot2_f32_bf16 v95, v159, s95, v95
    s_waitcnt vmcnt(11)
    s_nop 0
    v_dot2_f32_bf16 v80, v160, s94, v80
    v_dot2_f32_bf16 v81, v160, s95, v81
    v_dot2_f32_bf16 v82, v161, s94, v82
    v_dot2_f32_bf16 v83, v161, s95, v83
    v_dot2_f32_bf16 v84, v162, s94, v84
    v_dot2_f32_bf16 v85, v162, s95, v85
    v_dot2_f32_bf16 v86, v163, s94, v86
    v_dot2_f32_bf16 v87, v163, s95, v87
    s_waitcnt vmcnt(10)
    s_nop 0
    v_dot2_f32_bf16 v88, v164, s94, v88
    v_dot2_f32_bf16 v89, v164, s95, v89
    v_dot2_f32_bf16 v90, v165, s94, v90
    v_dot2_f32_bf16 v91, v165, s95, v91
    v_dot2_f32_bf16 v92, v166, s94, v92
    v_dot2_f32_bf16 v93, v166, s95, v93
    v_dot2_f32_bf16 v94, v167, s94, v94
    v_dot2_f32_bf16 v95, v167, s95, v95
    s_waitcnt vmcnt(9)
    s_nop 0
    v_dot2_f32_bf16 v80, v168, s94, v80
    v_dot2_f32_bf16 v81, v168, s95, v81
    v_dot2_f32_bf16 v82, v169, s94, v82
    v_dot2_f32_bf16 v83, v169, s95, v83
    v_dot2_f32_bf16 v84, v170, s94, v84
    v_dot2_f32_bf16 v85, v170, s95, v85
    v_dot2_f32_bf16 v86, v171, s94, v86
    v_dot2_f32_bf16 v87, v171, s95, v87
    s_waitcnt vmcnt(8)
    s_nop 0
    v_dot2_f32_bf16 v88, v172, s94, v88
    v_dot2_f32_bf16 v89, v172, s95, v89
    v_dot2_f32_bf16 v90, v173, s94, v90
    v_dot2_f32_bf16 v91, v173, s95, v91
    v_dot2_f32_bf16 v92, v174, s94, v92
    v_dot2_f32_bf16 v93, v174, s95, v93
    v_dot2_f32_bf16 v94, v175, s94, v94
    v_dot2_f32_bf16 v95, v175, s95, v95
    v_pk_mul_f32 v[96:97], v[80:81], v[14:15] op_sel:[0,1] op_sel_hi:[1,1]
    v_pk_mul_f32 v[98:99], v[82:83], v[14:15] op_sel:[0,1] op_sel_hi:[1,1]
    v_pk_mul_f32 v[100:101], v[84:85], v[14:15] op_sel:[0,1] op_sel_hi:[1,1]
    v_pk_mul_f32 v[102:103], v[86:87], v[14:15] op_sel:[0,1] op_sel_hi:[1,1]
    v_pk_mul_f32 v[104:105], v[88:89], v[14:15] op_sel:[0,1] op_sel_hi:[1,1]
    v_pk_mul_f32 v[106:107], v[90:91], v[14:15] op_sel:[0,1] op_sel_hi:[1,1]
    v_pk_mul_f32 v[108:109], v[92:93], v[14:15] op_sel:[0,1] op_sel_hi:[1,1]
    v_pk_mul_f32 v[110:111], v[94:95], v[14:15] op_sel:[0,1] op_sel_hi:[1,1]
    v_exp_f32 v96, v96
    v_exp_f32 v97, v97
    v_exp_f32 v98, v98
    v_exp_f32 v99, v99
    v_exp_f32 v100, v100
    v_exp_f32 v101, v101
    v_exp_f32 v102, v102
    v_exp_f32 v103, v103
    v_exp_f32 v104, v104
    v_exp_f32 v105, v105
    v_exp_f32 v106, v106
    v_exp_f32 v107, v107
    v_exp_f32 v108, v108
    v_exp_f32 v109, v109
    v_exp_f32 v110, v110
    v_exp_f32 v111, v111
    v_pk_mul_f32 v[32:33], v[32:33], v[80:81]
    v_pk_mul_f32 v[34:35], v[34:35], v[82:83]
    v_pk_mul_f32 v[36:37], v[36:37], v[84:85]
    v_pk_mul_f32 v[38:39], v[38:39], v[86:87]
    v_pk_mul_f32 v[40:41], v[40:41], v[88:89]
    v_pk_mul_f32 v[42:43], v[42:43], v[90:91]
    v_pk_mul_f32 v[44:45], v[44:45], v[92:93]
    v_pk_mul_f32 v[46:47], v[46:47], v[94:95]
    v_pk_add_f32 v[96:97], v[96:97], 1.0 op_sel_hi:[1,0]
    v_pk_add_f32 v[98:99], v[98:99], 1.0 op_sel_hi:[1,0]
    v_pk_add_f32 v[100:101], v[100:101], 1.0 op_sel_hi:[1,0]
    v_pk_add_f32 v[102:103], v[102:103], 1.0 op_sel_hi:[1,0]
    v_pk_add_f32 v[104:105], v[104:105], 1.0 op_sel_hi:[1,0]
    v_pk_add_f32 v[106:107], v[106:107], 1.0 op_sel_hi:[1,0]
    v_pk_add_f32 v[108:109], v[108:109], 1.0 op_sel_hi:[1,0]
    v_pk_add_f32 v[110:111], v[110:111], 1.0 op_sel_hi:[1,0]
    v_rcp_f32 v96, v96
    v_rcp_f32 v97, v97
    v_rcp_f32 v98, v98
    v_rcp_f32 v99, v99
    v_rcp_f32 v100, v100
    v_rcp_f32 v101, v101
    v_rcp_f32 v102, v102
    v_rcp_f32 v103, v103
    v_rcp_f32 v104, v104
    v_rcp_f32 v105, v105
    v_rcp_f32 v106, v106
    v_rcp_f32 v107, v107
    v_rcp_f32 v108, v108
    v_rcp_f32 v109, v109
    v_rcp_f32 v110, v110
    v_rcp_f32 v111, v111
    v_pk_mul_f32 v[32:33], v[32:33], v[96:97]
    v_pk_mul_f32 v[34:35], v[34:35], v[98:99]
    v_pk_mul_f32 v[36:37], v[36:37], v[100:101]
    v_pk_mul_f32 v[38:39], v[38:39], v[102:103]
    v_pk_mul_f32 v[40:41], v[40:41], v[104:105]
    v_pk_mul_f32 v[42:43], v[42:43], v[106:107]
    v_pk_mul_f32 v[44:45], v[44:45], v[108:109]
    v_pk_mul_f32 v[46:47], v[46:47], v[110:111]
    v_permlane16_swap_b32 v32, v36
    v_permlane16_swap_b32 v33, v37
    v_permlane16_swap_b32 v34, v38
    v_permlane16_swap_b32 v35, v39
    v_permlane16_swap_b32 v40, v44
    v_permlane16_swap_b32 v41, v45
    v_permlane16_swap_b32 v42, v46
    v_permlane16_swap_b32 v43, v47
    v_dot2c_f32_bf16 v32, s94, v248
    v_dot2c_f32_bf16 v33, s95, v248
    v_dot2c_f32_bf16 v34, s94, v249
    v_dot2c_f32_bf16 v35, s95, v249
    v_dot2c_f32_bf16 v36, s94, v250
    v_dot2c_f32_bf16 v37, s95, v250
    v_dot2c_f32_bf16 v38, s94, v251
    v_dot2c_f32_bf16 v39, s95, v251
    v_dot2c_f32_bf16 v40, s94, v252
    v_dot2c_f32_bf16 v41, s95, v252
    v_dot2c_f32_bf16 v42, s94, v253
    v_dot2c_f32_bf16 v43, s95, v253
    v_dot2c_f32_bf16 v44, s94, v254
    v_dot2c_f32_bf16 v45, s95, v254
    v_dot2c_f32_bf16 v46, s94, v255
    v_dot2c_f32_bf16 v47, s95, v255
    v_cvt_pk_bf16_f32 v248, v32, v33
    v_cvt_pk_bf16_f32 v249, v34, v35
    v_cvt_pk_bf16_f32 v250, v36, v37
    v_cvt_pk_bf16_f32 v251, v38, v39
    buffer_store_dwordx4 v[248:251], v30, s[36:39], s89 offen offset:0 sc1
    v_cvt_pk_bf16_f32 v252, v40, v41
    v_cvt_pk_bf16_f32 v253, v42, v43
    v_cvt_pk_bf16_f32 v254, v44, v45
    v_cvt_pk_bf16_f32 v255, v46, v47
    buffer_store_dwordx4 v[252:255], v30, s[36:39], s89 offen offset:64 sc1
    s_mov_b32 s89, s97
    v_pk_mul_f32 v[48:49], v[48:49], v[14:15] op_sel_hi:[1,0]
    v_pk_mul_f32 v[50:51], v[50:51], v[14:15] op_sel_hi:[1,0]
    v_pk_mul_f32 v[52:53], v[52:53], v[14:15] op_sel_hi:[1,0]
    v_pk_mul_f32 v[54:55], v[54:55], v[14:15] op_sel_hi:[1,0]
    s_waitcnt vmcnt(9)
    v_dot2_f32_bf16 v80, v176, s94, 0
    v_dot2_f32_bf16 v81, v176, s95, 0
    v_dot2_f32_bf16 v82, v177, s94, 0
    v_dot2_f32_bf16 v83, v177, s95, 0
    v_dot2_f32_bf16 v84, v178, s94, 0
    v_dot2_f32_bf16 v85, v178, s95, 0
    v_dot2_f32_bf16 v86, v179, s94, 0
    v_dot2_f32_bf16 v87, v179, s95, 0
    s_waitcnt vmcnt(8)
    s_nop 0
    v_dot2_f32_bf16 v80, v184, s94, v80
    v_dot2_f32_bf16 v81, v184, s95, v81
    v_dot2_f32_bf16 v82, v185, s94, v82
    v_dot2_f32_bf16 v83, v185, s95, v83
    v_dot2_f32_bf16 v84, v186, s94, v84
    v_dot2_f32_bf16 v85, v186, s95, v85
    v_dot2_f32_bf16 v86, v187, s94, v86
    v_dot2_f32_bf16 v87, v187, s95, v87
    s_waitcnt vmcnt(7)
    s_nop 0
    v_dot2_f32_bf16 v80, v192, s94, v80
    v_dot2_f32_bf16 v81, v192, s95, v81
    v_dot2_f32_bf16 v82, v193, s94, v82
    v_dot2_f32_bf16 v83, v193, s95, v83
    v_dot2_f32_bf16 v84, v194, s94, v84
    v_dot2_f32_bf16 v85, v194, s95, v85
    v_dot2_f32_bf16 v86, v195, s94, v86
    v_dot2_f32_bf16 v87, v195, s95, v87
    s_waitcnt vmcnt(6)
    s_nop 0
    v_dot2_f32_bf16 v80, v200, s94, v80
    v_dot2_f32_bf16 v81, v200, s95, v81
    v_dot2_f32_bf16 v82, v201, s94, v82
    v_dot2_f32_bf16 v83, v201, s95, v83
    v_dot2_f32_bf16 v84, v202, s94, v84
    v_dot2_f32_bf16 v85, v202, s95, v85
    v_dot2_f32_bf16 v86, v203, s94, v86
    v_dot2_f32_bf16 v87, v203, s95, v87
    s_waitcnt vmcnt(5)
    s_nop 0
    v_dot2_f32_bf16 v80, v208, s94, v80
    v_dot2_f32_bf16 v81, v208, s95, v81
    v_dot2_f32_bf16 v82, v209, s94, v82
    v_dot2_f32_bf16 v83, v209, s95, v83
    v_dot2_f32_bf16 v84, v210, s94, v84
    v_dot2_f32_bf16 v85, v210, s95, v85
    v_dot2_f32_bf16 v86, v211, s94, v86
    v_dot2_f32_bf16 v87, v211, s95, v87
    s_waitcnt vmcnt(4)
    s_nop 0
    v_dot2_f32_bf16 v80, v216, s94, v80
    v_dot2_f32_bf16 v81, v216, s95, v81
    v_dot2_f32_bf16 v82, v217, s94, v82
    v_dot2_f32_bf16 v83, v217, s95, v83
    v_dot2_f32_bf16 v84, v218, s94, v84
    v_dot2_f32_bf16 v85, v218, s95, v85
    v_dot2_f32_bf16 v86, v219, s94, v86
    v_dot2_f32_bf16 v87, v219, s95, v87
    s_waitcnt vmcnt(3)
    s_nop 0
    v_dot2_f32_bf16 v80, v224, s94, v80
    v_dot2_f32_bf16 v81, v224, s95, v81
    v_dot2_f32_bf16 v82, v225, s94, v82
    v_dot2_f32_bf16 v83, v225, s95, v83
    v_dot2_f32_bf16 v84, v226, s94, v84
    v_dot2_f32_bf16 v85, v226, s95, v85
    v_dot2_f32_bf16 v86, v227, s94, v86
    v_dot2_f32_bf16 v87, v227, s95, v87
    s_waitcnt vmcnt(2)
    s_nop 0
    v_dot2_f32_bf16 v80, v232, s94, v80
    v_dot2_f32_bf16 v81, v232, s95, v81
    v_dot2_f32_bf16 v82, v233, s94, v82
    v_dot2_f32_bf16 v83, v233, s95, v83
    v_dot2_f32_bf16 v84, v234, s94, v84
    v_dot2_f32_bf16 v85, v234, s95, v85
    v_dot2_f32_bf16 v86, v235, s94, v86
    v_dot2_f32_bf16 v87, v235, s95, v87
    v_pk_mul_f32 v[96:97], v[80:81], v[14:15] op_sel:[0,1] op_sel_hi:[1,1]
    v_pk_mul_f32 v[98:99], v[82:83], v[14:15] op_sel:[0,1] op_sel_hi:[1,1]
    v_pk_mul_f32 v[100:101], v[84:85], v[14:15] op_sel:[0,1] op_sel_hi:[1,1]
    v_pk_mul_f32 v[102:103], v[86:87], v[14:15] op_sel:[0,1] op_sel_hi:[1,1]
    v_exp_f32 v96, v96
    v_exp_f32 v97, v97
    v_exp_f32 v98, v98
    v_exp_f32 v99, v99
    v_exp_f32 v100, v100
    v_exp_f32 v101, v101
    v_exp_f32 v102, v102
    v_exp_f32 v103, v103
    v_pk_mul_f32 v[48:49], v[48:49], v[80:81]
    v_pk_mul_f32 v[50:51], v[50:51], v[82:83]
    v_pk_mul_f32 v[52:53], v[52:53], v[84:85]
    v_pk_mul_f32 v[54:55], v[54:55], v[86:87]
    v_pk_add_f32 v[96:97], v[96:97], 1.0 op_sel_hi:[1,0]
    v_pk_add_f32 v[98:99], v[98:99], 1.0 op_sel_hi:[1,0]
    v_pk_add_f32 v[100:101], v[100:101], 1.0 op_sel_hi:[1,0]
    v_pk_add_f32 v[102:103], v[102:103], 1.0 op_sel_hi:[1,0]
    v_rcp_f32 v96, v96
    v_rcp_f32 v97, v97
    v_rcp_f32 v98, v98
    v_rcp_f32 v99, v99
    v_rcp_f32 v100, v100
    v_rcp_f32 v101, v101
    v_rcp_f32 v102, v102
    v_rcp_f32 v103, v103
    v_pk_mul_f32 v[48:49], v[48:49], v[96:97]
    v_pk_mul_f32 v[50:51], v[50:51], v[98:99]
    v_pk_mul_f32 v[52:53], v[52:53], v[100:101]
    v_pk_mul_f32 v[54:55], v[54:55], v[102:103]
    s_nop 0
    v_permlane16_swap_b32 v48, v52
    v_permlane16_swap_b32 v49, v53
    v_permlane16_swap_b32 v50, v54
    v_permlane16_swap_b32 v51, v55
    v_dot2c_f32_bf16 v48, s94, v240
    v_dot2c_f32_bf16 v49, s95, v240
    v_dot2c_f32_bf16 v50, s94, v241
    v_dot2c_f32_bf16 v51, s95, v241
    v_dot2c_f32_bf16 v52, s94, v242
    v_dot2c_f32_bf16 v53, s95, v242
    v_dot2c_f32_bf16 v54, s94, v243
    v_dot2c_f32_bf16 v55, s95, v243
    v_cvt_pk_bf16_f32 v240, v48, v49
    v_cvt_pk_bf16_f32 v241, v50, v51
    v_cvt_pk_bf16_f32 v242, v52, v53
    v_cvt_pk_bf16_f32 v243, v54, v55
    buffer_store_dwordx4 v[240:243], v30, s[36:39], s89 offen offset:0 sc1
    s_branch dbl_e
d5_slow:
    s_mov_b32 s69, 400000
d5_loop:
    s_sleep 2
    buffer_load_dword v26, v13, s[44:47], s93 offen sc1
    s_waitcnt vmcnt(0)
    s_sub_u32 s69, s69, 1
    s_cbranch_scc1 d5_ok
    v_cmp_le_u32 vcc, s91, v26
    s_nop 1
    s_and_b32 s65, vcc_lo, s90
    s_cmp_eq_u32 s65, s90
    s_cbranch_scc0 d5_loop
    s_branch d5_ok
fp3_slow:
    s_mov_b32 s69, 400000
fp3_loop:
    buffer_load_dword v26, v13, s[44:47], s93 offen sc1
    s_waitcnt vmcnt(0)
    v_cmp_le_u32 vcc, s91, v26
    s_sub_u32 s69, s69, 1
    s_cbranch_scc1 fp3_ok
    s_andn2_b32 s65, s90, vcc_lo
    s_and_b32 s65, s65, 192
    s_cbranch_scc1 fp3_loop
    s_branch fp3_ok
fp2_slow:
    s_mov_b32 s69, 400000
fp2_loop:
    buffer_load_dword v26, v13, s[44:47], s93 offen sc1
    s_waitcnt vmcnt(0)
    v_cmp_le_u32 vcc, s91, v26
    s_sub_u32 s69, s69, 1
    s_cbranch_scc1 fp2_ok
    s_andn2_b32 s65, s90, vcc_lo
    s_and_b32 s65, s65, 48
    s_cbranch_scc1 fp2_loop
    s_branch fp2_ok
fp1_slow:
    s_mov_b32 s69, 400000
fp1_loop:
    buffer_load_dword v26, v13, s[44:47], s93 offen sc1
    s_waitcnt vmcnt(0)
    v_cmp_le_u32 vcc, s91, v26
    s_sub_u32 s69, s69, 1
    s_cbranch_scc1 fp1_ok
    s_andn2_b32 s65, s90, vcc_lo
    s_and_b32 s65, s65, 12
    s_cbranch_scc1 fp1_loop
    s_branch fp1_ok
fp0_slow:
    s_mov_b32 s69, 400000
fp0_loop:
    buffer_load_dword v26, v13, s[44:47], s93 offen sc1
    s_waitcnt vmcnt(0)
    v_cmp_le_u32 vcc, s91, v26
    s_sub_u32 s69, s69, 1
    s_cbranch_scc1 fp0_ok
    s_andn2_b32 s65, s90, vcc_lo
    s_and_b32 s65, s65, 3
    s_cbranch_scc1 fp0_loop
    s_branch fp0_ok
fp4_slow:
    s_mov_b32 s69, 400000
fp4_loop:
    buffer_load_dword v26, v13, s[44:47], s93 offen sc1
    s_waitcnt vmcnt(0)
    v_cmp_le_u32 vcc, s91, v26
    s_sub_u32 s69, s69, 1
    s_cbranch_scc1 fp4_ok
    s_andn2_b32 s65, s90, vcc_lo
    s_and_b32 s65, s65, 768
    s_cbranch_scc1 fp4_loop
    s_branch fp4_ok
fp5_slow:
    s_mov_b32 s69, 400000
fp5_loop:
    buffer_load_dword v26, v13, s[44:47], s93 offen sc1
    s_waitcnt vmcnt(0)
    v_cmp_le_u32 vcc, s91, v26
    s_sub_u32 s69, s69, 1
    s_cbranch_scc1 fp5_ok
    s_andn2_b32 s65, s90, vcc_lo
    s_and_b32 s65, s65, 3072
    s_cbranch_scc1 fp5_loop
    s_branch fp5_ok
fp6_slow:
    s_mov_b32 s69, 400000
fp6_loop:
    buffer_load_dword v26, v13, s[44:47], s93 offen sc1
    s_waitcnt vmcnt(0)
    v_cmp_le_u32 vcc, s91, v26
    s_sub_u32 s69, s69, 1
    s_cbranch_scc1 fp6_ok
    s_andn2_b32 s65, s90, vcc_lo
    s_and_b32 s65, s65, 12288
    s_cbranch_scc1 fp6_loop
    s_branch fp6_ok
fp7_slow:
    s_mov_b32 s69, 400000
fp7_loop:
    buffer_load_dword v26, v13, s[44:47], s93 offen sc1
    s_waitcnt vmcnt(0)
    v_cmp_le_u32 vcc, s91, v26
    s_sub_u32 s69, s69, 1
    s_cbranch_scc1 fp7_ok
    s_andn2_b32 s65, s90, vcc_lo
    s_and_b32 s65, s65, 49152
    s_cbranch_scc1 fp7_loop
    s_branch fp7_ok
o3_slow:
    s_mov_b32 s69, 400000
o3_loop:
    s_sleep 2
    buffer_load_dword v26, v13, s[44:47], s93 offen sc1
    s_waitcnt vmcnt(0)
    s_sub_u32 s69, s69, 1
    s_cbranch_scc1 o3_ok
    v_cmp_le_u32 vcc, 4, v26
    s_nop 1
    s_cmp_eq_u32 vcc_lo, 0xffff
    s_cbranch_scc0 o3_loop
    s_branch o3_ok
h3_slow:
    s_mov_b32 s69, 400000
h3_loop:
    s_sleep 2
    buffer_load_dword v26, off, s[44:47], s7 sc1
    s_waitcnt vmcnt(0)
    s_sub_u32 s69, s69, 1
    s_cbranch_scc1 h3_ok
    v_readfirstlane_b32 s65, v26
    s_nop 0
    s_cmp_ge_u32 s65, 3
    s_cbranch_scc0 h3_loop
    s_branch h3_ok
qkv_v:
    s_waitcnt lgkmcnt(12)
    v_mfma_f32_16x16x32_bf16 v[112:115], a[0:3], v[80:83], 0
    ds_read_b64_tr_b16 v[96:97], v14 offset:2048
    v_mfma_f32_16x16x32_bf16 v[112:115], a[16:19], v[84:87], v[112:115]
    ds_read_b64_tr_b16 v[98:99], v14 offset:2560
    v_mfma_f32_16x16x32_bf16 v[116:119], a[4:7], v[80:83], 0
    ds_read_b64_tr_b16 v[100:101], v14 offset:10240
    v_add_f32_dpp v26, v26, v26 quad_perm:[1,0,3,2] row_mask:0xf bank_mask:0xf
    v_mfma_f32_16x16x32_bf16 v[116:119], a[20:23], v[84:87], v[116:119]
    ds_read_b64_tr_b16 v[102:103], v14 offset:10752
    v_add_f32_dpp v27, v27, v27 quad_perm:[1,0,3,2] row_mask:0xf bank_mask:0xf
    s_waitcnt lgkmcnt(11)
    v_mfma_f32_16x16x32_bf16 v[120:123], a[8:11], v[80:83], 0
    ds_read_b64_tr_b16 v[104:105], v15 offset:2048
    v_add_f32_dpp v24, v24, v24 quad_perm:[1,0,3,2] row_mask:0xf bank_mask:0xf
    s_waitcnt lgkmcnt(10)
    v_mfma_f32_16x16x32_bf16 v[120:123], a[24:27], v[84:87], v[120:123]
    ds_read_b64_tr_b16 v[106:107], v15 offset:2560
    v_add_f32_dpp v25, v25, v25 quad_perm:[1,0,3,2] row_mask:0xf bank_mask:0xf
    v_mfma_f32_16x16x32_bf16 v[124:127], a[12:15], v[80:83], 0
    ds_read_b64_tr_b16 v[108:109], v15 offset:10240
    v_add_f32_dpp v26, v26, v26 quad_perm:[2,3,0,1] row_mask:0xf bank_mask:0xf
    s_waitcnt lgkmcnt(11)
    v_mfma_f32_16x16x32_bf16 v[124:127], a[28:31], v[84:87], v[124:127]
    ds_read_b64_tr_b16 v[110:111], v15 offset:10752
    s_waitcnt vmcnt(14)
    s_barrier
    v_mfma_f32_16x16x32_bf16 v[128:131], a[0:3], v[88:91], 0
    ds_read_b64_tr_b16 v[80:81], v14 offset:16384
    v_add_f32_dpp v27, v27, v27 quad_perm:[2,3,0,1] row_mask:0xf bank_mask:0xf
    v_mfma_f32_16x16x32_bf16 v[128:131], a[16:19], v[92:95], v[128:131]
    ds_read_b128 a[72:75], v65 offset:4096
    v_add_f32_dpp v24, v24, v24 quad_perm:[2,3,0,1] row_mask:0xf bank_mask:0xf
    v_mfma_f32_16x16x32_bf16 v[132:135], a[4:7], v[88:91], 0
    ds_read_b64_tr_b16 v[82:83], v14 offset:16896
    v_add_f32_dpp v25, v25, v25 quad_perm:[2,3,0,1] row_mask:0xf bank_mask:0xf
    v_mfma_f32_16x16x32_bf16 v[132:135], a[20:23], v[92:95], v[132:135]
    ds_read_b128 a[76:79], v65 offset:22528
    v_add_f32_dpp v26, v26, v26 row_half_mirror row_mask:0xf bank_mask:0xf
    v_mfma_f32_16x16x32_bf16 v[136:139], a[8:11], v[88:91], 0
    ds_read_b64_tr_b16 v[84:85], v14 offset:24576
    v_add_f32_dpp v27, v27, v27 row_half_mirror row_mask:0xf bank_mask:0xf
    v_mfma_f32_16x16x32_bf16 v[136:139], a[24:27], v[92:95], v[136:139]
    ds_read_b128 a[88:91], v66 offset:5120
    v_add_f32_dpp v24, v24, v24 row_half_mirror row_mask:0xf bank_mask:0xf
    v_mfma_f32_16x16x32_bf16 v[140:143], a[12:15], v[88:91], 0
    ds_read_b64_tr_b16 v[86:87], v14 offset:25088
    v_add_f32_dpp v25, v25, v25 row_half_mirror row_mask:0xf bank_mask:0xf
    v_mfma_f32_16x16x32_bf16 v[140:143], a[28:31], v[92:95], v[140:143]
    ds_read_b128 a[92:95], v66 offset:23552
    s_waitcnt lgkmcnt(12)
    v_mfma_f32_16x16x32_bf16 v[144:147], a[0:3], v[96:99], 0
    ds_read_b64_tr_b16 v[88:89], v15 offset:16384
    s_mov_b32 s76, 0xaaaaaaaa
    v_mfma_f32_16x16x32_bf16 v[144:147], a[16:19], v[100:103], v[144:147]
    ds_read_b128 a[104:107], v65 offset:6144
    s_mov_b32 s77, 0xaaaaaaaa
    v_mfma_f32_16x16x32_bf16 v[148:151], a[4:7], v[96:99], 0
    ds_read_b64_tr_b16 v[90:91], v15 offset:16896
    v_cndmask_b32 v26, v26, v27, s[76:77]
    v_mfma_f32_16x16x32_bf16 v[148:151], a[20:23], v[100:103], v[148:151]
    ds_read_b128 a[108:111], v65 offset:24576
    v_cndmask_b32 v24, v24, v25, s[76:77]
    v_mfma_f32_16x16x32_bf16 v[152:155], a[8:11], v[96:99], 0
    ds_read_b64_tr_b16 v[92:93], v15 offset:24576
    s_mov_b32 s76, 0xcccccccc
    v_mfma_f32_16x16x32_bf16 v[152:155], a[24:27], v[100:103], v[152:155]
    ds_read_b128 a[120:123], v66 offset:7168
    s_mov_b32 s77, 0xcccccccc
    v_mfma_f32_16x16x32_bf16 v[156:159], a[12:15], v[96:99], 0
    ds_read_b64_tr_b16 v[94:95], v15 offset:25088
    v_mov_b32 v181, 0x3727c5ac
    v_mfma_f32_16x16x32_bf16 v[156:159], a[28:31], v[100:103], v[156:159]
    ds_read_b128 a[124:127], v66 offset:25600
    s_waitcnt lgkmcnt(15)
    v_mfma_f32_16x16x32_bf16 v[160:163], a[0:3], v[104:107], 0
    ds_read_b64_tr_b16 v[96:97], v14 offset:18432
    v_cndmask_b32 v26, v26, v24, s[76:77]
    v_mfma_f32_16x16x32_bf16 v[160:163], a[16:19], v[108:111], v[160:163]
    ds_read_b128 a[136:139], v65 offset:8192
    v_fmac_f32 v181, 0x3ae38e39, v26
    v_mfma_f32_16x16x32_bf16 v[164:167], a[4:7], v[104:107], 0
    ds_read_b64_tr_b16 v[98:99], v14 offset:18944
    v_mfma_f32_16x16x32_bf16 v[164:167], a[20:23], v[108:111], v[164:167]
    ds_read_b128 a[140:143], v65 offset:26624
    v_mfma_f32_16x16x32_bf16 v[168:171], a[8:11], v[104:107], 0
    ds_read_b64_tr_b16 v[100:101], v14 offset:26624
    v_mfma_f32_16x16x32_bf16 v[168:171], a[24:27], v[108:111], v[168:171]
    ds_read_b128 a[152:155], v66 offset:9216
    v_mfma_f32_16x16x32_bf16 v[172:175], a[12:15], v[104:107], 0
    ds_read_b64_tr_b16 v[102:103], v14 offset:27136
    v_mfma_f32_16x16x32_bf16 v[172:175], a[28:31], v[108:111], v[172:175]
    ds_read_b128 a[156:159], v66 offset:27648
    s_waitcnt lgkmcnt(15)
    v_mfma_f32_16x16x32_bf16 v[112:115], a[32:35], v[80:83], v[112:115]
    ds_read_b64_tr_b16 v[104:105], v15 offset:18432
    v_lshrrev_b32 v68, 2, v1
    v_mfma_f32_16x16x32_bf16 v[112:115], a[48:51], v[84:87], v[112:115]
    ds_read_b128 a[168:171], v65 offset:10240
    v_mul_u32_u24 v68, 9216, v68
    v_mfma_f32_16x16x32_bf16 v[116:119], a[36:39], v[80:83], v[116:119]
    ds_read_b64_tr_b16 v[106:107], v15 offset:18944
    v_bfe_u32 v69, v1, 1, 1
    v_mfma_f32_16x16x32_bf16 v[116:119], a[52:55], v[84:87], v[116:119]
    ds_read_b128 a[172:175], v65 offset:28672
    v_mul_u32_u24 v69, 1152, v69
    v_mfma_f32_16x16x32_bf16 v[120:123], a[40:43], v[80:83], v[120:123]
    ds_read_b64_tr_b16 v[108:109], v15 offset:26624
    v_add_u32_e64 v68, v68, v69
    v_mfma_f32_16x16x32_bf16 v[120:123], a[56:59], v[84:87], v[120:123]
    ds_read_b128 a[184:187], v66 offset:11264
    v_and_b32_e64 v69, 1, v1
    v_mfma_f32_16x16x32_bf16 v[124:127], a[44:47], v[80:83], v[124:127]
    ds_read_b64_tr_b16 v[110:111], v15 offset:27136
    v_lshl_add_u32 v68, v69, 10, v68
    v_mfma_f32_16x16x32_bf16 v[124:127], a[60:63], v[84:87], v[124:127]
    s_waitcnt vmcnt(10) lgkmcnt(15)
    s_barrier
    v_mfma_f32_16x16x32_bf16 v[128:131], a[32:35], v[88:91], v[128:131]
    ds_read_b64_tr_b16 v[80:81], v14 offset:32768
    v_cmp_gt_u32 s[18:19], 36, v1
    v_mfma_f32_16x16x32_bf16 v[128:131], a[48:51], v[92:95], v[128:131]
    ds_read_b128 a[188:191], v66 offset:29696
    v_mov_b32 v70, 0x10000000
    v_mfma_f32_16x16x32_bf16 v[132:135], a[36:39], v[88:91], v[132:135]
    ds_read_b64_tr_b16 v[82:83], v14 offset:33280
    v_lshlrev_b32_e64 v69, 8, v69
    v_mfma_f32_16x16x32_bf16 v[132:135], a[52:55], v[92:95], v[132:135]
    ds_read_b128 a[200:203], v65 offset:12288
    v_cndmask_b32 v68, v70, v68, s[18:19]
    v_mfma_f32_16x16x32_bf16 v[136:139], a[40:43], v[88:91], v[136:139]
    ds_read_b64_tr_b16 v[84:85], v14 offset:40960
    v_sub_u32 v69, 128, v69
    v_mfma_f32_16x16x32_bf16 v[136:139], a[56:59], v[92:95], v[136:139]
    ds_read_b128 a[204:207], v65 offset:30720
    s_lshr_b32 s18, s2, 5
    v_mfma_f32_16x16x32_bf16 v[140:143], a[44:47], v[88:91], v[140:143]
    ds_read_b64_tr_b16 v[86:87], v14 offset:41472
    s_lshl_b32 s18, s18, 3
    v_mfma_f32_16x16x32_bf16 v[140:143], a[60:63], v[92:95], v[140:143]
    ds_read_b128 a[216:219], v66 offset:13312
    s_waitcnt lgkmcnt(15)
    v_mfma_f32_16x16x32_bf16 v[144:147], a[32:35], v[96:99], v[144:147]
    ds_read_b64_tr_b16 v[88:89], v15 offset:32768
    s_and_b32 s19, s2, 7
    v_mfma_f32_16x16x32_bf16 v[144:147], a[48:51], v[100:103], v[144:147]
    ds_read_b128 a[220:223], v66 offset:31744
    s_or_b32 s18, s18, s19
    v_mfma_f32_16x16x32_bf16 v[148:151], a[36:39], v[96:99], v[148:151]
    ds_read_b64_tr_b16 v[90:91], v15 offset:33280
    s_mul_i32 s20, s18, 82944
    v_mfma_f32_16x16x32_bf16 v[148:151], a[52:55], v[100:103], v[148:151]
    ds_read_b128 a[232:235], v65 offset:14336
    s_mul_i32 s19, s58, 2304
    v_mfma_f32_16x16x32_bf16 v[152:155], a[40:43], v[96:99], v[152:155]
    ds_read_b64_tr_b16 v[92:93], v15 offset:40960
    s_add_u32 s20, s20, s19
    v_mfma_f32_16x16x32_bf16 v[152:155], a[56:59], v[100:103], v[152:155]
    ds_read_b128 a[236:239], v65 offset:32768
    s_and_b32 s18, s101, 3
    v_mfma_f32_16x16x32_bf16 v[156:159], a[44:47], v[96:99], v[156:159]
    ds_read_b64_tr_b16 v[94:95], v15 offset:41472
    v_add_u32 v68, v68, v69
    v_mfma_f32_16x16x32_bf16 v[156:159], a[60:63], v[100:103], v[156:159]
    ds_read_b128 a[248:251], v66 offset:15360
    s_waitcnt lgkmcnt(15)
    v_mfma_f32_16x16x32_bf16 v[160:163], a[32:35], v[104:107], v[160:163]
    ds_read_b64_tr_b16 v[96:97], v14 offset:34816
    v_mfma_f32_16x16x32_bf16 v[160:163], a[48:51], v[108:111], v[160:163]
    ds_read_b128 a[252:255], v66 offset:33792
    v_mfma_f32_16x16x32_bf16 v[164:167], a[36:39], v[104:107], v[164:167]
    ds_read_b64_tr_b16 v[98:99], v14 offset:35328
    v_mfma_f32_16x16x32_bf16 v[164:167], a[52:55], v[108:111], v[164:167]
    ds_read_b128 v[40:43], v65 offset:16384
    v_mfma_f32_16x16x32_bf16 v[168:171], a[40:43], v[104:107], v[168:171]
    ds_read_b64_tr_b16 v[100:101], v14 offset:43008
    v_mfma_f32_16x16x32_bf16 v[168:171], a[56:59], v[108:111], v[168:171]
    ds_read_b128 v[44:47], v65 offset:34816
    v_mfma_f32_16x16x32_bf16 v[172:175], a[44:47], v[104:107], v[172:175]
    ds_read_b64_tr_b16 v[102:103], v14 offset:43520
    v_mfma_f32_16x16x32_bf16 v[172:175], a[60:63], v[108:111], v[172:175]
    ds_read_b128 v[56:59], v66 offset:17408
    s_waitcnt lgkmcnt(15)
    v_mfma_f32_16x16x32_bf16 v[112:115], a[64:67], v[80:83], v[112:115]
    ds_read_b64_tr_b16 v[104:105], v15 offset:34816
    v_mfma_f32_16x16x32_bf16 v[112:115], a[80:83], v[84:87], v[112:115]
    ds_read_b128 v[60:63], v66 offset:35840
    v_mfma_f32_16x16x32_bf16 v[116:119], a[68:71], v[80:83], v[116:119]
    ds_read_b64_tr_b16 v[106:107], v15 offset:35328
    v_mfma_f32_16x16x32_bf16 v[116:119], a[84:87], v[84:87], v[116:119]
    v_rsq_f32_e64 v176, v181
    v_mfma_f32_16x16x32_bf16 v[120:123], a[72:75], v[80:83], v[120:123]
    ds_read_b64_tr_b16 v[108:109], v15 offset:43008
    v_lshlrev_b32_e64 v180, 3, v1
    v_mfma_f32_16x16x32_bf16 v[120:123], a[88:91], v[84:87], v[120:123]
    v_xor_b32 v180, s97, v180
    v_and_b32 v180, 8, v180
    v_mfma_f32_16x16x32_bf16 v[124:127], a[76:79], v[80:83], v[124:127]
    ds_read_b64_tr_b16 v[110:111], v15 offset:43520
    v_add_u32_e64 v180, v180, v67
    v_mfma_f32_16x16x32_bf16 v[124:127], a[92:95], v[84:87], v[124:127]
    s_waitcnt vmcnt(6) lgkmcnt(3)
    s_barrier
    v_mfma_f32_16x16x32_bf16 v[128:131], a[64:67], v[88:91], v[128:131]
    ds_read_b64_tr_b16 v[80:81], v14 offset:49152
    s_add_u32 s67, s92, 1105920
    v_mfma_f32_16x16x32_bf16 v[128:131], a[80:83], v[92:95], v[128:131]
    s_add_u32 m0, s70, 81920
    v_and_b32_e64 v181, 2, v1
    v_mfma_f32_16x16x32_bf16 v[132:135], a[68:71], v[88:91], v[132:135]
    ds_read_b64_tr_b16 v[82:83], v14 offset:49664
    v_lshl_add_u32 v180, v181, 4, v180
    v_mfma_f32_16x16x32_bf16 v[132:135], a[84:87], v[92:95], v[132:135]
    buffer_load_dwordx4 v3, s[28:31], s67 offen offset:0 lds
    v_mov_b32_e64 v177, v176
    v_mfma_f32_16x16x32_bf16 v[136:139], a[72:75], v[88:91], v[136:139]
    ds_read_b64_tr_b16 v[84:85], v14 offset:57344
    v_mov_b32_e64 v178, v176
    v_mfma_f32_16x16x32_bf16 v[136:139], a[88:91], v[92:95], v[136:139]
    v_mov_b32_e64 v179, v176
    v_and_b32 v181, 0x70, v180
    v_mfma_f32_16x16x32_bf16 v[140:143], a[76:79], v[88:91], v[140:143]
    ds_read_b64_tr_b16 v[86:87], v14 offset:57856
    v_mul_u32_u24_e64 v181, 12, v181
    v_mfma_f32_16x16x32_bf16 v[140:143], a[92:95], v[92:95], v[140:143]
    buffer_load_dwordx4 v4, s[28:31], s67 offen offset:1024 lds
    v_mfma_f32_16x16x32_bf16 v[144:147], a[64:67], v[96:99], v[144:147]
    ds_read_b64_tr_b16 v[88:89], v15 offset:49152
    v_lshl_add_u32 v181, v180, 2, v181
    v_mfma_f32_16x16x32_bf16 v[144:147], a[80:83], v[100:103], v[144:147]
    v_add_u32 v181, 157696, v181
    v_lshlrev_b32_e64 v193, 2, v180
    v_mfma_f32_16x16x32_bf16 v[148:151], a[68:71], v[96:99], v[148:151]
    ds_read_b64_tr_b16 v[90:91], v15 offset:49664
    v_add_u32 v193, 163328, v193
    v_mfma_f32_16x16x32_bf16 v[148:151], a[84:87], v[100:103], v[148:151]
    buffer_load_dwordx4 v5, s[28:31], s67 offen offset:2048 lds
    v_lshlrev_b32_e64 v180, 4, v180
    v_mfma_f32_16x16x32_bf16 v[152:155], a[72:75], v[96:99], v[152:155]
    ds_read_b64_tr_b16 v[92:93], v15 offset:57344
    v_add_u32 v180, 155648, v180
    v_mfma_f32_16x16x32_bf16 v[152:155], a[88:91], v[100:103], v[152:155]
    ds_write_b128 v180, v[176:179]
    v_mfma_f32_16x16x32_bf16 v[156:159], a[76:79], v[96:99], v[156:159]
    ds_read_b64_tr_b16 v[94:95], v15 offset:57856
    v_mfma_f32_16x16x32_bf16 v[156:159], a[92:95], v[100:103], v[156:159]
    ds_write_b32 v181, v176
    s_waitcnt lgkmcnt(10)
    v_mfma_f32_16x16x32_bf16 v[160:163], a[64:67], v[104:107], v[160:163]
    ds_read_b64_tr_b16 v[96:97], v14 offset:51200
    v_mfma_f32_16x16x32_bf16 v[160:163], a[80:83], v[108:111], v[160:163]
    buffer_load_dwordx4 v6, s[28:31], s67 offen offset:3072 lds
    s_add_u32 s67, s92, 1327104
    v_mfma_f32_16x16x32_bf16 v[164:167], a[68:71], v[104:107], v[164:167]
    ds_read_b64_tr_b16 v[98:99], v14 offset:51712
    s_add_u32 m0, s70, 98304
    v_mfma_f32_16x16x32_bf16 v[164:167], a[84:87], v[108:111], v[164:167]
    ds_write_b32 v193, v176
    s_mul_i32 s71, s58, 3072
    v_mfma_f32_16x16x32_bf16 v[168:171], a[72:75], v[104:107], v[168:171]
    ds_read_b64_tr_b16 v[100:101], v14 offset:59392
    s_lshl_b32 s65, s56, 4
    v_mfma_f32_16x16x32_bf16 v[168:171], a[88:91], v[108:111], v[168:171]
    buffer_load_dwordx4 v3, s[28:31], s67 offen offset:0 lds
    s_add_u32 s65, s65, s57
    v_mfma_f32_16x16x32_bf16 v[172:175], a[76:79], v[104:107], v[172:175]
    ds_read_b64_tr_b16 v[102:103], v14 offset:59904
    v_mov_b32 v207, 0
    v_mfma_f32_16x16x32_bf16 v[172:175], a[92:95], v[108:111], v[172:175]
    s_xor_b32 s7, s6, 128
    s_waitcnt lgkmcnt(11)
    v_mfma_f32_16x16x32_bf16 v[112:115], a[96:99], v[80:83], v[112:115]
    ds_read_b64_tr_b16 v[104:105], v15 offset:51200
    s_mul_i32 s79, s65, 73728
    v_mfma_f32_16x16x32_bf16 v[112:115], a[112:115], v[84:87], v[112:115]
    s_xor_b32 s65, s65, 1
    s_mul_i32 s81, s65, 73728
    v_mfma_f32_16x16x32_bf16 v[116:119], a[100:103], v[80:83], v[116:119]
    ds_read_b64_tr_b16 v[106:107], v15 offset:51712
    s_lshl_b32 s65, s59, 12
    v_mfma_f32_16x16x32_bf16 v[116:119], a[116:119], v[84:87], v[116:119]
    buffer_load_dwordx4 v4, s[28:31], s67 offen offset:1024 lds
    s_add_u32 s79, s79, s65
    v_mfma_f32_16x16x32_bf16 v[120:123], a[104:107], v[80:83], v[120:123]
    ds_read_b64_tr_b16 v[108:109], v15 offset:59392
    s_lshl_b32 s66, s60, 11
    v_mfma_f32_16x16x32_bf16 v[120:123], a[120:123], v[84:87], v[120:123]
    s_add_u32 s80, s79, s66
    s_add_u32 s80, s80, 65536
    v_mfma_f32_16x16x32_bf16 v[124:127], a[108:111], v[80:83], v[124:127]
    ds_read_b64_tr_b16 v[110:111], v15 offset:59904
    s_add_u32 s81, s81, s65
    v_mfma_f32_16x16x32_bf16 v[124:127], a[124:127], v[84:87], v[124:127]
    v_add_u32 v14, 0x10000, v14
    s_waitcnt vmcnt(8) lgkmcnt(10)
    s_barrier
    v_mfma_f32_16x16x32_bf16 v[128:131], a[96:99], v[88:91], v[128:131]
    ds_read_b64_tr_b16 v[80:81], v14 offset:0
    s_lshl_b32 s66, s60, 13
    v_mfma_f32_16x16x32_bf16 v[128:131], a[112:115], v[92:95], v[128:131]
    buffer_load_dwordx4 v5, s[28:31], s67 offen offset:2048 lds
    s_add_u32 s79, s79, s66
    v_mfma_f32_16x16x32_bf16 v[132:135], a[100:103], v[88:91], v[132:135]
    ds_read_b64_tr_b16 v[82:83], v14 offset:512
    s_mul_i32 s73, s62, 1152
    v_mfma_f32_16x16x32_bf16 v[132:135], a[116:119], v[92:95], v[132:135]
    s_lshl_b32 s65, s61, 6
    s_add_u32 s65, s65, 512
    v_mfma_f32_16x16x32_bf16 v[136:139], a[104:107], v[88:91], v[136:139]
    ds_read_b64_tr_b16 v[84:85], v14 offset:8192
    s_add_u32 s73, s73, s65
    v_mfma_f32_16x16x32_bf16 v[136:139], a[120:123], v[92:95], v[136:139]
    buffer_load_dwordx4 v6, s[28:31], s67 offen offset:3072 lds
    s_add_u32 s67, s92, 1548288
    v_mfma_f32_16x16x32_bf16 v[140:143], a[108:111], v[88:91], v[140:143]
    ds_read_b64_tr_b16 v[86:87], v14 offset:8704
    s_add_u32 m0, s70, 114688
    v_mfma_f32_16x16x32_bf16 v[140:143], a[124:127], v[92:95], v[140:143]
    v_add_u32 v15, 0x10000, v15
    s_waitcnt lgkmcnt(8)
    v_mfma_f32_16x16x32_bf16 v[144:147], a[96:99], v[96:99], v[144:147]
    ds_read_b64_tr_b16 v[88:89], v15 offset:0
    s_mul_i32 s66, s59, 442368
    v_mfma_f32_16x16x32_bf16 v[144:147], a[112:115], v[100:103], v[144:147]
    buffer_load_dwordx4 v3, s[28:31], s67 offen offset:0 lds
    s_add_u32 s73, s73, s66
    v_mfma_f32_16x16x32_bf16 v[148:151], a[100:103], v[96:99], v[148:151]
    ds_read_b64_tr_b16 v[90:91], v15 offset:512
    s_mul_i32 s65, s63, 55296
    v_mfma_f32_16x16x32_bf16 v[148:151], a[116:119], v[100:103], v[148:151]
    s_lshl_b32 s66, s88, 12
    s_add_u32 s65, s65, s66
    v_mfma_f32_16x16x32_bf16 v[152:155], a[104:107], v[96:99], v[152:155]
    ds_read_b64_tr_b16 v[92:93], v15 offset:8192
    s_lshl_b32 s66, s60, 11
    v_mfma_f32_16x16x32_bf16 v[152:155], a[120:123], v[100:103], v[152:155]
    s_add_u32 s65, s65, s66
    s_add_u32 s65, s65, 0x241b000
    v_mfma_f32_16x16x32_bf16 v[156:159], a[108:111], v[96:99], v[156:159]
    ds_read_b64_tr_b16 v[94:95], v15 offset:8704
    s_and_b32 s3, s3, 2
    v_mfma_f32_16x16x32_bf16 v[156:159], a[124:127], v[100:103], v[156:159]
    buffer_load_dwordx4 v4, s[28:31], s67 offen offset:1024 lds
    s_waitcnt lgkmcnt(8)
    v_mfma_f32_16x16x32_bf16 v[160:163], a[96:99], v[104:107], v[160:163]
    ds_read_b64_tr_b16 v[96:97], v14 offset:2048
    s_mul_i32 s66, s3, 55296
    v_mfma_f32_16x16x32_bf16 v[160:163], a[112:115], v[108:111], v[160:163]
    s_add_u32 s65, s65, s66
    s_sub_u32 s89, 1, s3
    v_mfma_f32_16x16x32_bf16 v[164:167], a[100:103], v[104:107], v[164:167]
    ds_read_b64_tr_b16 v[98:99], v14 offset:2560
    s_mul_i32 s89, s89, 110592
    v_mfma_f32_16x16x32_bf16 v[164:167], a[116:119], v[108:111], v[164:167]
    buffer_load_dwordx4 v5, s[28:31], s67 offen offset:2048 lds
    s_lshl_b32 s3, s3, 10
    v_mfma_f32_16x16x32_bf16 v[168:171], a[104:107], v[104:107], v[168:171]
    ds_read_b64_tr_b16 v[100:101], v14 offset:10240
    s_add_u32 s91, s91, 4096
    v_mfma_f32_16x16x32_bf16 v[168:171], a[120:123], v[108:111], v[168:171]
    s_mov_b32 s87, s65
    s_mul_i32 s10, s90, 331776
    v_mfma_f32_16x16x32_bf16 v[172:175], a[108:111], v[104:107], v[172:175]
    ds_read_b64_tr_b16 v[102:103], v14 offset:10752
    s_mul_i32 s65, s86, 20736
    v_mfma_f32_16x16x32_bf16 v[172:175], a[124:127], v[108:111], v[172:175]
    s_add_u32 s10, s10, s65
    s_waitcnt lgkmcnt(8)
    v_mfma_f32_16x16x32_bf16 v[112:115], a[128:131], v[80:83], v[112:115]
    ds_read_b64_tr_b16 v[104:105], v15 offset:2048
    s_mul_i32 s65, s58, 5248
    v_mfma_f32_16x16x32_bf16 v[112:115], a[144:147], v[84:87], v[112:115]
    buffer_load_dwordx4 v6, s[28:31], s67 offen offset:3072 lds
    s_add_u32 s67, s92, 1769472
    v_mfma_f32_16x16x32_bf16 v[116:119], a[132:135], v[80:83], v[116:119]
    ds_read_b64_tr_b16 v[106:107], v15 offset:2560
    s_add_u32 m0, s70, 131072
    v_mfma_f32_16x16x32_bf16 v[116:119], a[148:151], v[84:87], v[116:119]
    s_add_u32 s10, s10, s65
    v_lshlrev_b32_e64 v2, 4, v1
    v_mfma_f32_16x16x32_bf16 v[120:123], a[136:139], v[80:83], v[120:123]
    ds_read_b64_tr_b16 v[108:109], v15 offset:10240
    v_lshrrev_b32_e64 v182, 3, v1
    v_mfma_f32_16x16x32_bf16 v[120:123], a[152:155], v[84:87], v[120:123]
    buffer_load_dwordx4 v3, s[28:31], s67 offen offset:0 lds
    v_and_b32_e64 v183, 7, v1
    v_mfma_f32_16x16x32_bf16 v[124:127], a[140:143], v[80:83], v[124:127]
    ds_read_b64_tr_b16 v[110:111], v15 offset:10752
    v_lshrrev_b32_e64 v184, 4, v1
    v_mfma_f32_16x16x32_bf16 v[124:127], a[156:159], v[84:87], v[124:127]
    s_waitcnt vmcnt(9) lgkmcnt(8)
    s_barrier
    v_mfma_f32_16x16x32_bf16 v[128:131], a[128:131], v[88:91], v[128:131]
    ds_read_b64_tr_b16 v[80:81], v14 offset:16384
    v_and_b32_e64 v185, 15, v1
    v_mfma_f32_16x16x32_bf16 v[128:131], a[144:147], v[92:95], v[128:131]
    buffer_load_dwordx4 v4, s[28:31], s67 offen offset:1024 lds
    v_and_b32_e64 v186, 6, v182
    v_mfma_f32_16x16x32_bf16 v[132:135], a[132:135], v[88:91], v[132:135]
    ds_read_b64_tr_b16 v[82:83], v14 offset:16896
    v_xor_b32_e64 v186, v183, v186
    v_mfma_f32_16x16x32_bf16 v[132:135], a[148:151], v[92:95], v[132:135]
    v_mul_u32_u24 v187, 1152, v182
    v_lshl_add_u32 v187, v186, 4, v187
    v_mfma_f32_16x16x32_bf16 v[136:139], a[136:139], v[88:91], v[136:139]
    ds_read_b64_tr_b16 v[84:85], v14 offset:24576
    v_add_u32 v16, 2048, v187
    v_mfma_f32_16x16x32_bf16 v[136:139], a[152:155], v[92:95], v[136:139]
    v_add_u32 v17, 10240, v187
    v_add_u32 v18, 128, v187
    v_mfma_f32_16x16x32_bf16 v[140:143], a[140:143], v[88:91], v[140:143]
    ds_read_b64_tr_b16 v[86:87], v14 offset:25088
    v_add_u32 v19, 8320, v187
    v_mfma_f32_16x16x32_bf16 v[140:143], a[156:159], v[92:95], v[140:143]
    buffer_load_dwordx4 v5, s[28:31], s67 offen offset:2048 lds
    s_waitcnt lgkmcnt(8)
    v_mfma_f32_16x16x32_bf16 v[144:147], a[128:131], v[96:99], v[144:147]
    ds_read_b64_tr_b16 v[88:89], v15 offset:16384
    v_lshrrev_b32 v186, 2, v1
    v_mfma_f32_16x16x32_bf16 v[144:147], a[144:147], v[100:103], v[144:147]
    v_and_b32 v187, 3, v1
    v_and_b32 v188, 2, v184
    v_mfma_f32_16x16x32_bf16 v[148:151], a[132:135], v[96:99], v[148:151]
    ds_read_b64_tr_b16 v[90:91], v15 offset:16896
    v_xor_b32_e64 v188, v187, v188
    v_mfma_f32_16x16x32_bf16 v[148:151], a[148:151], v[100:103], v[148:151]
    buffer_load_dwordx4 v6, s[28:31], s67 offen offset:3072 lds
    s_add_u32 s67, s72, 0
    v_mfma_f32_16x16x32_bf16 v[152:155], a[136:139], v[96:99], v[152:155]
    ds_read_b64_tr_b16 v[92:93], v15 offset:24576
    s_add_u32 m0, s70, 0
    v_mfma_f32_16x16x32_bf16 v[152:155], a[152:155], v[100:103], v[152:155]
    v_mul_u32_u24 v190, 9216, v186
    v_lshl_add_u32 v10, v188, 4, v190
    v_mfma_f32_16x16x32_bf16 v[156:159], a[140:143], v[96:99], v[156:159]
    ds_read_b64_tr_b16 v[94:95], v15 offset:25088
    v_and_b32_e64 v188, 1, v184
    v_mfma_f32_16x16x32_bf16 v[156:159], a[156:159], v[100:103], v[156:159]
    v_lshlrev_b32 v188, 1, v188
    s_waitcnt lgkmcnt(8)
    v_mfma_f32_16x16x32_bf16 v[160:163], a[128:131], v[104:107], v[160:163]
    ds_read_b64_tr_b16 v[96:97], v14 offset:18432
    v_xor_b32_e64 v188, v187, v188
    v_mfma_f32_16x16x32_bf16 v[160:163], a[144:147], v[108:111], v[160:163]
    buffer_load_dwordx4 v8, s[32:35], s67 offen offset:0 lds
    v_mul_u32_u24 v190, 1152, v186
    v_mfma_f32_16x16x32_bf16 v[164:167], a[132:135], v[104:107], v[164:167]
    ds_read_b64_tr_b16 v[98:99], v14 offset:18944
    v_lshl_add_u32 v7, v188, 4, v190
    v_mfma_f32_16x16x32_bf16 v[164:167], a[148:151], v[108:111], v[164:167]
    v_lshrrev_b32 v186, 2, v185
    v_and_b32 v188, 1, v184
    v_mfma_f32_16x16x32_bf16 v[168:171], a[136:139], v[104:107], v[168:171]
    ds_read_b64_tr_b16 v[100:101], v14 offset:26624
    v_lshrrev_b32_e64 v192, 1, v184
    v_mfma_f32_16x16x32_bf16 v[168:171], a[152:155], v[108:111], v[168:171]
    buffer_load_dwordx4 v9, s[32:35], s67 offen offset:1024 lds
    v_lshl_add_u32 v190, v184, 3, v186
    v_mfma_f32_16x16x32_bf16 v[172:175], a[140:143], v[104:107], v[172:175]
    ds_read_b64_tr_b16 v[102:103], v14 offset:27136
    v_lshlrev_b32_e64 v190, 6, v190
    v_mfma_f32_16x16x32_bf16 v[172:175], a[156:159], v[108:111], v[172:175]
    v_xor_b32 v191, s60, v188
    s_waitcnt lgkmcnt(8)
    v_mfma_f32_16x16x32_bf16 v[112:115], a[160:163], v[80:83], v[112:115]
    ds_read_b64_tr_b16 v[104:105], v15 offset:18432
    v_lshl_add_u32 v190, v191, 5, v190
    v_mfma_f32_16x16x32_bf16 v[112:115], a[176:179], v[84:87], v[112:115]
    buffer_load_dwordx4 v8, s[36:39], s67 offen offset:2048 lds
    v_lshl_add_u32 v13, v187, 3, v190
    v_mfma_f32_16x16x32_bf16 v[116:119], a[164:167], v[80:83], v[116:119]
    ds_read_b64_tr_b16 v[106:107], v15 offset:18944
    v_lshl_add_u32 v190, v184, 2, v186
    v_mfma_f32_16x16x32_bf16 v[116:119], a[180:183], v[84:87], v[116:119]
    v_lshlrev_b32_e64 v190, 6, v190
    v_lshl_add_u32 v190, v191, 5, v190
    v_mfma_f32_16x16x32_bf16 v[120:123], a[168:171], v[80:83], v[120:123]
    ds_read_b64_tr_b16 v[108:109], v15 offset:26624
    v_lshl_add_u32 v22, v187, 3, v190
    v_mfma_f32_16x16x32_bf16 v[120:123], a[184:187], v[84:87], v[120:123]
    v_lshl_add_u32 v190, v188, 2, v186
    v_lshrrev_b32_e64 v191, 1, v190
    v_mfma_f32_16x16x32_bf16 v[124:127], a[172:175], v[80:83], v[124:127]
    ds_read_b64_tr_b16 v[110:111], v15 offset:27136
    s_lshl_b32 s65, s60, 1
    v_mfma_f32_16x16x32_bf16 v[124:127], a[188:191], v[84:87], v[124:127]
    s_waitcnt vmcnt(11) lgkmcnt(8)
    s_barrier
    v_mfma_f32_16x16x32_bf16 v[128:131], a[160:163], v[88:91], v[128:131]
    ds_read_b64_tr_b16 v[80:81], v14 offset:32768
    v_xor_b32 v191, s65, v191
    v_mfma_f32_16x16x32_bf16 v[128:131], a[176:179], v[92:95], v[128:131]
    buffer_load_dwordx4 v9, s[36:39], s67 offen offset:3072 lds
    s_add_u32 s67, s72, 589824
    v_mfma_f32_16x16x32_bf16 v[132:135], a[164:167], v[88:91], v[132:135]
    ds_read_b64_tr_b16 v[82:83], v14 offset:33280
    s_add_u32 m0, s70, 16384
    v_mfma_f32_16x16x32_bf16 v[132:135], a[180:183], v[92:95], v[132:135]
    v_lshlrev_b32_e64 v190, 7, v190
    v_lshl_add_u32 v190, v192, 10, v190
    v_mfma_f32_16x16x32_bf16 v[136:139], a[168:171], v[88:91], v[136:139]
    ds_read_b64_tr_b16 v[84:85], v14 offset:40960
    v_lshl_add_u32 v190, v191, 5, v190
    v_mfma_f32_16x16x32_bf16 v[136:139], a[184:187], v[92:95], v[136:139]
    buffer_load_dwordx4 v8, s[32:35], s67 offen offset:0 lds
    v_lshl_add_u32 v20, v187, 3, v190
    v_mfma_f32_16x16x32_bf16 v[140:143], a[172:175], v[88:91], v[140:143]
    ds_read_b64_tr_b16 v[86:87], v14 offset:41472
    v_xor_b32_e64 v21, 32, v20
    v_mfma_f32_16x16x32_bf16 v[140:143], a[188:191], v[92:95], v[140:143]
    v_mov_b32 v189, 0x10000000
    s_waitcnt lgkmcnt(8)
    v_mfma_f32_16x16x32_bf16 v[144:147], a[160:163], v[96:99], v[144:147]
    ds_read_b64_tr_b16 v[88:89], v15 offset:32768
    v_cmp_eq_u32 vcc, 0, v184
    v_mfma_f32_16x16x32_bf16 v[144:147], a[176:179], v[100:103], v[144:147]
    buffer_load_dwordx4 v9, s[32:35], s67 offen offset:1024 lds
    v_lshlrev_b32_e64 v190, 2, v184
    v_mfma_f32_16x16x32_bf16 v[148:151], a[164:167], v[96:99], v[148:151]
    ds_read_b64_tr_b16 v[90:91], v15 offset:33280
    v_sub_u32_e64 v30, v190, v185
    v_mfma_f32_16x16x32_bf16 v[148:151], a[180:183], v[100:103], v[148:151]
    v_cndmask_b32 v31, v189, v2, vcc
    s_lshl_b32 s65, s59, 12
    v_mfma_f32_16x16x32_bf16 v[152:155], a[168:171], v[96:99], v[152:155]
    ds_read_b64_tr_b16 v[92:93], v15 offset:40960
    v_add_u32_e64 v28, s65, v2
    v_mfma_f32_16x16x32_bf16 v[152:155], a[184:187], v[100:103], v[152:155]
    s_cmp_ge_u32 s88, 18
    s_cselect_b64 vcc, -1, 0
    v_mfma_f32_16x16x32_bf16 v[156:159], a[172:175], v[96:99], v[156:159]
    ds_read_b64_tr_b16 v[94:95], v15 offset:41472
    v_lshlrev_b32_e64 v191, 6, v185
    v_mfma_f32_16x16x32_bf16 v[156:159], a[188:191], v[100:103], v[156:159]
    buffer_load_dwordx4 v8, s[36:39], s67 offen offset:2048 lds
    s_waitcnt lgkmcnt(8)
    v_mfma_f32_16x16x32_bf16 v[160:163], a[160:163], v[104:107], v[160:163]
    ds_read_b64_tr_b16 v[96:97], v14 offset:34816
    v_lshl_add_u32 v191, v184, 4, v191
    v_mfma_f32_16x16x32_bf16 v[160:163], a[176:179], v[108:111], v[160:163]
    v_cndmask_b32 v23, v2, v191, vcc
    v_lshlrev_b32_e64 v190, 4, v185
    v_mfma_f32_16x16x32_bf16 v[164:167], a[164:167], v[104:107], v[164:167]
    ds_read_b64_tr_b16 v[98:99], v14 offset:35328
    v_add_u32 v190, 155648, v190
    v_mfma_f32_16x16x32_bf16 v[164:167], a[180:183], v[108:111], v[164:167]
    buffer_load_dwordx4 v9, s[36:39], s67 offen offset:3072 lds
    s_add_u32 s67, s72, 1179648
    v_mfma_f32_16x16x32_bf16 v[168:171], a[168:171], v[104:107], v[168:171]
    ds_read_b64_tr_b16 v[100:101], v14 offset:43008
    s_add_u32 m0, s70, 32768
    v_mfma_f32_16x16x32_bf16 v[168:171], a[184:187], v[108:111], v[168:171]
    v_lshlrev_b32_e64 v191, 4, v184
    v_add_u32 v191, 157696, v191
    v_mfma_f32_16x16x32_bf16 v[172:175], a[172:175], v[104:107], v[172:175]
    ds_read_b64_tr_b16 v[102:103], v14 offset:43520
    v_cndmask_b32_e64 v190, v190, v191, vcc
    v_mfma_f32_16x16x32_bf16 v[172:175], a[188:191], v[108:111], v[172:175]
    s_lshl_b32 s65, s59, 10
    s_waitcnt lgkmcnt(8)
    v_mfma_f32_16x16x32_bf16 v[112:115], a[192:195], v[80:83], v[112:115]
    ds_read_b64_tr_b16 v[104:105], v15 offset:34816
    v_add_u32_e64 v25, s65, v190
    v_mfma_f32_16x16x32_bf16 v[112:115], a[208:211], v[84:87], v[112:115]
    buffer_load_dwordx4 v8, s[32:35], s67 offen offset:0 lds
    s_lshl_b32 s65, s59, 12
    v_mfma_f32_16x16x32_bf16 v[116:119], a[196:199], v[80:83], v[116:119]
    ds_read_b64_tr_b16 v[106:107], v15 offset:35328
    s_lshl_b32 s66, s56, 3
    v_mfma_f32_16x16x32_bf16 v[116:119], a[212:215], v[84:87], v[116:119]
    s_add_u32 s66, s66, s62
    s_mul_i32 s82, s66, 147456
    v_mfma_f32_16x16x32_bf16 v[120:123], a[200:203], v[80:83], v[120:123]
    ds_read_b64_tr_b16 v[108:109], v15 offset:43008
    s_add_u32 s82, s82, s65
    v_mfma_f32_16x16x32_bf16 v[120:123], a[216:219], v[84:87], v[120:123]
    buffer_load_dwordx4 v9, s[32:35], s67 offen offset:1024 lds
    s_add_u32 s82, s82, 0x0
    v_mfma_f32_16x16x32_bf16 v[124:127], a[204:207], v[80:83], v[124:127]
    ds_read_b64_tr_b16 v[110:111], v15 offset:43520
    s_sub_u32 s66, 9, s61
    v_mfma_f32_16x16x32_bf16 v[124:127], a[220:223], v[84:87], v[124:127]
    s_waitcnt vmcnt(14) lgkmcnt(8)
    s_barrier
    v_mfma_f32_16x16x32_bf16 v[128:131], a[192:195], v[88:91], v[128:131]
    ds_read_b64_tr_b16 v[80:81], v14 offset:49152
    s_lshl_b32 s66, s66, 13
    v_mfma_f32_16x16x32_bf16 v[128:131], a[208:211], v[92:95], v[128:131]
    buffer_load_dwordx4 v8, s[36:39], s67 offen offset:2048 lds
    s_add_u32 s83, s82, s66
    v_mfma_f32_16x16x32_bf16 v[132:135], a[196:199], v[88:91], v[132:135]
    ds_read_b64_tr_b16 v[82:83], v14 offset:49664
    s_lshl_b32 s66, s60, 11
    v_mfma_f32_16x16x32_bf16 v[132:135], a[212:215], v[92:95], v[132:135]
    s_xor_b32 s66, s66, s3
    s_add_u32 s83, s83, s66
    v_mfma_f32_16x16x32_bf16 v[136:139], a[200:203], v[88:91], v[136:139]
    ds_read_b64_tr_b16 v[84:85], v14 offset:57344
    s_add_u32 s82, s82, s3
    v_mfma_f32_16x16x32_bf16 v[136:139], a[216:219], v[92:95], v[136:139]
    s_mul_i32 s66, s61, 10
    s_add_u32 s66, s66, s60
    v_mfma_f32_16x16x32_bf16 v[140:143], a[204:207], v[88:91], v[140:143]
    ds_read_b64_tr_b16 v[86:87], v14 offset:57856
    s_sub_u32 s66, 17, s66
    v_mfma_f32_16x16x32_bf16 v[140:143], a[220:223], v[92:95], v[140:143]
    buffer_load_dwordx4 v9, s[36:39], s67 offen offset:3072 lds
    s_waitcnt lgkmcnt(8)
    v_mfma_f32_16x16x32_bf16 v[144:147], a[192:195], v[96:99], v[144:147]
    ds_read_b64_tr_b16 v[88:89], v15 offset:49152
    s_add_u32 s67, s72, 1769472
    v_mfma_f32_16x16x32_bf16 v[144:147], a[208:211], v[100:103], v[144:147]
    s_add_u32 m0, s70, 49152
    s_lshl_b32 s66, s66, 13
    v_mfma_f32_16x16x32_bf16 v[148:151], a[196:199], v[96:99], v[148:151]
    ds_read_b64_tr_b16 v[90:91], v15 offset:49664
    s_add_u32 s82, s82, s66
    v_mfma_f32_16x16x32_bf16 v[148:151], a[212:215], v[100:103], v[148:151]
    buffer_load_dwordx4 v8, s[32:35], s67 offen offset:0 lds
    s_lshl_b32 s65, s61, 6
    v_mfma_f32_16x16x32_bf16 v[152:155], a[200:203], v[96:99], v[152:155]
    ds_read_b64_tr_b16 v[92:93], v15 offset:57344
    s_add_u32 s65, s65, 512
    v_mfma_f32_16x16x32_bf16 v[152:155], a[216:219], v[100:103], v[152:155]
    s_mul_i32 s64, s62, 663552
    s_mul_i32 s66, s61, 626688
    v_mfma_f32_16x16x32_bf16 v[156:159], a[204:207], v[96:99], v[156:159]
    ds_read_b64_tr_b16 v[94:95], v15 offset:57856
    s_add_u32 s64, s64, s66
    v_mfma_f32_16x16x32_bf16 v[156:159], a[220:223], v[100:103], v[156:159]
    s_mul_i32 s74, s61, 640
    s_waitcnt lgkmcnt(8)
    v_mfma_f32_16x16x32_bf16 v[160:163], a[192:195], v[104:107], v[160:163]
    ds_read_b64_tr_b16 v[96:97], v14 offset:51200
    s_add_u32 s74, s74, s64
    v_mfma_f32_16x16x32_bf16 v[160:163], a[208:211], v[108:111], v[160:163]
    buffer_load_dwordx4 v9, s[32:35], s67 offen offset:1024 lds
    s_mul_i32 s66, s60, s75
    v_mfma_f32_16x16x32_bf16 v[164:167], a[196:199], v[104:107], v[164:167]
    ds_read_b64_tr_b16 v[98:99], v14 offset:51712
    s_mul_i32 s66, s66, 36864
    v_mfma_f32_16x16x32_bf16 v[164:167], a[212:215], v[108:111], v[164:167]
    s_add_u32 s74, s74, s66
    s_mul_i32 s66, s59, 18432
    v_mfma_f32_16x16x32_bf16 v[168:171], a[200:203], v[104:107], v[168:171]
    ds_read_b64_tr_b16 v[100:101], v14 offset:59392
    s_add_u32 s74, s74, s66
    v_mfma_f32_16x16x32_bf16 v[168:171], a[216:219], v[108:111], v[168:171]
    buffer_load_dwordx4 v8, s[36:39], s67 offen offset:2048 lds
    s_add_u32 s64, s64, s65
    v_mfma_f32_16x16x32_bf16 v[172:175], a[204:207], v[104:107], v[172:175]
    ds_read_b64_tr_b16 v[102:103], v14 offset:59904
    v_mfma_f32_16x16x32_bf16 v[172:175], a[220:223], v[108:111], v[172:175]
    s_waitcnt lgkmcnt(8)
    v_mfma_f32_16x16x32_bf16 v[112:115], a[224:227], v[80:83], v[112:115]
    ds_read_b64_tr_b16 v[104:105], v15 offset:51200
    v_mfma_f32_16x16x32_bf16 v[112:115], a[240:243], v[84:87], v[112:115]
    buffer_load_dwordx4 v9, s[36:39], s67 offen offset:3072 lds
    s_add_u32 s67, s72, 2359296
    v_mfma_f32_16x16x32_bf16 v[116:119], a[228:231], v[80:83], v[116:119]
    ds_read_b64_tr_b16 v[106:107], v15 offset:51712
    s_add_u32 m0, s70, 65536
    v_mfma_f32_16x16x32_bf16 v[116:119], a[244:247], v[84:87], v[116:119]
    v_mfma_f32_16x16x32_bf16 v[120:123], a[232:235], v[80:83], v[120:123]
    ds_read_b64_tr_b16 v[108:109], v15 offset:59392
    v_mfma_f32_16x16x32_bf16 v[120:123], a[248:251], v[84:87], v[120:123]
    v_mfma_f32_16x16x32_bf16 v[124:127], a[236:239], v[80:83], v[124:127]
    ds_read_b64_tr_b16 v[110:111], v15 offset:59904
    v_mfma_f32_16x16x32_bf16 v[124:127], a[252:255], v[84:87], v[124:127]
    v_add_u32 v14, 0x10000, v14
    s_waitcnt vmcnt(16) lgkmcnt(8)
    s_barrier
    v_mfma_f32_16x16x32_bf16 v[128:131], a[224:227], v[88:91], v[128:131]
    ds_read_b64_tr_b16 v[80:81], v14 offset:0
    v_mfma_f32_16x16x32_bf16 v[128:131], a[240:243], v[92:95], v[128:131]
    buffer_load_dwordx4 v8, s[32:35], s67 offen offset:0 lds
    v_mfma_f32_16x16x32_bf16 v[132:135], a[228:231], v[88:91], v[132:135]
    ds_read_b64_tr_b16 v[82:83], v14 offset:512
    v_mfma_f32_16x16x32_bf16 v[132:135], a[244:247], v[92:95], v[132:135]
    v_mfma_f32_16x16x32_bf16 v[136:139], a[232:235], v[88:91], v[136:139]
    ds_read_b64_tr_b16 v[84:85], v14 offset:8192
    v_mfma_f32_16x16x32_bf16 v[136:139], a[248:251], v[92:95], v[136:139]
    buffer_load_dwordx4 v9, s[32:35], s67 offen offset:1024 lds
    v_mfma_f32_16x16x32_bf16 v[140:143], a[236:239], v[88:91], v[140:143]
    ds_read_b64_tr_b16 v[86:87], v14 offset:8704
    v_mfma_f32_16x16x32_bf16 v[140:143], a[252:255], v[92:95], v[140:143]
    v_add_u32 v15, 0x10000, v15
    s_waitcnt lgkmcnt(8)
    v_mfma_f32_16x16x32_bf16 v[144:147], a[224:227], v[96:99], v[144:147]
    ds_read_b64_tr_b16 v[88:89], v15 offset:0
    v_add_u32_e64 v68, v68, v69
    v_mfma_f32_16x16x32_bf16 v[144:147], a[240:243], v[100:103], v[144:147]
    buffer_load_dwordx4 v8, s[36:39], s67 offen offset:2048 lds
    v_mfma_f32_16x16x32_bf16 v[148:151], a[228:231], v[96:99], v[148:151]
    ds_read_b64_tr_b16 v[90:91], v15 offset:512
    v_mfma_f32_16x16x32_bf16 v[148:151], a[244:247], v[100:103], v[148:151]
    s_cmp_eq_u32 s18, 2
    s_cselect_b32 s21, s20, 0x10000000
    v_mfma_f32_16x16x32_bf16 v[152:155], a[232:235], v[96:99], v[152:155]
    ds_read_b64_tr_b16 v[92:93], v15 offset:8192
    v_mfma_f32_16x16x32_bf16 v[152:155], a[248:251], v[100:103], v[152:155]
    v_mfma_f32_16x16x32_bf16 v[156:159], a[236:239], v[96:99], v[156:159]
    ds_read_b64_tr_b16 v[94:95], v15 offset:8704
    v_mfma_f32_16x16x32_bf16 v[156:159], a[252:255], v[100:103], v[156:159]
    buffer_load_dwordx4 v9, s[36:39], s67 offen offset:3072 lds
    s_waitcnt lgkmcnt(8)
    v_mfma_f32_16x16x32_bf16 v[160:163], a[224:227], v[104:107], v[160:163]
    ds_read_b64_tr_b16 v[96:97], v14 offset:2048
    s_add_u32 s67, s72, 2949120
    v_mfma_f32_16x16x32_bf16 v[160:163], a[240:243], v[108:111], v[160:163]
    s_add_u32 m0, s70, 81920
    v_mfma_f32_16x16x32_bf16 v[164:167], a[228:231], v[104:107], v[164:167]
    ds_read_b64_tr_b16 v[98:99], v14 offset:2560
    v_mfma_f32_16x16x32_bf16 v[164:167], a[244:247], v[108:111], v[164:167]
    buffer_load_dwordx4 v8, s[32:35], s67 offen offset:0 lds
    v_mfma_f32_16x16x32_bf16 v[168:171], a[232:235], v[104:107], v[168:171]
    ds_read_b64_tr_b16 v[100:101], v14 offset:10240
    v_mfma_f32_16x16x32_bf16 v[168:171], a[248:251], v[108:111], v[168:171]
    v_mfma_f32_16x16x32_bf16 v[172:175], a[236:239], v[104:107], v[172:175]
    ds_read_b64_tr_b16 v[102:103], v14 offset:10752
    v_mfma_f32_16x16x32_bf16 v[172:175], a[252:255], v[108:111], v[172:175]
    s_waitcnt lgkmcnt(8)
    v_mfma_f32_16x16x32_bf16 v[112:115], v[32:35], v[80:83], v[112:115]
    ds_read_b64_tr_b16 v[104:105], v15 offset:2048
    v_mfma_f32_16x16x32_bf16 v[112:115], v[48:51], v[84:87], v[112:115]
    buffer_load_dword v0, v68, s[32:35], s21 offen offset:0
    v_mfma_f32_16x16x32_bf16 v[116:119], v[36:39], v[80:83], v[116:119]
    ds_read_b64_tr_b16 v[106:107], v15 offset:2560
    v_mfma_f32_16x16x32_bf16 v[116:119], v[52:55], v[84:87], v[116:119]
    s_cmp_eq_u32 s18, 3
    s_cselect_b32 s21, s20, 0x10000000
    v_mfma_f32_16x16x32_bf16 v[120:123], v[40:43], v[80:83], v[120:123]
    ds_read_b64_tr_b16 v[108:109], v15 offset:10240
    v_mfma_f32_16x16x32_bf16 v[120:123], v[56:59], v[84:87], v[120:123]
    buffer_load_dword v0, v68, s[36:39], s21 offen offset:2048
    v_mfma_f32_16x16x32_bf16 v[124:127], v[44:47], v[80:83], v[124:127]
    ds_read_b64_tr_b16 v[110:111], v15 offset:10752
    v_mfma_f32_16x16x32_bf16 v[124:127], v[60:63], v[84:87], v[124:127]
    s_waitcnt vmcnt(19) lgkmcnt(8)
    s_barrier
    v_mfma_f32_16x16x32_bf16 v[128:131], v[32:35], v[88:91], v[128:131]
    ds_read_b64_tr_b16 v[80:81], v11 offset:0
    v_mfma_f32_16x16x32_bf16 v[128:131], v[48:51], v[92:95], v[128:131]
    v_mfma_f32_16x16x32_bf16 v[132:135], v[36:39], v[88:91], v[132:135]
    ds_read_b64_tr_b16 v[82:83], v11 offset:512
    v_mfma_f32_16x16x32_bf16 v[132:135], v[52:55], v[92:95], v[132:135]
    v_mfma_f32_16x16x32_bf16 v[136:139], v[40:43], v[88:91], v[136:139]
    ds_read_b64_tr_b16 v[84:85], v11 offset:8192
    v_mfma_f32_16x16x32_bf16 v[136:139], v[56:59], v[92:95], v[136:139]
    v_mfma_f32_16x16x32_bf16 v[140:143], v[44:47], v[88:91], v[140:143]
    ds_read_b64_tr_b16 v[86:87], v11 offset:8704
    v_mfma_f32_16x16x32_bf16 v[140:143], v[60:63], v[92:95], v[140:143]
    s_waitcnt lgkmcnt(8)
    v_mfma_f32_16x16x32_bf16 v[144:147], v[32:35], v[96:99], v[144:147]
    ds_read_b64_tr_b16 v[88:89], v12 offset:0
    v_mfma_f32_16x16x32_bf16 v[144:147], v[48:51], v[100:103], v[144:147]
    v_mfma_f32_16x16x32_bf16 v[148:151], v[36:39], v[96:99], v[148:151]
    ds_read_b64_tr_b16 v[90:91], v12 offset:512
    v_mfma_f32_16x16x32_bf16 v[148:151], v[52:55], v[100:103], v[148:151]
    v_mfma_f32_16x16x32_bf16 v[152:155], v[40:43], v[96:99], v[152:155]
    ds_read_b64_tr_b16 v[92:93], v12 offset:8192
    v_mfma_f32_16x16x32_bf16 v[152:155], v[56:59], v[100:103], v[152:155]
    v_mfma_f32_16x16x32_bf16 v[156:159], v[44:47], v[96:99], v[156:159]
    ds_read_b64_tr_b16 v[94:95], v12 offset:8704
    v_mfma_f32_16x16x32_bf16 v[156:159], v[60:63], v[100:103], v[156:159]
    s_waitcnt lgkmcnt(8)
    v_mfma_f32_16x16x32_bf16 v[160:163], v[32:35], v[104:107], v[160:163]
    ds_read_b64_tr_b16 v[96:97], v11 offset:2048
    v_mfma_f32_16x16x32_bf16 v[160:163], v[48:51], v[108:111], v[160:163]
    v_mfma_f32_16x16x32_bf16 v[164:167], v[36:39], v[104:107], v[164:167]
    ds_read_b64_tr_b16 v[98:99], v11 offset:2560
    v_mfma_f32_16x16x32_bf16 v[164:167], v[52:55], v[108:111], v[164:167]
    v_mfma_f32_16x16x32_bf16 v[168:171], v[40:43], v[104:107], v[168:171]
    ds_read_b64_tr_b16 v[100:101], v11 offset:10240
    v_mfma_f32_16x16x32_bf16 v[168:171], v[56:59], v[108:111], v[168:171]
    v_mfma_f32_16x16x32_bf16 v[172:175], v[44:47], v[104:107], v[172:175]
    ds_read_b64_tr_b16 v[102:103], v11 offset:10752
    v_mfma_f32_16x16x32_bf16 v[172:175], v[60:63], v[108:111], v[172:175]
    s_branch qkv_e
qkv_k:
    s_waitcnt lgkmcnt(12)
    v_mfma_f32_16x16x32_bf16 v[112:115], v[80:83], a[0:3], 0
    v_mfma_f32_16x16x32_bf16 v[112:115], v[84:87], a[16:19], v[112:115]
    v_mfma_f32_16x16x32_bf16 v[116:119], v[80:83], a[4:7], 0
    v_add_f32_dpp v26, v26, v26 quad_perm:[1,0,3,2] row_mask:0xf bank_mask:0xf
    v_mfma_f32_16x16x32_bf16 v[116:119], v[84:87], a[20:23], v[116:119]
    v_add_f32_dpp v27, v27, v27 quad_perm:[1,0,3,2] row_mask:0xf bank_mask:0xf
    s_waitcnt lgkmcnt(7)
    v_mfma_f32_16x16x32_bf16 v[120:123], v[80:83], a[8:11], 0
    v_add_f32_dpp v24, v24, v24 quad_perm:[1,0,3,2] row_mask:0xf bank_mask:0xf
    s_waitcnt lgkmcnt(5)
    v_mfma_f32_16x16x32_bf16 v[120:123], v[84:87], a[24:27], v[120:123]
    v_add_f32_dpp v25, v25, v25 quad_perm:[1,0,3,2] row_mask:0xf bank_mask:0xf
    v_mfma_f32_16x16x32_bf16 v[124:127], v[80:83], a[12:15], 0
    v_add_f32_dpp v26, v26, v26 quad_perm:[2,3,0,1] row_mask:0xf bank_mask:0xf
    s_waitcnt lgkmcnt(4)
    v_mfma_f32_16x16x32_bf16 v[124:127], v[84:87], a[28:31], v[124:127]
    s_waitcnt vmcnt(14)
    s_barrier
    v_mfma_f32_16x16x32_bf16 v[128:131], v[88:91], a[0:3], 0
    ds_read_b64_tr_b16 v[80:81], v14 offset:16384
    v_add_f32_dpp v27, v27, v27 quad_perm:[2,3,0,1] row_mask:0xf bank_mask:0xf
    v_mfma_f32_16x16x32_bf16 v[128:131], v[92:95], a[16:19], v[128:131]
    ds_read_b128 a[72:75], v65 offset:4096
    v_add_f32_dpp v24, v24, v24 quad_perm:[2,3,0,1] row_mask:0xf bank_mask:0xf
    v_mfma_f32_16x16x32_bf16 v[132:135], v[88:91], a[4:7], 0
    ds_read_b64_tr_b16 v[82:83], v14 offset:16896
    v_add_f32_dpp v25, v25, v25 quad_perm:[2,3,0,1] row_mask:0xf bank_mask:0xf
    v_mfma_f32_16x16x32_bf16 v[132:135], v[92:95], a[20:23], v[132:135]
    ds_read_b128 a[76:79], v65 offset:22528
    v_add_f32_dpp v26, v26, v26 row_half_mirror row_mask:0xf bank_mask:0xf
    v_mfma_f32_16x16x32_bf16 v[136:139], v[88:91], a[8:11], 0
    ds_read_b64_tr_b16 v[84:85], v14 offset:24576
    v_add_f32_dpp v27, v27, v27 row_half_mirror row_mask:0xf bank_mask:0xf
    v_mfma_f32_16x16x32_bf16 v[136:139], v[92:95], a[24:27], v[136:139]
    ds_read_b128 a[88:91], v66 offset:5120
    v_add_f32_dpp v24, v24, v24 row_half_mirror row_mask:0xf bank_mask:0xf
    v_mfma_f32_16x16x32_bf16 v[140:143], v[88:91], a[12:15], 0
    ds_read_b64_tr_b16 v[86:87], v14 offset:25088
    v_add_f32_dpp v25, v25, v25 row_half_mirror row_mask:0xf bank_mask:0xf
    v_mfma_f32_16x16x32_bf16 v[140:143], v[92:95], a[28:31], v[140:143]
    ds_read_b128 a[92:95], v66 offset:23552
    ds_read_b64_tr_b16 v[88:89], v15 offset:16384
    s_nop 0
    s_mov_b32 s76, 0xaaaaaaaa
    ds_read_b128 a[104:107], v65 offset:6144
    s_mov_b32 s77, 0xaaaaaaaa
    ds_read_b64_tr_b16 v[90:91], v15 offset:16896
    v_cndmask_b32 v26, v26, v27, s[76:77]
    ds_read_b128 a[108:111], v65 offset:24576
    v_cndmask_b32 v24, v24, v25, s[76:77]
    ds_read_b64_tr_b16 v[92:93], v15 offset:24576
    s_mov_b32 s76, 0xcccccccc
    ds_read_b128 a[120:123], v66 offset:7168
    s_mov_b32 s77, 0xcccccccc
    ds_read_b64_tr_b16 v[94:95], v15 offset:25088
    v_mov_b32 v181, 0x3727c5ac
    ds_read_b128 a[124:127], v66 offset:25600
    v_cndmask_b32 v26, v26, v24, s[76:77]
    ds_read_b128 a[136:139], v65 offset:8192
    v_fmac_f32 v181, 0x3ae38e39, v26
    ds_read_b128 a[140:143], v65 offset:26624
    ds_read_b128 a[152:155], v66 offset:9216
    ds_read_b128 a[156:159], v66 offset:27648
    s_waitcnt lgkmcnt(13)
    v_mfma_f32_16x16x32_bf16 v[112:115], v[80:83], a[32:35], v[112:115]
    v_lshrrev_b32 v68, 2, v1
    v_mfma_f32_16x16x32_bf16 v[112:115], v[84:87], a[48:51], v[112:115]
    ds_read_b128 a[168:171], v65 offset:10240
    v_mul_u32_u24 v68, 9216, v68
    v_mfma_f32_16x16x32_bf16 v[116:119], v[80:83], a[36:39], v[116:119]
    v_bfe_u32 v69, v1, 1, 1
    v_mfma_f32_16x16x32_bf16 v[116:119], v[84:87], a[52:55], v[116:119]
    ds_read_b128 a[172:175], v65 offset:28672
    v_mul_u32_u24 v69, 1152, v69
    v_mfma_f32_16x16x32_bf16 v[120:123], v[80:83], a[40:43], v[120:123]
    v_add_u32_e64 v68, v68, v69
    v_mfma_f32_16x16x32_bf16 v[120:123], v[84:87], a[56:59], v[120:123]
    ds_read_b128 a[184:187], v66 offset:11264
    v_and_b32_e64 v69, 1, v1
    v_mfma_f32_16x16x32_bf16 v[124:127], v[80:83], a[44:47], v[124:127]
    v_lshl_add_u32 v68, v69, 10, v68
    v_mfma_f32_16x16x32_bf16 v[124:127], v[84:87], a[60:63], v[124:127]
    s_waitcnt vmcnt(10) lgkmcnt(8)
    s_barrier
    v_mfma_f32_16x16x32_bf16 v[128:131], v[88:91], a[32:35], v[128:131]
    ds_read_b64_tr_b16 v[80:81], v14 offset:32768
    v_cmp_gt_u32 s[18:19], 36, v1
    v_mfma_f32_16x16x32_bf16 v[128:131], v[92:95], a[48:51], v[128:131]
    ds_read_b128 a[188:191], v66 offset:29696
    v_mov_b32 v70, 0x10000000
    v_mfma_f32_16x16x32_bf16 v[132:135], v[88:91], a[36:39], v[132:135]
    ds_read_b64_tr_b16 v[82:83], v14 offset:33280
    v_lshlrev_b32_e64 v69, 8, v69
    v_mfma_f32_16x16x32_bf16 v[132:135], v[92:95], a[52:55], v[132:135]
    ds_read_b128 a[200:203], v65 offset:12288
    v_cndmask_b32 v68, v70, v68, s[18:19]
    v_mfma_f32_16x16x32_bf16 v[136:139], v[88:91], a[40:43], v[136:139]
    ds_read_b64_tr_b16 v[84:85], v14 offset:40960
    v_sub_u32 v69, 128, v69
    v_mfma_f32_16x16x32_bf16 v[136:139], v[92:95], a[56:59], v[136:139]
    ds_read_b128 a[204:207], v65 offset:30720
    s_lshr_b32 s18, s2, 5
    v_mfma_f32_16x16x32_bf16 v[140:143], v[88:91], a[44:47], v[140:143]
    ds_read_b64_tr_b16 v[86:87], v14 offset:41472
    s_lshl_b32 s18, s18, 3
    v_mfma_f32_16x16x32_bf16 v[140:143], v[92:95], a[60:63], v[140:143]
    ds_read_b128 a[216:219], v66 offset:13312
    ds_read_b64_tr_b16 v[88:89], v15 offset:32768
    s_and_b32 s19, s2, 7
    ds_read_b128 a[220:223], v66 offset:31744
    s_or_b32 s18, s18, s19
    ds_read_b64_tr_b16 v[90:91], v15 offset:33280
    s_mul_i32 s20, s18, 82944
    ds_read_b128 a[232:235], v65 offset:14336
    s_mul_i32 s19, s58, 2304
    ds_read_b64_tr_b16 v[92:93], v15 offset:40960
    s_add_u32 s20, s20, s19
    ds_read_b128 a[236:239], v65 offset:32768
    s_and_b32 s18, s101, 3
    ds_read_b64_tr_b16 v[94:95], v15 offset:41472
    v_add_u32_e64 v68, v68, v69
    ds_read_b128 a[248:251], v66 offset:15360
    ds_read_b128 a[252:255], v66 offset:33792
    ds_read_b128 v[40:43], v65 offset:16384
    ds_read_b128 v[44:47], v65 offset:34816
    ds_read_b128 v[56:59], v66 offset:17408
    s_waitcnt lgkmcnt(13)
    v_mfma_f32_16x16x32_bf16 v[112:115], v[80:83], a[64:67], v[112:115]
    v_mfma_f32_16x16x32_bf16 v[112:115], v[84:87], a[80:83], v[112:115]
    ds_read_b128 v[60:63], v66 offset:35840
    v_mfma_f32_16x16x32_bf16 v[116:119], v[80:83], a[68:71], v[116:119]
    v_mfma_f32_16x16x32_bf16 v[116:119], v[84:87], a[84:87], v[116:119]
    v_rsq_f32 v176, v181
    v_mfma_f32_16x16x32_bf16 v[120:123], v[80:83], a[72:75], v[120:123]
    v_lshlrev_b32_e64 v180, 3, v1
    v_mfma_f32_16x16x32_bf16 v[120:123], v[84:87], a[88:91], v[120:123]
    v_xor_b32 v180, s97, v180
    v_and_b32 v180, 8, v180
    v_mfma_f32_16x16x32_bf16 v[124:127], v[80:83], a[76:79], v[124:127]
    v_add_u32_e64 v180, v180, v67
    v_mfma_f32_16x16x32_bf16 v[124:127], v[84:87], a[92:95], v[124:127]
    s_waitcnt vmcnt(6) lgkmcnt(0)
    s_barrier
    v_mfma_f32_16x16x32_bf16 v[128:131], v[88:91], a[64:67], v[128:131]
    ds_read_b64_tr_b16 v[80:81], v14 offset:49152
    s_add_u32 s67, s92, 1105920
    v_mfma_f32_16x16x32_bf16 v[128:131], v[92:95], a[80:83], v[128:131]
    s_add_u32 m0, s70, 81920
    v_and_b32_e64 v181, 2, v1
    v_mfma_f32_16x16x32_bf16 v[132:135], v[88:91], a[68:71], v[132:135]
    ds_read_b64_tr_b16 v[82:83], v14 offset:49664
    v_lshl_add_u32 v180, v181, 4, v180
    v_mfma_f32_16x16x32_bf16 v[132:135], v[92:95], a[84:87], v[132:135]
    buffer_load_dwordx4 v3, s[28:31], s67 offen offset:0 lds
    v_mov_b32_e64 v177, v176
    v_mfma_f32_16x16x32_bf16 v[136:139], v[88:91], a[72:75], v[136:139]
    ds_read_b64_tr_b16 v[84:85], v14 offset:57344
    v_mov_b32_e64 v178, v176
    v_mfma_f32_16x16x32_bf16 v[136:139], v[92:95], a[88:91], v[136:139]
    v_mov_b32_e64 v179, v176
    v_and_b32 v181, 0x70, v180
    v_mfma_f32_16x16x32_bf16 v[140:143], v[88:91], a[76:79], v[140:143]
    ds_read_b64_tr_b16 v[86:87], v14 offset:57856
    v_mul_u32_u24_e64 v181, 12, v181
    v_mfma_f32_16x16x32_bf16 v[140:143], v[92:95], a[92:95], v[140:143]
    buffer_load_dwordx4 v4, s[28:31], s67 offen offset:1024 lds
    ds_read_b64_tr_b16 v[88:89], v15 offset:49152
    v_lshl_add_u32 v181, v180, 2, v181
    v_add_u32 v181, 157696, v181
    v_lshlrev_b32_e64 v193, 2, v180
    ds_read_b64_tr_b16 v[90:91], v15 offset:49664
    v_add_u32 v193, 163328, v193
    buffer_load_dwordx4 v5, s[28:31], s67 offen offset:2048 lds
    v_lshlrev_b32_e64 v180, 4, v180
    ds_read_b64_tr_b16 v[92:93], v15 offset:57344
    v_add_u32 v180, 155648, v180
    ds_write_b128 v180, v[176:179]
    ds_read_b64_tr_b16 v[94:95], v15 offset:57856
    ds_write_b32 v181, v176
    buffer_load_dwordx4 v6, s[28:31], s67 offen offset:3072 lds
    s_add_u32 s67, s92, 1327104
    s_add_u32 m0, s70, 98304
    ds_write_b32 v193, v176
    s_mul_i32 s71, s58, 3072
    s_lshl_b32 s65, s56, 4
    buffer_load_dwordx4 v3, s[28:31], s67 offen offset:0 lds
    s_add_u32 s65, s65, s57
    v_mov_b32_e64 v207, 0
    s_xor_b32 s7, s6, 128
    s_waitcnt lgkmcnt(7)
    v_mfma_f32_16x16x32_bf16 v[112:115], v[80:83], a[96:99], v[112:115]
    s_mul_i32 s79, s65, 73728
    v_mfma_f32_16x16x32_bf16 v[112:115], v[84:87], a[112:115], v[112:115]
    s_xor_b32 s65, s65, 1
    s_mul_i32 s81, s65, 73728
    v_mfma_f32_16x16x32_bf16 v[116:119], v[80:83], a[100:103], v[116:119]
    s_lshl_b32 s65, s59, 12
    v_mfma_f32_16x16x32_bf16 v[116:119], v[84:87], a[116:119], v[116:119]
    buffer_load_dwordx4 v4, s[28:31], s67 offen offset:1024 lds
    s_add_u32 s79, s79, s65
    v_mfma_f32_16x16x32_bf16 v[120:123], v[80:83], a[104:107], v[120:123]
    s_lshl_b32 s66, s60, 11
    v_mfma_f32_16x16x32_bf16 v[120:123], v[84:87], a[120:123], v[120:123]
    s_add_u32 s80, s79, s66
    s_add_u32 s80, s80, 65536
    v_mfma_f32_16x16x32_bf16 v[124:127], v[80:83], a[108:111], v[124:127]
    s_add_u32 s81, s81, s65
    v_mfma_f32_16x16x32_bf16 v[124:127], v[84:87], a[124:127], v[124:127]
    v_add_u32 v14, 0x10000, v14
    s_waitcnt vmcnt(8) lgkmcnt(2)
    s_barrier
    v_mfma_f32_16x16x32_bf16 v[128:131], v[88:91], a[96:99], v[128:131]
    ds_read_b64_tr_b16 v[80:81], v14 offset:0
    s_lshl_b32 s66, s60, 13
    v_mfma_f32_16x16x32_bf16 v[128:131], v[92:95], a[112:115], v[128:131]
    buffer_load_dwordx4 v5, s[28:31], s67 offen offset:2048 lds
    s_add_u32 s79, s79, s66
    v_mfma_f32_16x16x32_bf16 v[132:135], v[88:91], a[100:103], v[132:135]
    ds_read_b64_tr_b16 v[82:83], v14 offset:512
    s_mul_i32 s73, s62, 1152
    v_mfma_f32_16x16x32_bf16 v[132:135], v[92:95], a[116:119], v[132:135]
    s_lshl_b32 s65, s61, 6
    s_add_u32 s65, s65, 512
    v_mfma_f32_16x16x32_bf16 v[136:139], v[88:91], a[104:107], v[136:139]
    ds_read_b64_tr_b16 v[84:85], v14 offset:8192
    s_add_u32 s73, s73, s65
    v_mfma_f32_16x16x32_bf16 v[136:139], v[92:95], a[120:123], v[136:139]
    buffer_load_dwordx4 v6, s[28:31], s67 offen offset:3072 lds
    s_add_u32 s67, s92, 1548288
    v_mfma_f32_16x16x32_bf16 v[140:143], v[88:91], a[108:111], v[140:143]
    ds_read_b64_tr_b16 v[86:87], v14 offset:8704
    s_add_u32 m0, s70, 114688
    v_mfma_f32_16x16x32_bf16 v[140:143], v[92:95], a[124:127], v[140:143]
    v_add_u32 v15, 0x10000, v15
    ds_read_b64_tr_b16 v[88:89], v15 offset:0
    s_mul_i32 s66, s59, 442368
    buffer_load_dwordx4 v3, s[28:31], s67 offen offset:0 lds
    s_add_u32 s73, s73, s66
    ds_read_b64_tr_b16 v[90:91], v15 offset:512
    s_mul_i32 s65, s63, 55296
    s_lshl_b32 s66, s88, 12
    s_add_u32 s65, s65, s66
    ds_read_b64_tr_b16 v[92:93], v15 offset:8192
    s_lshl_b32 s66, s60, 11
    s_add_u32 s65, s65, s66
    s_add_u32 s65, s65, 0x241b000
    ds_read_b64_tr_b16 v[94:95], v15 offset:8704
    s_and_b32 s3, s3, 2
    buffer_load_dwordx4 v4, s[28:31], s67 offen offset:1024 lds
    s_mul_i32 s66, s3, 55296
    s_add_u32 s65, s65, s66
    s_sub_u32 s89, 1, s3
    s_mul_i32 s89, s89, 110592
    buffer_load_dwordx4 v5, s[28:31], s67 offen offset:2048 lds
    s_lshl_b32 s3, s3, 10
    s_add_u32 s91, s91, 4096
    s_mov_b32 s87, s65
    s_mul_i32 s10, s90, 331776
    s_mul_i32 s65, s86, 20736
    s_add_u32 s10, s10, s65
    s_waitcnt lgkmcnt(4)
    v_mfma_f32_16x16x32_bf16 v[112:115], v[80:83], a[128:131], v[112:115]
    s_mul_i32 s65, s58, 5248
    v_mfma_f32_16x16x32_bf16 v[112:115], v[84:87], a[144:147], v[112:115]
    buffer_load_dwordx4 v6, s[28:31], s67 offen offset:3072 lds
    s_add_u32 s67, s92, 1769472
    v_mfma_f32_16x16x32_bf16 v[116:119], v[80:83], a[132:135], v[116:119]
    s_add_u32 m0, s70, 131072
    v_mfma_f32_16x16x32_bf16 v[116:119], v[84:87], a[148:151], v[116:119]
    s_add_u32 s10, s10, s65
    v_lshlrev_b32_e64 v2, 4, v1
    v_mfma_f32_16x16x32_bf16 v[120:123], v[80:83], a[136:139], v[120:123]
    v_lshrrev_b32_e64 v182, 3, v1
    v_mfma_f32_16x16x32_bf16 v[120:123], v[84:87], a[152:155], v[120:123]
    buffer_load_dwordx4 v3, s[28:31], s67 offen offset:0 lds
    v_and_b32_e64 v183, 7, v1
    v_mfma_f32_16x16x32_bf16 v[124:127], v[80:83], a[140:143], v[124:127]
    v_lshrrev_b32_e64 v184, 4, v1
    v_mfma_f32_16x16x32_bf16 v[124:127], v[84:87], a[156:159], v[124:127]
    s_waitcnt vmcnt(9) lgkmcnt(0)
    s_barrier
    v_mfma_f32_16x16x32_bf16 v[128:131], v[88:91], a[128:131], v[128:131]
    ds_read_b64_tr_b16 v[80:81], v14 offset:16384
    v_and_b32_e64 v185, 15, v1
    v_mfma_f32_16x16x32_bf16 v[128:131], v[92:95], a[144:147], v[128:131]
    buffer_load_dwordx4 v4, s[28:31], s67 offen offset:1024 lds
    v_and_b32_e64 v186, 6, v182
    v_mfma_f32_16x16x32_bf16 v[132:135], v[88:91], a[132:135], v[132:135]
    ds_read_b64_tr_b16 v[82:83], v14 offset:16896
    v_xor_b32_e64 v186, v183, v186
    v_mfma_f32_16x16x32_bf16 v[132:135], v[92:95], a[148:151], v[132:135]
    v_mul_u32_u24 v187, 1152, v182
    v_lshl_add_u32 v187, v186, 4, v187
    v_mfma_f32_16x16x32_bf16 v[136:139], v[88:91], a[136:139], v[136:139]
    ds_read_b64_tr_b16 v[84:85], v14 offset:24576
    v_add_u32 v16, 2048, v187
    v_mfma_f32_16x16x32_bf16 v[136:139], v[92:95], a[152:155], v[136:139]
    v_add_u32 v17, 10240, v187
    v_add_u32 v18, 128, v187
    v_mfma_f32_16x16x32_bf16 v[140:143], v[88:91], a[140:143], v[140:143]
    ds_read_b64_tr_b16 v[86:87], v14 offset:25088
    v_add_u32 v19, 8320, v187
    v_mfma_f32_16x16x32_bf16 v[140:143], v[92:95], a[156:159], v[140:143]
    buffer_load_dwordx4 v5, s[28:31], s67 offen offset:2048 lds
    ds_read_b64_tr_b16 v[88:89], v15 offset:16384
    v_lshrrev_b32 v186, 2, v1
    v_and_b32 v187, 3, v1
    v_and_b32_e64 v188, 2, v184
    ds_read_b64_tr_b16 v[90:91], v15 offset:16896
    v_xor_b32_e64 v188, v187, v188
    buffer_load_dwordx4 v6, s[28:31], s67 offen offset:3072 lds
    s_add_u32 s67, s72, 0
    ds_read_b64_tr_b16 v[92:93], v15 offset:24576
    s_add_u32 m0, s70, 0
    v_mul_u32_u24 v190, 9216, v186
    v_lshl_add_u32 v10, v188, 4, v190
    ds_read_b64_tr_b16 v[94:95], v15 offset:25088
    v_and_b32 v188, 1, v184
    v_lshlrev_b32 v188, 1, v188
    v_xor_b32_e64 v188, v187, v188
    buffer_load_dwordx4 v8, s[32:35], s67 offen offset:0 lds
    v_mul_u32_u24 v190, 1152, v186
    v_lshl_add_u32 v7, v188, 4, v190
    v_lshrrev_b32 v186, 2, v185
    v_and_b32 v188, 1, v184
    v_lshrrev_b32_e64 v192, 1, v184
    buffer_load_dwordx4 v9, s[32:35], s67 offen offset:1024 lds
    v_lshl_add_u32 v190, v184, 3, v186
    v_lshlrev_b32_e64 v190, 6, v190
    v_xor_b32 v191, s60, v188
    s_waitcnt lgkmcnt(4)
    v_mfma_f32_16x16x32_bf16 v[112:115], v[80:83], a[160:163], v[112:115]
    v_lshl_add_u32 v190, v191, 5, v190
    v_mfma_f32_16x16x32_bf16 v[112:115], v[84:87], a[176:179], v[112:115]
    buffer_load_dwordx4 v8, s[36:39], s67 offen offset:2048 lds
    v_lshl_add_u32 v13, v187, 3, v190
    v_mfma_f32_16x16x32_bf16 v[116:119], v[80:83], a[164:167], v[116:119]
    v_lshl_add_u32 v190, v184, 2, v186
    v_mfma_f32_16x16x32_bf16 v[116:119], v[84:87], a[180:183], v[116:119]
    v_lshlrev_b32_e64 v190, 6, v190
    v_lshl_add_u32 v190, v191, 5, v190
    v_mfma_f32_16x16x32_bf16 v[120:123], v[80:83], a[168:171], v[120:123]
    v_lshl_add_u32 v22, v187, 3, v190
    v_mfma_f32_16x16x32_bf16 v[120:123], v[84:87], a[184:187], v[120:123]
    v_lshl_add_u32 v190, v188, 2, v186
    v_lshrrev_b32_e64 v191, 1, v190
    v_mfma_f32_16x16x32_bf16 v[124:127], v[80:83], a[172:175], v[124:127]
    s_lshl_b32 s65, s60, 1
    v_mfma_f32_16x16x32_bf16 v[124:127], v[84:87], a[188:191], v[124:127]
    s_waitcnt vmcnt(11) lgkmcnt(0)
    s_barrier
    v_mfma_f32_16x16x32_bf16 v[128:131], v[88:91], a[160:163], v[128:131]
    ds_read_b64_tr_b16 v[80:81], v14 offset:32768
    v_xor_b32 v191, s65, v191
    v_mfma_f32_16x16x32_bf16 v[128:131], v[92:95], a[176:179], v[128:131]
    buffer_load_dwordx4 v9, s[36:39], s67 offen offset:3072 lds
    s_add_u32 s67, s72, 589824
    v_mfma_f32_16x16x32_bf16 v[132:135], v[88:91], a[164:167], v[132:135]
    ds_read_b64_tr_b16 v[82:83], v14 offset:33280
    s_add_u32 m0, s70, 16384
    v_mfma_f32_16x16x32_bf16 v[132:135], v[92:95], a[180:183], v[132:135]
    v_lshlrev_b32_e64 v190, 7, v190
    v_lshl_add_u32 v190, v192, 10, v190
    v_mfma_f32_16x16x32_bf16 v[136:139], v[88:91], a[168:171], v[136:139]
    ds_read_b64_tr_b16 v[84:85], v14 offset:40960
    v_lshl_add_u32 v190, v191, 5, v190
    v_mfma_f32_16x16x32_bf16 v[136:139], v[92:95], a[184:187], v[136:139]
    buffer_load_dwordx4 v8, s[32:35], s67 offen offset:0 lds
    v_lshl_add_u32 v20, v187, 3, v190
    v_mfma_f32_16x16x32_bf16 v[140:143], v[88:91], a[172:175], v[140:143]
    ds_read_b64_tr_b16 v[86:87], v14 offset:41472
    v_xor_b32_e64 v21, 32, v20
    v_mfma_f32_16x16x32_bf16 v[140:143], v[92:95], a[188:191], v[140:143]
    v_mov_b32 v189, 0x10000000
    ds_read_b64_tr_b16 v[88:89], v15 offset:32768
    v_cmp_eq_u32 vcc, 0, v184
    buffer_load_dwordx4 v9, s[32:35], s67 offen offset:1024 lds
    v_lshlrev_b32 v190, 2, v184
    ds_read_b64_tr_b16 v[90:91], v15 offset:33280
    v_sub_u32_e64 v30, v190, v185
    v_cndmask_b32 v31, v189, v2, vcc
    s_lshl_b32 s65, s59, 12
    ds_read_b64_tr_b16 v[92:93], v15 offset:40960
    v_add_u32_e64 v28, s65, v2
    s_cmp_ge_u32 s88, 18
    s_cselect_b64 vcc, -1, 0
    ds_read_b64_tr_b16 v[94:95], v15 offset:41472
    v_lshlrev_b32_e64 v191, 6, v185
    buffer_load_dwordx4 v8, s[36:39], s67 offen offset:2048 lds
    v_lshl_add_u32 v191, v184, 4, v191
    v_cndmask_b32 v23, v2, v191, vcc
    v_lshlrev_b32 v190, 4, v185
    v_add_u32 v190, 155648, v190
    buffer_load_dwordx4 v9, s[36:39], s67 offen offset:3072 lds
    s_add_u32 s67, s72, 1179648
    s_add_u32 m0, s70, 32768
    v_lshlrev_b32_e64 v191, 4, v184
    v_add_u32 v191, 157696, v191
    v_cndmask_b32_e64 v190, v190, v191, vcc
    s_lshl_b32 s65, s59, 10
    s_waitcnt lgkmcnt(4)
    v_mfma_f32_16x16x32_bf16 v[112:115], v[80:83], a[192:195], v[112:115]
    v_add_u32_e64 v25, s65, v190
    v_mfma_f32_16x16x32_bf16 v[112:115], v[84:87], a[208:211], v[112:115]
    buffer_load_dwordx4 v8, s[32:35], s67 offen offset:0 lds
    s_lshl_b32 s65, s59, 12
    v_mfma_f32_16x16x32_bf16 v[116:119], v[80:83], a[196:199], v[116:119]
    s_lshl_b32 s66, s56, 3
    v_mfma_f32_16x16x32_bf16 v[116:119], v[84:87], a[212:215], v[116:119]
    s_add_u32 s66, s66, s62
    s_mul_i32 s82, s66, 147456
    v_mfma_f32_16x16x32_bf16 v[120:123], v[80:83], a[200:203], v[120:123]
    s_add_u32 s82, s82, s65
    v_mfma_f32_16x16x32_bf16 v[120:123], v[84:87], a[216:219], v[120:123]
    buffer_load_dwordx4 v9, s[32:35], s67 offen offset:1024 lds
    s_add_u32 s82, s82, 0x0
    v_mfma_f32_16x16x32_bf16 v[124:127], v[80:83], a[204:207], v[124:127]
    s_sub_u32 s66, 9, s61
    v_mfma_f32_16x16x32_bf16 v[124:127], v[84:87], a[220:223], v[124:127]
    s_waitcnt vmcnt(14) lgkmcnt(0)
    s_barrier
    v_mfma_f32_16x16x32_bf16 v[128:131], v[88:91], a[192:195], v[128:131]
    ds_read_b64_tr_b16 v[80:81], v14 offset:49152
    s_lshl_b32 s66, s66, 13
    v_mfma_f32_16x16x32_bf16 v[128:131], v[92:95], a[208:211], v[128:131]
    buffer_load_dwordx4 v8, s[36:39], s67 offen offset:2048 lds
    s_add_u32 s83, s82, s66
    v_mfma_f32_16x16x32_bf16 v[132:135], v[88:91], a[196:199], v[132:135]
    ds_read_b64_tr_b16 v[82:83], v14 offset:49664
    s_lshl_b32 s66, s60, 11
    v_mfma_f32_16x16x32_bf16 v[132:135], v[92:95], a[212:215], v[132:135]
    s_xor_b32 s66, s66, s3
    s_add_u32 s83, s83, s66
    v_mfma_f32_16x16x32_bf16 v[136:139], v[88:91], a[200:203], v[136:139]
    ds_read_b64_tr_b16 v[84:85], v14 offset:57344
    s_add_u32 s82, s82, s3
    v_mfma_f32_16x16x32_bf16 v[136:139], v[92:95], a[216:219], v[136:139]
    s_mul_i32 s66, s61, 10
    s_add_u32 s66, s66, s60
    v_mfma_f32_16x16x32_bf16 v[140:143], v[88:91], a[204:207], v[140:143]
    ds_read_b64_tr_b16 v[86:87], v14 offset:57856
    s_sub_u32 s66, 17, s66
    v_mfma_f32_16x16x32_bf16 v[140:143], v[92:95], a[220:223], v[140:143]
    buffer_load_dwordx4 v9, s[36:39], s67 offen offset:3072 lds
    ds_read_b64_tr_b16 v[88:89], v15 offset:49152
    s_add_u32 s67, s72, 1769472
    s_add_u32 m0, s70, 49152
    s_lshl_b32 s66, s66, 13
    ds_read_b64_tr_b16 v[90:91], v15 offset:49664
    s_add_u32 s82, s82, s66
    buffer_load_dwordx4 v8, s[32:35], s67 offen offset:0 lds
    s_lshl_b32 s65, s61, 6
    ds_read_b64_tr_b16 v[92:93], v15 offset:57344
    s_add_u32 s65, s65, 512
    s_mul_i32 s64, s62, 663552
    s_mul_i32 s66, s61, 626688
    ds_read_b64_tr_b16 v[94:95], v15 offset:57856
    s_add_u32 s64, s64, s66
    s_mul_i32 s74, s61, 640
    s_add_u32 s74, s74, s64
    buffer_load_dwordx4 v9, s[32:35], s67 offen offset:1024 lds
    s_mul_i32 s66, s60, s75
    s_mul_i32 s66, s66, 36864
    s_add_u32 s74, s74, s66
    s_mul_i32 s66, s59, 18432
    s_add_u32 s74, s74, s66
    buffer_load_dwordx4 v8, s[36:39], s67 offen offset:2048 lds
    s_add_u32 s64, s64, s65
    s_waitcnt lgkmcnt(4)
    v_mfma_f32_16x16x32_bf16 v[112:115], v[80:83], a[224:227], v[112:115]
    v_mfma_f32_16x16x32_bf16 v[112:115], v[84:87], a[240:243], v[112:115]
    buffer_load_dwordx4 v9, s[36:39], s67 offen offset:3072 lds
    s_add_u32 s67, s72, 2359296
    v_mfma_f32_16x16x32_bf16 v[116:119], v[80:83], a[228:231], v[116:119]
    s_add_u32 m0, s70, 65536
    v_mfma_f32_16x16x32_bf16 v[116:119], v[84:87], a[244:247], v[116:119]
    v_mfma_f32_16x16x32_bf16 v[120:123], v[80:83], a[232:235], v[120:123]
    v_mfma_f32_16x16x32_bf16 v[120:123], v[84:87], a[248:251], v[120:123]
    v_mfma_f32_16x16x32_bf16 v[124:127], v[80:83], a[236:239], v[124:127]
    v_mfma_f32_16x16x32_bf16 v[124:127], v[84:87], a[252:255], v[124:127]
    v_add_u32 v14, 0x10000, v14
    s_waitcnt vmcnt(16) lgkmcnt(0)
    s_barrier
    v_mfma_f32_16x16x32_bf16 v[128:131], v[88:91], a[224:227], v[128:131]
    ds_read_b64_tr_b16 v[80:81], v14 offset:0
    v_mfma_f32_16x16x32_bf16 v[128:131], v[92:95], a[240:243], v[128:131]
    buffer_load_dwordx4 v8, s[32:35], s67 offen offset:0 lds
    v_mfma_f32_16x16x32_bf16 v[132:135], v[88:91], a[228:231], v[132:135]
    ds_read_b64_tr_b16 v[82:83], v14 offset:512
    v_mfma_f32_16x16x32_bf16 v[132:135], v[92:95], a[244:247], v[132:135]
    v_mfma_f32_16x16x32_bf16 v[136:139], v[88:91], a[232:235], v[136:139]
    ds_read_b64_tr_b16 v[84:85], v14 offset:8192
    v_mfma_f32_16x16x32_bf16 v[136:139], v[92:95], a[248:251], v[136:139]
    buffer_load_dwordx4 v9, s[32:35], s67 offen offset:1024 lds
    v_mfma_f32_16x16x32_bf16 v[140:143], v[88:91], a[236:239], v[140:143]
    ds_read_b64_tr_b16 v[86:87], v14 offset:8704
    v_mfma_f32_16x16x32_bf16 v[140:143], v[92:95], a[252:255], v[140:143]
    v_add_u32 v15, 0x10000, v15
    ds_read_b64_tr_b16 v[88:89], v15 offset:0
    v_add_u32 v68, v68, v69
    buffer_load_dwordx4 v8, s[36:39], s67 offen offset:2048 lds
    ds_read_b64_tr_b16 v[90:91], v15 offset:512
    s_cmp_eq_u32 s18, 2
    s_cselect_b32 s21, s20, 0x10000000
    ds_read_b64_tr_b16 v[92:93], v15 offset:8192
    ds_read_b64_tr_b16 v[94:95], v15 offset:8704
    buffer_load_dwordx4 v9, s[36:39], s67 offen offset:3072 lds
    s_add_u32 s67, s72, 2949120
    s_add_u32 m0, s70, 81920
    s_nop 0
    buffer_load_dwordx4 v8, s[32:35], s67 offen offset:0 lds
    s_waitcnt lgkmcnt(4)
    v_mfma_f32_16x16x32_bf16 v[112:115], v[80:83], v[32:35], v[112:115]
    v_mfma_f32_16x16x32_bf16 v[112:115], v[84:87], v[48:51], v[112:115]
    buffer_load_dword v0, v68, s[32:35], s21 offen offset:0
    v_mfma_f32_16x16x32_bf16 v[116:119], v[80:83], v[36:39], v[116:119]
    v_mfma_f32_16x16x32_bf16 v[116:119], v[84:87], v[52:55], v[116:119]
    s_cmp_eq_u32 s18, 3
    s_cselect_b32 s21, s20, 0x10000000
    v_mfma_f32_16x16x32_bf16 v[120:123], v[80:83], v[40:43], v[120:123]
    v_mfma_f32_16x16x32_bf16 v[120:123], v[84:87], v[56:59], v[120:123]
    buffer_load_dword v0, v68, s[36:39], s21 offen offset:2048
    v_mfma_f32_16x16x32_bf16 v[124:127], v[80:83], v[44:47], v[124:127]
    v_mfma_f32_16x16x32_bf16 v[124:127], v[84:87], v[60:63], v[124:127]
    s_waitcnt vmcnt(19) lgkmcnt(0)
    s_barrier
    v_mfma_f32_16x16x32_bf16 v[128:131], v[88:91], v[32:35], v[128:131]
    ds_read_b64_tr_b16 v[80:81], v11 offset:0
    v_mfma_f32_16x16x32_bf16 v[128:131], v[92:95], v[48:51], v[128:131]
    v_mfma_f32_16x16x32_bf16 v[132:135], v[88:91], v[36:39], v[132:135]
    ds_read_b64_tr_b16 v[82:83], v11 offset:512
    v_mfma_f32_16x16x32_bf16 v[132:135], v[92:95], v[52:55], v[132:135]
    v_mfma_f32_16x16x32_bf16 v[136:139], v[88:91], v[40:43], v[136:139]
    ds_read_b64_tr_b16 v[84:85], v11 offset:8192
    v_mfma_f32_16x16x32_bf16 v[136:139], v[92:95], v[56:59], v[136:139]
    v_mfma_f32_16x16x32_bf16 v[140:143], v[88:91], v[44:47], v[140:143]
    ds_read_b64_tr_b16 v[86:87], v11 offset:8704
    v_mfma_f32_16x16x32_bf16 v[140:143], v[92:95], v[60:63], v[140:143]
    ds_read_b64_tr_b16 v[88:89], v12 offset:0
    ds_read_b64_tr_b16 v[90:91], v12 offset:512
    ds_read_b64_tr_b16 v[92:93], v12 offset:8192
    ds_read_b64_tr_b16 v[94:95], v12 offset:8704
    ds_read_b64_tr_b16 v[96:97], v11 offset:2048
    ds_read_b64_tr_b16 v[98:99], v11 offset:2560
    ds_read_b64_tr_b16 v[100:101], v11 offset:10240
    ds_read_b64_tr_b16 v[102:103], v11 offset:10752
    s_waitcnt lgkmcnt(0)
    s_nop 4
    s_branch qkv_e
kw_slow:
    s_mov_b32 s69, 400000
kw_loop:
    s_sleep 2
    buffer_load_dword v252, v249, s[44:47], s11 offen sc1
    s_waitcnt vmcnt(0)
    s_sub_u32 s69, s69, 1
    s_cbranch_scc1 kw_ok
    v_cmp_le_u32 vcc, 1, v252
    s_nop 1
    s_or_b32 s65, vcc_lo, s86
    s_or_b32 s66, vcc_hi, 0xffff0000
    s_and_b32 s65, s65, s66
    s_cmp_eq_u32 s65, -1
    s_cbranch_scc0 kw_loop
    s_branch kw_ok
kv_slow:
    s_mov_b32 s69, 400000
kv_loop:
    s_sleep 2
    buffer_load_dwordx4 v[252:255], off, s[48:51], s11 sc1
    s_waitcnt vmcnt(0)
    s_sub_u32 s69, s69, 1
    s_cbranch_scc1 kv_ok
    v_readfirstlane_b32 s65, v252
    v_readfirstlane_b32 s66, v253
    v_readfirstlane_b32 s64, v254
    s_or_b32 s65, s65, s85
    s_or_b32 s66, s66, s86
    s_and_b32 s65, s65, s66
    s_and_b32 s65, s65, s64
    s_cmp_eq_u32 s65, 0xffff
    s_cbranch_scc0 kv_loop
    s_branch kv_ok
h2_slow:
    s_mov_b32 s69, 400000
h2_loop:
    s_sleep 2
    buffer_load_dword v26, off, s[44:47], s7 sc1
    s_waitcnt vmcnt(0)
    s_sub_u32 s69, s69, 1
    s_cbranch_scc1 h2_ok
    v_readfirstlane_b32 s65, v26
    s_nop 0
    s_cmp_ge_u32 s65, 2
    s_cbranch_scc0 h2_loop
    s_branch h2_ok
code_end:
.section .rodata,"a"
.p2align 6
.amdhsa_kernel recurrent_scan__sliding_block__glu_gated_bilinear__prompt_kernel
  .amdhsa_next_free_vgpr 512
  .amdhsa_next_free_sgpr 102
  .amdhsa_accum_offset 256
  .amdhsa_group_segment_fixed_size 0
  .amdhsa_kernarg_size 80
  .amdhsa_user_sgpr_count 2
  .amdhsa_user_sgpr_kernarg_segment_ptr 1
  .amdhsa_system_sgpr_workgroup_id_x 1
.end_amdhsa_kernel
```
